```python
import torch

def _softmax(x, axis=-1):
    return torch.softmax(x, dim=axis)
def _gelu(x):
    return torch.nn.functional.gelu(x, approximate="tanh")
def _silu(x):
    return torch.nn.functional.silu(x)
def _sigmoid(x):
    return torch.sigmoid(x)
def _layernorm(x, axis=-1, eps=1e-5):
    m = x.mean(dim=axis, keepdim=True)
    v = x.var(dim=axis, keepdim=True, unbiased=False)
    return (x - m) / torch.sqrt(v + eps)
def _scatter_add(tgt, idx, src, axis=0):
    return tgt.clone().index_add_(axis, idx, src)
def _segment_sum(src, seg, n):
    out = torch.zeros((n,) + src.shape[1:], dtype=src.dtype)
    return out.index_add_(0, seg, src)
def _pad(x, pw):
    flat = tuple(v for pair in reversed(pw) for v in pair)
    return torch.nn.functional.pad(x, flat)

kernel_name = 'recurrent_scan__mha_block_cached__glu_gated_reglu__prompt'

def setup_inputs():

    _w = (lambda a: (lambda t: t.to(torch.bfloat16) if t.is_floating_point() else t)(torch.as_tensor(a)))
    def _A_setup():
        B, Sq, D = 1, 2048, 512
        H, Sk, Dh = 32, 2048, 128
        return {
            "x": _w((lambda *s: torch.randn(*s, dtype=torch.bfloat16) * 0.05)(B, Sq, D)),
            "k_cache": _w((lambda *s: torch.randn(*s, dtype=torch.bfloat16) * 1.6)(B, H, Sk, Dh)),
            "v_cache": _w((lambda *s: torch.randn(*s, dtype=torch.bfloat16) * 1.6)(B, H, Sk, Dh)),
            "wq": _w((lambda *s: torch.randn(*s, dtype=torch.bfloat16) * 1.6)(D, H * Dh) * (D ** -0.5)),
            "wo": _w((lambda *s: torch.randn(*s, dtype=torch.bfloat16) * 1.6)(H * Dh, D) * ((H * Dh) ** -0.5)),
        }
    _A_in = _A_setup()

    def _B_setup():
        B, S, D, F = 1, 2048, 512, 1792
        return {
            "x": _w((lambda *s: torch.randn(*s, dtype=torch.bfloat16) * 0.05)(B, S, D)),
            "W_gate": _w((lambda *s: torch.randn(*s, dtype=torch.bfloat16) * 0.2)(D, F) * (2.0 / D) ** 0.5),
            "W_up": _w((lambda *s: torch.randn(*s, dtype=torch.bfloat16) * 0.2)(D, F) * (2.0 / D) ** 0.5),
            "W_down": _w((lambda *s: torch.randn(*s, dtype=torch.bfloat16) * 0.2)(F, D) * (1.0 / F) ** 0.5),
        }
    _B_in = _B_setup()

    return {
        "A_x": _A_in["x"],
        "A_k_cache": _A_in["k_cache"],
        "A_v_cache": _A_in["v_cache"],
        "A_wq": _A_in["wq"],
        "A_wo": _A_in["wo"],
        "B_x": _B_in["x"],
        "B_W_gate": _B_in["W_gate"],
        "B_W_up": _B_in["W_up"],
        "B_W_down": _B_in["W_down"],
    }

def reference(A_x, A_k_cache, A_v_cache, A_wq, A_wo, B_x, B_W_gate, B_W_up, B_W_down):
    def _A_ref(x, k_cache, v_cache, wq, wo):
        B, Sq, D = x.shape
        H, Dh = 32, 128
        q = (lambda x, *d: x.permute(*d))((x @ wq).reshape(B, Sq, H, Dh), 0, 2, 1, 3)
        scores = torch.einsum("bhqd,bhkd->bhqk", q, k_cache) * (Dh ** -0.5)
        p = _softmax(scores, axis=-1)
        o = torch.einsum("bhqk,bhkd->bhqd", p, v_cache)
        return (lambda x, *d: x.permute(*d))(o, 0, 2, 1, 3).reshape(B, Sq, H * Dh) @ wo

    def _B_ref(x, W_gate, W_up, W_down):
        gate = torch.einsum("bsd,df->bsf", x, W_gate)
        up = torch.einsum("bsd,df->bsf", x, W_up)
        gate = gate * (lambda x, dt: x.to(dt))(gate > 0, gate.dtype)
        h = gate * up
        return torch.einsum("bsf,fd->bsd", h, W_down)

    x = A_x
    xn = _layernorm(x, axis=-1)
    s = _A_ref(xn, A_k_cache, A_v_cache, A_wq, A_wo)
    g = _silu(_B_ref(xn, B_W_gate, B_W_up, B_W_down))
    return x + s * g
```

```asm
; @launch grid=(256,1,1) block=(256,1,1) lds=163840
.amdgcn_target "amdgcn-amd-amdhsa--gfx950"
.text
.globl recurrent_scan__mha_block_cached__glu_gated_reglu__prompt_kernel
.p2align 8
.type recurrent_scan__mha_block_cached__glu_gated_reglu__prompt_kernel,@function
recurrent_scan__mha_block_cached__glu_gated_reglu__prompt_kernel:
    s_cmp_ge_u32 s2, 256
    s_cbranch_scc1 mk_end
    s_load_dwordx2 s[60:61], s[0:1], 0
    s_getpc_b64 s[100:101]
mk_pc:
    s_load_dwordx2 s[58:59], s[0:1], 88
    s_load_dwordx4 s[48:51], s[0:1], 24
    s_load_dwordx2 s[8:9], s[0:1], 8
    s_load_dwordx2 s[12:13], s[0:1], 16
    s_load_dwordx4 s[52:55], s[0:1], 48
    s_load_dwordx2 s[56:57], s[0:1], 64
    v_and_b32 v1, 63, v0
    v_lshrrev_b32 v30, 6, v0
    s_and_b32 s4, s2, 31
    v_readfirstlane_b32 s3, v30
    s_lshr_b32 s5, s2, 5
    s_mov_b32 s62, 2097152
    s_mov_b32 s63, 0x00020000
    s_waitcnt lgkmcnt(0)
    v_and_b32 v60, 7, v1
    v_bfe_u32 v61, v1, 3, 2
    v_lshrrev_b32 v62, 5, v1
    s_lshl_b32 s44, s5, 8
    s_lshl_b32 s45, s4, 3
    s_add_u32 s44, s44, s45
    s_lshl_b32 s44, s44, 10
    s_lshl_b32 s45, s3, 8
    s_add_u32 s44, s44, s45
    v_lshlrev_b32 v63, 10, v60
    v_lshl_add_u32 v63, v62, 7, v63
    v_lshl_add_u32 v63, v61, 3, v63
    buffer_load_dwordx2 v[32:33], v63, s[60:63], s44 offen
    buffer_load_dwordx2 v[34:35], v63, s[60:63], s44 offen offset:32
    buffer_load_dwordx2 v[36:37], v63, s[60:63], s44 offen offset:64
    buffer_load_dwordx2 v[38:39], v63, s[60:63], s44 offen offset:96
    s_add_u32 s92, s58, 31457280
    s_addc_u32 s93, s59, 0
    s_mov_b32 s94, 16384
    s_mov_b32 s95, 0x00020000
    s_lshl_b32 s46, s5, 7
    v_mov_b32 v123, 0
    buffer_load_dword v121, v123, s[92:95], s46 offen sc1
    buffer_load_dword v120, v123, s[92:95], 0 offen offset:1024 sc1
    v_lshrrev_b32 v112, 4, v1
    v_and_b32 v113, 15, v1
    v_add_u32 v116, 0, v112
    v_lshlrev_b32 v117, 13, v116
    v_lshlrev_b32 v116, 1, v116
    v_xor_b32 v116, v116, v113
    v_lshl_add_u32 v24, v116, 4, v117
    v_add_u32 v116, 4, v112
    v_lshlrev_b32 v117, 13, v116
    v_lshlrev_b32 v116, 1, v116
    v_xor_b32 v116, v116, v113
    v_lshl_add_u32 v25, v116, 4, v117
    v_subrev_u32 v25, 1024, v25
    v_lshlrev_b32 v30, 4, v1
    v_mov_b32 v26, v30
    v_add_u32 v27, 16384, v30
    v_add_u32 v28, 32768, v30
    v_add_u32 v29, 49152, v30
    s_lshl_b32 s34, s3, 12
    s_lshl_b32 s35, s3, 11
    s_mov_b32 s37, 0
    s_lshl_b32 s41, s3, 16
    s_lshl_b32 s44, s4, 8
    s_sub_u32 s45, 4194304, s44
    s_add_u32 s16, s48, s44
    s_addc_u32 s17, s49, 0
    s_mov_b32 s18, s45
    s_mov_b32 s19, 0x00020000
    s_lshl_b32 s44, s5, 4
    s_lshl_b32 s45, s3, 2
    s_add_u32 s44, s44, s45
    s_lshl_b32 s44, s44, 14
    s_add_u32 s20, s58, s44
    s_addc_u32 s21, s59, 0
    s_mov_b32 s22, 65536
    s_mov_b32 s23, 0x00020000
    s_lshl_b32 s44, s4, 19
    s_add_u32 s8, s8, s44
    s_addc_u32 s9, s9, 0
    s_mov_b32 s10, 524288
    s_mov_b32 s11, 0x00020000
    s_add_u32 s12, s12, s44
    s_addc_u32 s13, s13, 0
    s_mov_b32 s14, 524288
    s_mov_b32 s15, 0x00020000
    s_cmp_ge_u32 s3, 2
    s_cselect_b32 s44, s54, s52
    s_cselect_b32 s45, s55, s53
    s_lshl_b32 s46, s4, 7
    s_add_u32 s24, s44, s46
    s_addc_u32 s25, s45, 0
    s_sub_u32 s26, 1835008, s46
    s_cmp_lt_u32 s4, 28
    s_cselect_b32 s26, s26, 0
    s_mov_b32 s27, 0x00020000
    s_and_b32 s44, s3, 1
    s_mul_i32 s38, s44, 57344
    v_bfe_u32 v114, v1, 2, 2
    v_and_b32 v115, 3, v1
    v_and_b32 v118, 1, v112
    v_lshl_add_u32 v118, v118, 2, v114
    v_lshl_add_u32 v119, v112, 2, v114
    v_lshrrev_b32 v116, 3, v1
    s_mov_b32 s46, 3584
    v_mul_lo_u32 v117, v116, s46
    s_waitcnt vmcnt(0)
    v_lshlrev_b32 v120, 1, v112
    v_and_b32 v116, 7, v1
    v_xor_b32 v116, v116, v120
    v_lshl_add_u32 v100, v116, 4, v117
    v_add_u32 v101, 27648, v100
    s_add_u32 m0, s35, 32768
    s_nop 0
    buffer_load_dwordx4 v24, s[16:19], s41 offen lds
    buffer_load_dwordx4 v25, s[16:19], s41 offen offset:1024 lds
    s_add_u32 s41, s41, 262144
    s_add_u32 m0, s35, 40960
    s_nop 0
    buffer_load_dwordx4 v100, s[24:27], s38 offen lds
    buffer_load_dwordx4 v101, s[24:27], s38 offen offset:1024 lds
    s_add_u32 s38, s38, 114688
    v_lshrrev_b32 v116, 3, v1
    v_lshlrev_b32 v116, 18, v116
    v_bfe_u32 v117, v1, 1, 2
    v_lshl_add_u32 v116, v117, 13, v116
    v_and_b32 v117, 1, v1
    v_lshl_add_u32 v116, v117, 7, v116
    s_lshl_b32 s45, s5, 15
    s_mov_b32 s44, 0
    s_add_u32 s44, s44, s45
    s_mov_b32 s60, s16
    s_mov_b32 s61, s17
    s_mov_b32 s62, s18
    s_mov_b32 s63, 0x00020000
    s_cmp_eq_u32 s3, 2
    s_cselect_b32 s62, s62, 0
    buffer_load_dword v124, v116, s[60:63], s44 offen
    v_and_b32 v116, 31, v1
    v_mov_b32 v117, 3584
    v_mul_lo_u32 v117, v117, v116
    s_mul_i32 s44, s5, 114688
    s_mov_b32 s60, s24
    s_mov_b32 s61, s25
    s_mov_b32 s62, s26
    s_and_b32 s46, s3, 1
    s_cmp_eq_u32 s46, 1
    s_cselect_b32 s62, s62, 0
    buffer_load_dword v125, v117, s[60:63], s44 offen
    s_add_u32 m0, s35, 49152
    s_nop 0
    buffer_load_dwordx4 v24, s[16:19], s41 offen lds
    buffer_load_dwordx4 v25, s[16:19], s41 offen offset:1024 lds
    s_add_u32 s41, s41, 262144
    s_add_u32 m0, s35, 57344
    s_nop 0
    buffer_load_dwordx4 v100, s[24:27], s38 offen lds
    buffer_load_dwordx4 v101, s[24:27], s38 offen offset:1024 lds
    s_add_u32 s38, s38, 114688
    v_readfirstlane_b32 s6, v121
    s_nop 3
    s_add_u32 s6, s6, 1
    v_readfirstlane_b32 s91, v120
    s_nop 3
    s_add_u32 s91, s91, 1
    v_lshlrev_b32 v40, 16, v32
    v_and_b32 v41, 0xffff0000, v32
    v_lshlrev_b32 v42, 16, v33
    v_and_b32 v43, 0xffff0000, v33
    v_lshlrev_b32 v44, 16, v34
    v_and_b32 v45, 0xffff0000, v34
    v_lshlrev_b32 v46, 16, v35
    v_and_b32 v47, 0xffff0000, v35
    v_lshlrev_b32 v48, 16, v36
    v_and_b32 v49, 0xffff0000, v36
    v_lshlrev_b32 v50, 16, v37
    v_and_b32 v51, 0xffff0000, v37
    v_lshlrev_b32 v52, 16, v38
    v_and_b32 v53, 0xffff0000, v38
    v_lshlrev_b32 v54, 16, v39
    v_and_b32 v55, 0xffff0000, v39
    v_lshlrev_b32 v59, 2, v60
    s_lshl_b32 s45, s3, 5
    v_add_u32 v58, s45, v59
    v_add_f32 v56, v40, v41
    v_add_f32 v57, v42, v43
    v_add_f32 v56, v56, v44
    v_add_f32 v57, v57, v45
    v_add_f32 v56, v56, v46
    v_add_f32 v57, v57, v47
    v_add_f32 v56, v56, v48
    v_add_f32 v57, v57, v49
    v_add_f32 v56, v56, v50
    v_add_f32 v57, v57, v51
    v_add_f32 v56, v56, v52
    v_add_f32 v57, v57, v53
    v_add_f32 v56, v56, v54
    v_add_f32 v57, v57, v55
    v_add_f32 v56, v56, v57
    s_nop 1
    v_add_f32_dpp v56, v56, v56 row_ror:8 row_mask:0xf bank_mask:0xf
    v_mov_b32 v64, v56
    s_nop 1
    v_permlane16_swap_b32 v64, v56
    s_nop 1
    v_add_f32 v56, v56, v64
    v_mov_b32 v64, v56
    s_nop 1
    v_permlane32_swap_b32 v64, v56
    s_nop 1
    v_add_f32 v56, v56, v64
    ds_write_b32 v58, v56
    s_waitcnt lgkmcnt(0)
    s_barrier
    ds_read_b32 v64, v59
    ds_read_b32 v65, v59 offset:32
    ds_read_b32 v66, v59 offset:64
    ds_read_b32 v67, v59 offset:96
    s_waitcnt lgkmcnt(2)
    v_add_f32 v64, v64, v65
    s_waitcnt lgkmcnt(0)
    v_add_f32 v66, v66, v67
    v_add_f32 v56, v64, v66
    v_mul_f32 v56, 0x3b000000, v56
    v_sub_f32 v68, v40, v56
    v_sub_f32 v69, v41, v56
    v_mul_f32 v70, v68, v68
    v_mul_f32 v71, v69, v69
    v_sub_f32 v68, v42, v56
    v_sub_f32 v69, v43, v56
    v_fmac_f32 v70, v68, v68
    v_fmac_f32 v71, v69, v69
    v_sub_f32 v68, v44, v56
    v_sub_f32 v69, v45, v56
    v_fmac_f32 v70, v68, v68
    v_fmac_f32 v71, v69, v69
    v_sub_f32 v68, v46, v56
    v_sub_f32 v69, v47, v56
    v_fmac_f32 v70, v68, v68
    v_fmac_f32 v71, v69, v69
    v_sub_f32 v68, v48, v56
    v_sub_f32 v69, v49, v56
    v_fmac_f32 v70, v68, v68
    v_fmac_f32 v71, v69, v69
    v_sub_f32 v68, v50, v56
    v_sub_f32 v69, v51, v56
    v_fmac_f32 v70, v68, v68
    v_fmac_f32 v71, v69, v69
    v_sub_f32 v68, v52, v56
    v_sub_f32 v69, v53, v56
    v_fmac_f32 v70, v68, v68
    v_fmac_f32 v71, v69, v69
    v_sub_f32 v68, v54, v56
    v_sub_f32 v69, v55, v56
    v_fmac_f32 v70, v68, v68
    v_fmac_f32 v71, v69, v69
    v_add_f32 v70, v70, v71
    s_nop 1
    v_add_f32_dpp v70, v70, v70 row_ror:8 row_mask:0xf bank_mask:0xf
    v_mov_b32 v64, v70
    s_nop 1
    v_permlane16_swap_b32 v64, v70
    s_nop 1
    v_add_f32 v70, v70, v64
    v_mov_b32 v64, v70
    s_nop 1
    v_permlane32_swap_b32 v64, v70
    s_nop 1
    v_add_f32 v70, v70, v64
    ds_write_b32 v58, v70 offset:128
    s_waitcnt lgkmcnt(0)
    s_barrier
    ds_read_b32 v64, v59 offset:128
    ds_read_b32 v65, v59 offset:160
    ds_read_b32 v66, v59 offset:192
    ds_read_b32 v67, v59 offset:224
    s_waitcnt lgkmcnt(2)
    v_add_f32 v64, v64, v65
    s_waitcnt lgkmcnt(0)
    v_add_f32 v66, v66, v67
    v_add_f32 v70, v64, v66
    v_mul_f32 v70, 0x3b000000, v70
    v_cvt_pk_bf16_f32 v56, v56, v56
    v_lshlrev_b32 v56, 16, v56
    v_cvt_pk_bf16_f32 v70, v70, v70
    v_lshlrev_b32 v70, 16, v70
    v_add_f32 v70, 0x3727c5ac, v70
    v_cvt_pk_bf16_f32 v70, v70, v70
    v_lshlrev_b32 v70, 16, v70
    v_sqrt_f32 v70, v70
    s_nop 0
    v_cvt_pk_bf16_f32 v70, v70, v70
    v_lshlrev_b32 v70, 16, v70
    v_rcp_f32 v71, v70
    s_nop 0
    v_fma_f32 v69, -v70, v71, 2.0
    v_mul_f32 v71, v71, v69
    v_sub_f32 v40, v40, v56
    v_sub_f32 v41, v41, v56
    v_sub_f32 v42, v42, v56
    v_sub_f32 v43, v43, v56
    v_sub_f32 v44, v44, v56
    v_sub_f32 v45, v45, v56
    v_sub_f32 v46, v46, v56
    v_sub_f32 v47, v47, v56
    v_sub_f32 v48, v48, v56
    v_sub_f32 v49, v49, v56
    v_sub_f32 v50, v50, v56
    v_sub_f32 v51, v51, v56
    v_sub_f32 v52, v52, v56
    v_sub_f32 v53, v53, v56
    v_sub_f32 v54, v54, v56
    v_sub_f32 v55, v55, v56
    v_cvt_pk_bf16_f32 v32, v40, v41
    v_cvt_pk_bf16_f32 v33, v42, v43
    v_cvt_pk_bf16_f32 v34, v44, v45
    v_cvt_pk_bf16_f32 v35, v46, v47
    v_cvt_pk_bf16_f32 v36, v48, v49
    v_cvt_pk_bf16_f32 v37, v50, v51
    v_cvt_pk_bf16_f32 v38, v52, v53
    v_cvt_pk_bf16_f32 v39, v54, v55
    v_lshlrev_b32 v40, 16, v32
    v_and_b32 v41, 0xffff0000, v32
    v_lshlrev_b32 v42, 16, v33
    v_and_b32 v43, 0xffff0000, v33
    v_lshlrev_b32 v44, 16, v34
    v_and_b32 v45, 0xffff0000, v34
    v_lshlrev_b32 v46, 16, v35
    v_and_b32 v47, 0xffff0000, v35
    v_lshlrev_b32 v48, 16, v36
    v_and_b32 v49, 0xffff0000, v36
    v_lshlrev_b32 v50, 16, v37
    v_and_b32 v51, 0xffff0000, v37
    v_lshlrev_b32 v52, 16, v38
    v_and_b32 v53, 0xffff0000, v38
    v_lshlrev_b32 v54, 16, v39
    v_and_b32 v55, 0xffff0000, v39
    v_mul_f32 v40, v40, v71
    v_mul_f32 v41, v41, v71
    v_mul_f32 v42, v42, v71
    v_mul_f32 v43, v43, v71
    v_mul_f32 v44, v44, v71
    v_mul_f32 v45, v45, v71
    v_mul_f32 v46, v46, v71
    v_mul_f32 v47, v47, v71
    v_mul_f32 v48, v48, v71
    v_mul_f32 v49, v49, v71
    v_mul_f32 v50, v50, v71
    v_mul_f32 v51, v51, v71
    v_mul_f32 v52, v52, v71
    v_mul_f32 v53, v53, v71
    v_mul_f32 v54, v54, v71
    v_mul_f32 v55, v55, v71
    v_cvt_pk_bf16_f32 v32, v40, v41
    v_cvt_pk_bf16_f32 v33, v42, v43
    v_cvt_pk_bf16_f32 v34, v44, v45
    v_cvt_pk_bf16_f32 v35, v46, v47
    v_cvt_pk_bf16_f32 v36, v48, v49
    v_cvt_pk_bf16_f32 v37, v50, v51
    v_cvt_pk_bf16_f32 v38, v52, v53
    v_cvt_pk_bf16_f32 v39, v54, v55
    s_lshl_b32 s44, s5, 4
    s_lshr_b32 s45, s4, 1
    s_add_u32 s44, s44, s45
    s_lshl_b32 s44, s44, 14
    s_lshl_b32 s45, s3, 12
    s_add_u32 s44, s44, s45
    s_and_b32 s45, s4, 1
    s_lshl_b32 s45, s45, 7
    s_add_u32 s44, s44, s45
    v_lshlrev_b32 v63, 4, v60
    v_lshl_add_u32 v63, v61, 8, v63
    v_lshl_add_u32 v63, v62, 11, v63
    s_mov_b32 s60, s58
    s_mov_b32 s61, s59
    s_mov_b32 s62, 33554432
    s_mov_b32 s63, 0x00020000
    buffer_store_dwordx4 v[32:35], v63, s[60:63], s44 offen sc1
    buffer_store_dwordx4 v[36:39], v63, s[60:63], s44 offen offset:1024 sc1
    s_waitcnt vmcnt(0)
    s_barrier
    s_cmp_lg_u32 s3, 0
    s_cbranch_scc1 mk_gb0_sig
    s_lshl_b32 s60, s5, 7
    s_add_u32 s60, s60, 4096
    s_lshl_b32 s61, s4, 2
    s_add_u32 s61, s61, s60
    v_mov_b32 v122, s6
    v_mov_b32 v123, 0
    s_mov_b64 exec, 1
    buffer_store_dword v122, v123, s[92:95], s61 offen sc1
    s_mov_b64 exec, -1
mk_gb0_sig:
    s_add_u32 m0, s35, 65536
    s_nop 0
    buffer_load_dwordx4 v24, s[16:19], s41 offen lds
    buffer_load_dwordx4 v25, s[16:19], s41 offen offset:1024 lds
    s_add_u32 s41, s41, 262144
    s_add_u32 m0, s35, 73728
    s_nop 0
    buffer_load_dwordx4 v100, s[24:27], s38 offen lds
    buffer_load_dwordx4 v101, s[24:27], s38 offen offset:1024 lds
    s_add_u32 s38, s38, 114688
    s_add_u32 m0, s35, 81920
    s_nop 0
    buffer_load_dwordx4 v24, s[16:19], s41 offen lds
    buffer_load_dwordx4 v25, s[16:19], s41 offen offset:1024 lds
    s_add_u32 s41, s41, 262144
    s_add_u32 m0, s35, 90112
    s_nop 0
    buffer_load_dwordx4 v100, s[24:27], s38 offen lds
    buffer_load_dwordx4 v101, s[24:27], s38 offen offset:1024 lds
    s_add_u32 s38, s38, 114688
    s_mov_b32 s60, s100
    s_mov_b32 s61, s101
    s_mov_b32 s62, mk_codeend-mk_pc
    s_mov_b32 s63, 0x00020000
    s_lshr_b32 s46, s2, 3
    s_and_b32 s46, s46, 15
    s_lshl_b32 s46, s46, 12
    v_lshlrev_b32 v116, 6, v1
    buffer_load_dword v127, v116, s[60:63], s46 offen
    v_add_u32 v116, 0, v112
    v_xor_b32 v116, v116, v113
    v_lshlrev_b32 v116, 4, v116
    v_lshl_add_u32 v14, v112, 8, v116
    v_add_u32 v116, 4, v112
    v_xor_b32 v116, v116, v113
    v_lshlrev_b32 v116, 4, v116
    v_lshl_add_u32 v15, v112, 8, v116
    v_add_u32 v116, 8, v112
    v_xor_b32 v116, v116, v113
    v_lshlrev_b32 v116, 4, v116
    v_lshl_add_u32 v16, v112, 8, v116
    v_add_u32 v116, 12, v112
    v_xor_b32 v116, v116, v113
    v_lshlrev_b32 v116, 4, v116
    v_lshl_add_u32 v17, v112, 8, v116
    s_mov_b32 s32, s34
    s_mov_b32 s33, s34
    v_lshlrev_b32 v117, 8, v119
    v_and_b32 v116, 1, v115
    v_lshl_add_u32 v117, v116, 4, v117
    v_add_u32 v117, 32768, v117
    v_lshrrev_b32 v120, 1, v115
    v_add_u32 v116, 0, v120
    v_xor_b32 v116, v116, v118
    v_lshl_add_u32 v20, v116, 5, v117
    v_add_u32 v116, 2, v120
    v_xor_b32 v116, v116, v118
    v_lshl_add_u32 v21, v116, 5, v117
    v_add_u32 v116, 4, v120
    v_xor_b32 v116, v116, v118
    v_lshl_add_u32 v22, v116, 5, v117
    v_add_u32 v116, 6, v120
    v_xor_b32 v116, v116, v118
    v_lshl_add_u32 v23, v116, 5, v117
    v_lshlrev_b32 v117, 7, v119
    v_lshl_add_u32 v117, v115, 3, v117
    v_add_u32 v117, 40960, v117
    v_and_b32 v120, 1, v112
    v_lshlrev_b32 v120, 1, v120
    v_lshrrev_b32 v116, 1, v114
    v_add_u32 v120, v120, v116
    v_xor_b32 v116, 0, v120
    v_lshl_add_u32 v96, v116, 5, v117
    v_xor_b32 v116, 1, v120
    v_lshl_add_u32 v97, v116, 5, v117
    v_xor_b32 v116, 2, v120
    v_lshl_add_u32 v98, v116, 5, v117
    v_xor_b32 v116, 3, v120
    v_lshl_add_u32 v99, v116, 5, v117
    v_add_u32 v116, 0, v112
    v_xor_b32 v116, v116, v113
    v_lshlrev_b32 v116, 4, v116
    v_lshl_add_u32 v2, v113, 8, v116
    v_add_u32 v116, 4, v112
    v_xor_b32 v116, v116, v113
    v_lshlrev_b32 v116, 4, v116
    v_lshl_add_u32 v3, v113, 8, v116
    v_add_u32 v116, 8, v112
    v_xor_b32 v116, v116, v113
    v_lshlrev_b32 v116, 4, v116
    v_lshl_add_u32 v4, v113, 8, v116
    v_add_u32 v116, 12, v112
    v_xor_b32 v116, v116, v113
    v_lshlrev_b32 v116, 4, v116
    v_lshl_add_u32 v5, v113, 8, v116
    v_lshlrev_b32 v117, 8, v119
    v_lshl_add_u32 v117, v115, 3, v117
    v_add_u32 v117, 65536, v117
    v_xor_b32 v116, 0, v118
    v_lshl_add_u32 v6, v116, 5, v117
    v_xor_b32 v116, 1, v118
    v_lshl_add_u32 v7, v116, 5, v117
    v_xor_b32 v116, 2, v118
    v_lshl_add_u32 v8, v116, 5, v117
    v_xor_b32 v116, 3, v118
    v_lshl_add_u32 v9, v116, 5, v117
    v_xor_b32 v116, 4, v118
    v_lshl_add_u32 v10, v116, 5, v117
    v_xor_b32 v116, 5, v118
    v_lshl_add_u32 v11, v116, 5, v117
    v_xor_b32 v116, 6, v118
    v_lshl_add_u32 v12, v116, 5, v117
    v_xor_b32 v116, 7, v118
    v_lshl_add_u32 v13, v116, 5, v117
    v_add_u32 v116, 0, v112
    v_lshlrev_b32 v116, 1, v116
    v_xor_b32 v116, v116, v113
    v_lshlrev_b32 v116, 4, v116
    v_lshl_add_u32 v18, v112, 8, v116
    v_add_u32 v116, 4, v112
    v_lshlrev_b32 v116, 1, v116
    v_xor_b32 v116, v116, v113
    v_lshlrev_b32 v116, 4, v116
    v_lshl_add_u32 v19, v112, 8, v116
    s_lshl_b32 s63, s5, 4
    s_lshl_b32 s62, s3, 2
    s_add_u32 s63, s63, s62
    s_mul_i32 s60, s63, 56
    s_lshl_b32 s61, s4, 1
    s_add_u32 s60, s60, s61
    s_lshl_b32 s60, s60, 10
    s_add_u32 s60, s60, 18874368
    s_add_u32 s28, s58, s60
    s_addc_u32 s29, s59, 0
    s_mov_b32 s30, 174080
    s_mov_b32 s31, 0x00020000
    s_cmp_lt_u32 s4, 28
    s_cselect_b32 s30, s30, 0
    v_lshrrev_b32 v112, 3, v1
    v_lshlrev_b32 v112, 18, v112
    v_bfe_u32 v113, v1, 1, 2
    v_lshl_add_u32 v112, v113, 13, v112
    v_and_b32 v113, 1, v1
    v_lshl_add_u32 v112, v113, 7, v112
    s_lshl_b32 s36, s5, 15
    s_add_u32 s36, s36, 2097152
    s_mov_b32 s84, s16
    s_mov_b32 s85, s17
    s_mov_b32 s86, s18
    s_mov_b32 s87, 0x00020000
    s_cmp_eq_u32 s3, 2
    s_cselect_b32 s86, s86, 0
    v_and_b32 v114, 31, v1
    v_mov_b32 v113, 3584
    v_mul_lo_u32 v113, v113, v114
    s_mul_i32 s39, s5, 114688
    s_add_u32 s39, s39, 917504
    v_lshlrev_b32 v114, 7, v114
    s_lshl_b32 s42, s5, 12
    s_cmp_eq_u32 s3, 3
    s_cselect_b32 s76, s8, s12
    s_cselect_b32 s77, s9, s13
    s_cselect_b32 s78, s10, s14
    s_mov_b32 s79, 0x00020000
    s_cmp_ge_u32 s3, 2
    s_cselect_b32 s78, s78, 0
    s_cmp_lg_u32 s3, 0
    s_cbranch_scc1 mk_gb0_skip
    s_lshl_b32 s60, s5, 7
    s_add_u32 s60, s60, 4096
    v_mov_b32 v122, s6
    s_mov_b32 exec_lo, -1
    s_mov_b32 exec_hi, 0
    v_lshlrev_b32 v123, 2, v1
    s_mov_b32 s62, 400000
mk_gb0_poll:
    buffer_load_dword v124, v123, s[92:95], s60 offen sc1
    s_waitcnt vmcnt(0)
    v_cmp_ne_u32 vcc, s6, v124
    s_nop 4
    s_cbranch_vccz mk_gb0_done
    s_sub_u32 s62, s62, 1
    s_cbranch_scc1 mk_gb0_done
    s_sleep 1
    s_branch mk_gb0_poll
mk_gb0_done:
    s_cmp_lg_u32 s4, 0
    s_cbranch_scc1 mk_gb0_noep
    s_mov_b64 exec, 1
    s_lshl_b32 s60, s5, 7
    v_mov_b32 v123, 0
    buffer_store_dword v122, v123, s[92:95], s60 offen sc1
mk_gb0_noep:
    s_mov_b64 exec, -1
mk_gb0_skip:
    s_barrier
    buffer_load_dwordx4 a[128:131], v26, s[20:23], s37 offen sc1
    buffer_load_dwordx4 a[132:135], v27, s[20:23], s37 offen sc1
    buffer_load_dwordx4 a[136:139], v28, s[20:23], s37 offen sc1
    buffer_load_dwordx4 a[140:143], v29, s[20:23], s37 offen sc1
    s_add_u32 s37, s37, 1024
    s_waitcnt vmcnt(9)
    s_barrier
    ds_read_b64_tr_b16 a[192:193], v20
    ds_read_b64_tr_b16 a[194:195], v20 offset:4096
    ds_read_b64_tr_b16 a[196:197], v20 offset:8
    ds_read_b64_tr_b16 a[198:199], v20 offset:4104
    ds_read_b64_tr_b16 a[200:201], v21
    ds_read_b64_tr_b16 a[202:203], v21 offset:4096
    ds_read_b64_tr_b16 a[204:205], v21 offset:8
    ds_read_b64_tr_b16 a[206:207], v21 offset:4104
    ds_read_b64_tr_b16 a[208:209], v22
    ds_read_b64_tr_b16 a[210:211], v22 offset:4096
    ds_read_b64_tr_b16 a[212:213], v22 offset:8
    ds_read_b64_tr_b16 a[214:215], v22 offset:4104
    ds_read_b64_tr_b16 a[216:217], v23
    ds_read_b64_tr_b16 a[218:219], v23 offset:4096
    ds_read_b64_tr_b16 a[220:221], v23 offset:8
    ds_read_b64_tr_b16 a[222:223], v23 offset:4104
    ds_read_b64_tr_b16 a[224:225], v96
    ds_read_b64_tr_b16 a[226:227], v96 offset:2048
    ds_read_b64_tr_b16 a[228:229], v97
    ds_read_b64_tr_b16 a[230:231], v97 offset:2048
    ds_read_b64_tr_b16 a[232:233], v98
    ds_read_b64_tr_b16 a[234:235], v98 offset:2048
    ds_read_b64_tr_b16 a[236:237], v99
    ds_read_b64_tr_b16 a[238:239], v99 offset:2048
    ds_read_b64_tr_b16 a[240:241], v96 offset:4096
    ds_read_b64_tr_b16 a[242:243], v96 offset:6144
    ds_read_b64_tr_b16 a[244:245], v97 offset:4096
    ds_read_b64_tr_b16 a[246:247], v97 offset:6144
    ds_read_b64_tr_b16 a[248:249], v98 offset:4096
    ds_read_b64_tr_b16 a[250:251], v98 offset:6144
    ds_read_b64_tr_b16 a[252:253], v99 offset:4096
    ds_read_b64_tr_b16 a[254:255], v99 offset:6144
    s_waitcnt vmcnt(3) lgkmcnt(15)
    v_mfma_f32_16x16x32_bf16 v[128:131], a[192:195], a[128:131], 0
    s_waitcnt vmcnt(2)
    buffer_load_dwordx4 a[144:147], v26, s[20:23], s37 offen sc1
    v_mfma_f32_16x16x32_bf16 v[132:135], a[192:195], a[132:135], 0
    s_waitcnt vmcnt(2)
    v_mfma_f32_16x16x32_bf16 v[136:139], a[192:195], a[136:139], 0
    s_waitcnt vmcnt(1)
    buffer_load_dwordx4 a[148:151], v27, s[20:23], s37 offen sc1
    v_mfma_f32_16x16x32_bf16 v[140:143], a[192:195], a[140:143], 0
    v_mfma_f32_16x16x32_bf16 v[144:147], a[196:199], a[128:131], 0
    buffer_load_dwordx4 a[152:155], v28, s[20:23], s37 offen sc1
    v_mfma_f32_16x16x32_bf16 v[148:151], a[196:199], a[132:135], 0
    ds_read_b64_tr_b16 a[192:193], v20 offset:16384
    v_mfma_f32_16x16x32_bf16 v[152:155], a[196:199], a[136:139], 0
    buffer_load_dwordx4 a[156:159], v29, s[20:23], s37 offen sc1
    v_mfma_f32_16x16x32_bf16 v[156:159], a[196:199], a[140:143], 0
    s_add_u32 s37, s37, 1024
    ds_read_b64_tr_b16 a[194:195], v20 offset:20480
    v_mfma_f32_16x16x32_bf16 v[160:163], a[200:203], a[128:131], 0
    buffer_load_dwordx4 a[160:163], v26, s[20:23], s37 offen sc1
    v_mfma_f32_16x16x32_bf16 v[164:167], a[200:203], a[132:135], 0
    ds_read_b64_tr_b16 a[196:197], v20 offset:16392
    v_mfma_f32_16x16x32_bf16 v[168:171], a[200:203], a[136:139], 0
    buffer_load_dwordx4 a[164:167], v27, s[20:23], s37 offen sc1
    v_mfma_f32_16x16x32_bf16 v[172:175], a[200:203], a[140:143], 0
    ds_read_b64_tr_b16 a[198:199], v20 offset:20488
    v_mfma_f32_16x16x32_bf16 v[176:179], a[204:207], a[128:131], 0
    buffer_load_dwordx4 a[168:171], v28, s[20:23], s37 offen sc1
    v_mfma_f32_16x16x32_bf16 v[180:183], a[204:207], a[132:135], 0
    ds_read_b64_tr_b16 a[200:201], v21 offset:16384
    v_mfma_f32_16x16x32_bf16 v[184:187], a[204:207], a[136:139], 0
    buffer_load_dwordx4 a[172:175], v29, s[20:23], s37 offen sc1
    v_mfma_f32_16x16x32_bf16 v[188:191], a[204:207], a[140:143], 0
    s_add_u32 s37, s37, 1024
    ds_read_b64_tr_b16 a[202:203], v21 offset:20480
    v_mfma_f32_16x16x32_bf16 v[192:195], a[208:211], a[128:131], 0
    buffer_load_dwordx4 a[176:179], v26, s[20:23], s37 offen sc1
    v_mfma_f32_16x16x32_bf16 v[196:199], a[208:211], a[132:135], 0
    ds_read_b64_tr_b16 a[204:205], v21 offset:16392
    v_mfma_f32_16x16x32_bf16 v[200:203], a[208:211], a[136:139], 0
    buffer_load_dwordx4 a[180:183], v27, s[20:23], s37 offen sc1
    v_mfma_f32_16x16x32_bf16 v[204:207], a[208:211], a[140:143], 0
    ds_read_b64_tr_b16 a[206:207], v21 offset:20488
    v_mfma_f32_16x16x32_bf16 v[208:211], a[212:215], a[128:131], 0
    buffer_load_dwordx4 a[184:187], v28, s[20:23], s37 offen sc1
    v_mfma_f32_16x16x32_bf16 v[212:215], a[212:215], a[132:135], 0
    ds_read_b64_tr_b16 a[208:209], v22 offset:16384
    v_mfma_f32_16x16x32_bf16 v[216:219], a[212:215], a[136:139], 0
    buffer_load_dwordx4 a[188:191], v29, s[20:23], s37 offen sc1
    v_mfma_f32_16x16x32_bf16 v[220:223], a[212:215], a[140:143], 0
    s_add_u32 s37, s37, 1024
    ds_read_b64_tr_b16 a[210:211], v22 offset:20480
    v_mfma_f32_16x16x32_bf16 v[224:227], a[216:219], a[128:131], 0
    v_mfma_f32_16x16x32_bf16 v[228:231], a[216:219], a[132:135], 0
    s_add_u32 m0, s35, 98304
    ds_read_b64_tr_b16 a[212:213], v22 offset:16392
    v_mfma_f32_16x16x32_bf16 v[232:235], a[216:219], a[136:139], 0
    buffer_load_dwordx4 v24, s[16:19], s41 offen lds
    v_mfma_f32_16x16x32_bf16 v[236:239], a[216:219], a[140:143], 0
    ds_read_b64_tr_b16 a[214:215], v22 offset:20488
    v_mfma_f32_16x16x32_bf16 v[240:243], a[220:223], a[128:131], 0
    v_mfma_f32_16x16x32_bf16 v[244:247], a[220:223], a[132:135], 0
    ds_read_b64_tr_b16 a[216:217], v23 offset:16384
    v_mfma_f32_16x16x32_bf16 v[248:251], a[220:223], a[136:139], 0
    buffer_load_dwordx4 v25, s[16:19], s41 offen offset:1024 lds
    v_mfma_f32_16x16x32_bf16 v[252:255], a[220:223], a[140:143], 0
    s_waitcnt lgkmcnt(3)
    s_add_u32 s41, s41, 262144
    ds_read_b64_tr_b16 a[218:219], v23 offset:20480
    v_mfma_f32_16x16x32_bf16 a[0:3], a[224:227], a[128:131], 0
    v_mfma_f32_16x16x32_bf16 a[4:7], a[224:227], a[132:135], 0
    s_add_u32 m0, s35, 106496
    ds_read_b64_tr_b16 a[220:221], v23 offset:16392
    v_mfma_f32_16x16x32_bf16 a[8:11], a[224:227], a[136:139], 0
    buffer_load_dwordx4 v100, s[24:27], s38 offen lds
    v_mfma_f32_16x16x32_bf16 a[12:15], a[224:227], a[140:143], 0
    ds_read_b64_tr_b16 a[222:223], v23 offset:20488
    v_mfma_f32_16x16x32_bf16 a[16:19], a[228:231], a[128:131], 0
    v_mfma_f32_16x16x32_bf16 a[20:23], a[228:231], a[132:135], 0
    ds_read_b64_tr_b16 a[224:225], v96 offset:16384
    v_mfma_f32_16x16x32_bf16 a[24:27], a[228:231], a[136:139], 0
    buffer_load_dwordx4 v101, s[24:27], s38 offen offset:1024 lds
    v_mfma_f32_16x16x32_bf16 a[28:31], a[228:231], a[140:143], 0
    s_add_u32 s38, s38, 114688
    ds_read_b64_tr_b16 a[226:227], v96 offset:18432
    v_mfma_f32_16x16x32_bf16 a[32:35], a[232:235], a[128:131], 0
    v_mfma_f32_16x16x32_bf16 a[36:39], a[232:235], a[132:135], 0
    ds_read_b64_tr_b16 a[228:229], v97 offset:16384
    v_mfma_f32_16x16x32_bf16 a[40:43], a[232:235], a[136:139], 0
    v_mfma_f32_16x16x32_bf16 a[44:47], a[232:235], a[140:143], 0
    s_add_u32 m0, s35, 114688
    ds_read_b64_tr_b16 a[230:231], v97 offset:18432
    v_mfma_f32_16x16x32_bf16 a[48:51], a[236:239], a[128:131], 0
    buffer_load_dwordx4 v24, s[16:19], s41 offen lds
    v_mfma_f32_16x16x32_bf16 a[52:55], a[236:239], a[132:135], 0
    ds_read_b64_tr_b16 a[232:233], v98 offset:16384
    v_mfma_f32_16x16x32_bf16 a[56:59], a[236:239], a[136:139], 0
    v_mfma_f32_16x16x32_bf16 a[60:63], a[236:239], a[140:143], 0
    ds_read_b64_tr_b16 a[234:235], v98 offset:18432
    v_mfma_f32_16x16x32_bf16 a[64:67], a[240:243], a[128:131], 0
    buffer_load_dwordx4 v25, s[16:19], s41 offen offset:1024 lds
    v_mfma_f32_16x16x32_bf16 a[68:71], a[240:243], a[132:135], 0
    s_add_u32 s41, s41, 262144
    ds_read_b64_tr_b16 a[236:237], v99 offset:16384
    v_mfma_f32_16x16x32_bf16 a[72:75], a[240:243], a[136:139], 0
    v_mfma_f32_16x16x32_bf16 a[76:79], a[240:243], a[140:143], 0
    s_add_u32 m0, s35, 122880
    ds_read_b64_tr_b16 a[238:239], v99 offset:18432
    v_mfma_f32_16x16x32_bf16 a[80:83], a[244:247], a[128:131], 0
    buffer_load_dwordx4 v100, s[24:27], s38 offen lds
    v_mfma_f32_16x16x32_bf16 a[84:87], a[244:247], a[132:135], 0
    ds_read_b64_tr_b16 a[240:241], v96 offset:20480
    v_mfma_f32_16x16x32_bf16 a[88:91], a[244:247], a[136:139], 0
    v_mfma_f32_16x16x32_bf16 a[92:95], a[244:247], a[140:143], 0
    ds_read_b64_tr_b16 a[242:243], v96 offset:22528
    v_mfma_f32_16x16x32_bf16 a[96:99], a[248:251], a[128:131], 0
    buffer_load_dwordx4 v101, s[24:27], s38 offen offset:1024 lds
    v_mfma_f32_16x16x32_bf16 a[100:103], a[248:251], a[132:135], 0
    s_add_u32 s38, s38, 114688
    ds_read_b64_tr_b16 a[244:245], v97 offset:20480
    v_mfma_f32_16x16x32_bf16 a[104:107], a[248:251], a[136:139], 0
    v_mfma_f32_16x16x32_bf16 a[108:111], a[248:251], a[140:143], 0
    ds_read_b64_tr_b16 a[246:247], v97 offset:22528
    v_mfma_f32_16x16x32_bf16 a[112:115], a[252:255], a[128:131], 0
    v_mfma_f32_16x16x32_bf16 a[116:119], a[252:255], a[132:135], 0
    ds_read_b64_tr_b16 a[248:249], v98 offset:20480
    v_mfma_f32_16x16x32_bf16 a[120:123], a[252:255], a[136:139], 0
    v_mfma_f32_16x16x32_bf16 a[124:127], a[252:255], a[140:143], 0
    s_waitcnt vmcnt(19)
    ds_read_b64_tr_b16 a[250:251], v98 offset:22528
    v_mfma_f32_16x16x32_bf16 v[128:131], a[192:195], a[144:147], v[128:131]
    s_waitcnt vmcnt(18)
    v_mfma_f32_16x16x32_bf16 v[132:135], a[192:195], a[148:151], v[132:135]
    s_waitcnt vmcnt(17)
    ds_read_b64_tr_b16 a[252:253], v99 offset:20480
    v_mfma_f32_16x16x32_bf16 v[136:139], a[192:195], a[152:155], v[136:139]
    s_waitcnt vmcnt(16)
    v_mfma_f32_16x16x32_bf16 v[140:143], a[192:195], a[156:159], v[140:143]
    ds_read_b64_tr_b16 a[254:255], v99 offset:22528
    v_mfma_f32_16x16x32_bf16 v[144:147], a[196:199], a[144:147], v[144:147]
    v_mfma_f32_16x16x32_bf16 v[148:151], a[196:199], a[148:151], v[148:151]
    s_add_u32 m0, s35, 131072
    ds_read_b64_tr_b16 a[192:193], v20 offset:32768
    v_mfma_f32_16x16x32_bf16 v[152:155], a[196:199], a[152:155], v[152:155]
    buffer_load_dwordx4 v24, s[16:19], s41 offen lds
    v_mfma_f32_16x16x32_bf16 v[156:159], a[196:199], a[156:159], v[156:159]
    ds_read_b64_tr_b16 a[194:195], v20 offset:36864
    v_mfma_f32_16x16x32_bf16 v[160:163], a[200:203], a[144:147], v[160:163]
    v_mfma_f32_16x16x32_bf16 v[164:167], a[200:203], a[148:151], v[164:167]
    ds_read_b64_tr_b16 a[196:197], v20 offset:32776
    v_mfma_f32_16x16x32_bf16 v[168:171], a[200:203], a[152:155], v[168:171]
    buffer_load_dwordx4 v25, s[16:19], s41 offen offset:1024 lds
    v_mfma_f32_16x16x32_bf16 v[172:175], a[200:203], a[156:159], v[172:175]
    s_add_u32 s41, s41, 262144
    ds_read_b64_tr_b16 a[198:199], v20 offset:36872
    v_mfma_f32_16x16x32_bf16 v[176:179], a[204:207], a[144:147], v[176:179]
    v_mfma_f32_16x16x32_bf16 v[180:183], a[204:207], a[148:151], v[180:183]
    s_add_u32 m0, s35, 139264
    ds_read_b64_tr_b16 a[200:201], v21 offset:32768
    v_mfma_f32_16x16x32_bf16 v[184:187], a[204:207], a[152:155], v[184:187]
    buffer_load_dwordx4 v100, s[24:27], s38 offen lds
    v_mfma_f32_16x16x32_bf16 v[188:191], a[204:207], a[156:159], v[188:191]
    ds_read_b64_tr_b16 a[202:203], v21 offset:36864
    v_mfma_f32_16x16x32_bf16 v[192:195], a[208:211], a[144:147], v[192:195]
    v_mfma_f32_16x16x32_bf16 v[196:199], a[208:211], a[148:151], v[196:199]
    ds_read_b64_tr_b16 a[204:205], v21 offset:32776
    v_mfma_f32_16x16x32_bf16 v[200:203], a[208:211], a[152:155], v[200:203]
    buffer_load_dwordx4 v101, s[24:27], s38 offen offset:1024 lds
    v_mfma_f32_16x16x32_bf16 v[204:207], a[208:211], a[156:159], v[204:207]
    s_waitcnt lgkmcnt(3)
    s_add_u32 s38, s38, 114688
    ds_read_b64_tr_b16 a[206:207], v21 offset:36872
    v_mfma_f32_16x16x32_bf16 v[208:211], a[212:215], a[144:147], v[208:211]
    v_mfma_f32_16x16x32_bf16 v[212:215], a[212:215], a[148:151], v[212:215]
    ds_read_b64_tr_b16 a[208:209], v22 offset:32768
    v_mfma_f32_16x16x32_bf16 v[216:219], a[212:215], a[152:155], v[216:219]
    v_mfma_f32_16x16x32_bf16 v[220:223], a[212:215], a[156:159], v[220:223]
    s_add_u32 m0, s35, 147456
    ds_read_b64_tr_b16 a[210:211], v22 offset:36864
    v_mfma_f32_16x16x32_bf16 v[224:227], a[216:219], a[144:147], v[224:227]
    buffer_load_dwordx4 v24, s[16:19], s41 offen lds
    v_mfma_f32_16x16x32_bf16 v[228:231], a[216:219], a[148:151], v[228:231]
    ds_read_b64_tr_b16 a[212:213], v22 offset:32776
    v_mfma_f32_16x16x32_bf16 v[232:235], a[216:219], a[152:155], v[232:235]
    v_mfma_f32_16x16x32_bf16 v[236:239], a[216:219], a[156:159], v[236:239]
    ds_read_b64_tr_b16 a[214:215], v22 offset:36872
    v_mfma_f32_16x16x32_bf16 v[240:243], a[220:223], a[144:147], v[240:243]
    buffer_load_dwordx4 v25, s[16:19], s41 offen offset:1024 lds
    v_mfma_f32_16x16x32_bf16 v[244:247], a[220:223], a[148:151], v[244:247]
    s_add_u32 s41, s41, 262144
    ds_read_b64_tr_b16 a[216:217], v23 offset:32768
    v_mfma_f32_16x16x32_bf16 v[248:251], a[220:223], a[152:155], v[248:251]
    v_mfma_f32_16x16x32_bf16 v[252:255], a[220:223], a[156:159], v[252:255]
    s_add_u32 m0, s35, 155648
    ds_read_b64_tr_b16 a[218:219], v23 offset:36864
    v_mfma_f32_16x16x32_bf16 a[0:3], a[224:227], a[144:147], a[0:3]
    buffer_load_dwordx4 v100, s[24:27], s38 offen lds
    v_mfma_f32_16x16x32_bf16 a[4:7], a[224:227], a[148:151], a[4:7]
    ds_read_b64_tr_b16 a[220:221], v23 offset:32776
    v_mfma_f32_16x16x32_bf16 a[8:11], a[224:227], a[152:155], a[8:11]
    v_mfma_f32_16x16x32_bf16 a[12:15], a[224:227], a[156:159], a[12:15]
    ds_read_b64_tr_b16 a[222:223], v23 offset:36872
    v_mfma_f32_16x16x32_bf16 a[16:19], a[228:231], a[144:147], a[16:19]
    buffer_load_dwordx4 v101, s[24:27], s38 offen offset:1024 lds
    v_mfma_f32_16x16x32_bf16 a[20:23], a[228:231], a[148:151], a[20:23]
    s_add_u32 s38, s38, 114688
    ds_read_b64_tr_b16 a[224:225], v96 offset:32768
    v_mfma_f32_16x16x32_bf16 a[24:27], a[228:231], a[152:155], a[24:27]
    v_mfma_f32_16x16x32_bf16 a[28:31], a[228:231], a[156:159], a[28:31]
    ds_read_b64_tr_b16 a[226:227], v96 offset:34816
    v_mfma_f32_16x16x32_bf16 a[32:35], a[232:235], a[144:147], a[32:35]
    v_mfma_f32_16x16x32_bf16 a[36:39], a[232:235], a[148:151], a[36:39]
    ds_read_b64_tr_b16 a[228:229], v97 offset:32768
    v_mfma_f32_16x16x32_bf16 a[40:43], a[232:235], a[152:155], a[40:43]
    buffer_load_dword v126, v114, s[76:79], s42 offen
    v_mfma_f32_16x16x32_bf16 a[44:47], a[232:235], a[156:159], a[44:47]
    ds_read_b64_tr_b16 a[230:231], v97 offset:34816
    v_mfma_f32_16x16x32_bf16 a[48:51], a[236:239], a[144:147], a[48:51]
    v_mfma_f32_16x16x32_bf16 a[52:55], a[236:239], a[148:151], a[52:55]
    ds_read_b64_tr_b16 a[232:233], v98 offset:32768
    v_mfma_f32_16x16x32_bf16 a[56:59], a[236:239], a[152:155], a[56:59]
    v_mfma_f32_16x16x32_bf16 a[60:63], a[236:239], a[156:159], a[60:63]
    ds_read_b64_tr_b16 a[234:235], v98 offset:34816
    v_mfma_f32_16x16x32_bf16 a[64:67], a[240:243], a[144:147], a[64:67]
    v_mfma_f32_16x16x32_bf16 a[68:71], a[240:243], a[148:151], a[68:71]
    ds_read_b64_tr_b16 a[236:237], v99 offset:32768
    v_mfma_f32_16x16x32_bf16 a[72:75], a[240:243], a[152:155], a[72:75]
    v_mfma_f32_16x16x32_bf16 a[76:79], a[240:243], a[156:159], a[76:79]
    ds_read_b64_tr_b16 a[238:239], v99 offset:34816
    v_mfma_f32_16x16x32_bf16 a[80:83], a[244:247], a[144:147], a[80:83]
    buffer_load_dwordx4 a[128:131], v26, s[20:23], s37 offen sc1
    v_mfma_f32_16x16x32_bf16 a[84:87], a[244:247], a[148:151], a[84:87]
    ds_read_b64_tr_b16 a[240:241], v96 offset:36864
    v_mfma_f32_16x16x32_bf16 a[88:91], a[244:247], a[152:155], a[88:91]
    v_mfma_f32_16x16x32_bf16 a[92:95], a[244:247], a[156:159], a[92:95]
    ds_read_b64_tr_b16 a[242:243], v96 offset:38912
    v_mfma_f32_16x16x32_bf16 a[96:99], a[248:251], a[144:147], a[96:99]
    buffer_load_dwordx4 a[132:135], v27, s[20:23], s37 offen sc1
    v_mfma_f32_16x16x32_bf16 a[100:103], a[248:251], a[148:151], a[100:103]
    ds_read_b64_tr_b16 a[244:245], v97 offset:36864
    v_mfma_f32_16x16x32_bf16 a[104:107], a[248:251], a[152:155], a[104:107]
    v_mfma_f32_16x16x32_bf16 a[108:111], a[248:251], a[156:159], a[108:111]
    ds_read_b64_tr_b16 a[246:247], v97 offset:38912
    v_mfma_f32_16x16x32_bf16 a[112:115], a[252:255], a[144:147], a[112:115]
    buffer_load_dwordx4 a[136:139], v28, s[20:23], s37 offen sc1
    v_mfma_f32_16x16x32_bf16 a[116:119], a[252:255], a[148:151], a[116:119]
    ds_read_b64_tr_b16 a[248:249], v98 offset:36864
    v_mfma_f32_16x16x32_bf16 a[120:123], a[252:255], a[152:155], a[120:123]
    buffer_load_dwordx4 a[140:143], v29, s[20:23], s37 offen sc1
    v_mfma_f32_16x16x32_bf16 a[124:127], a[252:255], a[156:159], a[124:127]
    s_add_u32 s37, s37, 1024
    ds_read_b64_tr_b16 a[250:251], v98 offset:38912
    s_waitcnt vmcnt(17)
    s_barrier
    v_mfma_f32_16x16x32_bf16 v[128:131], a[192:195], a[160:163], v[128:131]
    v_mfma_f32_16x16x32_bf16 v[132:135], a[192:195], a[164:167], v[132:135]
    ds_read_b64_tr_b16 a[252:253], v99 offset:36864
    v_mfma_f32_16x16x32_bf16 v[136:139], a[192:195], a[168:171], v[136:139]
    v_mfma_f32_16x16x32_bf16 v[140:143], a[192:195], a[172:175], v[140:143]
    ds_read_b64_tr_b16 a[254:255], v99 offset:38912
    v_mfma_f32_16x16x32_bf16 v[144:147], a[196:199], a[160:163], v[144:147]
    v_mfma_f32_16x16x32_bf16 v[148:151], a[196:199], a[164:167], v[148:151]
    s_add_u32 m0, s35, 32768
    ds_read_b64_tr_b16 a[192:193], v20 offset:49152
    v_mfma_f32_16x16x32_bf16 v[152:155], a[196:199], a[168:171], v[152:155]
    buffer_load_dwordx4 v24, s[16:19], s41 offen lds
    v_mfma_f32_16x16x32_bf16 v[156:159], a[196:199], a[172:175], v[156:159]
    s_waitcnt lgkmcnt(3)
    ds_read_b64_tr_b16 a[194:195], v20 offset:53248
    v_mfma_f32_16x16x32_bf16 v[160:163], a[200:203], a[160:163], v[160:163]
    v_mfma_f32_16x16x32_bf16 v[164:167], a[200:203], a[164:167], v[164:167]
    ds_read_b64_tr_b16 a[196:197], v20 offset:49160
    v_mfma_f32_16x16x32_bf16 v[168:171], a[200:203], a[168:171], v[168:171]
    v_mfma_f32_16x16x32_bf16 v[172:175], a[200:203], a[172:175], v[172:175]
    ds_read_b64_tr_b16 a[198:199], v20 offset:53256
    v_mfma_f32_16x16x32_bf16 v[176:179], a[204:207], a[160:163], v[176:179]
    buffer_load_dwordx4 v25, s[16:19], s41 offen offset:1024 lds
    v_mfma_f32_16x16x32_bf16 v[180:183], a[204:207], a[164:167], v[180:183]
    s_add_u32 s41, s41, 262144
    ds_read_b64_tr_b16 a[200:201], v21 offset:49152
    v_mfma_f32_16x16x32_bf16 v[184:187], a[204:207], a[168:171], v[184:187]
    v_mfma_f32_16x16x32_bf16 v[188:191], a[204:207], a[172:175], v[188:191]
    ds_read_b64_tr_b16 a[202:203], v21 offset:53248
    v_mfma_f32_16x16x32_bf16 v[192:195], a[208:211], a[160:163], v[192:195]
    v_mfma_f32_16x16x32_bf16 v[196:199], a[208:211], a[164:167], v[196:199]
    s_add_u32 m0, s35, 40960
    ds_read_b64_tr_b16 a[204:205], v21 offset:49160
    v_mfma_f32_16x16x32_bf16 v[200:203], a[208:211], a[168:171], v[200:203]
    buffer_load_dwordx4 v100, s[24:27], s38 offen lds
    v_mfma_f32_16x16x32_bf16 v[204:207], a[208:211], a[172:175], v[204:207]
    ds_read_b64_tr_b16 a[206:207], v21 offset:53256
    v_mfma_f32_16x16x32_bf16 v[208:211], a[212:215], a[160:163], v[208:211]
    v_mfma_f32_16x16x32_bf16 v[212:215], a[212:215], a[164:167], v[212:215]
    ds_read_b64_tr_b16 a[208:209], v22 offset:49152
    v_mfma_f32_16x16x32_bf16 v[216:219], a[212:215], a[168:171], v[216:219]
    v_mfma_f32_16x16x32_bf16 v[220:223], a[212:215], a[172:175], v[220:223]
    ds_read_b64_tr_b16 a[210:211], v22 offset:53248
    v_mfma_f32_16x16x32_bf16 v[224:227], a[216:219], a[160:163], v[224:227]
    buffer_load_dwordx4 v101, s[24:27], s38 offen offset:1024 lds
    v_mfma_f32_16x16x32_bf16 v[228:231], a[216:219], a[164:167], v[228:231]
    s_add_u32 s38, s38, 114688
    ds_read_b64_tr_b16 a[212:213], v22 offset:49160
    v_mfma_f32_16x16x32_bf16 v[232:235], a[216:219], a[168:171], v[232:235]
    v_mfma_f32_16x16x32_bf16 v[236:239], a[216:219], a[172:175], v[236:239]
    ds_read_b64_tr_b16 a[214:215], v22 offset:53256
    v_mfma_f32_16x16x32_bf16 v[240:243], a[220:223], a[160:163], v[240:243]
    v_mfma_f32_16x16x32_bf16 v[244:247], a[220:223], a[164:167], v[244:247]
    ds_read_b64_tr_b16 a[216:217], v23 offset:49152
    v_mfma_f32_16x16x32_bf16 v[248:251], a[220:223], a[168:171], v[248:251]
    v_mfma_f32_16x16x32_bf16 v[252:255], a[220:223], a[172:175], v[252:255]
    ds_read_b64_tr_b16 a[218:219], v23 offset:53248
    v_mfma_f32_16x16x32_bf16 a[0:3], a[224:227], a[160:163], a[0:3]
    v_mfma_f32_16x16x32_bf16 a[4:7], a[224:227], a[164:167], a[4:7]
    ds_read_b64_tr_b16 a[220:221], v23 offset:49160
    v_mfma_f32_16x16x32_bf16 a[8:11], a[224:227], a[168:171], a[8:11]
    v_mfma_f32_16x16x32_bf16 a[12:15], a[224:227], a[172:175], a[12:15]
    ds_read_b64_tr_b16 a[222:223], v23 offset:53256
    v_mfma_f32_16x16x32_bf16 a[16:19], a[228:231], a[160:163], a[16:19]
    v_mfma_f32_16x16x32_bf16 a[20:23], a[228:231], a[164:167], a[20:23]
    ds_read_b64_tr_b16 a[224:225], v96 offset:49152
    v_mfma_f32_16x16x32_bf16 a[24:27], a[228:231], a[168:171], a[24:27]
    v_mfma_f32_16x16x32_bf16 a[28:31], a[228:231], a[172:175], a[28:31]
    ds_read_b64_tr_b16 a[226:227], v96 offset:51200
    v_mfma_f32_16x16x32_bf16 a[32:35], a[232:235], a[160:163], a[32:35]
    v_mfma_f32_16x16x32_bf16 a[36:39], a[232:235], a[164:167], a[36:39]
    ds_read_b64_tr_b16 a[228:229], v97 offset:49152
    v_mfma_f32_16x16x32_bf16 a[40:43], a[232:235], a[168:171], a[40:43]
    v_mfma_f32_16x16x32_bf16 a[44:47], a[232:235], a[172:175], a[44:47]
    ds_read_b64_tr_b16 a[230:231], v97 offset:51200
    v_mfma_f32_16x16x32_bf16 a[48:51], a[236:239], a[160:163], a[48:51]
    v_mfma_f32_16x16x32_bf16 a[52:55], a[236:239], a[164:167], a[52:55]
    ds_read_b64_tr_b16 a[232:233], v98 offset:49152
    v_mfma_f32_16x16x32_bf16 a[56:59], a[236:239], a[168:171], a[56:59]
    v_mfma_f32_16x16x32_bf16 a[60:63], a[236:239], a[172:175], a[60:63]
    ds_read_b64_tr_b16 a[234:235], v98 offset:51200
    v_mfma_f32_16x16x32_bf16 a[64:67], a[240:243], a[160:163], a[64:67]
    v_mfma_f32_16x16x32_bf16 a[68:71], a[240:243], a[164:167], a[68:71]
    ds_read_b64_tr_b16 a[236:237], v99 offset:49152
    v_mfma_f32_16x16x32_bf16 a[72:75], a[240:243], a[168:171], a[72:75]
    v_mfma_f32_16x16x32_bf16 a[76:79], a[240:243], a[172:175], a[76:79]
    ds_read_b64_tr_b16 a[238:239], v99 offset:51200
    v_mfma_f32_16x16x32_bf16 a[80:83], a[244:247], a[160:163], a[80:83]
    buffer_load_dwordx4 a[144:147], v26, s[20:23], s37 offen sc1
    v_mfma_f32_16x16x32_bf16 a[84:87], a[244:247], a[164:167], a[84:87]
    ds_read_b64_tr_b16 a[240:241], v96 offset:53248
    v_mfma_f32_16x16x32_bf16 a[88:91], a[244:247], a[168:171], a[88:91]
    v_mfma_f32_16x16x32_bf16 a[92:95], a[244:247], a[172:175], a[92:95]
    ds_read_b64_tr_b16 a[242:243], v96 offset:55296
    v_mfma_f32_16x16x32_bf16 a[96:99], a[248:251], a[160:163], a[96:99]
    buffer_load_dwordx4 a[148:151], v27, s[20:23], s37 offen sc1
    v_mfma_f32_16x16x32_bf16 a[100:103], a[248:251], a[164:167], a[100:103]
    ds_read_b64_tr_b16 a[244:245], v97 offset:53248
    v_mfma_f32_16x16x32_bf16 a[104:107], a[248:251], a[168:171], a[104:107]
    v_mfma_f32_16x16x32_bf16 a[108:111], a[248:251], a[172:175], a[108:111]
    s_waitcnt lgkmcnt(3)
    ds_read_b64_tr_b16 a[246:247], v97 offset:55296
    v_mfma_f32_16x16x32_bf16 a[112:115], a[252:255], a[160:163], a[112:115]
    buffer_load_dwordx4 a[152:155], v28, s[20:23], s37 offen sc1
    v_mfma_f32_16x16x32_bf16 a[116:119], a[252:255], a[164:167], a[116:119]
    ds_read_b64_tr_b16 a[248:249], v98 offset:53248
    v_mfma_f32_16x16x32_bf16 a[120:123], a[252:255], a[168:171], a[120:123]
    buffer_load_dwordx4 a[156:159], v29, s[20:23], s37 offen sc1
    v_mfma_f32_16x16x32_bf16 a[124:127], a[252:255], a[172:175], a[124:127]
    s_add_u32 s37, s37, 1024
    ds_read_b64_tr_b16 a[250:251], v98 offset:55296
    v_mfma_f32_16x16x32_bf16 v[128:131], a[192:195], a[176:179], v[128:131]
    v_mfma_f32_16x16x32_bf16 v[132:135], a[192:195], a[180:183], v[132:135]
    ds_read_b64_tr_b16 a[252:253], v99 offset:53248
    v_mfma_f32_16x16x32_bf16 v[136:139], a[192:195], a[184:187], v[136:139]
    v_mfma_f32_16x16x32_bf16 v[140:143], a[192:195], a[188:191], v[140:143]
    ds_read_b64_tr_b16 a[254:255], v99 offset:55296
    v_mfma_f32_16x16x32_bf16 v[144:147], a[196:199], a[176:179], v[144:147]
    v_add_u32 v20, 65536, v20
    v_add_u32 v96, 65536, v96
    v_add_u32 v21, 65536, v21
    v_add_u32 v97, 65536, v97
    v_add_u32 v22, 65536, v22
    v_add_u32 v98, 65536, v98
    v_add_u32 v23, 65536, v23
    v_add_u32 v99, 65536, v99
    v_mfma_f32_16x16x32_bf16 v[148:151], a[196:199], a[180:183], v[148:151]
    s_add_u32 m0, s35, 49152
    ds_read_b64_tr_b16 a[192:193], v20
    v_mfma_f32_16x16x32_bf16 v[152:155], a[196:199], a[184:187], v[152:155]
    buffer_load_dwordx4 v24, s[16:19], s41 offen lds
    v_mfma_f32_16x16x32_bf16 v[156:159], a[196:199], a[188:191], v[156:159]
    ds_read_b64_tr_b16 a[194:195], v20 offset:4096
    v_mfma_f32_16x16x32_bf16 v[160:163], a[200:203], a[176:179], v[160:163]
    v_mfma_f32_16x16x32_bf16 v[164:167], a[200:203], a[180:183], v[164:167]
    ds_read_b64_tr_b16 a[196:197], v20 offset:8
    v_mfma_f32_16x16x32_bf16 v[168:171], a[200:203], a[184:187], v[168:171]
    v_mfma_f32_16x16x32_bf16 v[172:175], a[200:203], a[188:191], v[172:175]
    ds_read_b64_tr_b16 a[198:199], v20 offset:4104
    v_mfma_f32_16x16x32_bf16 v[176:179], a[204:207], a[176:179], v[176:179]
    buffer_load_dwordx4 v25, s[16:19], s41 offen offset:1024 lds
    v_mfma_f32_16x16x32_bf16 v[180:183], a[204:207], a[180:183], v[180:183]
    s_add_u32 s41, s41, 262144
    ds_read_b64_tr_b16 a[200:201], v21
    v_mfma_f32_16x16x32_bf16 v[184:187], a[204:207], a[184:187], v[184:187]
    v_mfma_f32_16x16x32_bf16 v[188:191], a[204:207], a[188:191], v[188:191]
    ds_read_b64_tr_b16 a[202:203], v21 offset:4096
    v_mfma_f32_16x16x32_bf16 v[192:195], a[208:211], a[176:179], v[192:195]
    v_mfma_f32_16x16x32_bf16 v[196:199], a[208:211], a[180:183], v[196:199]
    s_add_u32 m0, s35, 57344
    ds_read_b64_tr_b16 a[204:205], v21 offset:8
    v_mfma_f32_16x16x32_bf16 v[200:203], a[208:211], a[184:187], v[200:203]
    buffer_load_dwordx4 v100, s[24:27], s38 offen lds
    v_mfma_f32_16x16x32_bf16 v[204:207], a[208:211], a[188:191], v[204:207]
    ds_read_b64_tr_b16 a[206:207], v21 offset:4104
    v_mfma_f32_16x16x32_bf16 v[208:211], a[212:215], a[176:179], v[208:211]
    v_mfma_f32_16x16x32_bf16 v[212:215], a[212:215], a[180:183], v[212:215]
    ds_read_b64_tr_b16 a[208:209], v22
    v_mfma_f32_16x16x32_bf16 v[216:219], a[212:215], a[184:187], v[216:219]
    v_mfma_f32_16x16x32_bf16 v[220:223], a[212:215], a[188:191], v[220:223]
    ds_read_b64_tr_b16 a[210:211], v22 offset:4096
    v_mfma_f32_16x16x32_bf16 v[224:227], a[216:219], a[176:179], v[224:227]
    buffer_load_dwordx4 v101, s[24:27], s38 offen offset:1024 lds
    v_mfma_f32_16x16x32_bf16 v[228:231], a[216:219], a[180:183], v[228:231]
    s_add_u32 s38, s38, 114688
    ds_read_b64_tr_b16 a[212:213], v22 offset:8
    v_mfma_f32_16x16x32_bf16 v[232:235], a[216:219], a[184:187], v[232:235]
    v_mfma_f32_16x16x32_bf16 v[236:239], a[216:219], a[188:191], v[236:239]
    ds_read_b64_tr_b16 a[214:215], v22 offset:4104
    v_mfma_f32_16x16x32_bf16 v[240:243], a[220:223], a[176:179], v[240:243]
    v_mfma_f32_16x16x32_bf16 v[244:247], a[220:223], a[180:183], v[244:247]
    ds_read_b64_tr_b16 a[216:217], v23
    v_mfma_f32_16x16x32_bf16 v[248:251], a[220:223], a[184:187], v[248:251]
    v_mfma_f32_16x16x32_bf16 v[252:255], a[220:223], a[188:191], v[252:255]
    ds_read_b64_tr_b16 a[218:219], v23 offset:4096
    v_mfma_f32_16x16x32_bf16 a[0:3], a[224:227], a[176:179], a[0:3]
    v_mfma_f32_16x16x32_bf16 a[4:7], a[224:227], a[180:183], a[4:7]
    ds_read_b64_tr_b16 a[220:221], v23 offset:8
    v_mfma_f32_16x16x32_bf16 a[8:11], a[224:227], a[184:187], a[8:11]
    v_mfma_f32_16x16x32_bf16 a[12:15], a[224:227], a[188:191], a[12:15]
    ds_read_b64_tr_b16 a[222:223], v23 offset:4104
    v_mfma_f32_16x16x32_bf16 a[16:19], a[228:231], a[176:179], a[16:19]
    v_mfma_f32_16x16x32_bf16 a[20:23], a[228:231], a[180:183], a[20:23]
    ds_read_b64_tr_b16 a[224:225], v96
    v_mfma_f32_16x16x32_bf16 a[24:27], a[228:231], a[184:187], a[24:27]
    v_mfma_f32_16x16x32_bf16 a[28:31], a[228:231], a[188:191], a[28:31]
    ds_read_b64_tr_b16 a[226:227], v96 offset:2048
    v_mfma_f32_16x16x32_bf16 a[32:35], a[232:235], a[176:179], a[32:35]
    v_mfma_f32_16x16x32_bf16 a[36:39], a[232:235], a[180:183], a[36:39]
    ds_read_b64_tr_b16 a[228:229], v97
    v_mfma_f32_16x16x32_bf16 a[40:43], a[232:235], a[184:187], a[40:43]
    v_mfma_f32_16x16x32_bf16 a[44:47], a[232:235], a[188:191], a[44:47]
    ds_read_b64_tr_b16 a[230:231], v97 offset:2048
    v_mfma_f32_16x16x32_bf16 a[48:51], a[236:239], a[176:179], a[48:51]
    v_mfma_f32_16x16x32_bf16 a[52:55], a[236:239], a[180:183], a[52:55]
    ds_read_b64_tr_b16 a[232:233], v98
    v_mfma_f32_16x16x32_bf16 a[56:59], a[236:239], a[184:187], a[56:59]
    v_mfma_f32_16x16x32_bf16 a[60:63], a[236:239], a[188:191], a[60:63]
    s_waitcnt lgkmcnt(3)
    ds_read_b64_tr_b16 a[234:235], v98 offset:2048
    v_mfma_f32_16x16x32_bf16 a[64:67], a[240:243], a[176:179], a[64:67]
    v_mfma_f32_16x16x32_bf16 a[68:71], a[240:243], a[180:183], a[68:71]
    ds_read_b64_tr_b16 a[236:237], v99
    v_mfma_f32_16x16x32_bf16 a[72:75], a[240:243], a[184:187], a[72:75]
    v_mfma_f32_16x16x32_bf16 a[76:79], a[240:243], a[188:191], a[76:79]
    ds_read_b64_tr_b16 a[238:239], v99 offset:2048
    v_mfma_f32_16x16x32_bf16 a[80:83], a[244:247], a[176:179], a[80:83]
    buffer_load_dwordx4 a[160:163], v26, s[20:23], s37 offen sc1
    v_mfma_f32_16x16x32_bf16 a[84:87], a[244:247], a[180:183], a[84:87]
    ds_read_b64_tr_b16 a[240:241], v96 offset:4096
    v_mfma_f32_16x16x32_bf16 a[88:91], a[244:247], a[184:187], a[88:91]
    v_mfma_f32_16x16x32_bf16 a[92:95], a[244:247], a[188:191], a[92:95]
    ds_read_b64_tr_b16 a[242:243], v96 offset:6144
    v_mfma_f32_16x16x32_bf16 a[96:99], a[248:251], a[176:179], a[96:99]
    buffer_load_dwordx4 a[164:167], v27, s[20:23], s37 offen sc1
    v_mfma_f32_16x16x32_bf16 a[100:103], a[248:251], a[180:183], a[100:103]
    ds_read_b64_tr_b16 a[244:245], v97 offset:4096
    v_mfma_f32_16x16x32_bf16 a[104:107], a[248:251], a[184:187], a[104:107]
    v_mfma_f32_16x16x32_bf16 a[108:111], a[248:251], a[188:191], a[108:111]
    ds_read_b64_tr_b16 a[246:247], v97 offset:6144
    v_mfma_f32_16x16x32_bf16 a[112:115], a[252:255], a[176:179], a[112:115]
    buffer_load_dwordx4 a[168:171], v28, s[20:23], s37 offen sc1
    v_mfma_f32_16x16x32_bf16 a[116:119], a[252:255], a[180:183], a[116:119]
    ds_read_b64_tr_b16 a[248:249], v98 offset:4096
    v_mfma_f32_16x16x32_bf16 a[120:123], a[252:255], a[184:187], a[120:123]
    buffer_load_dwordx4 a[172:175], v29, s[20:23], s37 offen sc1
    v_mfma_f32_16x16x32_bf16 a[124:127], a[252:255], a[188:191], a[124:127]
    s_add_u32 s37, s37, 1024
    ds_read_b64_tr_b16 a[250:251], v98 offset:6144
    s_waitcnt vmcnt(25)
    s_barrier
    s_waitcnt vmcnt(19)
    v_mfma_f32_16x16x32_bf16 v[128:131], a[192:195], a[128:131], v[128:131]
    s_waitcnt vmcnt(18)
    v_mfma_f32_16x16x32_bf16 v[132:135], a[192:195], a[132:135], v[132:135]
    s_waitcnt vmcnt(17)
    ds_read_b64_tr_b16 a[252:253], v99 offset:4096
    v_mfma_f32_16x16x32_bf16 v[136:139], a[192:195], a[136:139], v[136:139]
    s_waitcnt vmcnt(16)
    v_mfma_f32_16x16x32_bf16 v[140:143], a[192:195], a[140:143], v[140:143]
    ds_read_b64_tr_b16 a[254:255], v99 offset:6144
    v_mfma_f32_16x16x32_bf16 v[144:147], a[196:199], a[128:131], v[144:147]
    v_mfma_f32_16x16x32_bf16 v[148:151], a[196:199], a[132:135], v[148:151]
    s_add_u32 m0, s35, 65536
    ds_read_b64_tr_b16 a[192:193], v20 offset:16384
    v_mfma_f32_16x16x32_bf16 v[152:155], a[196:199], a[136:139], v[152:155]
    buffer_load_dwordx4 v24, s[16:19], s41 offen lds
    v_mfma_f32_16x16x32_bf16 v[156:159], a[196:199], a[140:143], v[156:159]
    ds_read_b64_tr_b16 a[194:195], v20 offset:20480
    v_mfma_f32_16x16x32_bf16 v[160:163], a[200:203], a[128:131], v[160:163]
    v_mfma_f32_16x16x32_bf16 v[164:167], a[200:203], a[132:135], v[164:167]
    ds_read_b64_tr_b16 a[196:197], v20 offset:16392
    v_mfma_f32_16x16x32_bf16 v[168:171], a[200:203], a[136:139], v[168:171]
    v_mfma_f32_16x16x32_bf16 v[172:175], a[200:203], a[140:143], v[172:175]
    ds_read_b64_tr_b16 a[198:199], v20 offset:20488
    v_mfma_f32_16x16x32_bf16 v[176:179], a[204:207], a[128:131], v[176:179]
    buffer_load_dwordx4 v25, s[16:19], s41 offen offset:1024 lds
    v_mfma_f32_16x16x32_bf16 v[180:183], a[204:207], a[132:135], v[180:183]
    s_add_u32 s41, s41, 262144
    ds_read_b64_tr_b16 a[200:201], v21 offset:16384
    v_mfma_f32_16x16x32_bf16 v[184:187], a[204:207], a[136:139], v[184:187]
    v_mfma_f32_16x16x32_bf16 v[188:191], a[204:207], a[140:143], v[188:191]
    ds_read_b64_tr_b16 a[202:203], v21 offset:20480
    v_mfma_f32_16x16x32_bf16 v[192:195], a[208:211], a[128:131], v[192:195]
    v_mfma_f32_16x16x32_bf16 v[196:199], a[208:211], a[132:135], v[196:199]
    s_add_u32 m0, s35, 73728
    ds_read_b64_tr_b16 a[204:205], v21 offset:16392
    v_mfma_f32_16x16x32_bf16 v[200:203], a[208:211], a[136:139], v[200:203]
    buffer_load_dwordx4 v100, s[24:27], s38 offen lds
    v_mfma_f32_16x16x32_bf16 v[204:207], a[208:211], a[140:143], v[204:207]
    ds_read_b64_tr_b16 a[206:207], v21 offset:20488
    v_mfma_f32_16x16x32_bf16 v[208:211], a[212:215], a[128:131], v[208:211]
    v_mfma_f32_16x16x32_bf16 v[212:215], a[212:215], a[132:135], v[212:215]
    ds_read_b64_tr_b16 a[208:209], v22 offset:16384
    v_mfma_f32_16x16x32_bf16 v[216:219], a[212:215], a[136:139], v[216:219]
    v_mfma_f32_16x16x32_bf16 v[220:223], a[212:215], a[140:143], v[220:223]
    ds_read_b64_tr_b16 a[210:211], v22 offset:20480
    v_mfma_f32_16x16x32_bf16 v[224:227], a[216:219], a[128:131], v[224:227]
    buffer_load_dwordx4 v101, s[24:27], s38 offen offset:1024 lds
    v_mfma_f32_16x16x32_bf16 v[228:231], a[216:219], a[132:135], v[228:231]
    s_add_u32 s38, s38, 114688
    ds_read_b64_tr_b16 a[212:213], v22 offset:16392
    v_mfma_f32_16x16x32_bf16 v[232:235], a[216:219], a[136:139], v[232:235]
    v_mfma_f32_16x16x32_bf16 v[236:239], a[216:219], a[140:143], v[236:239]
    ds_read_b64_tr_b16 a[214:215], v22 offset:20488
    v_mfma_f32_16x16x32_bf16 v[240:243], a[220:223], a[128:131], v[240:243]
    v_mfma_f32_16x16x32_bf16 v[244:247], a[220:223], a[132:135], v[244:247]
    s_add_u32 m0, s34, 0
    ds_read_b64_tr_b16 a[216:217], v23 offset:16384
    v_mfma_f32_16x16x32_bf16 v[248:251], a[220:223], a[136:139], v[248:251]
    buffer_load_dwordx4 v14, s[8:11], s32 offen lds
    v_mfma_f32_16x16x32_bf16 v[252:255], a[220:223], a[140:143], v[252:255]
    ds_read_b64_tr_b16 a[218:219], v23 offset:20480
    v_mfma_f32_16x16x32_bf16 a[0:3], a[224:227], a[128:131], a[0:3]
    v_mfma_f32_16x16x32_bf16 a[4:7], a[224:227], a[132:135], a[4:7]
    ds_read_b64_tr_b16 a[220:221], v23 offset:16392
    v_mfma_f32_16x16x32_bf16 a[8:11], a[224:227], a[136:139], a[8:11]
    v_mfma_f32_16x16x32_bf16 a[12:15], a[224:227], a[140:143], a[12:15]
    s_waitcnt lgkmcnt(3)
    ds_read_b64_tr_b16 a[222:223], v23 offset:20488
    v_mfma_f32_16x16x32_bf16 a[16:19], a[228:231], a[128:131], a[16:19]
    buffer_load_dwordx4 v15, s[8:11], s32 offen offset:1024 lds
    v_mfma_f32_16x16x32_bf16 a[20:23], a[228:231], a[132:135], a[20:23]
    ds_read_b64_tr_b16 a[224:225], v96 offset:16384
    v_mfma_f32_16x16x32_bf16 a[24:27], a[228:231], a[136:139], a[24:27]
    v_mfma_f32_16x16x32_bf16 a[28:31], a[228:231], a[140:143], a[28:31]
    ds_read_b64_tr_b16 a[226:227], v96 offset:18432
    v_mfma_f32_16x16x32_bf16 a[32:35], a[232:235], a[128:131], a[32:35]
    v_mfma_f32_16x16x32_bf16 a[36:39], a[232:235], a[132:135], a[36:39]
    ds_read_b64_tr_b16 a[228:229], v97 offset:16384
    v_mfma_f32_16x16x32_bf16 a[40:43], a[232:235], a[136:139], a[40:43]
    buffer_load_dwordx4 v16, s[8:11], s32 offen offset:2048 lds
    v_mfma_f32_16x16x32_bf16 a[44:47], a[232:235], a[140:143], a[44:47]
    ds_read_b64_tr_b16 a[230:231], v97 offset:18432
    v_mfma_f32_16x16x32_bf16 a[48:51], a[236:239], a[128:131], a[48:51]
    v_mfma_f32_16x16x32_bf16 a[52:55], a[236:239], a[132:135], a[52:55]
    ds_read_b64_tr_b16 a[232:233], v98 offset:16384
    v_mfma_f32_16x16x32_bf16 a[56:59], a[236:239], a[136:139], a[56:59]
    v_mfma_f32_16x16x32_bf16 a[60:63], a[236:239], a[140:143], a[60:63]
    ds_read_b64_tr_b16 a[234:235], v98 offset:18432
    v_mfma_f32_16x16x32_bf16 a[64:67], a[240:243], a[128:131], a[64:67]
    buffer_load_dwordx4 v17, s[8:11], s32 offen offset:3072 lds
    v_mfma_f32_16x16x32_bf16 a[68:71], a[240:243], a[132:135], a[68:71]
    s_add_u32 s32, s32, 16384
    ds_read_b64_tr_b16 a[236:237], v99 offset:16384
    v_mfma_f32_16x16x32_bf16 a[72:75], a[240:243], a[136:139], a[72:75]
    v_mfma_f32_16x16x32_bf16 a[76:79], a[240:243], a[140:143], a[76:79]
    ds_read_b64_tr_b16 a[238:239], v99 offset:18432
    v_mfma_f32_16x16x32_bf16 a[80:83], a[244:247], a[128:131], a[80:83]
    buffer_load_dwordx4 a[176:179], v26, s[20:23], s37 offen sc1
    v_mfma_f32_16x16x32_bf16 a[84:87], a[244:247], a[132:135], a[84:87]
    ds_read_b64_tr_b16 a[240:241], v96 offset:20480
    v_mfma_f32_16x16x32_bf16 a[88:91], a[244:247], a[136:139], a[88:91]
    v_mfma_f32_16x16x32_bf16 a[92:95], a[244:247], a[140:143], a[92:95]
    ds_read_b64_tr_b16 a[242:243], v96 offset:22528
    v_mfma_f32_16x16x32_bf16 a[96:99], a[248:251], a[128:131], a[96:99]
    buffer_load_dwordx4 a[180:183], v27, s[20:23], s37 offen sc1
    v_mfma_f32_16x16x32_bf16 a[100:103], a[248:251], a[132:135], a[100:103]
    ds_read_b64_tr_b16 a[244:245], v97 offset:20480
    v_mfma_f32_16x16x32_bf16 a[104:107], a[248:251], a[136:139], a[104:107]
    v_mfma_f32_16x16x32_bf16 a[108:111], a[248:251], a[140:143], a[108:111]
    ds_read_b64_tr_b16 a[246:247], v97 offset:22528
    v_mfma_f32_16x16x32_bf16 a[112:115], a[252:255], a[128:131], a[112:115]
    buffer_load_dwordx4 a[184:187], v28, s[20:23], s37 offen sc1
    v_mfma_f32_16x16x32_bf16 a[116:119], a[252:255], a[132:135], a[116:119]
    ds_read_b64_tr_b16 a[248:249], v98 offset:20480
    v_mfma_f32_16x16x32_bf16 a[120:123], a[252:255], a[136:139], a[120:123]
    buffer_load_dwordx4 a[188:191], v29, s[20:23], s37 offen sc1
    v_mfma_f32_16x16x32_bf16 a[124:127], a[252:255], a[140:143], a[124:127]
    s_waitcnt vmcnt(23)
    s_add_u32 s37, s37, 1024
    ds_read_b64_tr_b16 a[250:251], v98 offset:22528
    v_mfma_f32_16x16x32_bf16 v[128:131], a[192:195], a[144:147], v[128:131]
    s_waitcnt vmcnt(22)
    v_mfma_f32_16x16x32_bf16 v[132:135], a[192:195], a[148:151], v[132:135]
    s_waitcnt vmcnt(21)
    ds_read_b64_tr_b16 a[252:253], v99 offset:20480
    v_mfma_f32_16x16x32_bf16 v[136:139], a[192:195], a[152:155], v[136:139]
    s_waitcnt vmcnt(20)
    v_mfma_f32_16x16x32_bf16 v[140:143], a[192:195], a[156:159], v[140:143]
    ds_read_b64_tr_b16 a[254:255], v99 offset:22528
    v_mfma_f32_16x16x32_bf16 v[144:147], a[196:199], a[144:147], v[144:147]
    v_mfma_f32_16x16x32_bf16 v[148:151], a[196:199], a[148:151], v[148:151]
    s_add_u32 m0, s35, 81920
    ds_read_b64_tr_b16 a[192:193], v20 offset:32768
    v_mfma_f32_16x16x32_bf16 v[152:155], a[196:199], a[152:155], v[152:155]
    buffer_load_dwordx4 v24, s[16:19], s41 offen lds
    v_mfma_f32_16x16x32_bf16 v[156:159], a[196:199], a[156:159], v[156:159]
    ds_read_b64_tr_b16 a[194:195], v20 offset:36864
    v_mfma_f32_16x16x32_bf16 v[160:163], a[200:203], a[144:147], v[160:163]
    v_mfma_f32_16x16x32_bf16 v[164:167], a[200:203], a[148:151], v[164:167]
    ds_read_b64_tr_b16 a[196:197], v20 offset:32776
    v_mfma_f32_16x16x32_bf16 v[168:171], a[200:203], a[152:155], v[168:171]
    v_mfma_f32_16x16x32_bf16 v[172:175], a[200:203], a[156:159], v[172:175]
    ds_read_b64_tr_b16 a[198:199], v20 offset:36872
    v_mfma_f32_16x16x32_bf16 v[176:179], a[204:207], a[144:147], v[176:179]
    buffer_load_dwordx4 v25, s[16:19], s41 offen offset:1024 lds
    v_mfma_f32_16x16x32_bf16 v[180:183], a[204:207], a[148:151], v[180:183]
    s_add_u32 s41, s41, 262144
    ds_read_b64_tr_b16 a[200:201], v21 offset:32768
    v_mfma_f32_16x16x32_bf16 v[184:187], a[204:207], a[152:155], v[184:187]
    v_mfma_f32_16x16x32_bf16 v[188:191], a[204:207], a[156:159], v[188:191]
    ds_read_b64_tr_b16 a[202:203], v21 offset:36864
    v_mfma_f32_16x16x32_bf16 v[192:195], a[208:211], a[144:147], v[192:195]
    v_mfma_f32_16x16x32_bf16 v[196:199], a[208:211], a[148:151], v[196:199]
    s_add_u32 m0, s35, 90112
    ds_read_b64_tr_b16 a[204:205], v21 offset:32776
    v_mfma_f32_16x16x32_bf16 v[200:203], a[208:211], a[152:155], v[200:203]
    buffer_load_dwordx4 v100, s[24:27], s38 offen lds
    v_mfma_f32_16x16x32_bf16 v[204:207], a[208:211], a[156:159], v[204:207]
    ds_read_b64_tr_b16 a[206:207], v21 offset:36872
    v_mfma_f32_16x16x32_bf16 v[208:211], a[212:215], a[144:147], v[208:211]
    v_mfma_f32_16x16x32_bf16 v[212:215], a[212:215], a[148:151], v[212:215]
    ds_read_b64_tr_b16 a[208:209], v22 offset:32768
    v_mfma_f32_16x16x32_bf16 v[216:219], a[212:215], a[152:155], v[216:219]
    v_mfma_f32_16x16x32_bf16 v[220:223], a[212:215], a[156:159], v[220:223]
    s_waitcnt lgkmcnt(3)
    ds_read_b64_tr_b16 a[210:211], v22 offset:36864
    v_mfma_f32_16x16x32_bf16 v[224:227], a[216:219], a[144:147], v[224:227]
    buffer_load_dwordx4 v101, s[24:27], s38 offen offset:1024 lds
    v_mfma_f32_16x16x32_bf16 v[228:231], a[216:219], a[148:151], v[228:231]
    s_add_u32 s38, s38, 114688
    ds_read_b64_tr_b16 a[212:213], v22 offset:32776
    v_mfma_f32_16x16x32_bf16 v[232:235], a[216:219], a[152:155], v[232:235]
    v_mfma_f32_16x16x32_bf16 v[236:239], a[216:219], a[156:159], v[236:239]
    ds_read_b64_tr_b16 a[214:215], v22 offset:36872
    v_mfma_f32_16x16x32_bf16 v[240:243], a[220:223], a[144:147], v[240:243]
    v_mfma_f32_16x16x32_bf16 v[244:247], a[220:223], a[148:151], v[244:247]
    s_add_u32 m0, s34, 16384
    ds_read_b64_tr_b16 a[216:217], v23 offset:32768
    v_mfma_f32_16x16x32_bf16 v[248:251], a[220:223], a[152:155], v[248:251]
    buffer_load_dwordx4 v14, s[8:11], s32 offen lds
    v_mfma_f32_16x16x32_bf16 v[252:255], a[220:223], a[156:159], v[252:255]
    ds_read_b64_tr_b16 a[218:219], v23 offset:36864
    v_mfma_f32_16x16x32_bf16 a[0:3], a[224:227], a[144:147], a[0:3]
    v_mfma_f32_16x16x32_bf16 a[4:7], a[224:227], a[148:151], a[4:7]
    ds_read_b64_tr_b16 a[220:221], v23 offset:32776
    v_mfma_f32_16x16x32_bf16 a[8:11], a[224:227], a[152:155], a[8:11]
    v_mfma_f32_16x16x32_bf16 a[12:15], a[224:227], a[156:159], a[12:15]
    ds_read_b64_tr_b16 a[222:223], v23 offset:36872
    v_mfma_f32_16x16x32_bf16 a[16:19], a[228:231], a[144:147], a[16:19]
    buffer_load_dwordx4 v15, s[8:11], s32 offen offset:1024 lds
    v_mfma_f32_16x16x32_bf16 a[20:23], a[228:231], a[148:151], a[20:23]
    ds_read_b64_tr_b16 a[224:225], v96 offset:32768
    v_mfma_f32_16x16x32_bf16 a[24:27], a[228:231], a[152:155], a[24:27]
    v_mfma_f32_16x16x32_bf16 a[28:31], a[228:231], a[156:159], a[28:31]
    ds_read_b64_tr_b16 a[226:227], v96 offset:34816
    v_mfma_f32_16x16x32_bf16 a[32:35], a[232:235], a[144:147], a[32:35]
    v_mfma_f32_16x16x32_bf16 a[36:39], a[232:235], a[148:151], a[36:39]
    ds_read_b64_tr_b16 a[228:229], v97 offset:32768
    v_mfma_f32_16x16x32_bf16 a[40:43], a[232:235], a[152:155], a[40:43]
    buffer_load_dwordx4 v16, s[8:11], s32 offen offset:2048 lds
    v_mfma_f32_16x16x32_bf16 a[44:47], a[232:235], a[156:159], a[44:47]
    ds_read_b64_tr_b16 a[230:231], v97 offset:34816
    v_mfma_f32_16x16x32_bf16 a[48:51], a[236:239], a[144:147], a[48:51]
    v_mfma_f32_16x16x32_bf16 a[52:55], a[236:239], a[148:151], a[52:55]
    ds_read_b64_tr_b16 a[232:233], v98 offset:32768
    v_mfma_f32_16x16x32_bf16 a[56:59], a[236:239], a[152:155], a[56:59]
    v_mfma_f32_16x16x32_bf16 a[60:63], a[236:239], a[156:159], a[60:63]
    ds_read_b64_tr_b16 a[234:235], v98 offset:34816
    v_mfma_f32_16x16x32_bf16 a[64:67], a[240:243], a[144:147], a[64:67]
    buffer_load_dwordx4 v17, s[8:11], s32 offen offset:3072 lds
    v_mfma_f32_16x16x32_bf16 a[68:71], a[240:243], a[148:151], a[68:71]
    s_add_u32 s32, s32, 16384
    ds_read_b64_tr_b16 a[236:237], v99 offset:32768
    v_mfma_f32_16x16x32_bf16 a[72:75], a[240:243], a[152:155], a[72:75]
    v_mfma_f32_16x16x32_bf16 a[76:79], a[240:243], a[156:159], a[76:79]
    ds_read_b64_tr_b16 a[238:239], v99 offset:34816
    v_mfma_f32_16x16x32_bf16 a[80:83], a[244:247], a[144:147], a[80:83]
    buffer_load_dwordx4 a[128:131], v26, s[20:23], s37 offen sc1
    v_mfma_f32_16x16x32_bf16 a[84:87], a[244:247], a[148:151], a[84:87]
    ds_read_b64_tr_b16 a[240:241], v96 offset:36864
    v_mfma_f32_16x16x32_bf16 a[88:91], a[244:247], a[152:155], a[88:91]
    v_mfma_f32_16x16x32_bf16 a[92:95], a[244:247], a[156:159], a[92:95]
    ds_read_b64_tr_b16 a[242:243], v96 offset:38912
    v_mfma_f32_16x16x32_bf16 a[96:99], a[248:251], a[144:147], a[96:99]
    buffer_load_dwordx4 a[132:135], v27, s[20:23], s37 offen sc1
    v_mfma_f32_16x16x32_bf16 a[100:103], a[248:251], a[148:151], a[100:103]
    ds_read_b64_tr_b16 a[244:245], v97 offset:36864
    v_mfma_f32_16x16x32_bf16 a[104:107], a[248:251], a[152:155], a[104:107]
    v_mfma_f32_16x16x32_bf16 a[108:111], a[248:251], a[156:159], a[108:111]
    ds_read_b64_tr_b16 a[246:247], v97 offset:38912
    v_mfma_f32_16x16x32_bf16 a[112:115], a[252:255], a[144:147], a[112:115]
    buffer_load_dwordx4 a[136:139], v28, s[20:23], s37 offen sc1
    v_mfma_f32_16x16x32_bf16 a[116:119], a[252:255], a[148:151], a[116:119]
    ds_read_b64_tr_b16 a[248:249], v98 offset:36864
    v_mfma_f32_16x16x32_bf16 a[120:123], a[252:255], a[152:155], a[120:123]
    buffer_load_dwordx4 a[140:143], v29, s[20:23], s37 offen sc1
    v_mfma_f32_16x16x32_bf16 a[124:127], a[252:255], a[156:159], a[124:127]
    s_add_u32 s37, s37, 1024
    ds_read_b64_tr_b16 a[250:251], v98 offset:38912
    s_barrier
    s_waitcnt vmcnt(27)
    v_mfma_f32_16x16x32_bf16 v[128:131], a[192:195], a[160:163], v[128:131]
    s_waitcnt vmcnt(26)
    v_mfma_f32_16x16x32_bf16 v[132:135], a[192:195], a[164:167], v[132:135]
    s_waitcnt vmcnt(25)
    ds_read_b64_tr_b16 a[252:253], v99 offset:36864
    v_mfma_f32_16x16x32_bf16 v[136:139], a[192:195], a[168:171], v[136:139]
    s_waitcnt vmcnt(24)
    v_mfma_f32_16x16x32_bf16 v[140:143], a[192:195], a[172:175], v[140:143]
    ds_read_b64_tr_b16 a[254:255], v99 offset:38912
    v_mfma_f32_16x16x32_bf16 v[144:147], a[196:199], a[160:163], v[144:147]
    v_mfma_f32_16x16x32_bf16 v[148:151], a[196:199], a[164:167], v[148:151]
    s_add_u32 m0, s35, 98304
    ds_read_b64_tr_b16 a[192:193], v20 offset:49152
    v_mfma_f32_16x16x32_bf16 v[152:155], a[196:199], a[168:171], v[152:155]
    buffer_load_dwordx4 v24, s[16:19], s41 offen lds
    v_mfma_f32_16x16x32_bf16 v[156:159], a[196:199], a[172:175], v[156:159]
    ds_read_b64_tr_b16 a[194:195], v20 offset:53248
    v_mfma_f32_16x16x32_bf16 v[160:163], a[200:203], a[160:163], v[160:163]
    v_mfma_f32_16x16x32_bf16 v[164:167], a[200:203], a[164:167], v[164:167]
    ds_read_b64_tr_b16 a[196:197], v20 offset:49160
    v_mfma_f32_16x16x32_bf16 v[168:171], a[200:203], a[168:171], v[168:171]
    v_mfma_f32_16x16x32_bf16 v[172:175], a[200:203], a[172:175], v[172:175]
    s_waitcnt lgkmcnt(3)
    ds_read_b64_tr_b16 a[198:199], v20 offset:53256
    v_mfma_f32_16x16x32_bf16 v[176:179], a[204:207], a[160:163], v[176:179]
    buffer_load_dwordx4 v25, s[16:19], s41 offen offset:1024 lds
    v_mfma_f32_16x16x32_bf16 v[180:183], a[204:207], a[164:167], v[180:183]
    s_add_u32 s41, s41, 262144
    ds_read_b64_tr_b16 a[200:201], v21 offset:49152
    v_mfma_f32_16x16x32_bf16 v[184:187], a[204:207], a[168:171], v[184:187]
    v_mfma_f32_16x16x32_bf16 v[188:191], a[204:207], a[172:175], v[188:191]
    ds_read_b64_tr_b16 a[202:203], v21 offset:53248
    v_mfma_f32_16x16x32_bf16 v[192:195], a[208:211], a[160:163], v[192:195]
    v_mfma_f32_16x16x32_bf16 v[196:199], a[208:211], a[164:167], v[196:199]
    s_add_u32 m0, s35, 106496
    ds_read_b64_tr_b16 a[204:205], v21 offset:49160
    v_mfma_f32_16x16x32_bf16 v[200:203], a[208:211], a[168:171], v[200:203]
    buffer_load_dwordx4 v100, s[24:27], s38 offen lds
    v_mfma_f32_16x16x32_bf16 v[204:207], a[208:211], a[172:175], v[204:207]
    ds_read_b64_tr_b16 a[206:207], v21 offset:53256
    v_mfma_f32_16x16x32_bf16 v[208:211], a[212:215], a[160:163], v[208:211]
    v_mfma_f32_16x16x32_bf16 v[212:215], a[212:215], a[164:167], v[212:215]
    ds_read_b64_tr_b16 a[208:209], v22 offset:49152
    v_mfma_f32_16x16x32_bf16 v[216:219], a[212:215], a[168:171], v[216:219]
    v_mfma_f32_16x16x32_bf16 v[220:223], a[212:215], a[172:175], v[220:223]
    ds_read_b64_tr_b16 a[210:211], v22 offset:53248
    v_mfma_f32_16x16x32_bf16 v[224:227], a[216:219], a[160:163], v[224:227]
    buffer_load_dwordx4 v101, s[24:27], s38 offen offset:1024 lds
    v_mfma_f32_16x16x32_bf16 v[228:231], a[216:219], a[164:167], v[228:231]
    s_add_u32 s38, s38, 114688
    ds_read_b64_tr_b16 a[212:213], v22 offset:49160
    v_mfma_f32_16x16x32_bf16 v[232:235], a[216:219], a[168:171], v[232:235]
    v_mfma_f32_16x16x32_bf16 v[236:239], a[216:219], a[172:175], v[236:239]
    ds_read_b64_tr_b16 a[214:215], v22 offset:53256
    v_mfma_f32_16x16x32_bf16 v[240:243], a[220:223], a[160:163], v[240:243]
    v_mfma_f32_16x16x32_bf16 v[244:247], a[220:223], a[164:167], v[244:247]
    ds_read_b64_tr_b16 a[216:217], v23 offset:49152
    v_mfma_f32_16x16x32_bf16 v[248:251], a[220:223], a[168:171], v[248:251]
    v_mfma_f32_16x16x32_bf16 v[252:255], a[220:223], a[172:175], v[252:255]
    ds_read_b64_tr_b16 a[218:219], v23 offset:53248
    v_mfma_f32_16x16x32_bf16 a[0:3], a[224:227], a[160:163], a[0:3]
    v_mfma_f32_16x16x32_bf16 a[4:7], a[224:227], a[164:167], a[4:7]
    ds_read_b64_tr_b16 a[220:221], v23 offset:49160
    v_mfma_f32_16x16x32_bf16 a[8:11], a[224:227], a[168:171], a[8:11]
    v_mfma_f32_16x16x32_bf16 a[12:15], a[224:227], a[172:175], a[12:15]
    ds_read_b64_tr_b16 a[222:223], v23 offset:53256
    v_mfma_f32_16x16x32_bf16 a[16:19], a[228:231], a[160:163], a[16:19]
    v_mfma_f32_16x16x32_bf16 a[20:23], a[228:231], a[164:167], a[20:23]
    ds_read_b64_tr_b16 a[224:225], v96 offset:49152
    v_mfma_f32_16x16x32_bf16 a[24:27], a[228:231], a[168:171], a[24:27]
    v_mfma_f32_16x16x32_bf16 a[28:31], a[228:231], a[172:175], a[28:31]
    ds_read_b64_tr_b16 a[226:227], v96 offset:51200
    v_mfma_f32_16x16x32_bf16 a[32:35], a[232:235], a[160:163], a[32:35]
    v_mfma_f32_16x16x32_bf16 a[36:39], a[232:235], a[164:167], a[36:39]
    ds_read_b64_tr_b16 a[228:229], v97 offset:49152
    v_mfma_f32_16x16x32_bf16 a[40:43], a[232:235], a[168:171], a[40:43]
    v_mfma_f32_16x16x32_bf16 a[44:47], a[232:235], a[172:175], a[44:47]
    ds_read_b64_tr_b16 a[230:231], v97 offset:51200
    v_mfma_f32_16x16x32_bf16 a[48:51], a[236:239], a[160:163], a[48:51]
    v_mfma_f32_16x16x32_bf16 a[52:55], a[236:239], a[164:167], a[52:55]
    ds_read_b64_tr_b16 a[232:233], v98 offset:49152
    v_mfma_f32_16x16x32_bf16 a[56:59], a[236:239], a[168:171], a[56:59]
    v_mfma_f32_16x16x32_bf16 a[60:63], a[236:239], a[172:175], a[60:63]
    ds_read_b64_tr_b16 a[234:235], v98 offset:51200
    v_mfma_f32_16x16x32_bf16 a[64:67], a[240:243], a[160:163], a[64:67]
    v_mfma_f32_16x16x32_bf16 a[68:71], a[240:243], a[164:167], a[68:71]
    ds_read_b64_tr_b16 a[236:237], v99 offset:49152
    v_mfma_f32_16x16x32_bf16 a[72:75], a[240:243], a[168:171], a[72:75]
    v_mfma_f32_16x16x32_bf16 a[76:79], a[240:243], a[172:175], a[76:79]
    ds_read_b64_tr_b16 a[238:239], v99 offset:51200
    v_mfma_f32_16x16x32_bf16 a[80:83], a[244:247], a[160:163], a[80:83]
    buffer_load_dwordx4 a[144:147], v26, s[20:23], s37 offen sc1
    v_mfma_f32_16x16x32_bf16 a[84:87], a[244:247], a[164:167], a[84:87]
    ds_read_b64_tr_b16 a[240:241], v96 offset:53248
    v_mfma_f32_16x16x32_bf16 a[88:91], a[244:247], a[168:171], a[88:91]
    v_mfma_f32_16x16x32_bf16 a[92:95], a[244:247], a[172:175], a[92:95]
    ds_read_b64_tr_b16 a[242:243], v96 offset:55296
    v_mfma_f32_16x16x32_bf16 a[96:99], a[248:251], a[160:163], a[96:99]
    buffer_load_dwordx4 a[148:151], v27, s[20:23], s37 offen sc1
    v_mfma_f32_16x16x32_bf16 a[100:103], a[248:251], a[164:167], a[100:103]
    ds_read_b64_tr_b16 a[244:245], v97 offset:53248
    v_mfma_f32_16x16x32_bf16 a[104:107], a[248:251], a[168:171], a[104:107]
    v_mfma_f32_16x16x32_bf16 a[108:111], a[248:251], a[172:175], a[108:111]
    ds_read_b64_tr_b16 a[246:247], v97 offset:55296
    v_mfma_f32_16x16x32_bf16 a[112:115], a[252:255], a[160:163], a[112:115]
    buffer_load_dwordx4 a[152:155], v28, s[20:23], s37 offen sc1
    v_mfma_f32_16x16x32_bf16 a[116:119], a[252:255], a[164:167], a[116:119]
    ds_read_b64_tr_b16 a[248:249], v98 offset:53248
    v_mfma_f32_16x16x32_bf16 a[120:123], a[252:255], a[168:171], a[120:123]
    buffer_load_dwordx4 a[156:159], v29, s[20:23], s37 offen sc1
    v_mfma_f32_16x16x32_bf16 a[124:127], a[252:255], a[172:175], a[124:127]
    s_waitcnt vmcnt(23) lgkmcnt(3)
    s_add_u32 s37, s37, 1024
    ds_read_b64_tr_b16 a[250:251], v98 offset:55296
    v_mfma_f32_16x16x32_bf16 v[128:131], a[192:195], a[176:179], v[128:131]
    s_waitcnt vmcnt(22)
    v_mfma_f32_16x16x32_bf16 v[132:135], a[192:195], a[180:183], v[132:135]
    s_waitcnt vmcnt(21)
    ds_read_b64_tr_b16 a[252:253], v99 offset:53248
    v_mfma_f32_16x16x32_bf16 v[136:139], a[192:195], a[184:187], v[136:139]
    s_waitcnt vmcnt(20)
    v_mfma_f32_16x16x32_bf16 v[140:143], a[192:195], a[188:191], v[140:143]
    ds_read_b64_tr_b16 a[254:255], v99 offset:55296
    v_mfma_f32_16x16x32_bf16 v[144:147], a[196:199], a[176:179], v[144:147]
    v_add_u32 v20, 4294901760, v20
    v_add_u32 v96, 4294901760, v96
    v_add_u32 v21, 4294901760, v21
    v_add_u32 v97, 4294901760, v97
    v_add_u32 v22, 4294901760, v22
    v_add_u32 v98, 4294901760, v98
    v_add_u32 v23, 4294901760, v23
    v_add_u32 v99, 4294901760, v99
    v_mfma_f32_16x16x32_bf16 v[148:151], a[196:199], a[180:183], v[148:151]
    s_add_u32 m0, s35, 114688
    ds_read_b64_tr_b16 a[192:193], v20
    v_mfma_f32_16x16x32_bf16 v[152:155], a[196:199], a[184:187], v[152:155]
    buffer_load_dwordx4 v24, s[16:19], s41 offen lds
    v_mfma_f32_16x16x32_bf16 v[156:159], a[196:199], a[188:191], v[156:159]
    ds_read_b64_tr_b16 a[194:195], v20 offset:4096
    v_mfma_f32_16x16x32_bf16 v[160:163], a[200:203], a[176:179], v[160:163]
    v_mfma_f32_16x16x32_bf16 v[164:167], a[200:203], a[180:183], v[164:167]
    ds_read_b64_tr_b16 a[196:197], v20 offset:8
    v_mfma_f32_16x16x32_bf16 v[168:171], a[200:203], a[184:187], v[168:171]
    v_mfma_f32_16x16x32_bf16 v[172:175], a[200:203], a[188:191], v[172:175]
    ds_read_b64_tr_b16 a[198:199], v20 offset:4104
    v_mfma_f32_16x16x32_bf16 v[176:179], a[204:207], a[176:179], v[176:179]
    buffer_load_dwordx4 v25, s[16:19], s41 offen offset:1024 lds
    v_mfma_f32_16x16x32_bf16 v[180:183], a[204:207], a[180:183], v[180:183]
    s_add_u32 s41, s41, 262144
    ds_read_b64_tr_b16 a[200:201], v21
    v_mfma_f32_16x16x32_bf16 v[184:187], a[204:207], a[184:187], v[184:187]
    v_mfma_f32_16x16x32_bf16 v[188:191], a[204:207], a[188:191], v[188:191]
    ds_read_b64_tr_b16 a[202:203], v21 offset:4096
    v_mfma_f32_16x16x32_bf16 v[192:195], a[208:211], a[176:179], v[192:195]
    v_mfma_f32_16x16x32_bf16 v[196:199], a[208:211], a[180:183], v[196:199]
    s_add_u32 m0, s35, 122880
    ds_read_b64_tr_b16 a[204:205], v21 offset:8
    v_mfma_f32_16x16x32_bf16 v[200:203], a[208:211], a[184:187], v[200:203]
    buffer_load_dwordx4 v100, s[24:27], s38 offen lds
    v_mfma_f32_16x16x32_bf16 v[204:207], a[208:211], a[188:191], v[204:207]
    ds_read_b64_tr_b16 a[206:207], v21 offset:4104
    v_mfma_f32_16x16x32_bf16 v[208:211], a[212:215], a[176:179], v[208:211]
    v_mfma_f32_16x16x32_bf16 v[212:215], a[212:215], a[180:183], v[212:215]
    ds_read_b64_tr_b16 a[208:209], v22
    v_mfma_f32_16x16x32_bf16 v[216:219], a[212:215], a[184:187], v[216:219]
    v_mfma_f32_16x16x32_bf16 v[220:223], a[212:215], a[188:191], v[220:223]
    ds_read_b64_tr_b16 a[210:211], v22 offset:4096
    v_mfma_f32_16x16x32_bf16 v[224:227], a[216:219], a[176:179], v[224:227]
    buffer_load_dwordx4 v101, s[24:27], s38 offen offset:1024 lds
    v_mfma_f32_16x16x32_bf16 v[228:231], a[216:219], a[180:183], v[228:231]
    s_add_u32 s38, s38, 114688
    ds_read_b64_tr_b16 a[212:213], v22 offset:8
    v_mfma_f32_16x16x32_bf16 v[232:235], a[216:219], a[184:187], v[232:235]
    v_mfma_f32_16x16x32_bf16 v[236:239], a[216:219], a[188:191], v[236:239]
    ds_read_b64_tr_b16 a[214:215], v22 offset:4104
    v_mfma_f32_16x16x32_bf16 v[240:243], a[220:223], a[176:179], v[240:243]
    v_mfma_f32_16x16x32_bf16 v[244:247], a[220:223], a[180:183], v[244:247]
    ds_read_b64_tr_b16 a[216:217], v23
    v_mfma_f32_16x16x32_bf16 v[248:251], a[220:223], a[184:187], v[248:251]
    v_mfma_f32_16x16x32_bf16 v[252:255], a[220:223], a[188:191], v[252:255]
    ds_read_b64_tr_b16 a[218:219], v23 offset:4096
    v_mfma_f32_16x16x32_bf16 a[0:3], a[224:227], a[176:179], a[0:3]
    v_mfma_f32_16x16x32_bf16 a[4:7], a[224:227], a[180:183], a[4:7]
    ds_read_b64_tr_b16 a[220:221], v23 offset:8
    v_mfma_f32_16x16x32_bf16 a[8:11], a[224:227], a[184:187], a[8:11]
    v_mfma_f32_16x16x32_bf16 a[12:15], a[224:227], a[188:191], a[12:15]
    ds_read_b64_tr_b16 a[222:223], v23 offset:4104
    v_mfma_f32_16x16x32_bf16 a[16:19], a[228:231], a[176:179], a[16:19]
    v_mfma_f32_16x16x32_bf16 a[20:23], a[228:231], a[180:183], a[20:23]
    ds_read_b64_tr_b16 a[224:225], v96
    v_mfma_f32_16x16x32_bf16 a[24:27], a[228:231], a[184:187], a[24:27]
    v_mfma_f32_16x16x32_bf16 a[28:31], a[228:231], a[188:191], a[28:31]
    ds_read_b64_tr_b16 a[226:227], v96 offset:2048
    v_mfma_f32_16x16x32_bf16 a[32:35], a[232:235], a[176:179], a[32:35]
    v_mfma_f32_16x16x32_bf16 a[36:39], a[232:235], a[180:183], a[36:39]
    ds_read_b64_tr_b16 a[228:229], v97
    v_mfma_f32_16x16x32_bf16 a[40:43], a[232:235], a[184:187], a[40:43]
    v_mfma_f32_16x16x32_bf16 a[44:47], a[232:235], a[188:191], a[44:47]
    ds_read_b64_tr_b16 a[230:231], v97 offset:2048
    v_mfma_f32_16x16x32_bf16 a[48:51], a[236:239], a[176:179], a[48:51]
    v_mfma_f32_16x16x32_bf16 a[52:55], a[236:239], a[180:183], a[52:55]
    ds_read_b64_tr_b16 a[232:233], v98
    v_mfma_f32_16x16x32_bf16 a[56:59], a[236:239], a[184:187], a[56:59]
    v_mfma_f32_16x16x32_bf16 a[60:63], a[236:239], a[188:191], a[60:63]
    ds_read_b64_tr_b16 a[234:235], v98 offset:2048
    v_mfma_f32_16x16x32_bf16 a[64:67], a[240:243], a[176:179], a[64:67]
    v_mfma_f32_16x16x32_bf16 a[68:71], a[240:243], a[180:183], a[68:71]
    ds_read_b64_tr_b16 a[236:237], v99
    v_mfma_f32_16x16x32_bf16 a[72:75], a[240:243], a[184:187], a[72:75]
    v_mfma_f32_16x16x32_bf16 a[76:79], a[240:243], a[188:191], a[76:79]
    s_waitcnt lgkmcnt(3)
    ds_read_b64_tr_b16 a[238:239], v99 offset:2048
    v_mfma_f32_16x16x32_bf16 a[80:83], a[244:247], a[176:179], a[80:83]
    buffer_load_dwordx4 a[160:163], v26, s[20:23], s37 offen sc1
    v_mfma_f32_16x16x32_bf16 a[84:87], a[244:247], a[180:183], a[84:87]
    ds_read_b64_tr_b16 a[240:241], v96 offset:4096
    v_mfma_f32_16x16x32_bf16 a[88:91], a[244:247], a[184:187], a[88:91]
    v_mfma_f32_16x16x32_bf16 a[92:95], a[244:247], a[188:191], a[92:95]
    ds_read_b64_tr_b16 a[242:243], v96 offset:6144
    v_mfma_f32_16x16x32_bf16 a[96:99], a[248:251], a[176:179], a[96:99]
    buffer_load_dwordx4 a[164:167], v27, s[20:23], s37 offen sc1
    v_mfma_f32_16x16x32_bf16 a[100:103], a[248:251], a[180:183], a[100:103]
    ds_read_b64_tr_b16 a[244:245], v97 offset:4096
    v_mfma_f32_16x16x32_bf16 a[104:107], a[248:251], a[184:187], a[104:107]
    v_mfma_f32_16x16x32_bf16 a[108:111], a[248:251], a[188:191], a[108:111]
    ds_read_b64_tr_b16 a[246:247], v97 offset:6144
    v_mfma_f32_16x16x32_bf16 a[112:115], a[252:255], a[176:179], a[112:115]
    buffer_load_dwordx4 a[168:171], v28, s[20:23], s37 offen sc1
    v_mfma_f32_16x16x32_bf16 a[116:119], a[252:255], a[180:183], a[116:119]
    ds_read_b64_tr_b16 a[248:249], v98 offset:4096
    v_mfma_f32_16x16x32_bf16 a[120:123], a[252:255], a[184:187], a[120:123]
    buffer_load_dwordx4 a[172:175], v29, s[20:23], s37 offen sc1
    v_mfma_f32_16x16x32_bf16 a[124:127], a[252:255], a[188:191], a[124:127]
    s_add_u32 s37, s37, 1024
    ds_read_b64_tr_b16 a[250:251], v98 offset:6144
    s_barrier
    s_waitcnt vmcnt(19)
    v_mfma_f32_16x16x32_bf16 v[128:131], a[192:195], a[128:131], v[128:131]
    s_waitcnt vmcnt(18)
    v_mfma_f32_16x16x32_bf16 v[132:135], a[192:195], a[132:135], v[132:135]
    s_waitcnt vmcnt(17)
    ds_read_b64_tr_b16 a[252:253], v99 offset:4096
    v_mfma_f32_16x16x32_bf16 v[136:139], a[192:195], a[136:139], v[136:139]
    s_waitcnt vmcnt(16)
    v_mfma_f32_16x16x32_bf16 v[140:143], a[192:195], a[140:143], v[140:143]
    ds_read_b64_tr_b16 a[254:255], v99 offset:6144
    v_mfma_f32_16x16x32_bf16 v[144:147], a[196:199], a[128:131], v[144:147]
    v_mfma_f32_16x16x32_bf16 v[148:151], a[196:199], a[132:135], v[148:151]
    s_add_u32 m0, s35, 131072
    ds_read_b64_tr_b16 a[192:193], v20 offset:16384
    v_mfma_f32_16x16x32_bf16 v[152:155], a[196:199], a[136:139], v[152:155]
    buffer_load_dwordx4 v24, s[16:19], s41 offen lds
    v_mfma_f32_16x16x32_bf16 v[156:159], a[196:199], a[140:143], v[156:159]
    ds_read_b64_tr_b16 a[194:195], v20 offset:20480
    v_mfma_f32_16x16x32_bf16 v[160:163], a[200:203], a[128:131], v[160:163]
    v_mfma_f32_16x16x32_bf16 v[164:167], a[200:203], a[132:135], v[164:167]
    ds_read_b64_tr_b16 a[196:197], v20 offset:16392
    v_mfma_f32_16x16x32_bf16 v[168:171], a[200:203], a[136:139], v[168:171]
    v_mfma_f32_16x16x32_bf16 v[172:175], a[200:203], a[140:143], v[172:175]
    ds_read_b64_tr_b16 a[198:199], v20 offset:20488
    v_mfma_f32_16x16x32_bf16 v[176:179], a[204:207], a[128:131], v[176:179]
    buffer_load_dwordx4 v25, s[16:19], s41 offen offset:1024 lds
    v_mfma_f32_16x16x32_bf16 v[180:183], a[204:207], a[132:135], v[180:183]
    s_add_u32 s41, s41, 262144
    ds_read_b64_tr_b16 a[200:201], v21 offset:16384
    v_mfma_f32_16x16x32_bf16 v[184:187], a[204:207], a[136:139], v[184:187]
    v_mfma_f32_16x16x32_bf16 v[188:191], a[204:207], a[140:143], v[188:191]
    ds_read_b64_tr_b16 a[202:203], v21 offset:20480
    v_mfma_f32_16x16x32_bf16 v[192:195], a[208:211], a[128:131], v[192:195]
    v_mfma_f32_16x16x32_bf16 v[196:199], a[208:211], a[132:135], v[196:199]
    s_add_u32 m0, s35, 139264
    ds_read_b64_tr_b16 a[204:205], v21 offset:16392
    v_mfma_f32_16x16x32_bf16 v[200:203], a[208:211], a[136:139], v[200:203]
    buffer_load_dwordx4 v100, s[24:27], s38 offen lds
    v_mfma_f32_16x16x32_bf16 v[204:207], a[208:211], a[140:143], v[204:207]
    ds_read_b64_tr_b16 a[206:207], v21 offset:20488
    v_mfma_f32_16x16x32_bf16 v[208:211], a[212:215], a[128:131], v[208:211]
    v_mfma_f32_16x16x32_bf16 v[212:215], a[212:215], a[132:135], v[212:215]
    ds_read_b64_tr_b16 a[208:209], v22 offset:16384
    v_mfma_f32_16x16x32_bf16 v[216:219], a[212:215], a[136:139], v[216:219]
    v_mfma_f32_16x16x32_bf16 v[220:223], a[212:215], a[140:143], v[220:223]
    ds_read_b64_tr_b16 a[210:211], v22 offset:20480
    v_mfma_f32_16x16x32_bf16 v[224:227], a[216:219], a[128:131], v[224:227]
    buffer_load_dwordx4 v101, s[24:27], s38 offen offset:1024 lds
    v_mfma_f32_16x16x32_bf16 v[228:231], a[216:219], a[132:135], v[228:231]
    s_add_u32 s38, s38, 114688
    ds_read_b64_tr_b16 a[212:213], v22 offset:16392
    v_mfma_f32_16x16x32_bf16 v[232:235], a[216:219], a[136:139], v[232:235]
    v_mfma_f32_16x16x32_bf16 v[236:239], a[216:219], a[140:143], v[236:239]
    ds_read_b64_tr_b16 a[214:215], v22 offset:20488
    v_mfma_f32_16x16x32_bf16 v[240:243], a[220:223], a[128:131], v[240:243]
    v_mfma_f32_16x16x32_bf16 v[244:247], a[220:223], a[132:135], v[244:247]
    ds_read_b64_tr_b16 a[216:217], v23 offset:16384
    v_mfma_f32_16x16x32_bf16 v[248:251], a[220:223], a[136:139], v[248:251]
    v_mfma_f32_16x16x32_bf16 v[252:255], a[220:223], a[140:143], v[252:255]
    ds_read_b64_tr_b16 a[218:219], v23 offset:20480
    v_mfma_f32_16x16x32_bf16 a[0:3], a[224:227], a[128:131], a[0:3]
    v_mfma_f32_16x16x32_bf16 a[4:7], a[224:227], a[132:135], a[4:7]
    ds_read_b64_tr_b16 a[220:221], v23 offset:16392
    v_mfma_f32_16x16x32_bf16 a[8:11], a[224:227], a[136:139], a[8:11]
    v_mfma_f32_16x16x32_bf16 a[12:15], a[224:227], a[140:143], a[12:15]
    ds_read_b64_tr_b16 a[222:223], v23 offset:20488
    v_mfma_f32_16x16x32_bf16 a[16:19], a[228:231], a[128:131], a[16:19]
    v_mfma_f32_16x16x32_bf16 a[20:23], a[228:231], a[132:135], a[20:23]
    ds_read_b64_tr_b16 a[224:225], v96 offset:16384
    v_mfma_f32_16x16x32_bf16 a[24:27], a[228:231], a[136:139], a[24:27]
    v_mfma_f32_16x16x32_bf16 a[28:31], a[228:231], a[140:143], a[28:31]
    s_waitcnt lgkmcnt(3)
    ds_read_b64_tr_b16 a[226:227], v96 offset:18432
    v_mfma_f32_16x16x32_bf16 a[32:35], a[232:235], a[128:131], a[32:35]
    v_mfma_f32_16x16x32_bf16 a[36:39], a[232:235], a[132:135], a[36:39]
    ds_read_b64_tr_b16 a[228:229], v97 offset:16384
    v_mfma_f32_16x16x32_bf16 a[40:43], a[232:235], a[136:139], a[40:43]
    v_mfma_f32_16x16x32_bf16 a[44:47], a[232:235], a[140:143], a[44:47]
    ds_read_b64_tr_b16 a[230:231], v97 offset:18432
    v_mfma_f32_16x16x32_bf16 a[48:51], a[236:239], a[128:131], a[48:51]
    v_mfma_f32_16x16x32_bf16 a[52:55], a[236:239], a[132:135], a[52:55]
    ds_read_b64_tr_b16 a[232:233], v98 offset:16384
    v_mfma_f32_16x16x32_bf16 a[56:59], a[236:239], a[136:139], a[56:59]
    v_mfma_f32_16x16x32_bf16 a[60:63], a[236:239], a[140:143], a[60:63]
    ds_read_b64_tr_b16 a[234:235], v98 offset:18432
    v_mfma_f32_16x16x32_bf16 a[64:67], a[240:243], a[128:131], a[64:67]
    v_mfma_f32_16x16x32_bf16 a[68:71], a[240:243], a[132:135], a[68:71]
    ds_read_b64_tr_b16 a[236:237], v99 offset:16384
    v_mfma_f32_16x16x32_bf16 a[72:75], a[240:243], a[136:139], a[72:75]
    v_mfma_f32_16x16x32_bf16 a[76:79], a[240:243], a[140:143], a[76:79]
    ds_read_b64_tr_b16 a[238:239], v99 offset:18432
    v_mfma_f32_16x16x32_bf16 a[80:83], a[244:247], a[128:131], a[80:83]
    buffer_load_dwordx4 a[176:179], v26, s[20:23], s37 offen sc1
    v_mfma_f32_16x16x32_bf16 a[84:87], a[244:247], a[132:135], a[84:87]
    ds_read_b64_tr_b16 a[240:241], v96 offset:20480
    v_mfma_f32_16x16x32_bf16 a[88:91], a[244:247], a[136:139], a[88:91]
    v_mfma_f32_16x16x32_bf16 a[92:95], a[244:247], a[140:143], a[92:95]
    ds_read_b64_tr_b16 a[242:243], v96 offset:22528
    v_mfma_f32_16x16x32_bf16 a[96:99], a[248:251], a[128:131], a[96:99]
    buffer_load_dwordx4 a[180:183], v27, s[20:23], s37 offen sc1
    v_mfma_f32_16x16x32_bf16 a[100:103], a[248:251], a[132:135], a[100:103]
    ds_read_b64_tr_b16 a[244:245], v97 offset:20480
    v_mfma_f32_16x16x32_bf16 a[104:107], a[248:251], a[136:139], a[104:107]
    v_mfma_f32_16x16x32_bf16 a[108:111], a[248:251], a[140:143], a[108:111]
    ds_read_b64_tr_b16 a[246:247], v97 offset:22528
    v_mfma_f32_16x16x32_bf16 a[112:115], a[252:255], a[128:131], a[112:115]
    buffer_load_dwordx4 a[184:187], v28, s[20:23], s37 offen sc1
    v_mfma_f32_16x16x32_bf16 a[116:119], a[252:255], a[132:135], a[116:119]
    ds_read_b64_tr_b16 a[248:249], v98 offset:20480
    v_mfma_f32_16x16x32_bf16 a[120:123], a[252:255], a[136:139], a[120:123]
    buffer_load_dwordx4 a[188:191], v29, s[20:23], s37 offen sc1
    v_mfma_f32_16x16x32_bf16 a[124:127], a[252:255], a[140:143], a[124:127]
    s_waitcnt vmcnt(19)
    s_add_u32 s37, s37, 1024
    ds_read_b64_tr_b16 a[250:251], v98 offset:22528
    v_mfma_f32_16x16x32_bf16 v[128:131], a[192:195], a[144:147], v[128:131]
    s_waitcnt vmcnt(18)
    v_mfma_f32_16x16x32_bf16 v[132:135], a[192:195], a[148:151], v[132:135]
    s_waitcnt vmcnt(17)
    ds_read_b64_tr_b16 a[252:253], v99 offset:20480
    v_mfma_f32_16x16x32_bf16 v[136:139], a[192:195], a[152:155], v[136:139]
    s_waitcnt vmcnt(16)
    v_mfma_f32_16x16x32_bf16 v[140:143], a[192:195], a[156:159], v[140:143]
    ds_read_b64_tr_b16 a[254:255], v99 offset:22528
    v_mfma_f32_16x16x32_bf16 v[144:147], a[196:199], a[144:147], v[144:147]
    v_mfma_f32_16x16x32_bf16 v[148:151], a[196:199], a[148:151], v[148:151]
    s_add_u32 m0, s35, 147456
    ds_read_b64_tr_b16 a[192:193], v20 offset:32768
    v_mfma_f32_16x16x32_bf16 v[152:155], a[196:199], a[152:155], v[152:155]
    buffer_load_dwordx4 v24, s[16:19], s41 offen lds
    v_mfma_f32_16x16x32_bf16 v[156:159], a[196:199], a[156:159], v[156:159]
    ds_read_b64_tr_b16 a[194:195], v20 offset:36864
    v_mfma_f32_16x16x32_bf16 v[160:163], a[200:203], a[144:147], v[160:163]
    v_mfma_f32_16x16x32_bf16 v[164:167], a[200:203], a[148:151], v[164:167]
    ds_read_b64_tr_b16 a[196:197], v20 offset:32776
    v_mfma_f32_16x16x32_bf16 v[168:171], a[200:203], a[152:155], v[168:171]
    v_mfma_f32_16x16x32_bf16 v[172:175], a[200:203], a[156:159], v[172:175]
    ds_read_b64_tr_b16 a[198:199], v20 offset:36872
    v_mfma_f32_16x16x32_bf16 v[176:179], a[204:207], a[144:147], v[176:179]
    buffer_load_dwordx4 v25, s[16:19], s41 offen offset:1024 lds
    v_mfma_f32_16x16x32_bf16 v[180:183], a[204:207], a[148:151], v[180:183]
    s_add_u32 s41, s41, 262144
    ds_read_b64_tr_b16 a[200:201], v21 offset:32768
    v_mfma_f32_16x16x32_bf16 v[184:187], a[204:207], a[152:155], v[184:187]
    v_mfma_f32_16x16x32_bf16 v[188:191], a[204:207], a[156:159], v[188:191]
    ds_read_b64_tr_b16 a[202:203], v21 offset:36864
    v_mfma_f32_16x16x32_bf16 v[192:195], a[208:211], a[144:147], v[192:195]
    v_mfma_f32_16x16x32_bf16 v[196:199], a[208:211], a[148:151], v[196:199]
    s_add_u32 m0, s35, 155648
    ds_read_b64_tr_b16 a[204:205], v21 offset:32776
    v_mfma_f32_16x16x32_bf16 v[200:203], a[208:211], a[152:155], v[200:203]
    buffer_load_dwordx4 v100, s[24:27], s38 offen lds
    v_mfma_f32_16x16x32_bf16 v[204:207], a[208:211], a[156:159], v[204:207]
    ds_read_b64_tr_b16 a[206:207], v21 offset:36872
    v_mfma_f32_16x16x32_bf16 v[208:211], a[212:215], a[144:147], v[208:211]
    v_mfma_f32_16x16x32_bf16 v[212:215], a[212:215], a[148:151], v[212:215]
    ds_read_b64_tr_b16 a[208:209], v22 offset:32768
    v_mfma_f32_16x16x32_bf16 v[216:219], a[212:215], a[152:155], v[216:219]
    v_mfma_f32_16x16x32_bf16 v[220:223], a[212:215], a[156:159], v[220:223]
    ds_read_b64_tr_b16 a[210:211], v22 offset:36864
    v_mfma_f32_16x16x32_bf16 v[224:227], a[216:219], a[144:147], v[224:227]
    buffer_load_dwordx4 v101, s[24:27], s38 offen offset:1024 lds
    v_mfma_f32_16x16x32_bf16 v[228:231], a[216:219], a[148:151], v[228:231]
    s_add_u32 s38, s38, 114688
    ds_read_b64_tr_b16 a[212:213], v22 offset:32776
    v_mfma_f32_16x16x32_bf16 v[232:235], a[216:219], a[152:155], v[232:235]
    v_mfma_f32_16x16x32_bf16 v[236:239], a[216:219], a[156:159], v[236:239]
    s_waitcnt lgkmcnt(3)
    ds_read_b64_tr_b16 a[214:215], v22 offset:36872
    v_mfma_f32_16x16x32_bf16 v[240:243], a[220:223], a[144:147], v[240:243]
    v_mfma_f32_16x16x32_bf16 v[244:247], a[220:223], a[148:151], v[244:247]
    ds_read_b64_tr_b16 a[216:217], v23 offset:32768
    v_mfma_f32_16x16x32_bf16 v[248:251], a[220:223], a[152:155], v[248:251]
    v_mfma_f32_16x16x32_bf16 v[252:255], a[220:223], a[156:159], v[252:255]
    ds_read_b64_tr_b16 a[218:219], v23 offset:36864
    v_mfma_f32_16x16x32_bf16 a[0:3], a[224:227], a[144:147], a[0:3]
    v_mfma_f32_16x16x32_bf16 a[4:7], a[224:227], a[148:151], a[4:7]
    ds_read_b64_tr_b16 a[220:221], v23 offset:32776
    v_mfma_f32_16x16x32_bf16 a[8:11], a[224:227], a[152:155], a[8:11]
    v_mfma_f32_16x16x32_bf16 a[12:15], a[224:227], a[156:159], a[12:15]
    ds_read_b64_tr_b16 a[222:223], v23 offset:36872
    v_mfma_f32_16x16x32_bf16 a[16:19], a[228:231], a[144:147], a[16:19]
    v_mfma_f32_16x16x32_bf16 a[20:23], a[228:231], a[148:151], a[20:23]
    ds_read_b64_tr_b16 a[224:225], v96 offset:32768
    v_mfma_f32_16x16x32_bf16 a[24:27], a[228:231], a[152:155], a[24:27]
    v_mfma_f32_16x16x32_bf16 a[28:31], a[228:231], a[156:159], a[28:31]
    ds_read_b64_tr_b16 a[226:227], v96 offset:34816
    v_mfma_f32_16x16x32_bf16 a[32:35], a[232:235], a[144:147], a[32:35]
    v_mfma_f32_16x16x32_bf16 a[36:39], a[232:235], a[148:151], a[36:39]
    ds_read_b64_tr_b16 a[228:229], v97 offset:32768
    v_mfma_f32_16x16x32_bf16 a[40:43], a[232:235], a[152:155], a[40:43]
    v_mfma_f32_16x16x32_bf16 a[44:47], a[232:235], a[156:159], a[44:47]
    ds_read_b64_tr_b16 a[230:231], v97 offset:34816
    v_mfma_f32_16x16x32_bf16 a[48:51], a[236:239], a[144:147], a[48:51]
    v_mfma_f32_16x16x32_bf16 a[52:55], a[236:239], a[148:151], a[52:55]
    ds_read_b64_tr_b16 a[232:233], v98 offset:32768
    v_mfma_f32_16x16x32_bf16 a[56:59], a[236:239], a[152:155], a[56:59]
    v_mfma_f32_16x16x32_bf16 a[60:63], a[236:239], a[156:159], a[60:63]
    ds_read_b64_tr_b16 a[234:235], v98 offset:34816
    v_mfma_f32_16x16x32_bf16 a[64:67], a[240:243], a[144:147], a[64:67]
    v_mfma_f32_16x16x32_bf16 a[68:71], a[240:243], a[148:151], a[68:71]
    ds_read_b64_tr_b16 a[236:237], v99 offset:32768
    v_mfma_f32_16x16x32_bf16 a[72:75], a[240:243], a[152:155], a[72:75]
    v_mfma_f32_16x16x32_bf16 a[76:79], a[240:243], a[156:159], a[76:79]
    ds_read_b64_tr_b16 a[238:239], v99 offset:34816
    v_mfma_f32_16x16x32_bf16 a[80:83], a[244:247], a[144:147], a[80:83]
    buffer_load_dwordx4 a[128:131], v26, s[20:23], s37 offen sc1
    v_mfma_f32_16x16x32_bf16 a[84:87], a[244:247], a[148:151], a[84:87]
    ds_read_b64_tr_b16 a[240:241], v96 offset:36864
    v_mfma_f32_16x16x32_bf16 a[88:91], a[244:247], a[152:155], a[88:91]
    v_mfma_f32_16x16x32_bf16 a[92:95], a[244:247], a[156:159], a[92:95]
    ds_read_b64_tr_b16 a[242:243], v96 offset:38912
    v_mfma_f32_16x16x32_bf16 a[96:99], a[248:251], a[144:147], a[96:99]
    buffer_load_dwordx4 a[132:135], v27, s[20:23], s37 offen sc1
    v_mfma_f32_16x16x32_bf16 a[100:103], a[248:251], a[148:151], a[100:103]
    ds_read_b64_tr_b16 a[244:245], v97 offset:36864
    v_mfma_f32_16x16x32_bf16 a[104:107], a[248:251], a[152:155], a[104:107]
    v_mfma_f32_16x16x32_bf16 a[108:111], a[248:251], a[156:159], a[108:111]
    ds_read_b64_tr_b16 a[246:247], v97 offset:38912
    v_mfma_f32_16x16x32_bf16 a[112:115], a[252:255], a[144:147], a[112:115]
    buffer_load_dwordx4 a[136:139], v28, s[20:23], s37 offen sc1
    v_mfma_f32_16x16x32_bf16 a[116:119], a[252:255], a[148:151], a[116:119]
    ds_read_b64_tr_b16 a[248:249], v98 offset:36864
    v_mfma_f32_16x16x32_bf16 a[120:123], a[252:255], a[152:155], a[120:123]
    buffer_load_dwordx4 a[140:143], v29, s[20:23], s37 offen sc1
    v_mfma_f32_16x16x32_bf16 a[124:127], a[252:255], a[156:159], a[124:127]
    s_add_u32 s37, s37, 1024
    ds_read_b64_tr_b16 a[250:251], v98 offset:38912
    s_barrier
    s_waitcnt vmcnt(19)
    v_mfma_f32_16x16x32_bf16 v[128:131], a[192:195], a[160:163], v[128:131]
    s_waitcnt vmcnt(18)
    v_mfma_f32_16x16x32_bf16 v[132:135], a[192:195], a[164:167], v[132:135]
    s_waitcnt vmcnt(17)
    ds_read_b64_tr_b16 a[252:253], v99 offset:36864
    v_mfma_f32_16x16x32_bf16 v[136:139], a[192:195], a[168:171], v[136:139]
    s_waitcnt vmcnt(16)
    v_mfma_f32_16x16x32_bf16 v[140:143], a[192:195], a[172:175], v[140:143]
    ds_read_b64_tr_b16 a[254:255], v99 offset:38912
    v_mfma_f32_16x16x32_bf16 v[144:147], a[196:199], a[160:163], v[144:147]
    v_mfma_f32_16x16x32_bf16 v[148:151], a[196:199], a[164:167], v[148:151]
    ds_read_b64_tr_b16 a[192:193], v20 offset:49152
    v_mfma_f32_16x16x32_bf16 v[152:155], a[196:199], a[168:171], v[152:155]
    v_mfma_f32_16x16x32_bf16 v[156:159], a[196:199], a[172:175], v[156:159]
    ds_read_b64_tr_b16 a[194:195], v20 offset:53248
    v_mfma_f32_16x16x32_bf16 v[160:163], a[200:203], a[160:163], v[160:163]
    v_mfma_f32_16x16x32_bf16 v[164:167], a[200:203], a[164:167], v[164:167]
    ds_read_b64_tr_b16 a[196:197], v20 offset:49160
    v_mfma_f32_16x16x32_bf16 v[168:171], a[200:203], a[168:171], v[168:171]
    v_mfma_f32_16x16x32_bf16 v[172:175], a[200:203], a[172:175], v[172:175]
    ds_read_b64_tr_b16 a[198:199], v20 offset:53256
    v_mfma_f32_16x16x32_bf16 v[176:179], a[204:207], a[160:163], v[176:179]
    v_mfma_f32_16x16x32_bf16 v[180:183], a[204:207], a[164:167], v[180:183]
    ds_read_b64_tr_b16 a[200:201], v21 offset:49152
    v_mfma_f32_16x16x32_bf16 v[184:187], a[204:207], a[168:171], v[184:187]
    v_mfma_f32_16x16x32_bf16 v[188:191], a[204:207], a[172:175], v[188:191]
    s_waitcnt lgkmcnt(3)
    ds_read_b64_tr_b16 a[202:203], v21 offset:53248
    v_mfma_f32_16x16x32_bf16 v[192:195], a[208:211], a[160:163], v[192:195]
    v_mfma_f32_16x16x32_bf16 v[196:199], a[208:211], a[164:167], v[196:199]
    ds_read_b64_tr_b16 a[204:205], v21 offset:49160
    v_mfma_f32_16x16x32_bf16 v[200:203], a[208:211], a[168:171], v[200:203]
    v_mfma_f32_16x16x32_bf16 v[204:207], a[208:211], a[172:175], v[204:207]
    ds_read_b64_tr_b16 a[206:207], v21 offset:53256
    v_mfma_f32_16x16x32_bf16 v[208:211], a[212:215], a[160:163], v[208:211]
    v_mfma_f32_16x16x32_bf16 v[212:215], a[212:215], a[164:167], v[212:215]
    ds_read_b64_tr_b16 a[208:209], v22 offset:49152
    v_mfma_f32_16x16x32_bf16 v[216:219], a[212:215], a[168:171], v[216:219]
    v_mfma_f32_16x16x32_bf16 v[220:223], a[212:215], a[172:175], v[220:223]
    ds_read_b64_tr_b16 a[210:211], v22 offset:53248
    v_mfma_f32_16x16x32_bf16 v[224:227], a[216:219], a[160:163], v[224:227]
    v_mfma_f32_16x16x32_bf16 v[228:231], a[216:219], a[164:167], v[228:231]
    ds_read_b64_tr_b16 a[212:213], v22 offset:49160
    v_mfma_f32_16x16x32_bf16 v[232:235], a[216:219], a[168:171], v[232:235]
    v_mfma_f32_16x16x32_bf16 v[236:239], a[216:219], a[172:175], v[236:239]
    ds_read_b64_tr_b16 a[214:215], v22 offset:53256
    v_mfma_f32_16x16x32_bf16 v[240:243], a[220:223], a[160:163], v[240:243]
    v_mfma_f32_16x16x32_bf16 v[244:247], a[220:223], a[164:167], v[244:247]
    s_add_u32 m0, s34, 32768
    ds_read_b64_tr_b16 a[216:217], v23 offset:49152
    v_mfma_f32_16x16x32_bf16 v[248:251], a[220:223], a[168:171], v[248:251]
    buffer_load_dwordx4 v14, s[8:11], s32 offen lds
    v_mfma_f32_16x16x32_bf16 v[252:255], a[220:223], a[172:175], v[252:255]
    ds_read_b64_tr_b16 a[218:219], v23 offset:53248
    v_mfma_f32_16x16x32_bf16 a[0:3], a[224:227], a[160:163], a[0:3]
    v_mfma_f32_16x16x32_bf16 a[4:7], a[224:227], a[164:167], a[4:7]
    ds_read_b64_tr_b16 a[220:221], v23 offset:49160
    v_mfma_f32_16x16x32_bf16 a[8:11], a[224:227], a[168:171], a[8:11]
    v_mfma_f32_16x16x32_bf16 a[12:15], a[224:227], a[172:175], a[12:15]
    ds_read_b64_tr_b16 a[222:223], v23 offset:53256
    v_mfma_f32_16x16x32_bf16 a[16:19], a[228:231], a[160:163], a[16:19]
    buffer_load_dwordx4 v15, s[8:11], s32 offen offset:1024 lds
    v_mfma_f32_16x16x32_bf16 a[20:23], a[228:231], a[164:167], a[20:23]
    ds_read_b64_tr_b16 a[224:225], v96 offset:49152
    v_mfma_f32_16x16x32_bf16 a[24:27], a[228:231], a[168:171], a[24:27]
    v_mfma_f32_16x16x32_bf16 a[28:31], a[228:231], a[172:175], a[28:31]
    ds_read_b64_tr_b16 a[226:227], v96 offset:51200
    v_mfma_f32_16x16x32_bf16 a[32:35], a[232:235], a[160:163], a[32:35]
    v_mfma_f32_16x16x32_bf16 a[36:39], a[232:235], a[164:167], a[36:39]
    ds_read_b64_tr_b16 a[228:229], v97 offset:49152
    v_mfma_f32_16x16x32_bf16 a[40:43], a[232:235], a[168:171], a[40:43]
    buffer_load_dwordx4 v16, s[8:11], s32 offen offset:2048 lds
    v_mfma_f32_16x16x32_bf16 a[44:47], a[232:235], a[172:175], a[44:47]
    ds_read_b64_tr_b16 a[230:231], v97 offset:51200
    v_mfma_f32_16x16x32_bf16 a[48:51], a[236:239], a[160:163], a[48:51]
    v_mfma_f32_16x16x32_bf16 a[52:55], a[236:239], a[164:167], a[52:55]
    ds_read_b64_tr_b16 a[232:233], v98 offset:49152
    v_mfma_f32_16x16x32_bf16 a[56:59], a[236:239], a[168:171], a[56:59]
    v_mfma_f32_16x16x32_bf16 a[60:63], a[236:239], a[172:175], a[60:63]
    ds_read_b64_tr_b16 a[234:235], v98 offset:51200
    v_mfma_f32_16x16x32_bf16 a[64:67], a[240:243], a[160:163], a[64:67]
    buffer_load_dwordx4 v17, s[8:11], s32 offen offset:3072 lds
    v_mfma_f32_16x16x32_bf16 a[68:71], a[240:243], a[164:167], a[68:71]
    s_add_u32 s32, s32, 16384
    ds_read_b64_tr_b16 a[236:237], v99 offset:49152
    v_mfma_f32_16x16x32_bf16 a[72:75], a[240:243], a[168:171], a[72:75]
    v_mfma_f32_16x16x32_bf16 a[76:79], a[240:243], a[172:175], a[76:79]
    ds_read_b64_tr_b16 a[238:239], v99 offset:51200
    v_mfma_f32_16x16x32_bf16 a[80:83], a[244:247], a[160:163], a[80:83]
    buffer_load_dwordx4 a[144:147], v26, s[20:23], s37 offen sc1
    v_mfma_f32_16x16x32_bf16 a[84:87], a[244:247], a[164:167], a[84:87]
    ds_read_b64_tr_b16 a[240:241], v96 offset:53248
    v_mfma_f32_16x16x32_bf16 a[88:91], a[244:247], a[168:171], a[88:91]
    v_mfma_f32_16x16x32_bf16 a[92:95], a[244:247], a[172:175], a[92:95]
    ds_read_b64_tr_b16 a[242:243], v96 offset:55296
    v_mfma_f32_16x16x32_bf16 a[96:99], a[248:251], a[160:163], a[96:99]
    buffer_load_dwordx4 a[148:151], v27, s[20:23], s37 offen sc1
    v_mfma_f32_16x16x32_bf16 a[100:103], a[248:251], a[164:167], a[100:103]
    ds_read_b64_tr_b16 a[244:245], v97 offset:53248
    v_mfma_f32_16x16x32_bf16 a[104:107], a[248:251], a[168:171], a[104:107]
    v_mfma_f32_16x16x32_bf16 a[108:111], a[248:251], a[172:175], a[108:111]
    ds_read_b64_tr_b16 a[246:247], v97 offset:55296
    v_mfma_f32_16x16x32_bf16 a[112:115], a[252:255], a[160:163], a[112:115]
    buffer_load_dwordx4 a[152:155], v28, s[20:23], s37 offen sc1
    v_mfma_f32_16x16x32_bf16 a[116:119], a[252:255], a[164:167], a[116:119]
    ds_read_b64_tr_b16 a[248:249], v98 offset:53248
    v_mfma_f32_16x16x32_bf16 a[120:123], a[252:255], a[168:171], a[120:123]
    buffer_load_dwordx4 a[156:159], v29, s[20:23], s37 offen sc1
    v_mfma_f32_16x16x32_bf16 a[124:127], a[252:255], a[172:175], a[124:127]
    s_waitcnt vmcnt(19)
    s_add_u32 s37, s37, 1024
    ds_read_b64_tr_b16 a[250:251], v98 offset:55296
    v_mfma_f32_16x16x32_bf16 v[128:131], a[192:195], a[176:179], v[128:131]
    s_waitcnt vmcnt(18)
    v_mfma_f32_16x16x32_bf16 v[132:135], a[192:195], a[180:183], v[132:135]
    s_waitcnt vmcnt(17)
    ds_read_b64_tr_b16 a[252:253], v99 offset:53248
    v_mfma_f32_16x16x32_bf16 v[136:139], a[192:195], a[184:187], v[136:139]
    s_waitcnt vmcnt(16)
    v_mfma_f32_16x16x32_bf16 v[140:143], a[192:195], a[188:191], v[140:143]
    s_waitcnt lgkmcnt(3)
    ds_read_b64_tr_b16 a[254:255], v99 offset:55296
    v_mfma_f32_16x16x32_bf16 v[144:147], a[196:199], a[176:179], v[144:147]
    v_add_u32 v20, 65536, v20
    v_add_u32 v96, 65536, v96
    v_add_u32 v21, 65536, v21
    v_add_u32 v97, 65536, v97
    v_add_u32 v22, 65536, v22
    v_add_u32 v98, 65536, v98
    v_add_u32 v23, 65536, v23
    v_add_u32 v99, 65536, v99
    v_mfma_f32_16x16x32_bf16 v[148:151], a[196:199], a[180:183], v[148:151]
    ds_read_b64_tr_b16 a[192:193], v20
    v_mfma_f32_16x16x32_bf16 v[152:155], a[196:199], a[184:187], v[152:155]
    v_mfma_f32_16x16x32_bf16 v[156:159], a[196:199], a[188:191], v[156:159]
    ds_read_b64_tr_b16 a[194:195], v20 offset:4096
    v_mfma_f32_16x16x32_bf16 v[160:163], a[200:203], a[176:179], v[160:163]
    v_mfma_f32_16x16x32_bf16 v[164:167], a[200:203], a[180:183], v[164:167]
    ds_read_b64_tr_b16 a[196:197], v20 offset:8
    v_mfma_f32_16x16x32_bf16 v[168:171], a[200:203], a[184:187], v[168:171]
    v_mfma_f32_16x16x32_bf16 v[172:175], a[200:203], a[188:191], v[172:175]
    ds_read_b64_tr_b16 a[198:199], v20 offset:4104
    v_mfma_f32_16x16x32_bf16 v[176:179], a[204:207], a[176:179], v[176:179]
    v_mfma_f32_16x16x32_bf16 v[180:183], a[204:207], a[180:183], v[180:183]
    ds_read_b64_tr_b16 a[200:201], v21
    v_mfma_f32_16x16x32_bf16 v[184:187], a[204:207], a[184:187], v[184:187]
    v_mfma_f32_16x16x32_bf16 v[188:191], a[204:207], a[188:191], v[188:191]
    ds_read_b64_tr_b16 a[202:203], v21 offset:4096
    v_mfma_f32_16x16x32_bf16 v[192:195], a[208:211], a[176:179], v[192:195]
    v_mfma_f32_16x16x32_bf16 v[196:199], a[208:211], a[180:183], v[196:199]
    ds_read_b64_tr_b16 a[204:205], v21 offset:8
    v_mfma_f32_16x16x32_bf16 v[200:203], a[208:211], a[184:187], v[200:203]
    v_mfma_f32_16x16x32_bf16 v[204:207], a[208:211], a[188:191], v[204:207]
    ds_read_b64_tr_b16 a[206:207], v21 offset:4104
    v_mfma_f32_16x16x32_bf16 v[208:211], a[212:215], a[176:179], v[208:211]
    v_mfma_f32_16x16x32_bf16 v[212:215], a[212:215], a[180:183], v[212:215]
    ds_read_b64_tr_b16 a[208:209], v22
    v_mfma_f32_16x16x32_bf16 v[216:219], a[212:215], a[184:187], v[216:219]
    v_mfma_f32_16x16x32_bf16 v[220:223], a[212:215], a[188:191], v[220:223]
    ds_read_b64_tr_b16 a[210:211], v22 offset:4096
    v_mfma_f32_16x16x32_bf16 v[224:227], a[216:219], a[176:179], v[224:227]
    v_mfma_f32_16x16x32_bf16 v[228:231], a[216:219], a[180:183], v[228:231]
    ds_read_b64_tr_b16 a[212:213], v22 offset:8
    v_mfma_f32_16x16x32_bf16 v[232:235], a[216:219], a[184:187], v[232:235]
    v_mfma_f32_16x16x32_bf16 v[236:239], a[216:219], a[188:191], v[236:239]
    ds_read_b64_tr_b16 a[214:215], v22 offset:4104
    v_mfma_f32_16x16x32_bf16 v[240:243], a[220:223], a[176:179], v[240:243]
    v_mfma_f32_16x16x32_bf16 v[244:247], a[220:223], a[180:183], v[244:247]
    s_add_u32 m0, s34, 49152
    ds_read_b64_tr_b16 a[216:217], v23
    v_mfma_f32_16x16x32_bf16 v[248:251], a[220:223], a[184:187], v[248:251]
    buffer_load_dwordx4 v14, s[8:11], s32 offen lds
    v_mfma_f32_16x16x32_bf16 v[252:255], a[220:223], a[188:191], v[252:255]
    ds_read_b64_tr_b16 a[218:219], v23 offset:4096
    v_mfma_f32_16x16x32_bf16 a[0:3], a[224:227], a[176:179], a[0:3]
    v_mfma_f32_16x16x32_bf16 a[4:7], a[224:227], a[180:183], a[4:7]
    ds_read_b64_tr_b16 a[220:221], v23 offset:8
    v_mfma_f32_16x16x32_bf16 a[8:11], a[224:227], a[184:187], a[8:11]
    v_mfma_f32_16x16x32_bf16 a[12:15], a[224:227], a[188:191], a[12:15]
    ds_read_b64_tr_b16 a[222:223], v23 offset:4104
    v_mfma_f32_16x16x32_bf16 a[16:19], a[228:231], a[176:179], a[16:19]
    buffer_load_dwordx4 v15, s[8:11], s32 offen offset:1024 lds
    v_mfma_f32_16x16x32_bf16 a[20:23], a[228:231], a[180:183], a[20:23]
    ds_read_b64_tr_b16 a[224:225], v96
    v_mfma_f32_16x16x32_bf16 a[24:27], a[228:231], a[184:187], a[24:27]
    v_mfma_f32_16x16x32_bf16 a[28:31], a[228:231], a[188:191], a[28:31]
    ds_read_b64_tr_b16 a[226:227], v96 offset:2048
    v_mfma_f32_16x16x32_bf16 a[32:35], a[232:235], a[176:179], a[32:35]
    v_mfma_f32_16x16x32_bf16 a[36:39], a[232:235], a[180:183], a[36:39]
    ds_read_b64_tr_b16 a[228:229], v97
    v_mfma_f32_16x16x32_bf16 a[40:43], a[232:235], a[184:187], a[40:43]
    buffer_load_dwordx4 v16, s[8:11], s32 offen offset:2048 lds
    v_mfma_f32_16x16x32_bf16 a[44:47], a[232:235], a[188:191], a[44:47]
    ds_read_b64_tr_b16 a[230:231], v97 offset:2048
    v_mfma_f32_16x16x32_bf16 a[48:51], a[236:239], a[176:179], a[48:51]
    v_mfma_f32_16x16x32_bf16 a[52:55], a[236:239], a[180:183], a[52:55]
    ds_read_b64_tr_b16 a[232:233], v98
    v_mfma_f32_16x16x32_bf16 a[56:59], a[236:239], a[184:187], a[56:59]
    v_mfma_f32_16x16x32_bf16 a[60:63], a[236:239], a[188:191], a[60:63]
    ds_read_b64_tr_b16 a[234:235], v98 offset:2048
    v_mfma_f32_16x16x32_bf16 a[64:67], a[240:243], a[176:179], a[64:67]
    buffer_load_dwordx4 v17, s[8:11], s32 offen offset:3072 lds
    v_mfma_f32_16x16x32_bf16 a[68:71], a[240:243], a[180:183], a[68:71]
    s_add_u32 s32, s32, 16384
    ds_read_b64_tr_b16 a[236:237], v99
    v_mfma_f32_16x16x32_bf16 a[72:75], a[240:243], a[184:187], a[72:75]
    v_mfma_f32_16x16x32_bf16 a[76:79], a[240:243], a[188:191], a[76:79]
    ds_read_b64_tr_b16 a[238:239], v99 offset:2048
    v_mfma_f32_16x16x32_bf16 a[80:83], a[244:247], a[176:179], a[80:83]
    buffer_load_dwordx4 a[160:163], v26, s[20:23], s37 offen sc1
    v_mfma_f32_16x16x32_bf16 a[84:87], a[244:247], a[180:183], a[84:87]
    ds_read_b64_tr_b16 a[240:241], v96 offset:4096
    v_mfma_f32_16x16x32_bf16 a[88:91], a[244:247], a[184:187], a[88:91]
    v_mfma_f32_16x16x32_bf16 a[92:95], a[244:247], a[188:191], a[92:95]
    s_waitcnt lgkmcnt(3)
    ds_read_b64_tr_b16 a[242:243], v96 offset:6144
    v_mfma_f32_16x16x32_bf16 a[96:99], a[248:251], a[176:179], a[96:99]
    buffer_load_dwordx4 a[164:167], v27, s[20:23], s37 offen sc1
    v_mfma_f32_16x16x32_bf16 a[100:103], a[248:251], a[180:183], a[100:103]
    ds_read_b64_tr_b16 a[244:245], v97 offset:4096
    v_mfma_f32_16x16x32_bf16 a[104:107], a[248:251], a[184:187], a[104:107]
    v_mfma_f32_16x16x32_bf16 a[108:111], a[248:251], a[188:191], a[108:111]
    ds_read_b64_tr_b16 a[246:247], v97 offset:6144
    v_mfma_f32_16x16x32_bf16 a[112:115], a[252:255], a[176:179], a[112:115]
    buffer_load_dwordx4 a[168:171], v28, s[20:23], s37 offen sc1
    v_mfma_f32_16x16x32_bf16 a[116:119], a[252:255], a[180:183], a[116:119]
    ds_read_b64_tr_b16 a[248:249], v98 offset:4096
    v_mfma_f32_16x16x32_bf16 a[120:123], a[252:255], a[184:187], a[120:123]
    buffer_load_dwordx4 a[172:175], v29, s[20:23], s37 offen sc1
    v_mfma_f32_16x16x32_bf16 a[124:127], a[252:255], a[188:191], a[124:127]
    s_add_u32 s37, s37, 1024
    ds_read_b64_tr_b16 a[250:251], v98 offset:6144
    s_barrier
    s_waitcnt vmcnt(19)
    v_mfma_f32_16x16x32_bf16 v[128:131], a[192:195], a[128:131], v[128:131]
    s_waitcnt vmcnt(18)
    v_mfma_f32_16x16x32_bf16 v[132:135], a[192:195], a[132:135], v[132:135]
    s_waitcnt vmcnt(17)
    ds_read_b64_tr_b16 a[252:253], v99 offset:4096
    v_mfma_f32_16x16x32_bf16 v[136:139], a[192:195], a[136:139], v[136:139]
    s_waitcnt vmcnt(16)
    v_mfma_f32_16x16x32_bf16 v[140:143], a[192:195], a[140:143], v[140:143]
    ds_read_b64_tr_b16 a[254:255], v99 offset:6144
    v_mfma_f32_16x16x32_bf16 v[144:147], a[196:199], a[128:131], v[144:147]
    v_mfma_f32_16x16x32_bf16 v[148:151], a[196:199], a[132:135], v[148:151]
    ds_read_b64_tr_b16 a[192:193], v20 offset:16384
    v_mfma_f32_16x16x32_bf16 v[152:155], a[196:199], a[136:139], v[152:155]
    v_mfma_f32_16x16x32_bf16 v[156:159], a[196:199], a[140:143], v[156:159]
    ds_read_b64_tr_b16 a[194:195], v20 offset:20480
    v_mfma_f32_16x16x32_bf16 v[160:163], a[200:203], a[128:131], v[160:163]
    v_mfma_f32_16x16x32_bf16 v[164:167], a[200:203], a[132:135], v[164:167]
    ds_read_b64_tr_b16 a[196:197], v20 offset:16392
    v_mfma_f32_16x16x32_bf16 v[168:171], a[200:203], a[136:139], v[168:171]
    v_mfma_f32_16x16x32_bf16 v[172:175], a[200:203], a[140:143], v[172:175]
    ds_read_b64_tr_b16 a[198:199], v20 offset:20488
    v_mfma_f32_16x16x32_bf16 v[176:179], a[204:207], a[128:131], v[176:179]
    v_mfma_f32_16x16x32_bf16 v[180:183], a[204:207], a[132:135], v[180:183]
    ds_read_b64_tr_b16 a[200:201], v21 offset:16384
    v_mfma_f32_16x16x32_bf16 v[184:187], a[204:207], a[136:139], v[184:187]
    v_mfma_f32_16x16x32_bf16 v[188:191], a[204:207], a[140:143], v[188:191]
    ds_read_b64_tr_b16 a[202:203], v21 offset:20480
    v_mfma_f32_16x16x32_bf16 v[192:195], a[208:211], a[128:131], v[192:195]
    v_mfma_f32_16x16x32_bf16 v[196:199], a[208:211], a[132:135], v[196:199]
    ds_read_b64_tr_b16 a[204:205], v21 offset:16392
    v_mfma_f32_16x16x32_bf16 v[200:203], a[208:211], a[136:139], v[200:203]
    v_mfma_f32_16x16x32_bf16 v[204:207], a[208:211], a[140:143], v[204:207]
    ds_read_b64_tr_b16 a[206:207], v21 offset:20488
    v_mfma_f32_16x16x32_bf16 v[208:211], a[212:215], a[128:131], v[208:211]
    v_mfma_f32_16x16x32_bf16 v[212:215], a[212:215], a[132:135], v[212:215]
    ds_read_b64_tr_b16 a[208:209], v22 offset:16384
    v_mfma_f32_16x16x32_bf16 v[216:219], a[212:215], a[136:139], v[216:219]
    v_mfma_f32_16x16x32_bf16 v[220:223], a[212:215], a[140:143], v[220:223]
    ds_read_b64_tr_b16 a[210:211], v22 offset:20480
    v_mfma_f32_16x16x32_bf16 v[224:227], a[216:219], a[128:131], v[224:227]
    v_mfma_f32_16x16x32_bf16 v[228:231], a[216:219], a[132:135], v[228:231]
    ds_read_b64_tr_b16 a[212:213], v22 offset:16392
    v_mfma_f32_16x16x32_bf16 v[232:235], a[216:219], a[136:139], v[232:235]
    v_mfma_f32_16x16x32_bf16 v[236:239], a[216:219], a[140:143], v[236:239]
    ds_read_b64_tr_b16 a[214:215], v22 offset:20488
    v_mfma_f32_16x16x32_bf16 v[240:243], a[220:223], a[128:131], v[240:243]
    v_mfma_f32_16x16x32_bf16 v[244:247], a[220:223], a[132:135], v[244:247]
    s_add_u32 m0, s34, 65536
    ds_read_b64_tr_b16 a[216:217], v23 offset:16384
    v_mfma_f32_16x16x32_bf16 v[248:251], a[220:223], a[136:139], v[248:251]
    buffer_load_dwordx4 v18, s[12:15], s33 offen lds
    v_mfma_f32_16x16x32_bf16 v[252:255], a[220:223], a[140:143], v[252:255]
    ds_read_b64_tr_b16 a[218:219], v23 offset:20480
    v_mfma_f32_16x16x32_bf16 a[0:3], a[224:227], a[128:131], a[0:3]
    v_mfma_f32_16x16x32_bf16 a[4:7], a[224:227], a[132:135], a[4:7]
    ds_read_b64_tr_b16 a[220:221], v23 offset:16392
    v_mfma_f32_16x16x32_bf16 a[8:11], a[224:227], a[136:139], a[8:11]
    v_mfma_f32_16x16x32_bf16 a[12:15], a[224:227], a[140:143], a[12:15]
    ds_read_b64_tr_b16 a[222:223], v23 offset:20488
    v_mfma_f32_16x16x32_bf16 a[16:19], a[228:231], a[128:131], a[16:19]
    buffer_load_dwordx4 v19, s[12:15], s33 offen offset:1024 lds
    v_mfma_f32_16x16x32_bf16 a[20:23], a[228:231], a[132:135], a[20:23]
    ds_read_b64_tr_b16 a[224:225], v96 offset:16384
    v_mfma_f32_16x16x32_bf16 a[24:27], a[228:231], a[136:139], a[24:27]
    v_mfma_f32_16x16x32_bf16 a[28:31], a[228:231], a[140:143], a[28:31]
    ds_read_b64_tr_b16 a[226:227], v96 offset:18432
    v_mfma_f32_16x16x32_bf16 a[32:35], a[232:235], a[128:131], a[32:35]
    v_mfma_f32_16x16x32_bf16 a[36:39], a[232:235], a[132:135], a[36:39]
    ds_read_b64_tr_b16 a[228:229], v97 offset:16384
    v_mfma_f32_16x16x32_bf16 a[40:43], a[232:235], a[136:139], a[40:43]
    buffer_load_dwordx4 v18, s[12:15], s33 offen offset:2048 lds
    v_mfma_f32_16x16x32_bf16 a[44:47], a[232:235], a[140:143], a[44:47]
    s_waitcnt lgkmcnt(3)
    ds_read_b64_tr_b16 a[230:231], v97 offset:18432
    v_mfma_f32_16x16x32_bf16 a[48:51], a[236:239], a[128:131], a[48:51]
    v_mfma_f32_16x16x32_bf16 a[52:55], a[236:239], a[132:135], a[52:55]
    ds_read_b64_tr_b16 a[232:233], v98 offset:16384
    v_mfma_f32_16x16x32_bf16 a[56:59], a[236:239], a[136:139], a[56:59]
    v_mfma_f32_16x16x32_bf16 a[60:63], a[236:239], a[140:143], a[60:63]
    ds_read_b64_tr_b16 a[234:235], v98 offset:18432
    v_mfma_f32_16x16x32_bf16 a[64:67], a[240:243], a[128:131], a[64:67]
    buffer_load_dwordx4 v19, s[12:15], s33 offen offset:3072 lds
    v_mfma_f32_16x16x32_bf16 a[68:71], a[240:243], a[132:135], a[68:71]
    s_add_u32 s33, s33, 16384
    ds_read_b64_tr_b16 a[236:237], v99 offset:16384
    v_mfma_f32_16x16x32_bf16 a[72:75], a[240:243], a[136:139], a[72:75]
    v_mfma_f32_16x16x32_bf16 a[76:79], a[240:243], a[140:143], a[76:79]
    ds_read_b64_tr_b16 a[238:239], v99 offset:18432
    v_mfma_f32_16x16x32_bf16 a[80:83], a[244:247], a[128:131], a[80:83]
    buffer_load_dwordx4 a[176:179], v26, s[20:23], s37 offen sc1
    v_mfma_f32_16x16x32_bf16 a[84:87], a[244:247], a[132:135], a[84:87]
    ds_read_b64_tr_b16 a[240:241], v96 offset:20480
    v_mfma_f32_16x16x32_bf16 a[88:91], a[244:247], a[136:139], a[88:91]
    v_mfma_f32_16x16x32_bf16 a[92:95], a[244:247], a[140:143], a[92:95]
    ds_read_b64_tr_b16 a[242:243], v96 offset:22528
    v_mfma_f32_16x16x32_bf16 a[96:99], a[248:251], a[128:131], a[96:99]
    buffer_load_dwordx4 a[180:183], v27, s[20:23], s37 offen sc1
    v_mfma_f32_16x16x32_bf16 a[100:103], a[248:251], a[132:135], a[100:103]
    ds_read_b64_tr_b16 a[244:245], v97 offset:20480
    v_mfma_f32_16x16x32_bf16 a[104:107], a[248:251], a[136:139], a[104:107]
    v_mfma_f32_16x16x32_bf16 a[108:111], a[248:251], a[140:143], a[108:111]
    ds_read_b64_tr_b16 a[246:247], v97 offset:22528
    v_mfma_f32_16x16x32_bf16 a[112:115], a[252:255], a[128:131], a[112:115]
    buffer_load_dwordx4 a[184:187], v28, s[20:23], s37 offen sc1
    v_mfma_f32_16x16x32_bf16 a[116:119], a[252:255], a[132:135], a[116:119]
    ds_read_b64_tr_b16 a[248:249], v98 offset:20480
    v_mfma_f32_16x16x32_bf16 a[120:123], a[252:255], a[136:139], a[120:123]
    buffer_load_dwordx4 a[188:191], v29, s[20:23], s37 offen sc1
    v_mfma_f32_16x16x32_bf16 a[124:127], a[252:255], a[140:143], a[124:127]
    s_waitcnt vmcnt(19)
    s_add_u32 s37, s37, 1024
    ds_read_b64_tr_b16 a[250:251], v98 offset:22528
    v_mfma_f32_16x16x32_bf16 v[128:131], a[192:195], a[144:147], v[128:131]
    s_waitcnt vmcnt(18)
    v_mfma_f32_16x16x32_bf16 v[132:135], a[192:195], a[148:151], v[132:135]
    s_waitcnt vmcnt(17)
    ds_read_b64_tr_b16 a[252:253], v99 offset:20480
    v_mfma_f32_16x16x32_bf16 v[136:139], a[192:195], a[152:155], v[136:139]
    s_waitcnt vmcnt(16)
    v_mfma_f32_16x16x32_bf16 v[140:143], a[192:195], a[156:159], v[140:143]
    ds_read_b64_tr_b16 a[254:255], v99 offset:22528
    v_mfma_f32_16x16x32_bf16 v[144:147], a[196:199], a[144:147], v[144:147]
    v_mfma_f32_16x16x32_bf16 v[148:151], a[196:199], a[148:151], v[148:151]
    ds_read_b64_tr_b16 a[192:193], v20 offset:32768
    v_mfma_f32_16x16x32_bf16 v[152:155], a[196:199], a[152:155], v[152:155]
    v_mfma_f32_16x16x32_bf16 v[156:159], a[196:199], a[156:159], v[156:159]
    ds_read_b64_tr_b16 a[194:195], v20 offset:36864
    v_mfma_f32_16x16x32_bf16 v[160:163], a[200:203], a[144:147], v[160:163]
    v_mfma_f32_16x16x32_bf16 v[164:167], a[200:203], a[148:151], v[164:167]
    ds_read_b64_tr_b16 a[196:197], v20 offset:32776
    v_mfma_f32_16x16x32_bf16 v[168:171], a[200:203], a[152:155], v[168:171]
    v_mfma_f32_16x16x32_bf16 v[172:175], a[200:203], a[156:159], v[172:175]
    ds_read_b64_tr_b16 a[198:199], v20 offset:36872
    v_mfma_f32_16x16x32_bf16 v[176:179], a[204:207], a[144:147], v[176:179]
    v_mfma_f32_16x16x32_bf16 v[180:183], a[204:207], a[148:151], v[180:183]
    ds_read_b64_tr_b16 a[200:201], v21 offset:32768
    v_mfma_f32_16x16x32_bf16 v[184:187], a[204:207], a[152:155], v[184:187]
    v_mfma_f32_16x16x32_bf16 v[188:191], a[204:207], a[156:159], v[188:191]
    ds_read_b64_tr_b16 a[202:203], v21 offset:36864
    v_mfma_f32_16x16x32_bf16 v[192:195], a[208:211], a[144:147], v[192:195]
    v_mfma_f32_16x16x32_bf16 v[196:199], a[208:211], a[148:151], v[196:199]
    ds_read_b64_tr_b16 a[204:205], v21 offset:32776
    v_mfma_f32_16x16x32_bf16 v[200:203], a[208:211], a[152:155], v[200:203]
    v_mfma_f32_16x16x32_bf16 v[204:207], a[208:211], a[156:159], v[204:207]
    ds_read_b64_tr_b16 a[206:207], v21 offset:36872
    v_mfma_f32_16x16x32_bf16 v[208:211], a[212:215], a[144:147], v[208:211]
    v_mfma_f32_16x16x32_bf16 v[212:215], a[212:215], a[148:151], v[212:215]
    ds_read_b64_tr_b16 a[208:209], v22 offset:32768
    v_mfma_f32_16x16x32_bf16 v[216:219], a[212:215], a[152:155], v[216:219]
    v_mfma_f32_16x16x32_bf16 v[220:223], a[212:215], a[156:159], v[220:223]
    ds_read_b64_tr_b16 a[210:211], v22 offset:36864
    v_mfma_f32_16x16x32_bf16 v[224:227], a[216:219], a[144:147], v[224:227]
    v_mfma_f32_16x16x32_bf16 v[228:231], a[216:219], a[148:151], v[228:231]
    ds_read_b64_tr_b16 a[212:213], v22 offset:32776
    v_mfma_f32_16x16x32_bf16 v[232:235], a[216:219], a[152:155], v[232:235]
    v_mfma_f32_16x16x32_bf16 v[236:239], a[216:219], a[156:159], v[236:239]
    ds_read_b64_tr_b16 a[214:215], v22 offset:36872
    v_mfma_f32_16x16x32_bf16 v[240:243], a[220:223], a[144:147], v[240:243]
    v_mfma_f32_16x16x32_bf16 v[244:247], a[220:223], a[148:151], v[244:247]
    s_add_u32 m0, s34, 81920
    ds_read_b64_tr_b16 a[216:217], v23 offset:32768
    v_mfma_f32_16x16x32_bf16 v[248:251], a[220:223], a[152:155], v[248:251]
    buffer_load_dwordx4 v18, s[12:15], s33 offen lds
    v_mfma_f32_16x16x32_bf16 v[252:255], a[220:223], a[156:159], v[252:255]
    s_waitcnt lgkmcnt(3)
    ds_read_b64_tr_b16 a[218:219], v23 offset:36864
    v_mfma_f32_16x16x32_bf16 a[0:3], a[224:227], a[144:147], a[0:3]
    v_mfma_f32_16x16x32_bf16 a[4:7], a[224:227], a[148:151], a[4:7]
    ds_read_b64_tr_b16 a[220:221], v23 offset:32776
    v_mfma_f32_16x16x32_bf16 a[8:11], a[224:227], a[152:155], a[8:11]
    v_mfma_f32_16x16x32_bf16 a[12:15], a[224:227], a[156:159], a[12:15]
    ds_read_b64_tr_b16 a[222:223], v23 offset:36872
    v_mfma_f32_16x16x32_bf16 a[16:19], a[228:231], a[144:147], a[16:19]
    buffer_load_dwordx4 v19, s[12:15], s33 offen offset:1024 lds
    v_mfma_f32_16x16x32_bf16 a[20:23], a[228:231], a[148:151], a[20:23]
    ds_read_b64_tr_b16 a[224:225], v96 offset:32768
    v_mfma_f32_16x16x32_bf16 a[24:27], a[228:231], a[152:155], a[24:27]
    v_mfma_f32_16x16x32_bf16 a[28:31], a[228:231], a[156:159], a[28:31]
    ds_read_b64_tr_b16 a[226:227], v96 offset:34816
    v_mfma_f32_16x16x32_bf16 a[32:35], a[232:235], a[144:147], a[32:35]
    v_mfma_f32_16x16x32_bf16 a[36:39], a[232:235], a[148:151], a[36:39]
    ds_read_b64_tr_b16 a[228:229], v97 offset:32768
    v_mfma_f32_16x16x32_bf16 a[40:43], a[232:235], a[152:155], a[40:43]
    buffer_load_dwordx4 v18, s[12:15], s33 offen offset:2048 lds
    v_mfma_f32_16x16x32_bf16 a[44:47], a[232:235], a[156:159], a[44:47]
    ds_read_b64_tr_b16 a[230:231], v97 offset:34816
    v_mfma_f32_16x16x32_bf16 a[48:51], a[236:239], a[144:147], a[48:51]
    v_mfma_f32_16x16x32_bf16 a[52:55], a[236:239], a[148:151], a[52:55]
    ds_read_b64_tr_b16 a[232:233], v98 offset:32768
    v_mfma_f32_16x16x32_bf16 a[56:59], a[236:239], a[152:155], a[56:59]
    v_mfma_f32_16x16x32_bf16 a[60:63], a[236:239], a[156:159], a[60:63]
    ds_read_b64_tr_b16 a[234:235], v98 offset:34816
    v_mfma_f32_16x16x32_bf16 a[64:67], a[240:243], a[144:147], a[64:67]
    buffer_load_dwordx4 v19, s[12:15], s33 offen offset:3072 lds
    v_mfma_f32_16x16x32_bf16 a[68:71], a[240:243], a[148:151], a[68:71]
    s_add_u32 s33, s33, 16384
    ds_read_b64_tr_b16 a[236:237], v99 offset:32768
    v_mfma_f32_16x16x32_bf16 a[72:75], a[240:243], a[152:155], a[72:75]
    v_mfma_f32_16x16x32_bf16 a[76:79], a[240:243], a[156:159], a[76:79]
    ds_read_b64_tr_b16 a[238:239], v99 offset:34816
    v_mfma_f32_16x16x32_bf16 a[80:83], a[244:247], a[144:147], a[80:83]
    v_mfma_f32_16x16x32_bf16 a[84:87], a[244:247], a[148:151], a[84:87]
    ds_read_b64_tr_b16 a[240:241], v96 offset:36864
    v_mfma_f32_16x16x32_bf16 a[88:91], a[244:247], a[152:155], a[88:91]
    v_mfma_f32_16x16x32_bf16 a[92:95], a[244:247], a[156:159], a[92:95]
    ds_read_b64_tr_b16 a[242:243], v96 offset:38912
    v_mfma_f32_16x16x32_bf16 a[96:99], a[248:251], a[144:147], a[96:99]
    v_mfma_f32_16x16x32_bf16 a[100:103], a[248:251], a[148:151], a[100:103]
    ds_read_b64_tr_b16 a[244:245], v97 offset:36864
    v_mfma_f32_16x16x32_bf16 a[104:107], a[248:251], a[152:155], a[104:107]
    v_mfma_f32_16x16x32_bf16 a[108:111], a[248:251], a[156:159], a[108:111]
    ds_read_b64_tr_b16 a[246:247], v97 offset:38912
    v_mfma_f32_16x16x32_bf16 a[112:115], a[252:255], a[144:147], a[112:115]
    v_mfma_f32_16x16x32_bf16 a[116:119], a[252:255], a[148:151], a[116:119]
    ds_read_b64_tr_b16 a[248:249], v98 offset:36864
    v_mfma_f32_16x16x32_bf16 a[120:123], a[252:255], a[152:155], a[120:123]
    v_mfma_f32_16x16x32_bf16 a[124:127], a[252:255], a[156:159], a[124:127]
    ds_read_b64_tr_b16 a[250:251], v98 offset:38912
    s_barrier
    s_waitcnt vmcnt(15)
    v_mfma_f32_16x16x32_bf16 v[128:131], a[192:195], a[160:163], v[128:131]
    s_waitcnt vmcnt(14)
    v_mfma_f32_16x16x32_bf16 v[132:135], a[192:195], a[164:167], v[132:135]
    s_waitcnt vmcnt(13)
    ds_read_b64_tr_b16 a[252:253], v99 offset:36864
    v_mfma_f32_16x16x32_bf16 v[136:139], a[192:195], a[168:171], v[136:139]
    s_waitcnt vmcnt(12)
    v_mfma_f32_16x16x32_bf16 v[140:143], a[192:195], a[172:175], v[140:143]
    ds_read_b64_tr_b16 a[254:255], v99 offset:38912
    v_mfma_f32_16x16x32_bf16 v[144:147], a[196:199], a[160:163], v[144:147]
    v_mfma_f32_16x16x32_bf16 v[148:151], a[196:199], a[164:167], v[148:151]
    ds_read_b64_tr_b16 a[192:193], v20 offset:49152
    v_mfma_f32_16x16x32_bf16 v[152:155], a[196:199], a[168:171], v[152:155]
    v_mfma_f32_16x16x32_bf16 v[156:159], a[196:199], a[172:175], v[156:159]
    ds_read_b64_tr_b16 a[194:195], v20 offset:53248
    v_mfma_f32_16x16x32_bf16 v[160:163], a[200:203], a[160:163], v[160:163]
    v_mfma_f32_16x16x32_bf16 v[164:167], a[200:203], a[164:167], v[164:167]
    ds_read_b64_tr_b16 a[196:197], v20 offset:49160
    v_mfma_f32_16x16x32_bf16 v[168:171], a[200:203], a[168:171], v[168:171]
    v_mfma_f32_16x16x32_bf16 v[172:175], a[200:203], a[172:175], v[172:175]
    ds_read_b64_tr_b16 a[198:199], v20 offset:53256
    v_mfma_f32_16x16x32_bf16 v[176:179], a[204:207], a[160:163], v[176:179]
    v_mfma_f32_16x16x32_bf16 v[180:183], a[204:207], a[164:167], v[180:183]
    ds_read_b64_tr_b16 a[200:201], v21 offset:49152
    v_mfma_f32_16x16x32_bf16 v[184:187], a[204:207], a[168:171], v[184:187]
    v_mfma_f32_16x16x32_bf16 v[188:191], a[204:207], a[172:175], v[188:191]
    ds_read_b64_tr_b16 a[202:203], v21 offset:53248
    v_mfma_f32_16x16x32_bf16 v[192:195], a[208:211], a[160:163], v[192:195]
    v_mfma_f32_16x16x32_bf16 v[196:199], a[208:211], a[164:167], v[196:199]
    ds_read_b64_tr_b16 a[204:205], v21 offset:49160
    v_mfma_f32_16x16x32_bf16 v[200:203], a[208:211], a[168:171], v[200:203]
    v_mfma_f32_16x16x32_bf16 v[204:207], a[208:211], a[172:175], v[204:207]
    s_waitcnt lgkmcnt(3)
    ds_read_b64_tr_b16 a[206:207], v21 offset:53256
    v_mfma_f32_16x16x32_bf16 v[208:211], a[212:215], a[160:163], v[208:211]
    v_mfma_f32_16x16x32_bf16 v[212:215], a[212:215], a[164:167], v[212:215]
    ds_read_b64_tr_b16 a[208:209], v22 offset:49152
    v_mfma_f32_16x16x32_bf16 v[216:219], a[212:215], a[168:171], v[216:219]
    v_mfma_f32_16x16x32_bf16 v[220:223], a[212:215], a[172:175], v[220:223]
    ds_read_b64_tr_b16 a[210:211], v22 offset:53248
    v_mfma_f32_16x16x32_bf16 v[224:227], a[216:219], a[160:163], v[224:227]
    v_mfma_f32_16x16x32_bf16 v[228:231], a[216:219], a[164:167], v[228:231]
    ds_read_b64_tr_b16 a[212:213], v22 offset:49160
    v_mfma_f32_16x16x32_bf16 v[232:235], a[216:219], a[168:171], v[232:235]
    v_mfma_f32_16x16x32_bf16 v[236:239], a[216:219], a[172:175], v[236:239]
    ds_read_b64_tr_b16 a[214:215], v22 offset:53256
    v_mfma_f32_16x16x32_bf16 v[240:243], a[220:223], a[160:163], v[240:243]
    v_mfma_f32_16x16x32_bf16 v[244:247], a[220:223], a[164:167], v[244:247]
    s_add_u32 m0, s34, 98304
    ds_read_b64_tr_b16 a[216:217], v23 offset:49152
    v_mfma_f32_16x16x32_bf16 v[248:251], a[220:223], a[168:171], v[248:251]
    buffer_load_dwordx4 v18, s[12:15], s33 offen lds
    v_mfma_f32_16x16x32_bf16 v[252:255], a[220:223], a[172:175], v[252:255]
    ds_read_b64_tr_b16 a[218:219], v23 offset:53248
    v_mfma_f32_16x16x32_bf16 a[0:3], a[224:227], a[160:163], a[0:3]
    v_mfma_f32_16x16x32_bf16 a[4:7], a[224:227], a[164:167], a[4:7]
    ds_read_b64_tr_b16 a[220:221], v23 offset:49160
    v_mfma_f32_16x16x32_bf16 a[8:11], a[224:227], a[168:171], a[8:11]
    v_mfma_f32_16x16x32_bf16 a[12:15], a[224:227], a[172:175], a[12:15]
    ds_read_b64_tr_b16 a[222:223], v23 offset:53256
    v_mfma_f32_16x16x32_bf16 a[16:19], a[228:231], a[160:163], a[16:19]
    buffer_load_dwordx4 v19, s[12:15], s33 offen offset:1024 lds
    v_mfma_f32_16x16x32_bf16 a[20:23], a[228:231], a[164:167], a[20:23]
    ds_read_b64_tr_b16 a[224:225], v96 offset:49152
    v_mfma_f32_16x16x32_bf16 a[24:27], a[228:231], a[168:171], a[24:27]
    v_mfma_f32_16x16x32_bf16 a[28:31], a[228:231], a[172:175], a[28:31]
    ds_read_b64_tr_b16 a[226:227], v96 offset:51200
    v_mfma_f32_16x16x32_bf16 a[32:35], a[232:235], a[160:163], a[32:35]
    s_mov_b32 s44, 0x3e0293ee
    v_mfma_f32_16x16x32_bf16 a[36:39], a[232:235], a[164:167], a[36:39]
    ds_read_b64_tr_b16 a[228:229], v97 offset:49152
    v_mfma_f32_16x16x32_bf16 a[40:43], a[232:235], a[168:171], a[40:43]
    buffer_load_dwordx4 v18, s[12:15], s33 offen offset:2048 lds
    v_mfma_f32_16x16x32_bf16 a[44:47], a[232:235], a[172:175], a[44:47]
    ds_read_b64_tr_b16 a[230:231], v97 offset:51200
    v_mfma_f32_16x16x32_bf16 a[48:51], a[236:239], a[160:163], a[48:51]
    v_mfma_f32_16x16x32_bf16 a[52:55], a[236:239], a[164:167], a[52:55]
    ds_read_b64_tr_b16 a[232:233], v98 offset:49152
    v_mfma_f32_16x16x32_bf16 a[56:59], a[236:239], a[168:171], a[56:59]
    v_mfma_f32_16x16x32_bf16 a[60:63], a[236:239], a[172:175], a[60:63]
    ds_read_b64_tr_b16 a[234:235], v98 offset:51200
    v_mfma_f32_16x16x32_bf16 a[64:67], a[240:243], a[160:163], a[64:67]
    buffer_load_dwordx4 v19, s[12:15], s33 offen offset:3072 lds
    v_mfma_f32_16x16x32_bf16 a[68:71], a[240:243], a[164:167], a[68:71]
    s_add_u32 s33, s33, 16384
    ds_read_b64_tr_b16 a[236:237], v99 offset:49152
    v_mfma_f32_16x16x32_bf16 a[72:75], a[240:243], a[168:171], a[72:75]
    v_mfma_f32_16x16x32_bf16 a[76:79], a[240:243], a[172:175], a[76:79]
    ds_read_b64_tr_b16 a[238:239], v99 offset:51200
    v_mfma_f32_16x16x32_bf16 a[80:83], a[244:247], a[160:163], a[80:83]
    v_mfma_f32_16x16x32_bf16 a[84:87], a[244:247], a[164:167], a[84:87]
    ds_read_b64_tr_b16 a[240:241], v96 offset:53248
    v_mfma_f32_16x16x32_bf16 a[88:91], a[244:247], a[168:171], a[88:91]
    v_mfma_f32_16x16x32_bf16 a[92:95], a[244:247], a[172:175], a[92:95]
    ds_read_b64_tr_b16 a[242:243], v96 offset:55296
    v_mfma_f32_16x16x32_bf16 a[96:99], a[248:251], a[160:163], a[96:99]
    v_mfma_f32_16x16x32_bf16 a[100:103], a[248:251], a[164:167], a[100:103]
    ds_read_b64_tr_b16 a[244:245], v97 offset:53248
    v_mfma_f32_16x16x32_bf16 a[104:107], a[248:251], a[168:171], a[104:107]
    v_mfma_f32_16x16x32_bf16 a[108:111], a[248:251], a[172:175], a[108:111]
    ds_read_b64_tr_b16 a[246:247], v97 offset:55296
    v_mfma_f32_16x16x32_bf16 a[112:115], a[252:255], a[160:163], a[112:115]
    v_mfma_f32_16x16x32_bf16 a[116:119], a[252:255], a[164:167], a[116:119]
    ds_read_b64_tr_b16 a[248:249], v98 offset:53248
    v_mfma_f32_16x16x32_bf16 a[120:123], a[252:255], a[168:171], a[120:123]
    v_mfma_f32_16x16x32_bf16 a[124:127], a[252:255], a[172:175], a[124:127]
    s_waitcnt vmcnt(11)
    ds_read_b64_tr_b16 a[250:251], v98 offset:55296
    v_mfma_f32_16x16x32_bf16 v[128:131], a[192:195], a[176:179], v[128:131]
    s_waitcnt vmcnt(10)
    v_mfma_f32_16x16x32_bf16 v[132:135], a[192:195], a[180:183], v[132:135]
    s_waitcnt vmcnt(9)
    ds_read_b64_tr_b16 a[252:253], v99 offset:53248
    v_mfma_f32_16x16x32_bf16 v[136:139], a[192:195], a[184:187], v[136:139]
    s_waitcnt vmcnt(8)
    v_mfma_f32_16x16x32_bf16 v[140:143], a[192:195], a[188:191], v[140:143]
    ds_read_b64_tr_b16 a[254:255], v99 offset:55296
    v_mfma_f32_16x16x32_bf16 v[144:147], a[196:199], a[176:179], v[144:147]
    v_mfma_f32_16x16x32_bf16 v[148:151], a[196:199], a[180:183], v[148:151]
    v_mfma_f32_16x16x32_bf16 v[152:155], a[196:199], a[184:187], v[152:155]
    v_mfma_f32_16x16x32_bf16 v[156:159], a[196:199], a[188:191], v[156:159]
    s_waitcnt lgkmcnt(2)
    v_mfma_f32_16x16x32_bf16 v[160:163], a[200:203], a[176:179], v[160:163]
    v_mfma_f32_16x16x32_bf16 v[164:167], a[200:203], a[180:183], v[164:167]
    v_mfma_f32_16x16x32_bf16 v[168:171], a[200:203], a[184:187], v[168:171]
    v_mul_f32 v128, s44, v128
    v_mul_f32 v144, s44, v144
    v_mfma_f32_16x16x32_bf16 v[172:175], a[200:203], a[188:191], v[172:175]
    v_mul_f32 v129, s44, v129
    v_mul_f32 v145, s44, v145
    v_mfma_f32_16x16x32_bf16 v[176:179], a[204:207], a[176:179], v[176:179]
    v_mul_f32 v130, s44, v130
    v_mul_f32 v146, s44, v146
    v_mfma_f32_16x16x32_bf16 v[180:183], a[204:207], a[180:183], v[180:183]
    v_mul_f32 v131, s44, v131
    v_mul_f32 v147, s44, v147
    v_mfma_f32_16x16x32_bf16 v[184:187], a[204:207], a[184:187], v[184:187]
    v_cvt_pk_bf16_f32 v147, v146, v147
    v_cvt_pk_bf16_f32 v146, v144, v145
    v_mfma_f32_16x16x32_bf16 v[188:191], a[204:207], a[188:191], v[188:191]
    v_cvt_pk_bf16_f32 v145, v130, v131
    v_cvt_pk_bf16_f32 v144, v128, v129
    v_mfma_f32_16x16x32_bf16 v[192:195], a[208:211], a[176:179], v[192:195]
    v_mul_f32 v132, s44, v132
    v_mul_f32 v148, s44, v148
    v_mfma_f32_16x16x32_bf16 v[196:199], a[208:211], a[180:183], v[196:199]
    v_mul_f32 v133, s44, v133
    v_mul_f32 v149, s44, v149
    v_mfma_f32_16x16x32_bf16 v[200:203], a[208:211], a[184:187], v[200:203]
    v_mul_f32 v134, s44, v134
    v_mul_f32 v150, s44, v150
    v_mfma_f32_16x16x32_bf16 v[204:207], a[208:211], a[188:191], v[204:207]
    v_mul_f32 v135, s44, v135
    v_mul_f32 v151, s44, v151
    v_mfma_f32_16x16x32_bf16 v[208:211], a[212:215], a[176:179], v[208:211]
    v_cvt_pk_bf16_f32 v151, v150, v151
    v_cvt_pk_bf16_f32 v150, v148, v149
    v_mfma_f32_16x16x32_bf16 v[212:215], a[212:215], a[180:183], v[212:215]
    v_cvt_pk_bf16_f32 v149, v134, v135
    v_cvt_pk_bf16_f32 v148, v132, v133
    v_mfma_f32_16x16x32_bf16 v[216:219], a[212:215], a[184:187], v[216:219]
    v_mul_f32 v136, s44, v136
    v_mul_f32 v152, s44, v152
    v_mfma_f32_16x16x32_bf16 v[220:223], a[212:215], a[188:191], v[220:223]
    v_mul_f32 v137, s44, v137
    v_mul_f32 v153, s44, v153
    v_mfma_f32_16x16x32_bf16 v[224:227], a[216:219], a[176:179], v[224:227]
    v_mul_f32 v138, s44, v138
    v_mul_f32 v154, s44, v154
    v_mfma_f32_16x16x32_bf16 v[228:231], a[216:219], a[180:183], v[228:231]
    v_mul_f32 v139, s44, v139
    v_mul_f32 v155, s44, v155
    v_mfma_f32_16x16x32_bf16 v[232:235], a[216:219], a[184:187], v[232:235]
    v_cvt_pk_bf16_f32 v155, v154, v155
    v_cvt_pk_bf16_f32 v154, v152, v153
    v_mfma_f32_16x16x32_bf16 v[236:239], a[216:219], a[188:191], v[236:239]
    v_cvt_pk_bf16_f32 v153, v138, v139
    v_cvt_pk_bf16_f32 v152, v136, v137
    v_mfma_f32_16x16x32_bf16 v[240:243], a[220:223], a[176:179], v[240:243]
    v_mul_f32 v140, s44, v140
    v_mul_f32 v156, s44, v156
    v_mfma_f32_16x16x32_bf16 v[244:247], a[220:223], a[180:183], v[244:247]
    v_mul_f32 v141, s44, v141
    v_mul_f32 v157, s44, v157
    v_mfma_f32_16x16x32_bf16 v[248:251], a[220:223], a[184:187], v[248:251]
    v_mul_f32 v142, s44, v142
    v_mul_f32 v158, s44, v158
    v_mfma_f32_16x16x32_bf16 v[252:255], a[220:223], a[188:191], v[252:255]
    v_mul_f32 v143, s44, v143
    v_mul_f32 v159, s44, v159
    v_mfma_f32_16x16x32_bf16 a[0:3], a[224:227], a[176:179], a[0:3]
    v_cvt_pk_bf16_f32 v159, v158, v159
    v_cvt_pk_bf16_f32 v158, v156, v157
    v_mfma_f32_16x16x32_bf16 a[4:7], a[224:227], a[180:183], a[4:7]
    ds_read_b128 a[192:195], v2
    v_cvt_pk_bf16_f32 v157, v142, v143
    v_mfma_f32_16x16x32_bf16 a[8:11], a[224:227], a[184:187], a[8:11]
    v_cvt_pk_bf16_f32 v156, v140, v141
    v_mul_f32 v160, s44, v160
    v_mfma_f32_16x16x32_bf16 a[12:15], a[224:227], a[188:191], a[12:15]
    v_mul_f32 v176, s44, v176
    v_mul_f32 v161, s44, v161
    v_mfma_f32_16x16x32_bf16 a[16:19], a[228:231], a[176:179], a[16:19]
    v_mul_f32 v177, s44, v177
    v_mul_f32 v162, s44, v162
    v_mfma_f32_16x16x32_bf16 a[20:23], a[228:231], a[180:183], a[20:23]
    ds_read_b128 a[196:199], v3
    v_mul_f32 v178, s44, v178
    v_mfma_f32_16x16x32_bf16 a[24:27], a[228:231], a[184:187], a[24:27]
    v_mul_f32 v163, s44, v163
    v_mul_f32 v179, s44, v179
    v_mfma_f32_16x16x32_bf16 a[28:31], a[228:231], a[188:191], a[28:31]
    v_cvt_pk_bf16_f32 v179, v178, v179
    v_cvt_pk_bf16_f32 v178, v176, v177
    v_mfma_f32_16x16x32_bf16 a[32:35], a[232:235], a[176:179], a[32:35]
    v_cvt_pk_bf16_f32 v177, v162, v163
    v_cvt_pk_bf16_f32 v176, v160, v161
    v_mfma_f32_16x16x32_bf16 a[36:39], a[232:235], a[180:183], a[36:39]
    ds_read_b128 a[200:203], v4
    v_mul_f32 v164, s44, v164
    v_mfma_f32_16x16x32_bf16 a[40:43], a[232:235], a[184:187], a[40:43]
    v_mul_f32 v180, s44, v180
    v_mul_f32 v165, s44, v165
    v_mfma_f32_16x16x32_bf16 a[44:47], a[232:235], a[188:191], a[44:47]
    v_mul_f32 v181, s44, v181
    v_mul_f32 v166, s44, v166
    v_mfma_f32_16x16x32_bf16 a[48:51], a[236:239], a[176:179], a[48:51]
    v_mul_f32 v182, s44, v182
    v_mul_f32 v167, s44, v167
    v_mfma_f32_16x16x32_bf16 a[52:55], a[236:239], a[180:183], a[52:55]
    ds_read_b128 a[204:207], v5
    v_mul_f32 v183, s44, v183
    v_mfma_f32_16x16x32_bf16 a[56:59], a[236:239], a[184:187], a[56:59]
    v_cvt_pk_bf16_f32 v183, v182, v183
    v_cvt_pk_bf16_f32 v182, v180, v181
    v_mfma_f32_16x16x32_bf16 a[60:63], a[236:239], a[188:191], a[60:63]
    v_cvt_pk_bf16_f32 v181, v166, v167
    v_cvt_pk_bf16_f32 v180, v164, v165
    v_mfma_f32_16x16x32_bf16 a[64:67], a[240:243], a[176:179], a[64:67]
    v_mul_f32 v168, s44, v168
    v_mul_f32 v184, s44, v184
    v_mfma_f32_16x16x32_bf16 a[68:71], a[240:243], a[180:183], a[68:71]
    ds_read_b128 a[208:211], v2 offset:4096
    v_mul_f32 v169, s44, v169
    v_mfma_f32_16x16x32_bf16 a[72:75], a[240:243], a[184:187], a[72:75]
    v_mul_f32 v185, s44, v185
    v_mul_f32 v170, s44, v170
    v_mfma_f32_16x16x32_bf16 a[76:79], a[240:243], a[188:191], a[76:79]
    v_mul_f32 v186, s44, v186
    v_mul_f32 v171, s44, v171
    v_mfma_f32_16x16x32_bf16 a[80:83], a[244:247], a[176:179], a[80:83]
    v_mul_f32 v187, s44, v187
    v_cvt_pk_bf16_f32 v187, v186, v187
    v_mfma_f32_16x16x32_bf16 a[84:87], a[244:247], a[180:183], a[84:87]
    ds_read_b128 a[212:215], v3 offset:4096
    v_cvt_pk_bf16_f32 v186, v184, v185
    v_mfma_f32_16x16x32_bf16 a[88:91], a[244:247], a[184:187], a[88:91]
    v_cvt_pk_bf16_f32 v185, v170, v171
    v_cvt_pk_bf16_f32 v184, v168, v169
    v_mfma_f32_16x16x32_bf16 a[92:95], a[244:247], a[188:191], a[92:95]
    v_mul_f32 v172, s44, v172
    v_mul_f32 v188, s44, v188
    v_mfma_f32_16x16x32_bf16 a[96:99], a[248:251], a[176:179], a[96:99]
    v_mul_f32 v173, s44, v173
    v_mul_f32 v189, s44, v189
    v_mfma_f32_16x16x32_bf16 a[100:103], a[248:251], a[180:183], a[100:103]
    ds_read_b128 a[216:219], v4 offset:4096
    v_mul_f32 v174, s44, v174
    v_mfma_f32_16x16x32_bf16 a[104:107], a[248:251], a[184:187], a[104:107]
    v_mul_f32 v190, s44, v190
    v_mul_f32 v175, s44, v175
    v_mfma_f32_16x16x32_bf16 a[108:111], a[248:251], a[188:191], a[108:111]
    s_waitcnt lgkmcnt(2)
    v_mul_f32 v191, s44, v191
    v_cvt_pk_bf16_f32 v191, v190, v191
    v_mfma_f32_16x16x32_bf16 a[112:115], a[252:255], a[176:179], a[112:115]
    v_cvt_pk_bf16_f32 v190, v188, v189
    v_cvt_pk_bf16_f32 v189, v174, v175
    v_mfma_f32_16x16x32_bf16 a[116:119], a[252:255], a[180:183], a[116:119]
    ds_read_b128 a[220:223], v5 offset:4096
    v_cvt_pk_bf16_f32 v188, v172, v173
    v_mfma_f32_16x16x32_bf16 a[120:123], a[252:255], a[184:187], a[120:123]
    v_mfma_f32_16x16x32_bf16 a[124:127], a[252:255], a[188:191], a[124:127]
    s_lshl_b32 s60, s2, 2
    s_add_u32 s60, s60, s3
    s_cmp_lt_u32 s60, 512
    s_cselect_b32 s72, s50, s56
    s_cselect_b32 s73, s51, s57
    s_mov_b32 s74, 1835008
    s_cselect_b32 s74, 4194304, s74
    s_mov_b32 s75, 0x00020000
    s_and_b32 s61, s60, 511
    s_lshl_b32 s61, s61, 13
    s_add_u32 s61, s61, 384
    v_lshrrev_b32 v172, 3, v1
    v_lshlrev_b32 v172, 10, v172
    v_and_b32 v173, 7, v1
    v_lshl_add_u32 v172, v173, 4, v172
    v_mov_b32 v171, v172
    buffer_load_dwordx4 v[172:175], v171, s[72:75], s61 offen
    v_mov_b32 v128, 0
    v_mov_b32 v129, 0
    v_mov_b32 v130, 0
    v_mov_b32 v131, 0
    v_mov_b32 v132, 0
    v_mov_b32 v133, 0
    v_mov_b32 v134, 0
    v_mov_b32 v135, 0
    v_mov_b32 v136, 0
    v_mov_b32 v137, 0
    v_mov_b32 v138, 0
    v_mov_b32 v139, 0
    v_mov_b32 v140, 0
    v_mov_b32 v141, 0
    v_mov_b32 v142, 0
    v_mov_b32 v143, 0
    v_mov_b32 v160, 0x3f803f80
    v_mov_b32 v161, 0x3f803f80
    v_mov_b32 v162, 0x3f803f80
    v_mov_b32 v163, 0x3f803f80
    v_mfma_f32_16x16x32_bf16 v[32:35], a[192:195], v[144:147], 0
    v_mul_f32 v192, s44, v192
    v_mul_f32 v208, s44, v208
    v_mul_f32 v193, s44, v193
    v_mfma_f32_16x16x32_bf16 v[36:39], a[192:195], v[148:151], 0
    v_mul_f32 v209, s44, v209
    v_mul_f32 v194, s44, v194
    v_mul_f32 v210, s44, v210
    v_mfma_f32_16x16x32_bf16 v[40:43], a[192:195], v[152:155], 0
    v_mul_f32 v195, s44, v195
    v_mul_f32 v211, s44, v211
    v_cvt_pk_bf16_f32 v211, v210, v211
    v_mfma_f32_16x16x32_bf16 v[44:47], a[192:195], v[156:159], 0
    v_cvt_pk_bf16_f32 v210, v208, v209
    v_cvt_pk_bf16_f32 v209, v194, v195
    v_cvt_pk_bf16_f32 v208, v192, v193
    v_mfma_f32_16x16x32_bf16 v[48:51], a[208:211], v[144:147], 0
    v_mul_f32 v196, s44, v196
    v_mul_f32 v212, s44, v212
    v_mul_f32 v197, s44, v197
    v_mfma_f32_16x16x32_bf16 v[52:55], a[208:211], v[148:151], 0
    v_mul_f32 v213, s44, v213
    v_mul_f32 v198, s44, v198
    v_mul_f32 v214, s44, v214
    v_mfma_f32_16x16x32_bf16 v[56:59], a[208:211], v[152:155], 0
    v_mul_f32 v199, s44, v199
    v_mul_f32 v215, s44, v215
    v_cvt_pk_bf16_f32 v215, v214, v215
    v_mfma_f32_16x16x32_bf16 v[60:63], a[208:211], v[156:159], 0
    v_cvt_pk_bf16_f32 v214, v212, v213
    v_cvt_pk_bf16_f32 v213, v198, v199
    v_cvt_pk_bf16_f32 v212, v196, v197
    v_mfma_f32_16x16x32_bf16 v[32:35], a[196:199], v[176:179], v[32:35]
    v_mul_f32 v200, s44, v200
    v_mul_f32 v216, s44, v216
    v_mul_f32 v201, s44, v201
    v_mfma_f32_16x16x32_bf16 v[36:39], a[196:199], v[180:183], v[36:39]
    v_mul_f32 v217, s44, v217
    v_mul_f32 v202, s44, v202
    v_mul_f32 v218, s44, v218
    v_mfma_f32_16x16x32_bf16 v[40:43], a[196:199], v[184:187], v[40:43]
    v_mul_f32 v203, s44, v203
    v_mul_f32 v219, s44, v219
    v_cvt_pk_bf16_f32 v219, v218, v219
    v_mfma_f32_16x16x32_bf16 v[44:47], a[196:199], v[188:191], v[44:47]
    s_waitcnt lgkmcnt(0)
    v_cvt_pk_bf16_f32 v218, v216, v217
    v_cvt_pk_bf16_f32 v217, v202, v203
    v_cvt_pk_bf16_f32 v216, v200, v201
    v_mfma_f32_16x16x32_bf16 v[48:51], a[212:215], v[176:179], v[48:51]
    v_mul_f32 v204, s44, v204
    v_mul_f32 v220, s44, v220
    v_mul_f32 v205, s44, v205
    v_mfma_f32_16x16x32_bf16 v[52:55], a[212:215], v[180:183], v[52:55]
    v_mul_f32 v221, s44, v221
    v_mul_f32 v206, s44, v206
    v_mul_f32 v222, s44, v222
    v_mfma_f32_16x16x32_bf16 v[56:59], a[212:215], v[184:187], v[56:59]
    v_mul_f32 v207, s44, v207
    v_mul_f32 v223, s44, v223
    v_cvt_pk_bf16_f32 v223, v222, v223
    v_mfma_f32_16x16x32_bf16 v[60:63], a[212:215], v[188:191], v[60:63]
    v_cvt_pk_bf16_f32 v222, v220, v221
    v_cvt_pk_bf16_f32 v221, v206, v207
    v_cvt_pk_bf16_f32 v220, v204, v205
    v_mfma_f32_16x16x32_bf16 v[32:35], a[200:203], v[208:211], v[32:35]
    v_mul_f32 v224, s44, v224
    v_mul_f32 v240, s44, v240
    v_mul_f32 v225, s44, v225
    v_mul_f32 v241, s44, v241
    v_mul_f32 v226, s44, v226
    v_mul_f32 v242, s44, v242
    v_mfma_f32_16x16x32_bf16 v[36:39], a[200:203], v[212:215], v[36:39]
    v_mul_f32 v227, s44, v227
    v_mul_f32 v243, s44, v243
    v_cvt_pk_bf16_f32 v243, v242, v243
    v_cvt_pk_bf16_f32 v242, v240, v241
    v_cvt_pk_bf16_f32 v241, v226, v227
    v_cvt_pk_bf16_f32 v240, v224, v225
    v_mfma_f32_16x16x32_bf16 v[40:43], a[200:203], v[216:219], v[40:43]
    v_mul_f32 v228, s44, v228
    v_mul_f32 v244, s44, v244
    v_mul_f32 v229, s44, v229
    v_mul_f32 v245, s44, v245
    v_mul_f32 v230, s44, v230
    v_mul_f32 v246, s44, v246
    v_mfma_f32_16x16x32_bf16 v[44:47], a[200:203], v[220:223], v[44:47]
    v_mul_f32 v231, s44, v231
    v_mul_f32 v247, s44, v247
    v_cvt_pk_bf16_f32 v247, v246, v247
    v_cvt_pk_bf16_f32 v246, v244, v245
    v_cvt_pk_bf16_f32 v245, v230, v231
    v_cvt_pk_bf16_f32 v244, v228, v229
    v_mfma_f32_16x16x32_bf16 v[48:51], a[216:219], v[208:211], v[48:51]
    v_mul_f32 v232, s44, v232
    v_mul_f32 v248, s44, v248
    v_mul_f32 v233, s44, v233
    v_mul_f32 v249, s44, v249
    v_mul_f32 v234, s44, v234
    v_mul_f32 v250, s44, v250
    v_mfma_f32_16x16x32_bf16 v[52:55], a[216:219], v[212:215], v[52:55]
    v_mul_f32 v235, s44, v235
    v_mul_f32 v251, s44, v251
    v_cvt_pk_bf16_f32 v251, v250, v251
    v_cvt_pk_bf16_f32 v250, v248, v249
    v_cvt_pk_bf16_f32 v249, v234, v235
    v_cvt_pk_bf16_f32 v248, v232, v233
    v_mfma_f32_16x16x32_bf16 v[56:59], a[216:219], v[216:219], v[56:59]
    v_mul_f32 v236, s44, v236
    v_mul_f32 v252, s44, v252
    v_mul_f32 v237, s44, v237
    v_mul_f32 v253, s44, v253
    v_mul_f32 v238, s44, v238
    v_mul_f32 v254, s44, v254
    v_mfma_f32_16x16x32_bf16 v[60:63], a[216:219], v[220:223], v[60:63]
    v_mul_f32 v239, s44, v239
    v_mul_f32 v255, s44, v255
    v_cvt_pk_bf16_f32 v255, v254, v255
    v_cvt_pk_bf16_f32 v254, v252, v253
    v_cvt_pk_bf16_f32 v253, v238, v239
    v_cvt_pk_bf16_f32 v252, v236, v237
    s_nop 1
    v_mfma_f32_16x16x32_bf16 v[32:35], a[204:207], v[240:243], v[32:35]
    v_mfma_f32_16x16x32_bf16 v[36:39], a[204:207], v[244:247], v[36:39]
    v_mfma_f32_16x16x32_bf16 v[40:43], a[204:207], v[248:251], v[40:43]
    v_mfma_f32_16x16x32_bf16 v[44:47], a[204:207], v[252:255], v[44:47]
    v_mfma_f32_16x16x32_bf16 v[48:51], a[220:223], v[240:243], v[48:51]
    v_mfma_f32_16x16x32_bf16 v[52:55], a[220:223], v[244:247], v[52:55]
    v_mfma_f32_16x16x32_bf16 v[56:59], a[220:223], v[248:251], v[56:59]
    v_mfma_f32_16x16x32_bf16 v[60:63], a[220:223], v[252:255], v[60:63]
    s_mov_b32 s44, 0
    s_mov_b32 s45, 57344
    s_mov_b32 s46, 114688
    s_mov_b32 s47, 172032
    v_accvgpr_read_b32 v64, a0
    v_accvgpr_read_b32 v68, a64
    v_accvgpr_read_b32 v65, a1
    v_accvgpr_read_b32 v69, a65
    v_accvgpr_read_b32 v66, a2
    v_accvgpr_read_b32 v70, a66
    v_accvgpr_read_b32 v67, a3
    v_accvgpr_read_b32 v71, a67
    v_accvgpr_read_b32 v72, a16
    v_accvgpr_read_b32 v76, a80
    v_accvgpr_read_b32 v73, a17
    v_accvgpr_read_b32 v77, a81
    v_accvgpr_read_b32 v74, a18
    v_accvgpr_read_b32 v78, a82
    v_accvgpr_read_b32 v75, a19
    v_accvgpr_read_b32 v79, a83
    v_max_f32 v64, 0, v64
    v_max_f32 v65, 0, v65
    v_max_f32 v66, 0, v66
    v_max_f32 v67, 0, v67
    v_max_f32 v72, 0, v72
    v_max_f32 v73, 0, v73
    v_max_f32 v74, 0, v74
    v_max_f32 v75, 0, v75
    v_mul_f32 v64, v64, v68
    v_mul_f32 v65, v65, v69
    v_mul_f32 v66, v66, v70
    v_mul_f32 v67, v67, v71
    v_mul_f32 v72, v72, v76
    v_mul_f32 v73, v73, v77
    v_mul_f32 v74, v74, v78
    v_mul_f32 v75, v75, v79
    v_cvt_pk_bf16_f32 v104, v64, v65
    v_cvt_pk_bf16_f32 v105, v66, v67
    v_cvt_pk_bf16_f32 v106, v72, v73
    v_cvt_pk_bf16_f32 v107, v74, v75
    buffer_store_dwordx4 v[104:107], v30, s[28:31], s44 offen sc1
    v_accvgpr_read_b32 v80, a32
    v_accvgpr_read_b32 v84, a96
    v_accvgpr_read_b32 v81, a33
    v_accvgpr_read_b32 v85, a97
    v_accvgpr_read_b32 v82, a34
    v_accvgpr_read_b32 v86, a98
    v_accvgpr_read_b32 v83, a35
    v_accvgpr_read_b32 v87, a99
    v_accvgpr_read_b32 v88, a48
    v_accvgpr_read_b32 v92, a112
    v_accvgpr_read_b32 v89, a49
    v_accvgpr_read_b32 v93, a113
    v_accvgpr_read_b32 v90, a50
    v_accvgpr_read_b32 v94, a114
    v_accvgpr_read_b32 v91, a51
    v_accvgpr_read_b32 v95, a115
    v_max_f32 v80, 0, v80
    v_max_f32 v81, 0, v81
    v_max_f32 v82, 0, v82
    v_max_f32 v83, 0, v83
    v_max_f32 v88, 0, v88
    v_max_f32 v89, 0, v89
    v_max_f32 v90, 0, v90
    v_max_f32 v91, 0, v91
    v_mul_f32 v80, v80, v84
    v_mul_f32 v81, v81, v85
    v_mul_f32 v82, v82, v86
    v_mul_f32 v83, v83, v87
    v_mul_f32 v88, v88, v92
    v_mul_f32 v89, v89, v93
    v_mul_f32 v90, v90, v94
    v_mul_f32 v91, v91, v95
    v_cvt_pk_bf16_f32 v108, v80, v81
    v_cvt_pk_bf16_f32 v109, v82, v83
    v_cvt_pk_bf16_f32 v110, v88, v89
    v_cvt_pk_bf16_f32 v111, v90, v91
    buffer_store_dwordx4 v[108:111], v30, s[28:31], s44 offen offset:1024 sc1
    v_max3_f32 v112, v32, v33, v34
    v_max3_f32 v112, v112, v35, v48
    v_max3_f32 v112, v112, v49, v50
    v_max_f32 v112, v112, v51
    v_max3_f32 v113, v36, v37, v38
    v_max3_f32 v113, v113, v39, v52
    v_max3_f32 v113, v113, v53, v54
    v_max_f32 v113, v113, v55
    v_max3_f32 v114, v40, v41, v42
    v_max3_f32 v114, v114, v43, v56
    v_max3_f32 v114, v114, v57, v58
    v_max_f32 v114, v114, v59
    v_max3_f32 v115, v44, v45, v46
    v_max3_f32 v115, v115, v47, v60
    v_max3_f32 v115, v115, v61, v62
    v_max_f32 v115, v115, v63
    v_mov_b32 v116, v112
    v_mov_b32 v117, v113
    v_mov_b32 v118, v114
    v_mov_b32 v119, v115
    v_accvgpr_read_b32 v64, a4
    v_accvgpr_read_b32 v68, a68
    v_permlane16_swap_b32 v116, v112
    v_permlane16_swap_b32 v117, v113
    v_permlane16_swap_b32 v118, v114
    v_permlane16_swap_b32 v119, v115
    v_accvgpr_read_b32 v65, a5
    v_accvgpr_read_b32 v69, a69
    v_max_f32 v112, v112, v116
    v_max_f32 v113, v113, v117
    v_max_f32 v114, v114, v118
    v_max_f32 v115, v115, v119
    v_mov_b32 v116, v112
    v_mov_b32 v117, v113
    v_mov_b32 v118, v114
    v_mov_b32 v119, v115
    v_accvgpr_read_b32 v66, a6
    v_accvgpr_read_b32 v70, a70
    v_permlane32_swap_b32 v116, v112
    v_permlane32_swap_b32 v117, v113
    v_permlane32_swap_b32 v118, v114
    v_permlane32_swap_b32 v119, v115
    v_accvgpr_read_b32 v67, a7
    v_accvgpr_read_b32 v71, a71
    v_max_f32 v112, v112, v116
    v_max_f32 v113, v113, v117
    v_max_f32 v114, v114, v118
    v_max_f32 v115, v115, v119
    v_sub_f32 v112, 0xc2200000, v112
    v_sub_f32 v113, 0xc2200000, v113
    v_sub_f32 v114, 0xc2200000, v114
    v_sub_f32 v115, 0xc2200000, v115
    v_accvgpr_read_b32 v72, a20
    v_accvgpr_read_b32 v76, a84
    v_accvgpr_read_b32 v73, a21
    v_accvgpr_read_b32 v77, a85
    v_accvgpr_read_b32 v74, a22
    v_accvgpr_read_b32 v78, a86
    v_accvgpr_read_b32 v75, a23
    v_accvgpr_read_b32 v79, a87
    v_max_f32 v64, 0, v64
    v_max_f32 v65, 0, v65
    v_max_f32 v66, 0, v66
    v_max_f32 v67, 0, v67
    v_max_f32 v72, 0, v72
    v_max_f32 v73, 0, v73
    v_max_f32 v74, 0, v74
    v_max_f32 v75, 0, v75
    v_mul_f32 v64, v64, v68
    v_mul_f32 v65, v65, v69
    v_mul_f32 v66, v66, v70
    v_mul_f32 v67, v67, v71
    v_mul_f32 v72, v72, v76
    v_mul_f32 v73, v73, v77
    v_mul_f32 v74, v74, v78
    v_mul_f32 v75, v75, v79
    v_cvt_pk_bf16_f32 v104, v64, v65
    v_cvt_pk_bf16_f32 v105, v66, v67
    v_cvt_pk_bf16_f32 v106, v72, v73
    v_cvt_pk_bf16_f32 v107, v74, v75
    buffer_store_dwordx4 v[104:107], v30, s[28:31], s45 offen sc1
    v_accvgpr_read_b32 v80, a36
    v_accvgpr_read_b32 v84, a100
    v_accvgpr_read_b32 v81, a37
    v_accvgpr_read_b32 v85, a101
    v_accvgpr_read_b32 v82, a38
    v_accvgpr_read_b32 v86, a102
    v_accvgpr_read_b32 v83, a39
    v_accvgpr_read_b32 v87, a103
    v_accvgpr_read_b32 v88, a52
    v_accvgpr_read_b32 v92, a116
    v_accvgpr_read_b32 v89, a53
    v_accvgpr_read_b32 v93, a117
    v_accvgpr_read_b32 v90, a54
    v_accvgpr_read_b32 v94, a118
    v_accvgpr_read_b32 v91, a55
    v_accvgpr_read_b32 v95, a119
    v_max_f32 v80, 0, v80
    v_max_f32 v81, 0, v81
    v_max_f32 v82, 0, v82
    v_max_f32 v83, 0, v83
    v_max_f32 v88, 0, v88
    v_max_f32 v89, 0, v89
    v_max_f32 v90, 0, v90
    v_max_f32 v91, 0, v91
    v_mul_f32 v80, v80, v84
    v_mul_f32 v81, v81, v85
    v_mul_f32 v82, v82, v86
    v_mul_f32 v83, v83, v87
    v_mul_f32 v88, v88, v92
    v_mul_f32 v89, v89, v93
    v_mul_f32 v90, v90, v94
    v_mul_f32 v91, v91, v95
    v_cvt_pk_bf16_f32 v108, v80, v81
    v_cvt_pk_bf16_f32 v109, v82, v83
    v_cvt_pk_bf16_f32 v110, v88, v89
    v_cvt_pk_bf16_f32 v111, v90, v91
    buffer_store_dwordx4 v[108:111], v30, s[28:31], s45 offen offset:1024 sc1
    v_accvgpr_read_b32 v64, a8
    v_accvgpr_read_b32 v68, a72
    v_accvgpr_read_b32 v65, a9
    v_accvgpr_read_b32 v69, a73
    v_accvgpr_read_b32 v66, a10
    v_accvgpr_read_b32 v70, a74
    v_accvgpr_read_b32 v67, a11
    v_accvgpr_read_b32 v71, a75
    v_accvgpr_read_b32 v72, a24
    v_accvgpr_read_b32 v76, a88
    v_accvgpr_read_b32 v73, a25
    v_accvgpr_read_b32 v77, a89
    v_accvgpr_read_b32 v74, a26
    v_accvgpr_read_b32 v78, a90
    v_accvgpr_read_b32 v75, a27
    v_accvgpr_read_b32 v79, a91
    v_max_f32 v64, 0, v64
    v_max_f32 v65, 0, v65
    v_max_f32 v66, 0, v66
    v_max_f32 v67, 0, v67
    v_max_f32 v72, 0, v72
    v_max_f32 v73, 0, v73
    v_max_f32 v74, 0, v74
    v_max_f32 v75, 0, v75
    v_mul_f32 v64, v64, v68
    v_mul_f32 v65, v65, v69
    v_mul_f32 v66, v66, v70
    v_mul_f32 v67, v67, v71
    v_mul_f32 v72, v72, v76
    v_mul_f32 v73, v73, v77
    v_mul_f32 v74, v74, v78
    v_mul_f32 v75, v75, v79
    v_cvt_pk_bf16_f32 v104, v64, v65
    v_cvt_pk_bf16_f32 v105, v66, v67
    v_cvt_pk_bf16_f32 v106, v72, v73
    v_cvt_pk_bf16_f32 v107, v74, v75
    buffer_store_dwordx4 v[104:107], v30, s[28:31], s46 offen sc1
    v_accvgpr_read_b32 v80, a40
    v_accvgpr_read_b32 v84, a104
    v_accvgpr_read_b32 v81, a41
    v_accvgpr_read_b32 v85, a105
    v_accvgpr_read_b32 v82, a42
    v_accvgpr_read_b32 v86, a106
    v_accvgpr_read_b32 v83, a43
    v_accvgpr_read_b32 v87, a107
    v_accvgpr_read_b32 v88, a56
    v_accvgpr_read_b32 v92, a120
    v_accvgpr_read_b32 v89, a57
    v_accvgpr_read_b32 v93, a121
    v_accvgpr_read_b32 v90, a58
    v_accvgpr_read_b32 v94, a122
    v_accvgpr_read_b32 v91, a59
    v_accvgpr_read_b32 v95, a123
    v_max_f32 v80, 0, v80
    v_max_f32 v81, 0, v81
    v_max_f32 v82, 0, v82
    v_max_f32 v83, 0, v83
    v_max_f32 v88, 0, v88
    v_max_f32 v89, 0, v89
    v_max_f32 v90, 0, v90
    v_max_f32 v91, 0, v91
    v_mul_f32 v80, v80, v84
    v_mul_f32 v81, v81, v85
    v_mul_f32 v82, v82, v86
    v_mul_f32 v83, v83, v87
    v_mul_f32 v88, v88, v92
    v_mul_f32 v89, v89, v93
    v_mul_f32 v90, v90, v94
    v_mul_f32 v91, v91, v95
    v_cvt_pk_bf16_f32 v108, v80, v81
    v_cvt_pk_bf16_f32 v109, v82, v83
    v_cvt_pk_bf16_f32 v110, v88, v89
    v_cvt_pk_bf16_f32 v111, v90, v91
    buffer_store_dwordx4 v[108:111], v30, s[28:31], s46 offen offset:1024 sc1
    v_accvgpr_read_b32 v64, a12
    v_accvgpr_read_b32 v68, a76
    v_accvgpr_read_b32 v65, a13
    v_accvgpr_read_b32 v69, a77
    v_accvgpr_read_b32 v66, a14
    v_accvgpr_read_b32 v70, a78
    v_accvgpr_read_b32 v67, a15
    v_accvgpr_read_b32 v71, a79
    v_accvgpr_read_b32 v72, a28
    v_accvgpr_read_b32 v76, a92
    v_accvgpr_read_b32 v73, a29
    v_accvgpr_read_b32 v77, a93
    v_accvgpr_read_b32 v74, a30
    v_accvgpr_read_b32 v78, a94
    v_accvgpr_read_b32 v75, a31
    v_accvgpr_read_b32 v79, a95
    v_max_f32 v64, 0, v64
    v_max_f32 v65, 0, v65
    v_max_f32 v66, 0, v66
    v_max_f32 v67, 0, v67
    v_max_f32 v72, 0, v72
    v_max_f32 v73, 0, v73
    v_max_f32 v74, 0, v74
    v_max_f32 v75, 0, v75
    v_mul_f32 v64, v64, v68
    v_mul_f32 v65, v65, v69
    v_mul_f32 v66, v66, v70
    v_mul_f32 v67, v67, v71
    v_mul_f32 v72, v72, v76
    v_mul_f32 v73, v73, v77
    v_mul_f32 v74, v74, v78
    v_mul_f32 v75, v75, v79
    v_cvt_pk_bf16_f32 v104, v64, v65
    v_cvt_pk_bf16_f32 v105, v66, v67
    v_cvt_pk_bf16_f32 v106, v72, v73
    v_cvt_pk_bf16_f32 v107, v74, v75
    buffer_store_dwordx4 v[104:107], v30, s[28:31], s47 offen sc1
    v_accvgpr_read_b32 v80, a44
    v_accvgpr_read_b32 v84, a108
    v_accvgpr_read_b32 v81, a45
    v_accvgpr_read_b32 v85, a109
    v_accvgpr_read_b32 v82, a46
    v_accvgpr_read_b32 v86, a110
    v_accvgpr_read_b32 v83, a47
    v_accvgpr_read_b32 v87, a111
    v_accvgpr_read_b32 v88, a60
    v_accvgpr_read_b32 v92, a124
    v_accvgpr_read_b32 v89, a61
    v_accvgpr_read_b32 v93, a125
    v_accvgpr_read_b32 v90, a62
    v_accvgpr_read_b32 v94, a126
    v_accvgpr_read_b32 v91, a63
    v_accvgpr_read_b32 v95, a127
    v_max_f32 v80, 0, v80
    v_max_f32 v81, 0, v81
    v_max_f32 v82, 0, v82
    v_max_f32 v83, 0, v83
    v_max_f32 v88, 0, v88
    v_max_f32 v89, 0, v89
    v_max_f32 v90, 0, v90
    v_max_f32 v91, 0, v91
    v_mul_f32 v80, v80, v84
    v_mul_f32 v81, v81, v85
    v_mul_f32 v82, v82, v86
    v_mul_f32 v83, v83, v87
    v_mul_f32 v88, v88, v92
    v_mul_f32 v89, v89, v93
    v_mul_f32 v90, v90, v94
    v_mul_f32 v91, v91, v95
    v_cvt_pk_bf16_f32 v108, v80, v81
    v_cvt_pk_bf16_f32 v109, v82, v83
    v_cvt_pk_bf16_f32 v110, v88, v89
    v_cvt_pk_bf16_f32 v111, v90, v91
    buffer_store_dwordx4 v[108:111], v30, s[28:31], s47 offen offset:1024 sc1
    v_mov_b32 v96, v112
    v_mov_b32 v97, v112
    v_mov_b32 v98, v112
    v_mov_b32 v99, v112
    v_mov_b32 v100, v113
    v_mov_b32 v101, v113
    v_mov_b32 v102, v113
    v_mov_b32 v103, v113
    v_mov_b32 v104, v114
    v_mov_b32 v105, v114
    v_mov_b32 v106, v114
    v_mov_b32 v107, v114
    v_mov_b32 v108, v115
    v_mov_b32 v109, v115
    v_mov_b32 v110, v115
    v_mov_b32 v111, v115
    v_mfma_f32_16x16x32_bf16 v[32:35], a[192:195], v[144:147], v[96:99]
    v_mfma_f32_16x16x32_bf16 v[32:35], a[196:199], v[176:179], v[32:35]
    v_mfma_f32_16x16x32_bf16 v[32:35], a[200:203], v[208:211], v[32:35]
    v_mfma_f32_16x16x32_bf16 v[32:35], a[204:207], v[240:243], v[32:35]
    v_mfma_f32_16x16x32_bf16 v[36:39], a[192:195], v[148:151], v[100:103]
    v_mfma_f32_16x16x32_bf16 v[36:39], a[196:199], v[180:183], v[36:39]
    v_mfma_f32_16x16x32_bf16 v[36:39], a[200:203], v[212:215], v[36:39]
    v_mfma_f32_16x16x32_bf16 v[36:39], a[204:207], v[244:247], v[36:39]
    v_mfma_f32_16x16x32_bf16 v[40:43], a[192:195], v[152:155], v[104:107]
    v_mfma_f32_16x16x32_bf16 v[40:43], a[196:199], v[184:187], v[40:43]
    v_mfma_f32_16x16x32_bf16 v[40:43], a[200:203], v[216:219], v[40:43]
    v_mfma_f32_16x16x32_bf16 v[40:43], a[204:207], v[248:251], v[40:43]
    v_mfma_f32_16x16x32_bf16 v[44:47], a[192:195], v[156:159], v[108:111]
    v_mfma_f32_16x16x32_bf16 v[44:47], a[196:199], v[188:191], v[44:47]
    v_mfma_f32_16x16x32_bf16 v[44:47], a[200:203], v[220:223], v[44:47]
    v_mfma_f32_16x16x32_bf16 v[44:47], a[204:207], v[252:255], v[44:47]
    v_mfma_f32_16x16x32_bf16 v[48:51], a[208:211], v[144:147], v[96:99]
    s_nop 3
    v_mfma_f32_16x16x32_bf16 v[48:51], a[212:215], v[176:179], v[48:51]
    v_mfma_f32_16x16x32_bf16 v[48:51], a[216:219], v[208:211], v[48:51]
    v_exp_f32 v32, v32
    v_mfma_f32_16x16x32_bf16 v[48:51], a[220:223], v[240:243], v[48:51]
    v_mfma_f32_16x16x32_bf16 v[52:55], a[208:211], v[148:151], v[100:103]
    v_exp_f32 v33, v33
    v_mfma_f32_16x16x32_bf16 v[52:55], a[212:215], v[180:183], v[52:55]
    v_cvt_pk_bf16_f32 v64, v32, v33
    v_mfma_f32_16x16x32_bf16 v[52:55], a[216:219], v[212:215], v[52:55]
    v_exp_f32 v34, v34
    v_mfma_f32_16x16x32_bf16 v[52:55], a[220:223], v[244:247], v[52:55]
    v_mfma_f32_16x16x32_bf16 v[56:59], a[208:211], v[152:155], v[104:107]
    v_exp_f32 v35, v35
    v_mfma_f32_16x16x32_bf16 v[56:59], a[212:215], v[184:187], v[56:59]
    v_cvt_pk_bf16_f32 v65, v34, v35
    v_mfma_f32_16x16x32_bf16 v[56:59], a[216:219], v[216:219], v[56:59]
    v_exp_f32 v36, v36
    v_mfma_f32_16x16x32_bf16 v[56:59], a[220:223], v[248:251], v[56:59]
    v_mfma_f32_16x16x32_bf16 v[60:63], a[208:211], v[156:159], v[108:111]
    v_exp_f32 v37, v37
    v_mfma_f32_16x16x32_bf16 v[60:63], a[212:215], v[188:191], v[60:63]
    v_cvt_pk_bf16_f32 v68, v36, v37
    v_mfma_f32_16x16x32_bf16 v[60:63], a[216:219], v[220:223], v[60:63]
    v_exp_f32 v38, v38
    v_mfma_f32_16x16x32_bf16 v[60:63], a[220:223], v[252:255], v[60:63]
    v_mfma_f32_16x16x32_bf16 a[0:3], v[128:131], v[128:131], 0
    v_exp_f32 v39, v39
    v_mfma_f32_16x16x32_bf16 a[4:7], v[128:131], v[128:131], 0
    ds_read_b128 a[192:195], v2 offset:8192
    v_cvt_pk_bf16_f32 v69, v38, v39
    v_mfma_f32_16x16x32_bf16 a[8:11], v[128:131], v[128:131], 0
    v_exp_f32 v40, v40
    v_mfma_f32_16x16x32_bf16 a[12:15], v[128:131], v[128:131], 0
    v_mfma_f32_16x16x32_bf16 a[16:19], v[128:131], v[128:131], 0
    v_exp_f32 v41, v41
    v_mfma_f32_16x16x32_bf16 a[20:23], v[128:131], v[128:131], 0
    ds_read_b128 a[196:199], v3 offset:8192
    v_cvt_pk_bf16_f32 v72, v40, v41
    v_mfma_f32_16x16x32_bf16 a[24:27], v[128:131], v[128:131], 0
    v_exp_f32 v42, v42
    v_mfma_f32_16x16x32_bf16 a[28:31], v[128:131], v[128:131], 0
    v_mfma_f32_16x16x32_bf16 a[32:35], v[128:131], v[128:131], 0
    v_exp_f32 v43, v43
    v_mfma_f32_16x16x32_bf16 a[36:39], v[128:131], v[128:131], 0
    ds_read_b128 a[200:203], v4 offset:8192
    v_cvt_pk_bf16_f32 v73, v42, v43
    v_mfma_f32_16x16x32_bf16 a[40:43], v[128:131], v[128:131], 0
    v_exp_f32 v44, v44
    v_mfma_f32_16x16x32_bf16 a[44:47], v[128:131], v[128:131], 0
    v_mfma_f32_16x16x32_bf16 a[48:51], v[128:131], v[128:131], 0
    v_exp_f32 v45, v45
    v_mfma_f32_16x16x32_bf16 a[52:55], v[128:131], v[128:131], 0
    ds_read_b128 a[204:207], v5 offset:8192
    v_cvt_pk_bf16_f32 v76, v44, v45
    v_mfma_f32_16x16x32_bf16 a[56:59], v[128:131], v[128:131], 0
    v_exp_f32 v46, v46
    v_mfma_f32_16x16x32_bf16 a[60:63], v[128:131], v[128:131], 0
    v_mfma_f32_16x16x32_bf16 a[64:67], v[128:131], v[128:131], 0
    v_exp_f32 v47, v47
    v_mfma_f32_16x16x32_bf16 a[68:71], v[128:131], v[128:131], 0
    ds_read_b128 a[208:211], v2 offset:12288
    v_cvt_pk_bf16_f32 v77, v46, v47
    v_mfma_f32_16x16x32_bf16 a[72:75], v[128:131], v[128:131], 0
    v_exp_f32 v48, v48
    v_mfma_f32_16x16x32_bf16 a[76:79], v[128:131], v[128:131], 0
    v_mfma_f32_16x16x32_bf16 a[80:83], v[128:131], v[128:131], 0
    v_exp_f32 v49, v49
    v_mfma_f32_16x16x32_bf16 a[84:87], v[128:131], v[128:131], 0
    ds_read_b128 a[212:215], v3 offset:12288
    v_cvt_pk_bf16_f32 v66, v48, v49
    v_mfma_f32_16x16x32_bf16 a[88:91], v[128:131], v[128:131], 0
    v_exp_f32 v50, v50
    v_mfma_f32_16x16x32_bf16 a[92:95], v[128:131], v[128:131], 0
    v_mfma_f32_16x16x32_bf16 a[96:99], v[128:131], v[128:131], 0
    v_exp_f32 v51, v51
    v_mfma_f32_16x16x32_bf16 a[100:103], v[128:131], v[128:131], 0
    ds_read_b128 a[216:219], v4 offset:12288
    v_cvt_pk_bf16_f32 v67, v50, v51
    v_mfma_f32_16x16x32_bf16 a[104:107], v[128:131], v[128:131], 0
    v_exp_f32 v52, v52
    v_mfma_f32_16x16x32_bf16 a[108:111], v[128:131], v[128:131], 0
    v_mfma_f32_16x16x32_bf16 a[112:115], v[128:131], v[128:131], 0
    v_exp_f32 v53, v53
    v_mfma_f32_16x16x32_bf16 a[116:119], v[128:131], v[128:131], 0
    ds_read_b128 a[220:223], v5 offset:12288
    v_cvt_pk_bf16_f32 v70, v52, v53
    v_mfma_f32_16x16x32_bf16 a[120:123], v[128:131], v[128:131], 0
    v_exp_f32 v54, v54
    v_mfma_f32_16x16x32_bf16 a[124:127], v[128:131], v[128:131], 0
    s_nop 0
    v_exp_f32 v55, v55
    s_nop 0
    v_cvt_pk_bf16_f32 v71, v54, v55
    s_nop 0
    v_exp_f32 v56, v56
    s_nop 0
    s_mov_b32 s40, 0
    s_lshl_b32 s60, s2, 2
    s_add_u32 s60, s60, s3
    s_add_u32 s72, s58, 29360128
    s_addc_u32 s73, s59, 0
    s_mov_b32 s74, 753664
    s_mov_b32 s75, 0x00020000
    s_lshl_b32 s61, s60, 10
    s_waitcnt vmcnt(8)
    buffer_store_dwordx4 v[172:175], v30, s[72:75], s61 offen sc1
    s_lshl_b32 s60, s2, 2
    s_add_u32 s60, s60, 14336
    v_lshlrev_b32 v119, 14, v0
    v_add_u32 v118, s60, v119
    v_mov_b32 v119, s91
    s_mov_b32 s75, 14336
    s_and_b32 s60, s4, 7
    s_lshr_b32 s61, s4, 3
    s_lshr_b32 s62, s60, 1
    s_lshl_b32 s44, s5, 2
    s_add_u32 s62, s62, s44
    s_and_b32 s60, s60, 1
    s_lshl_b32 s60, s60, 2
    s_add_u32 s63, s60, s61
    s_mul_i32 s60, s62, 224
    s_mul_i32 s61, s3, 14
    s_add_u32 s60, s60, s61
    s_lshl_b32 s60, s60, 10
    s_add_u32 s60, s60, 18874368
    s_add_u32 s20, s58, s60
    s_addc_u32 s21, s59, 0
    s_mov_b32 s22, 186368
    s_mov_b32 s23, 0x00020000
    s_lshl_b32 s61, s63, 7
    s_mul_i32 s60, s3, 458752
    s_add_u32 s60, s60, s61
    s_sub_u32 s61, 1835008, s60
    s_add_u32 s16, s56, s60
    s_addc_u32 s17, s57, 0
    s_mov_b32 s18, s61
    s_mov_b32 s19, 0x00020000
    s_mul_i32 s60, s3, 57344
    s_add_u32 s60, s60, 29884416
    s_add_u32 s60, s60, s58
    s_addc_u32 s61, s59, 0
    s_cmp_eq_u32 s63, 3
    s_cselect_b32 s16, s60, s16
    s_cselect_b32 s17, s61, s17
    s_cselect_b32 s18, 57344, s18
    s_mov_b32 s28, 1024
    s_cselect_b32 s28, 128, s28
    s_lshl_b32 s29, s28, 5
    s_mov_b32 s41, 0
    s_mov_b32 s36, 0
    s_mov_b32 s37, 57344
    s_mov_b32 s39, 114688
    s_mov_b32 s42, 172032
    s_lshl_b32 s38, s3, 12
    v_lshrrev_b32 v168, 4, v1
    v_bfe_u32 v169, v1, 2, 2
    v_and_b32 v170, 3, v1
    v_lshl_add_u32 v172, v168, 2, v169
    v_lshlrev_b32 v172, 7, v172
    v_lshl_add_u32 v172, v170, 3, v172
    v_add_u32 v172, s38, v172
    v_and_b32 v173, 1, v168
    v_lshlrev_b32 v173, 1, v173
    v_lshrrev_b32 v171, 1, v169
    v_add_u32 v173, v173, v171
    v_xor_b32 v171, 0, v173
    v_lshl_add_u32 v164, v171, 5, v172
    v_add_u32 v20, 131072, v164
    v_xor_b32 v171, 1, v173
    v_lshl_add_u32 v165, v171, 5, v172
    v_add_u32 v21, 131072, v165
    v_xor_b32 v171, 2, v173
    v_lshl_add_u32 v166, v171, 5, v172
    v_add_u32 v22, 131072, v166
    v_xor_b32 v171, 3, v173
    v_lshl_add_u32 v167, v171, 5, v172
    v_add_u32 v23, 131072, v167
    v_lshrrev_b32 v171, 3, v1
    v_mul_lo_u32 v172, v171, s28
    v_lshlrev_b32 v173, 1, v168
    v_and_b32 v171, 7, v1
    v_xor_b32 v171, v171, v173
    v_lshl_add_u32 v24, v171, 4, v172
    s_lshl_b32 s60, s28, 3
    s_sub_u32 s60, s60, 1024
    v_add_u32 v25, s60, v24
    v_add_u32 v26, s60, v25
    v_add_u32 v27, s60, v26
    v_and_b32 v29, 31, v1
    v_lshlrev_b32 v29, 2, v29
    s_lshl_b32 s60, s5, 7
    s_add_u32 s60, s60, 12288
    v_add_u32 v29, s60, v29
    s_lshl_b32 s44, s5, 7
    s_add_u32 s44, s44, 12288
    s_lshl_b32 s45, s4, 2
    s_add_u32 s44, s44, s45
    v_mov_b32 v122, s44
    v_lshlrev_b32 v123, 14, v0
    v_add_u32 v122, v122, v123
    v_mov_b32 v123, s6
    s_lshl_b32 s7, s2, 2
    s_add_u32 s7, s7, s3
    s_lshl_b32 s7, s7, 12
    v_and_b32 v127, 31, v1
    v_lshlrev_b32 v127, 7, v127
    s_mov_b32 s60, s56
    s_mov_b32 s61, s57
    s_mov_b32 s62, 1835008
    s_mov_b32 s63, 0x00020000
    s_mov_b32 s76, s100
    s_mov_b32 s77, s101
    s_mov_b32 s78, mk_codeend-mk_pc
    s_mov_b32 s79, 0x00020000
    s_lshr_b32 s90, s2, 3
    s_and_b32 s90, s90, 15
    s_lshl_b32 s90, s90, 12
    v_lshlrev_b32 v126, 6, v1
mk_loop:
    s_waitcnt lgkmcnt(2)
    v_mfma_f32_16x16x32_bf16 v[32:35], a[192:195], v[144:147], v[96:99]
    v_exp_f32 v57, v57
    v_mfma_f32_16x16x32_bf16 v[32:35], a[196:199], v[176:179], v[32:35]
    ds_read_b64_tr_b16 a[224:225], v6
    v_cvt_pk_bf16_f32 v74, v56, v57
    v_mfma_f32_16x16x32_bf16 v[32:35], a[200:203], v[208:211], v[32:35]
    v_exp_f32 v58, v58
    v_mfma_f32_16x16x32_bf16 v[32:35], a[204:207], v[240:243], v[32:35]
    ds_read_b64_tr_b16 a[226:227], v6 offset:4096
    v_mfma_f32_16x16x32_bf16 v[36:39], a[192:195], v[148:151], v[100:103]
    v_exp_f32 v59, v59
    v_mfma_f32_16x16x32_bf16 v[36:39], a[196:199], v[180:183], v[36:39]
    ds_read_b64_tr_b16 a[228:229], v7
    v_cvt_pk_bf16_f32 v75, v58, v59
    v_mfma_f32_16x16x32_bf16 v[36:39], a[200:203], v[212:215], v[36:39]
    v_exp_f32 v60, v60
    v_mfma_f32_16x16x32_bf16 v[36:39], a[204:207], v[244:247], v[36:39]
    ds_read_b64_tr_b16 a[230:231], v7 offset:4096
    v_mfma_f32_16x16x32_bf16 v[40:43], a[192:195], v[152:155], v[104:107]
    v_exp_f32 v61, v61
    v_mfma_f32_16x16x32_bf16 v[40:43], a[196:199], v[184:187], v[40:43]
    ds_read_b64_tr_b16 a[232:233], v8
    v_cvt_pk_bf16_f32 v78, v60, v61
    v_mfma_f32_16x16x32_bf16 v[40:43], a[200:203], v[216:219], v[40:43]
    v_exp_f32 v62, v62
    v_mfma_f32_16x16x32_bf16 v[40:43], a[204:207], v[248:251], v[40:43]
    ds_read_b64_tr_b16 a[234:235], v8 offset:4096
    v_mfma_f32_16x16x32_bf16 v[44:47], a[192:195], v[156:159], v[108:111]
    v_exp_f32 v63, v63
    v_mfma_f32_16x16x32_bf16 v[44:47], a[196:199], v[188:191], v[44:47]
    ds_read_b64_tr_b16 a[236:237], v9
    v_cvt_pk_bf16_f32 v79, v62, v63
    v_mfma_f32_16x16x32_bf16 v[44:47], a[200:203], v[220:223], v[44:47]
    v_mfma_f32_16x16x32_bf16 v[44:47], a[204:207], v[252:255], v[44:47]
    ds_read_b64_tr_b16 a[238:239], v9 offset:4096
    v_mfma_f32_16x16x32_bf16 v[48:51], a[208:211], v[144:147], v[96:99]
    s_waitcnt lgkmcnt(3)
    v_mfma_f32_16x16x32_bf16 v[48:51], a[212:215], v[176:179], v[48:51]
    s_waitcnt lgkmcnt(3)
    ds_read_b64_tr_b16 a[240:241], v10
    v_mfma_f32_16x16x32_bf16 v[48:51], a[216:219], v[208:211], v[48:51]
    v_exp_f32 v32, v32
    v_mfma_f32_16x16x32_bf16 v[48:51], a[220:223], v[240:243], v[48:51]
    ds_read_b64_tr_b16 a[242:243], v10 offset:4096
    v_mfma_f32_16x16x32_bf16 v[52:55], a[208:211], v[148:151], v[100:103]
    v_exp_f32 v33, v33
    v_mfma_f32_16x16x32_bf16 v[52:55], a[212:215], v[180:183], v[52:55]
    ds_read_b64_tr_b16 a[244:245], v11
    v_cvt_pk_bf16_f32 v80, v32, v33
    v_mfma_f32_16x16x32_bf16 v[52:55], a[216:219], v[212:215], v[52:55]
    v_exp_f32 v34, v34
    v_mfma_f32_16x16x32_bf16 v[52:55], a[220:223], v[244:247], v[52:55]
    ds_read_b64_tr_b16 a[246:247], v11 offset:4096
    v_mfma_f32_16x16x32_bf16 v[56:59], a[208:211], v[152:155], v[104:107]
    v_exp_f32 v35, v35
    v_mfma_f32_16x16x32_bf16 v[56:59], a[212:215], v[184:187], v[56:59]
    ds_read_b64_tr_b16 a[248:249], v12
    v_cvt_pk_bf16_f32 v81, v34, v35
    v_mfma_f32_16x16x32_bf16 v[56:59], a[216:219], v[216:219], v[56:59]
    v_exp_f32 v36, v36
    v_mfma_f32_16x16x32_bf16 v[56:59], a[220:223], v[248:251], v[56:59]
    ds_read_b64_tr_b16 a[250:251], v12 offset:4096
    v_mfma_f32_16x16x32_bf16 v[60:63], a[208:211], v[156:159], v[108:111]
    v_exp_f32 v37, v37
    v_mfma_f32_16x16x32_bf16 v[60:63], a[212:215], v[188:191], v[60:63]
    ds_read_b64_tr_b16 a[252:253], v13
    v_cvt_pk_bf16_f32 v84, v36, v37
    v_mfma_f32_16x16x32_bf16 v[60:63], a[216:219], v[220:223], v[60:63]
    v_exp_f32 v38, v38
    v_mfma_f32_16x16x32_bf16 v[60:63], a[220:223], v[252:255], v[60:63]
    ds_read_b64_tr_b16 a[254:255], v13 offset:4096
    s_waitcnt vmcnt(10)
    s_barrier
    v_mfma_f32_16x16x32_bf16 a[0:3], a[224:227], v[64:67], a[0:3]
    v_exp_f32 v39, v39
    v_mfma_f32_16x16x32_bf16 a[4:7], a[224:227], v[68:71], a[4:7]
    ds_read_b128 a[192:195], v2 offset:16384
    v_cvt_pk_bf16_f32 v85, v38, v39
    v_mfma_f32_16x16x32_bf16 a[8:11], a[224:227], v[72:75], a[8:11]
    s_add_u32 m0, s34, 0
    v_exp_f32 v40, v40
    v_mfma_f32_16x16x32_bf16 a[12:15], a[224:227], v[76:79], a[12:15]
    buffer_load_dwordx4 v14, s[8:11], s32 offen lds
    v_mfma_f32_16x16x32_bf16 a[16:19], a[228:231], v[64:67], a[16:19]
    v_exp_f32 v41, v41
    v_mfma_f32_16x16x32_bf16 a[20:23], a[228:231], v[68:71], a[20:23]
    ds_read_b128 a[196:199], v3 offset:16384
    v_cvt_pk_bf16_f32 v88, v40, v41
    v_mfma_f32_16x16x32_bf16 a[24:27], a[228:231], v[72:75], a[24:27]
    v_exp_f32 v42, v42
    v_mfma_f32_16x16x32_bf16 a[28:31], a[228:231], v[76:79], a[28:31]
    v_mfma_f32_16x16x32_bf16 v[128:131], v[160:163], v[64:67], v[128:131]
    s_waitcnt lgkmcnt(1)
    v_exp_f32 v43, v43
    v_mfma_f32_16x16x32_bf16 a[32:35], a[232:235], v[64:67], a[32:35]
    ds_read_b128 a[200:203], v4 offset:16384
    v_cvt_pk_bf16_f32 v89, v42, v43
    v_mfma_f32_16x16x32_bf16 a[36:39], a[232:235], v[68:71], a[36:39]
    v_exp_f32 v44, v44
    v_mfma_f32_16x16x32_bf16 a[40:43], a[232:235], v[72:75], a[40:43]
    buffer_load_dwordx4 v15, s[8:11], s32 offen offset:1024 lds
    v_mfma_f32_16x16x32_bf16 a[44:47], a[232:235], v[76:79], a[44:47]
    v_exp_f32 v45, v45
    v_mfma_f32_16x16x32_bf16 a[48:51], a[236:239], v[64:67], a[48:51]
    ds_read_b128 a[204:207], v5 offset:16384
    v_cvt_pk_bf16_f32 v92, v44, v45
    v_mfma_f32_16x16x32_bf16 a[52:55], a[236:239], v[68:71], a[52:55]
    v_exp_f32 v46, v46
    v_mfma_f32_16x16x32_bf16 a[56:59], a[236:239], v[72:75], a[56:59]
    v_mfma_f32_16x16x32_bf16 a[60:63], a[236:239], v[76:79], a[60:63]
    v_exp_f32 v47, v47
    v_mfma_f32_16x16x32_bf16 v[132:135], v[160:163], v[68:71], v[132:135]
    ds_read_b128 a[208:211], v2 offset:20480
    v_cvt_pk_bf16_f32 v93, v46, v47
    v_mfma_f32_16x16x32_bf16 a[64:67], a[240:243], v[64:67], a[64:67]
    v_exp_f32 v48, v48
    v_mfma_f32_16x16x32_bf16 a[68:71], a[240:243], v[68:71], a[68:71]
    buffer_load_dwordx4 v16, s[8:11], s32 offen offset:2048 lds
    v_mfma_f32_16x16x32_bf16 a[72:75], a[240:243], v[72:75], a[72:75]
    v_exp_f32 v49, v49
    v_mfma_f32_16x16x32_bf16 a[76:79], a[240:243], v[76:79], a[76:79]
    ds_read_b128 a[212:215], v3 offset:20480
    v_cvt_pk_bf16_f32 v82, v48, v49
    v_mfma_f32_16x16x32_bf16 a[80:83], a[244:247], v[64:67], a[80:83]
    v_exp_f32 v50, v50
    v_mfma_f32_16x16x32_bf16 a[84:87], a[244:247], v[68:71], a[84:87]
    v_mfma_f32_16x16x32_bf16 a[88:91], a[244:247], v[72:75], a[88:91]
    v_exp_f32 v51, v51
    v_mfma_f32_16x16x32_bf16 a[92:95], a[244:247], v[76:79], a[92:95]
    ds_read_b128 a[216:219], v4 offset:20480
    v_cvt_pk_bf16_f32 v83, v50, v51
    v_mfma_f32_16x16x32_bf16 v[136:139], v[160:163], v[72:75], v[136:139]
    v_exp_f32 v52, v52
    v_mfma_f32_16x16x32_bf16 a[96:99], a[248:251], v[64:67], a[96:99]
    buffer_load_dwordx4 v17, s[8:11], s32 offen offset:3072 lds
    v_mfma_f32_16x16x32_bf16 a[100:103], a[248:251], v[68:71], a[100:103]
    v_exp_f32 v53, v53
    v_mfma_f32_16x16x32_bf16 a[104:107], a[248:251], v[72:75], a[104:107]
    ds_read_b128 a[220:223], v5 offset:20480
    v_cvt_pk_bf16_f32 v86, v52, v53
    v_mfma_f32_16x16x32_bf16 a[108:111], a[248:251], v[76:79], a[108:111]
    v_exp_f32 v54, v54
    v_mfma_f32_16x16x32_bf16 a[112:115], a[252:255], v[64:67], a[112:115]
    v_mfma_f32_16x16x32_bf16 a[116:119], a[252:255], v[68:71], a[116:119]
    v_exp_f32 v55, v55
    v_mfma_f32_16x16x32_bf16 a[120:123], a[252:255], v[72:75], a[120:123]
    v_cvt_pk_bf16_f32 v87, v54, v55
    v_mfma_f32_16x16x32_bf16 a[124:127], a[252:255], v[76:79], a[124:127]
    s_add_u32 s32, s32, 16384
    v_exp_f32 v56, v56
    v_mfma_f32_16x16x32_bf16 v[140:143], v[160:163], v[76:79], v[140:143]
    v_mfma_f32_16x16x32_bf16 v[32:35], a[192:195], v[144:147], v[96:99]
    s_waitcnt lgkmcnt(0)
    v_exp_f32 v57, v57
    v_mfma_f32_16x16x32_bf16 v[32:35], a[196:199], v[176:179], v[32:35]
    ds_read_b64_tr_b16 a[224:225], v6 offset:8192
    v_cvt_pk_bf16_f32 v90, v56, v57
    v_mfma_f32_16x16x32_bf16 v[32:35], a[200:203], v[208:211], v[32:35]
    v_exp_f32 v58, v58
    v_mfma_f32_16x16x32_bf16 v[32:35], a[204:207], v[240:243], v[32:35]
    ds_read_b64_tr_b16 a[226:227], v6 offset:12288
    v_mfma_f32_16x16x32_bf16 v[36:39], a[192:195], v[148:151], v[100:103]
    v_exp_f32 v59, v59
    v_mfma_f32_16x16x32_bf16 v[36:39], a[196:199], v[180:183], v[36:39]
    ds_read_b64_tr_b16 a[228:229], v7 offset:8192
    v_cvt_pk_bf16_f32 v91, v58, v59
    v_mfma_f32_16x16x32_bf16 v[36:39], a[200:203], v[212:215], v[36:39]
    v_exp_f32 v60, v60
    v_mfma_f32_16x16x32_bf16 v[36:39], a[204:207], v[244:247], v[36:39]
    ds_read_b64_tr_b16 a[230:231], v7 offset:12288
    v_mfma_f32_16x16x32_bf16 v[40:43], a[192:195], v[152:155], v[104:107]
    v_exp_f32 v61, v61
    v_mfma_f32_16x16x32_bf16 v[40:43], a[196:199], v[184:187], v[40:43]
    ds_read_b64_tr_b16 a[232:233], v8 offset:8192
    v_cvt_pk_bf16_f32 v94, v60, v61
    v_mfma_f32_16x16x32_bf16 v[40:43], a[200:203], v[216:219], v[40:43]
    v_exp_f32 v62, v62
    v_mfma_f32_16x16x32_bf16 v[40:43], a[204:207], v[248:251], v[40:43]
    ds_read_b64_tr_b16 a[234:235], v8 offset:12288
    v_mfma_f32_16x16x32_bf16 v[44:47], a[192:195], v[156:159], v[108:111]
    v_exp_f32 v63, v63
    v_mfma_f32_16x16x32_bf16 v[44:47], a[196:199], v[188:191], v[44:47]
    ds_read_b64_tr_b16 a[236:237], v9 offset:8192
    v_cvt_pk_bf16_f32 v95, v62, v63
    v_mfma_f32_16x16x32_bf16 v[44:47], a[200:203], v[220:223], v[44:47]
    v_mfma_f32_16x16x32_bf16 v[44:47], a[204:207], v[252:255], v[44:47]
    ds_read_b64_tr_b16 a[238:239], v9 offset:12288
    v_mfma_f32_16x16x32_bf16 v[48:51], a[208:211], v[144:147], v[96:99]
    v_mfma_f32_16x16x32_bf16 v[48:51], a[212:215], v[176:179], v[48:51]
    ds_read_b64_tr_b16 a[240:241], v10 offset:8192
    v_mfma_f32_16x16x32_bf16 v[48:51], a[216:219], v[208:211], v[48:51]
    v_exp_f32 v32, v32
    v_mfma_f32_16x16x32_bf16 v[48:51], a[220:223], v[240:243], v[48:51]
    ds_read_b64_tr_b16 a[242:243], v10 offset:12288
    v_mfma_f32_16x16x32_bf16 v[52:55], a[208:211], v[148:151], v[100:103]
    v_exp_f32 v33, v33
    v_mfma_f32_16x16x32_bf16 v[52:55], a[212:215], v[180:183], v[52:55]
    ds_read_b64_tr_b16 a[244:245], v11 offset:8192
    v_cvt_pk_bf16_f32 v64, v32, v33
    v_mfma_f32_16x16x32_bf16 v[52:55], a[216:219], v[212:215], v[52:55]
    v_exp_f32 v34, v34
    v_mfma_f32_16x16x32_bf16 v[52:55], a[220:223], v[244:247], v[52:55]
    ds_read_b64_tr_b16 a[246:247], v11 offset:12288
    v_mfma_f32_16x16x32_bf16 v[56:59], a[208:211], v[152:155], v[104:107]
    v_exp_f32 v35, v35
    v_mfma_f32_16x16x32_bf16 v[56:59], a[212:215], v[184:187], v[56:59]
    ds_read_b64_tr_b16 a[248:249], v12 offset:8192
    v_cvt_pk_bf16_f32 v65, v34, v35
    v_mfma_f32_16x16x32_bf16 v[56:59], a[216:219], v[216:219], v[56:59]
    v_exp_f32 v36, v36
    v_mfma_f32_16x16x32_bf16 v[56:59], a[220:223], v[248:251], v[56:59]
    ds_read_b64_tr_b16 a[250:251], v12 offset:12288
    v_mfma_f32_16x16x32_bf16 v[60:63], a[208:211], v[156:159], v[108:111]
    v_exp_f32 v37, v37
    v_mfma_f32_16x16x32_bf16 v[60:63], a[212:215], v[188:191], v[60:63]
    ds_read_b64_tr_b16 a[252:253], v13 offset:8192
    v_cvt_pk_bf16_f32 v68, v36, v37
    v_mfma_f32_16x16x32_bf16 v[60:63], a[216:219], v[220:223], v[60:63]
    v_exp_f32 v38, v38
    v_mfma_f32_16x16x32_bf16 v[60:63], a[220:223], v[252:255], v[60:63]
    s_waitcnt lgkmcnt(3)
    ds_read_b64_tr_b16 a[254:255], v13 offset:12288
    v_mfma_f32_16x16x32_bf16 a[0:3], a[224:227], v[80:83], a[0:3]
    v_exp_f32 v39, v39
    v_mfma_f32_16x16x32_bf16 a[4:7], a[224:227], v[84:87], a[4:7]
    ds_read_b128 a[192:195], v2 offset:24576
    v_cvt_pk_bf16_f32 v69, v38, v39
    v_mfma_f32_16x16x32_bf16 a[8:11], a[224:227], v[88:91], a[8:11]
    s_add_u32 m0, s34, 114688
    v_exp_f32 v40, v40
    v_mfma_f32_16x16x32_bf16 a[12:15], a[224:227], v[92:95], a[12:15]
    buffer_load_dwordx4 v18, s[12:15], s33 offen lds
    v_mfma_f32_16x16x32_bf16 a[16:19], a[228:231], v[80:83], a[16:19]
    v_exp_f32 v41, v41
    v_mfma_f32_16x16x32_bf16 a[20:23], a[228:231], v[84:87], a[20:23]
    ds_read_b128 a[196:199], v3 offset:24576
    v_cvt_pk_bf16_f32 v72, v40, v41
    v_mfma_f32_16x16x32_bf16 a[24:27], a[228:231], v[88:91], a[24:27]
    v_exp_f32 v42, v42
    v_mfma_f32_16x16x32_bf16 a[28:31], a[228:231], v[92:95], a[28:31]
    buffer_load_dword v124, v127, s[60:63], s7 offen
    v_mfma_f32_16x16x32_bf16 v[128:131], v[160:163], v[80:83], v[128:131]
    v_exp_f32 v43, v43
    v_mfma_f32_16x16x32_bf16 a[32:35], a[232:235], v[80:83], a[32:35]
    ds_read_b128 a[200:203], v4 offset:24576
    v_cvt_pk_bf16_f32 v73, v42, v43
    v_mfma_f32_16x16x32_bf16 a[36:39], a[232:235], v[84:87], a[36:39]
    v_exp_f32 v44, v44
    v_mfma_f32_16x16x32_bf16 a[40:43], a[232:235], v[88:91], a[40:43]
    buffer_load_dwordx4 v19, s[12:15], s33 offen offset:1024 lds
    v_mfma_f32_16x16x32_bf16 a[44:47], a[232:235], v[92:95], a[44:47]
    v_exp_f32 v45, v45
    v_mfma_f32_16x16x32_bf16 a[48:51], a[236:239], v[80:83], a[48:51]
    ds_read_b128 a[204:207], v5 offset:24576
    v_cvt_pk_bf16_f32 v76, v44, v45
    v_mfma_f32_16x16x32_bf16 a[52:55], a[236:239], v[84:87], a[52:55]
    v_exp_f32 v46, v46
    v_mfma_f32_16x16x32_bf16 a[56:59], a[236:239], v[88:91], a[56:59]
    v_mfma_f32_16x16x32_bf16 a[60:63], a[236:239], v[92:95], a[60:63]
    v_exp_f32 v47, v47
    v_mfma_f32_16x16x32_bf16 v[132:135], v[160:163], v[84:87], v[132:135]
    ds_read_b128 a[208:211], v2 offset:28672
    v_cvt_pk_bf16_f32 v77, v46, v47
    v_mfma_f32_16x16x32_bf16 a[64:67], a[240:243], v[80:83], a[64:67]
    v_exp_f32 v48, v48
    v_mfma_f32_16x16x32_bf16 a[68:71], a[240:243], v[84:87], a[68:71]
    buffer_load_dwordx4 v18, s[12:15], s33 offen offset:2048 lds
    v_mfma_f32_16x16x32_bf16 a[72:75], a[240:243], v[88:91], a[72:75]
    v_exp_f32 v49, v49
    v_mfma_f32_16x16x32_bf16 a[76:79], a[240:243], v[92:95], a[76:79]
    ds_read_b128 a[212:215], v3 offset:28672
    v_cvt_pk_bf16_f32 v66, v48, v49
    v_mfma_f32_16x16x32_bf16 a[80:83], a[244:247], v[80:83], a[80:83]
    v_exp_f32 v50, v50
    v_mfma_f32_16x16x32_bf16 a[84:87], a[244:247], v[84:87], a[84:87]
    v_mfma_f32_16x16x32_bf16 a[88:91], a[244:247], v[88:91], a[88:91]
    v_exp_f32 v51, v51
    v_mfma_f32_16x16x32_bf16 a[92:95], a[244:247], v[92:95], a[92:95]
    ds_read_b128 a[216:219], v4 offset:28672
    v_cvt_pk_bf16_f32 v67, v50, v51
    v_mfma_f32_16x16x32_bf16 v[136:139], v[160:163], v[88:91], v[136:139]
    s_waitcnt lgkmcnt(2)
    v_exp_f32 v52, v52
    v_mfma_f32_16x16x32_bf16 a[96:99], a[248:251], v[80:83], a[96:99]
    buffer_load_dwordx4 v19, s[12:15], s33 offen offset:3072 lds
    v_mfma_f32_16x16x32_bf16 a[100:103], a[248:251], v[84:87], a[100:103]
    v_exp_f32 v53, v53
    v_mfma_f32_16x16x32_bf16 a[104:107], a[248:251], v[88:91], a[104:107]
    ds_read_b128 a[220:223], v5 offset:28672
    v_cvt_pk_bf16_f32 v70, v52, v53
    v_mfma_f32_16x16x32_bf16 a[108:111], a[248:251], v[92:95], a[108:111]
    v_exp_f32 v54, v54
    v_mfma_f32_16x16x32_bf16 a[112:115], a[252:255], v[80:83], a[112:115]
    v_mfma_f32_16x16x32_bf16 a[116:119], a[252:255], v[84:87], a[116:119]
    v_exp_f32 v55, v55
    v_mfma_f32_16x16x32_bf16 a[120:123], a[252:255], v[88:91], a[120:123]
    v_cvt_pk_bf16_f32 v71, v54, v55
    v_mfma_f32_16x16x32_bf16 a[124:127], a[252:255], v[92:95], a[124:127]
    s_add_u32 s33, s33, 16384
    v_exp_f32 v56, v56
    v_mfma_f32_16x16x32_bf16 v[140:143], v[160:163], v[92:95], v[140:143]
    v_mfma_f32_16x16x32_bf16 v[32:35], a[192:195], v[144:147], v[96:99]
    v_exp_f32 v57, v57
    v_mfma_f32_16x16x32_bf16 v[32:35], a[196:199], v[176:179], v[32:35]
    ds_read_b64_tr_b16 a[224:225], v6 offset:16384
    v_cvt_pk_bf16_f32 v74, v56, v57
    v_mfma_f32_16x16x32_bf16 v[32:35], a[200:203], v[208:211], v[32:35]
    v_exp_f32 v58, v58
    v_mfma_f32_16x16x32_bf16 v[32:35], a[204:207], v[240:243], v[32:35]
    ds_read_b64_tr_b16 a[226:227], v6 offset:20480
    v_mfma_f32_16x16x32_bf16 v[36:39], a[192:195], v[148:151], v[100:103]
    v_exp_f32 v59, v59
    v_mfma_f32_16x16x32_bf16 v[36:39], a[196:199], v[180:183], v[36:39]
    ds_read_b64_tr_b16 a[228:229], v7 offset:16384
    v_cvt_pk_bf16_f32 v75, v58, v59
    v_mfma_f32_16x16x32_bf16 v[36:39], a[200:203], v[212:215], v[36:39]
    v_exp_f32 v60, v60
    v_mfma_f32_16x16x32_bf16 v[36:39], a[204:207], v[244:247], v[36:39]
    ds_read_b64_tr_b16 a[230:231], v7 offset:20480
    v_mfma_f32_16x16x32_bf16 v[40:43], a[192:195], v[152:155], v[104:107]
    v_exp_f32 v61, v61
    v_mfma_f32_16x16x32_bf16 v[40:43], a[196:199], v[184:187], v[40:43]
    ds_read_b64_tr_b16 a[232:233], v8 offset:16384
    v_cvt_pk_bf16_f32 v78, v60, v61
    v_mfma_f32_16x16x32_bf16 v[40:43], a[200:203], v[216:219], v[40:43]
    v_exp_f32 v62, v62
    v_mfma_f32_16x16x32_bf16 v[40:43], a[204:207], v[248:251], v[40:43]
    ds_read_b64_tr_b16 a[234:235], v8 offset:20480
    v_mfma_f32_16x16x32_bf16 v[44:47], a[192:195], v[156:159], v[108:111]
    v_exp_f32 v63, v63
    v_mfma_f32_16x16x32_bf16 v[44:47], a[196:199], v[188:191], v[44:47]
    ds_read_b64_tr_b16 a[236:237], v9 offset:16384
    v_cvt_pk_bf16_f32 v79, v62, v63
    v_mfma_f32_16x16x32_bf16 v[44:47], a[200:203], v[220:223], v[44:47]
    v_mfma_f32_16x16x32_bf16 v[44:47], a[204:207], v[252:255], v[44:47]
    ds_read_b64_tr_b16 a[238:239], v9 offset:20480
    v_mfma_f32_16x16x32_bf16 v[48:51], a[208:211], v[144:147], v[96:99]
    s_waitcnt lgkmcnt(3)
    v_mfma_f32_16x16x32_bf16 v[48:51], a[212:215], v[176:179], v[48:51]
    ds_read_b64_tr_b16 a[240:241], v10 offset:16384
    v_mfma_f32_16x16x32_bf16 v[48:51], a[216:219], v[208:211], v[48:51]
    v_exp_f32 v32, v32
    v_mfma_f32_16x16x32_bf16 v[48:51], a[220:223], v[240:243], v[48:51]
    ds_read_b64_tr_b16 a[242:243], v10 offset:20480
    v_mfma_f32_16x16x32_bf16 v[52:55], a[208:211], v[148:151], v[100:103]
    v_exp_f32 v33, v33
    v_mfma_f32_16x16x32_bf16 v[52:55], a[212:215], v[180:183], v[52:55]
    ds_read_b64_tr_b16 a[244:245], v11 offset:16384
    v_cvt_pk_bf16_f32 v80, v32, v33
    v_mfma_f32_16x16x32_bf16 v[52:55], a[216:219], v[212:215], v[52:55]
    v_exp_f32 v34, v34
    v_mfma_f32_16x16x32_bf16 v[52:55], a[220:223], v[244:247], v[52:55]
    ds_read_b64_tr_b16 a[246:247], v11 offset:20480
    v_mfma_f32_16x16x32_bf16 v[56:59], a[208:211], v[152:155], v[104:107]
    v_exp_f32 v35, v35
    v_mfma_f32_16x16x32_bf16 v[56:59], a[212:215], v[184:187], v[56:59]
    ds_read_b64_tr_b16 a[248:249], v12 offset:16384
    v_cvt_pk_bf16_f32 v81, v34, v35
    v_mfma_f32_16x16x32_bf16 v[56:59], a[216:219], v[216:219], v[56:59]
    v_exp_f32 v36, v36
    v_mfma_f32_16x16x32_bf16 v[56:59], a[220:223], v[248:251], v[56:59]
    ds_read_b64_tr_b16 a[250:251], v12 offset:20480
    v_mfma_f32_16x16x32_bf16 v[60:63], a[208:211], v[156:159], v[108:111]
    v_exp_f32 v37, v37
    v_mfma_f32_16x16x32_bf16 v[60:63], a[212:215], v[188:191], v[60:63]
    ds_read_b64_tr_b16 a[252:253], v13 offset:16384
    v_cvt_pk_bf16_f32 v84, v36, v37
    v_mfma_f32_16x16x32_bf16 v[60:63], a[216:219], v[220:223], v[60:63]
    v_exp_f32 v38, v38
    v_mfma_f32_16x16x32_bf16 v[60:63], a[220:223], v[252:255], v[60:63]
    ds_read_b64_tr_b16 a[254:255], v13 offset:20480
    s_waitcnt vmcnt(9)
    s_barrier
    v_mfma_f32_16x16x32_bf16 a[0:3], a[224:227], v[64:67], a[0:3]
    v_exp_f32 v39, v39
    v_mfma_f32_16x16x32_bf16 a[4:7], a[224:227], v[68:71], a[4:7]
    ds_read_b128 a[192:195], v2 offset:32768
    v_cvt_pk_bf16_f32 v85, v38, v39
    v_mfma_f32_16x16x32_bf16 a[8:11], a[224:227], v[72:75], a[8:11]
    s_add_u32 m0, s34, 16384
    v_exp_f32 v40, v40
    v_mfma_f32_16x16x32_bf16 a[12:15], a[224:227], v[76:79], a[12:15]
    buffer_load_dwordx4 v14, s[8:11], s32 offen lds
    v_mfma_f32_16x16x32_bf16 a[16:19], a[228:231], v[64:67], a[16:19]
    v_exp_f32 v41, v41
    v_mfma_f32_16x16x32_bf16 a[20:23], a[228:231], v[68:71], a[20:23]
    ds_read_b128 a[196:199], v3 offset:32768
    v_cvt_pk_bf16_f32 v88, v40, v41
    v_mfma_f32_16x16x32_bf16 a[24:27], a[228:231], v[72:75], a[24:27]
    v_exp_f32 v42, v42
    v_mfma_f32_16x16x32_bf16 a[28:31], a[228:231], v[76:79], a[28:31]
    v_mfma_f32_16x16x32_bf16 v[128:131], v[160:163], v[64:67], v[128:131]
    s_waitcnt lgkmcnt(1)
    v_exp_f32 v43, v43
    v_mfma_f32_16x16x32_bf16 a[32:35], a[232:235], v[64:67], a[32:35]
    ds_read_b128 a[200:203], v4 offset:32768
    v_cvt_pk_bf16_f32 v89, v42, v43
    v_mfma_f32_16x16x32_bf16 a[36:39], a[232:235], v[68:71], a[36:39]
    v_exp_f32 v44, v44
    v_mfma_f32_16x16x32_bf16 a[40:43], a[232:235], v[72:75], a[40:43]
    buffer_load_dwordx4 v15, s[8:11], s32 offen offset:1024 lds
    v_mfma_f32_16x16x32_bf16 a[44:47], a[232:235], v[76:79], a[44:47]
    v_exp_f32 v45, v45
    v_mfma_f32_16x16x32_bf16 a[48:51], a[236:239], v[64:67], a[48:51]
    ds_read_b128 a[204:207], v5 offset:32768
    v_cvt_pk_bf16_f32 v92, v44, v45
    v_mfma_f32_16x16x32_bf16 a[52:55], a[236:239], v[68:71], a[52:55]
    v_exp_f32 v46, v46
    v_mfma_f32_16x16x32_bf16 a[56:59], a[236:239], v[72:75], a[56:59]
    v_mfma_f32_16x16x32_bf16 a[60:63], a[236:239], v[76:79], a[60:63]
    v_exp_f32 v47, v47
    v_mfma_f32_16x16x32_bf16 v[132:135], v[160:163], v[68:71], v[132:135]
    ds_read_b128 a[208:211], v2 offset:36864
    v_cvt_pk_bf16_f32 v93, v46, v47
    v_mfma_f32_16x16x32_bf16 a[64:67], a[240:243], v[64:67], a[64:67]
    v_exp_f32 v48, v48
    v_mfma_f32_16x16x32_bf16 a[68:71], a[240:243], v[68:71], a[68:71]
    buffer_load_dwordx4 v16, s[8:11], s32 offen offset:2048 lds
    v_mfma_f32_16x16x32_bf16 a[72:75], a[240:243], v[72:75], a[72:75]
    v_exp_f32 v49, v49
    v_mfma_f32_16x16x32_bf16 a[76:79], a[240:243], v[76:79], a[76:79]
    ds_read_b128 a[212:215], v3 offset:36864
    v_cvt_pk_bf16_f32 v82, v48, v49
    v_mfma_f32_16x16x32_bf16 a[80:83], a[244:247], v[64:67], a[80:83]
    v_exp_f32 v50, v50
    v_mfma_f32_16x16x32_bf16 a[84:87], a[244:247], v[68:71], a[84:87]
    v_mfma_f32_16x16x32_bf16 a[88:91], a[244:247], v[72:75], a[88:91]
    v_exp_f32 v51, v51
    v_mfma_f32_16x16x32_bf16 a[92:95], a[244:247], v[76:79], a[92:95]
    ds_read_b128 a[216:219], v4 offset:36864
    v_cvt_pk_bf16_f32 v83, v50, v51
    v_mfma_f32_16x16x32_bf16 v[136:139], v[160:163], v[72:75], v[136:139]
    v_exp_f32 v52, v52
    v_mfma_f32_16x16x32_bf16 a[96:99], a[248:251], v[64:67], a[96:99]
    buffer_load_dwordx4 v17, s[8:11], s32 offen offset:3072 lds
    v_mfma_f32_16x16x32_bf16 a[100:103], a[248:251], v[68:71], a[100:103]
    v_exp_f32 v53, v53
    v_mfma_f32_16x16x32_bf16 a[104:107], a[248:251], v[72:75], a[104:107]
    ds_read_b128 a[220:223], v5 offset:36864
    v_cvt_pk_bf16_f32 v86, v52, v53
    v_mfma_f32_16x16x32_bf16 a[108:111], a[248:251], v[76:79], a[108:111]
    v_exp_f32 v54, v54
    v_mfma_f32_16x16x32_bf16 a[112:115], a[252:255], v[64:67], a[112:115]
    v_mfma_f32_16x16x32_bf16 a[116:119], a[252:255], v[68:71], a[116:119]
    v_exp_f32 v55, v55
    v_mfma_f32_16x16x32_bf16 a[120:123], a[252:255], v[72:75], a[120:123]
    v_cvt_pk_bf16_f32 v87, v54, v55
    v_mfma_f32_16x16x32_bf16 a[124:127], a[252:255], v[76:79], a[124:127]
    s_add_u32 s32, s32, 16384
    v_exp_f32 v56, v56
    v_mfma_f32_16x16x32_bf16 v[140:143], v[160:163], v[76:79], v[140:143]
    v_mfma_f32_16x16x32_bf16 v[32:35], a[192:195], v[144:147], v[96:99]
    s_waitcnt lgkmcnt(0)
    v_exp_f32 v57, v57
    v_mfma_f32_16x16x32_bf16 v[32:35], a[196:199], v[176:179], v[32:35]
    ds_read_b64_tr_b16 a[224:225], v6 offset:24576
    v_cvt_pk_bf16_f32 v90, v56, v57
    v_mfma_f32_16x16x32_bf16 v[32:35], a[200:203], v[208:211], v[32:35]
    v_exp_f32 v58, v58
    v_mfma_f32_16x16x32_bf16 v[32:35], a[204:207], v[240:243], v[32:35]
    ds_read_b64_tr_b16 a[226:227], v6 offset:28672
    v_mfma_f32_16x16x32_bf16 v[36:39], a[192:195], v[148:151], v[100:103]
    v_exp_f32 v59, v59
    v_mfma_f32_16x16x32_bf16 v[36:39], a[196:199], v[180:183], v[36:39]
    ds_read_b64_tr_b16 a[228:229], v7 offset:24576
    v_cvt_pk_bf16_f32 v91, v58, v59
    v_mfma_f32_16x16x32_bf16 v[36:39], a[200:203], v[212:215], v[36:39]
    v_exp_f32 v60, v60
    v_mfma_f32_16x16x32_bf16 v[36:39], a[204:207], v[244:247], v[36:39]
    ds_read_b64_tr_b16 a[230:231], v7 offset:28672
    v_mfma_f32_16x16x32_bf16 v[40:43], a[192:195], v[152:155], v[104:107]
    v_exp_f32 v61, v61
    v_mfma_f32_16x16x32_bf16 v[40:43], a[196:199], v[184:187], v[40:43]
    ds_read_b64_tr_b16 a[232:233], v8 offset:24576
    v_cvt_pk_bf16_f32 v94, v60, v61
    v_mfma_f32_16x16x32_bf16 v[40:43], a[200:203], v[216:219], v[40:43]
    v_exp_f32 v62, v62
    v_mfma_f32_16x16x32_bf16 v[40:43], a[204:207], v[248:251], v[40:43]
    ds_read_b64_tr_b16 a[234:235], v8 offset:28672
    v_mfma_f32_16x16x32_bf16 v[44:47], a[192:195], v[156:159], v[108:111]
    v_exp_f32 v63, v63
    v_mfma_f32_16x16x32_bf16 v[44:47], a[196:199], v[188:191], v[44:47]
    ds_read_b64_tr_b16 a[236:237], v9 offset:24576
    v_cvt_pk_bf16_f32 v95, v62, v63
    v_mfma_f32_16x16x32_bf16 v[44:47], a[200:203], v[220:223], v[44:47]
    v_mfma_f32_16x16x32_bf16 v[44:47], a[204:207], v[252:255], v[44:47]
    s_cmp_eq_u32 s40, 0
    s_cselect_b32 s60, s50, s56
    s_cselect_b32 s61, s51, s57
    s_cselect_b32 s62, 4194304, 0
    ds_read_b64_tr_b16 a[238:239], v9 offset:28672
    v_mfma_f32_16x16x32_bf16 v[48:51], a[208:211], v[144:147], v[96:99]
    v_mfma_f32_16x16x32_bf16 v[48:51], a[212:215], v[176:179], v[48:51]
    ds_read_b64_tr_b16 a[240:241], v10 offset:24576
    v_mfma_f32_16x16x32_bf16 v[48:51], a[216:219], v[208:211], v[48:51]
    v_exp_f32 v32, v32
    v_mfma_f32_16x16x32_bf16 v[48:51], a[220:223], v[240:243], v[48:51]
    ds_read_b64_tr_b16 a[242:243], v10 offset:28672
    v_mfma_f32_16x16x32_bf16 v[52:55], a[208:211], v[148:151], v[100:103]
    v_exp_f32 v33, v33
    v_mfma_f32_16x16x32_bf16 v[52:55], a[212:215], v[180:183], v[52:55]
    ds_read_b64_tr_b16 a[244:245], v11 offset:24576
    v_cvt_pk_bf16_f32 v64, v32, v33
    v_mfma_f32_16x16x32_bf16 v[52:55], a[216:219], v[212:215], v[52:55]
    v_exp_f32 v34, v34
    v_mfma_f32_16x16x32_bf16 v[52:55], a[220:223], v[244:247], v[52:55]
    ds_read_b64_tr_b16 a[246:247], v11 offset:28672
    v_mfma_f32_16x16x32_bf16 v[56:59], a[208:211], v[152:155], v[104:107]
    v_exp_f32 v35, v35
    v_mfma_f32_16x16x32_bf16 v[56:59], a[212:215], v[184:187], v[56:59]
    ds_read_b64_tr_b16 a[248:249], v12 offset:24576
    v_cvt_pk_bf16_f32 v65, v34, v35
    v_mfma_f32_16x16x32_bf16 v[56:59], a[216:219], v[216:219], v[56:59]
    v_exp_f32 v36, v36
    v_mfma_f32_16x16x32_bf16 v[56:59], a[220:223], v[248:251], v[56:59]
    ds_read_b64_tr_b16 a[250:251], v12 offset:28672
    v_mfma_f32_16x16x32_bf16 v[60:63], a[208:211], v[156:159], v[108:111]
    v_exp_f32 v37, v37
    v_mfma_f32_16x16x32_bf16 v[60:63], a[212:215], v[188:191], v[60:63]
    ds_read_b64_tr_b16 a[252:253], v13 offset:24576
    v_cvt_pk_bf16_f32 v68, v36, v37
    v_mfma_f32_16x16x32_bf16 v[60:63], a[216:219], v[220:223], v[60:63]
    v_exp_f32 v38, v38
    v_mfma_f32_16x16x32_bf16 v[60:63], a[220:223], v[252:255], v[60:63]
    s_waitcnt lgkmcnt(3)
    ds_read_b64_tr_b16 a[254:255], v13 offset:28672
    v_mfma_f32_16x16x32_bf16 a[0:3], a[224:227], v[80:83], a[0:3]
    v_exp_f32 v39, v39
    v_mfma_f32_16x16x32_bf16 a[4:7], a[224:227], v[84:87], a[4:7]
    ds_read_b128 a[192:195], v2 offset:40960
    v_cvt_pk_bf16_f32 v69, v38, v39
    v_mfma_f32_16x16x32_bf16 a[8:11], a[224:227], v[88:91], a[8:11]
    s_add_u32 m0, s34, 65536
    v_exp_f32 v40, v40
    v_mfma_f32_16x16x32_bf16 a[12:15], a[224:227], v[92:95], a[12:15]
    buffer_load_dwordx4 v18, s[12:15], s33 offen lds
    v_mfma_f32_16x16x32_bf16 a[16:19], a[228:231], v[80:83], a[16:19]
    v_exp_f32 v41, v41
    v_mfma_f32_16x16x32_bf16 a[20:23], a[228:231], v[84:87], a[20:23]
    ds_read_b128 a[196:199], v3 offset:40960
    v_cvt_pk_bf16_f32 v72, v40, v41
    v_mfma_f32_16x16x32_bf16 a[24:27], a[228:231], v[88:91], a[24:27]
    v_exp_f32 v42, v42
    v_mfma_f32_16x16x32_bf16 a[28:31], a[228:231], v[92:95], a[28:31]
    v_mfma_f32_16x16x32_bf16 v[128:131], v[160:163], v[80:83], v[128:131]
    v_exp_f32 v43, v43
    v_mfma_f32_16x16x32_bf16 a[32:35], a[232:235], v[80:83], a[32:35]
    ds_read_b128 a[200:203], v4 offset:40960
    v_cvt_pk_bf16_f32 v73, v42, v43
    v_mfma_f32_16x16x32_bf16 a[36:39], a[232:235], v[84:87], a[36:39]
    v_exp_f32 v44, v44
    v_mfma_f32_16x16x32_bf16 a[40:43], a[232:235], v[88:91], a[40:43]
    buffer_load_dwordx4 v19, s[12:15], s33 offen offset:1024 lds
    v_mfma_f32_16x16x32_bf16 a[44:47], a[232:235], v[92:95], a[44:47]
    v_exp_f32 v45, v45
    v_mfma_f32_16x16x32_bf16 a[48:51], a[236:239], v[80:83], a[48:51]
    ds_read_b128 a[204:207], v5 offset:40960
    v_cvt_pk_bf16_f32 v76, v44, v45
    v_mfma_f32_16x16x32_bf16 a[52:55], a[236:239], v[84:87], a[52:55]
    v_exp_f32 v46, v46
    v_mfma_f32_16x16x32_bf16 a[56:59], a[236:239], v[88:91], a[56:59]
    v_mfma_f32_16x16x32_bf16 a[60:63], a[236:239], v[92:95], a[60:63]
    v_exp_f32 v47, v47
    v_mfma_f32_16x16x32_bf16 v[132:135], v[160:163], v[84:87], v[132:135]
    ds_read_b128 a[208:211], v2 offset:45056
    v_cvt_pk_bf16_f32 v77, v46, v47
    v_mfma_f32_16x16x32_bf16 a[64:67], a[240:243], v[80:83], a[64:67]
    v_exp_f32 v48, v48
    v_mfma_f32_16x16x32_bf16 a[68:71], a[240:243], v[84:87], a[68:71]
    buffer_load_dwordx4 v18, s[12:15], s33 offen offset:2048 lds
    v_mfma_f32_16x16x32_bf16 a[72:75], a[240:243], v[88:91], a[72:75]
    v_exp_f32 v49, v49
    v_mfma_f32_16x16x32_bf16 a[76:79], a[240:243], v[92:95], a[76:79]
    ds_read_b128 a[212:215], v3 offset:45056
    v_cvt_pk_bf16_f32 v66, v48, v49
    v_mfma_f32_16x16x32_bf16 a[80:83], a[244:247], v[80:83], a[80:83]
    v_exp_f32 v50, v50
    v_mfma_f32_16x16x32_bf16 a[84:87], a[244:247], v[84:87], a[84:87]
    v_mfma_f32_16x16x32_bf16 a[88:91], a[244:247], v[88:91], a[88:91]
    v_exp_f32 v51, v51
    v_mfma_f32_16x16x32_bf16 a[92:95], a[244:247], v[92:95], a[92:95]
    ds_read_b128 a[216:219], v4 offset:45056
    v_cvt_pk_bf16_f32 v67, v50, v51
    v_mfma_f32_16x16x32_bf16 v[136:139], v[160:163], v[88:91], v[136:139]
    s_waitcnt lgkmcnt(2)
    v_exp_f32 v52, v52
    v_mfma_f32_16x16x32_bf16 a[96:99], a[248:251], v[80:83], a[96:99]
    buffer_load_dwordx4 v19, s[12:15], s33 offen offset:3072 lds
    v_mfma_f32_16x16x32_bf16 a[100:103], a[248:251], v[84:87], a[100:103]
    v_exp_f32 v53, v53
    v_mfma_f32_16x16x32_bf16 a[104:107], a[248:251], v[88:91], a[104:107]
    ds_read_b128 a[220:223], v5 offset:45056
    v_cvt_pk_bf16_f32 v70, v52, v53
    v_mfma_f32_16x16x32_bf16 a[108:111], a[248:251], v[92:95], a[108:111]
    v_exp_f32 v54, v54
    v_mfma_f32_16x16x32_bf16 a[112:115], a[252:255], v[80:83], a[112:115]
    v_mfma_f32_16x16x32_bf16 a[116:119], a[252:255], v[84:87], a[116:119]
    v_exp_f32 v55, v55
    v_mfma_f32_16x16x32_bf16 a[120:123], a[252:255], v[88:91], a[120:123]
    v_cvt_pk_bf16_f32 v71, v54, v55
    v_mfma_f32_16x16x32_bf16 a[124:127], a[252:255], v[92:95], a[124:127]
    s_add_u32 s33, s33, 16384
    v_exp_f32 v56, v56
    v_mfma_f32_16x16x32_bf16 v[140:143], v[160:163], v[92:95], v[140:143]
    v_mfma_f32_16x16x32_bf16 v[32:35], a[192:195], v[144:147], v[96:99]
    v_exp_f32 v57, v57
    v_mfma_f32_16x16x32_bf16 v[32:35], a[196:199], v[176:179], v[32:35]
    ds_read_b64_tr_b16 a[224:225], v6 offset:32768
    v_cvt_pk_bf16_f32 v74, v56, v57
    v_mfma_f32_16x16x32_bf16 v[32:35], a[200:203], v[208:211], v[32:35]
    v_exp_f32 v58, v58
    v_mfma_f32_16x16x32_bf16 v[32:35], a[204:207], v[240:243], v[32:35]
    ds_read_b64_tr_b16 a[226:227], v6 offset:36864
    v_mfma_f32_16x16x32_bf16 v[36:39], a[192:195], v[148:151], v[100:103]
    v_exp_f32 v59, v59
    v_mfma_f32_16x16x32_bf16 v[36:39], a[196:199], v[180:183], v[36:39]
    ds_read_b64_tr_b16 a[228:229], v7 offset:32768
    v_cvt_pk_bf16_f32 v75, v58, v59
    v_mfma_f32_16x16x32_bf16 v[36:39], a[200:203], v[212:215], v[36:39]
    v_exp_f32 v60, v60
    v_mfma_f32_16x16x32_bf16 v[36:39], a[204:207], v[244:247], v[36:39]
    ds_read_b64_tr_b16 a[230:231], v7 offset:36864
    v_mfma_f32_16x16x32_bf16 v[40:43], a[192:195], v[152:155], v[104:107]
    v_exp_f32 v61, v61
    v_mfma_f32_16x16x32_bf16 v[40:43], a[196:199], v[184:187], v[40:43]
    ds_read_b64_tr_b16 a[232:233], v8 offset:32768
    v_cvt_pk_bf16_f32 v78, v60, v61
    v_mfma_f32_16x16x32_bf16 v[40:43], a[200:203], v[216:219], v[40:43]
    v_exp_f32 v62, v62
    v_mfma_f32_16x16x32_bf16 v[40:43], a[204:207], v[248:251], v[40:43]
    ds_read_b64_tr_b16 a[234:235], v8 offset:36864
    v_mfma_f32_16x16x32_bf16 v[44:47], a[192:195], v[156:159], v[108:111]
    v_exp_f32 v63, v63
    v_mfma_f32_16x16x32_bf16 v[44:47], a[196:199], v[188:191], v[44:47]
    ds_read_b64_tr_b16 a[236:237], v9 offset:32768
    v_cvt_pk_bf16_f32 v79, v62, v63
    v_mfma_f32_16x16x32_bf16 v[44:47], a[200:203], v[220:223], v[44:47]
    v_mfma_f32_16x16x32_bf16 v[44:47], a[204:207], v[252:255], v[44:47]
    ds_read_b64_tr_b16 a[238:239], v9 offset:36864
    v_mfma_f32_16x16x32_bf16 v[48:51], a[208:211], v[144:147], v[96:99]
    s_waitcnt lgkmcnt(3)
    v_mfma_f32_16x16x32_bf16 v[48:51], a[212:215], v[176:179], v[48:51]
    ds_read_b64_tr_b16 a[240:241], v10 offset:32768
    v_mfma_f32_16x16x32_bf16 v[48:51], a[216:219], v[208:211], v[48:51]
    v_exp_f32 v32, v32
    v_mfma_f32_16x16x32_bf16 v[48:51], a[220:223], v[240:243], v[48:51]
    ds_read_b64_tr_b16 a[242:243], v10 offset:36864
    v_mfma_f32_16x16x32_bf16 v[52:55], a[208:211], v[148:151], v[100:103]
    v_exp_f32 v33, v33
    v_mfma_f32_16x16x32_bf16 v[52:55], a[212:215], v[180:183], v[52:55]
    ds_read_b64_tr_b16 a[244:245], v11 offset:32768
    v_cvt_pk_bf16_f32 v80, v32, v33
    v_mfma_f32_16x16x32_bf16 v[52:55], a[216:219], v[212:215], v[52:55]
    v_exp_f32 v34, v34
    v_mfma_f32_16x16x32_bf16 v[52:55], a[220:223], v[244:247], v[52:55]
    ds_read_b64_tr_b16 a[246:247], v11 offset:36864
    v_mfma_f32_16x16x32_bf16 v[56:59], a[208:211], v[152:155], v[104:107]
    v_exp_f32 v35, v35
    v_mfma_f32_16x16x32_bf16 v[56:59], a[212:215], v[184:187], v[56:59]
    ds_read_b64_tr_b16 a[248:249], v12 offset:32768
    v_cvt_pk_bf16_f32 v81, v34, v35
    v_mfma_f32_16x16x32_bf16 v[56:59], a[216:219], v[216:219], v[56:59]
    v_exp_f32 v36, v36
    v_mfma_f32_16x16x32_bf16 v[56:59], a[220:223], v[248:251], v[56:59]
    ds_read_b64_tr_b16 a[250:251], v12 offset:36864
    v_mfma_f32_16x16x32_bf16 v[60:63], a[208:211], v[156:159], v[108:111]
    v_exp_f32 v37, v37
    v_mfma_f32_16x16x32_bf16 v[60:63], a[212:215], v[188:191], v[60:63]
    ds_read_b64_tr_b16 a[252:253], v13 offset:32768
    v_cvt_pk_bf16_f32 v84, v36, v37
    v_mfma_f32_16x16x32_bf16 v[60:63], a[216:219], v[220:223], v[60:63]
    v_exp_f32 v38, v38
    v_mfma_f32_16x16x32_bf16 v[60:63], a[220:223], v[252:255], v[60:63]
    ds_read_b64_tr_b16 a[254:255], v13 offset:36864
    s_waitcnt vmcnt(8)
    s_barrier
    v_mfma_f32_16x16x32_bf16 a[0:3], a[224:227], v[64:67], a[0:3]
    v_exp_f32 v39, v39
    v_mfma_f32_16x16x32_bf16 a[4:7], a[224:227], v[68:71], a[4:7]
    ds_read_b128 a[192:195], v2 offset:49152
    v_cvt_pk_bf16_f32 v85, v38, v39
    v_mfma_f32_16x16x32_bf16 a[8:11], a[224:227], v[72:75], a[8:11]
    s_add_u32 m0, s34, 32768
    v_exp_f32 v40, v40
    v_mfma_f32_16x16x32_bf16 a[12:15], a[224:227], v[76:79], a[12:15]
    buffer_load_dwordx4 v14, s[8:11], s32 offen lds
    v_mfma_f32_16x16x32_bf16 a[16:19], a[228:231], v[64:67], a[16:19]
    v_exp_f32 v41, v41
    v_mfma_f32_16x16x32_bf16 a[20:23], a[228:231], v[68:71], a[20:23]
    ds_read_b128 a[196:199], v3 offset:49152
    v_cvt_pk_bf16_f32 v88, v40, v41
    v_mfma_f32_16x16x32_bf16 a[24:27], a[228:231], v[72:75], a[24:27]
    v_exp_f32 v42, v42
    v_mfma_f32_16x16x32_bf16 a[28:31], a[228:231], v[76:79], a[28:31]
    buffer_store_dword v123, v122, s[92:95], 0 offen sc1
    v_mfma_f32_16x16x32_bf16 v[128:131], v[160:163], v[64:67], v[128:131]
    s_waitcnt lgkmcnt(1)
    v_exp_f32 v43, v43
    v_mfma_f32_16x16x32_bf16 a[32:35], a[232:235], v[64:67], a[32:35]
    ds_read_b128 a[200:203], v4 offset:49152
    v_cvt_pk_bf16_f32 v89, v42, v43
    v_or_b32 v122, 0x40000000, v122
    v_mfma_f32_16x16x32_bf16 a[36:39], a[232:235], v[68:71], a[36:39]
    v_exp_f32 v44, v44
    v_mfma_f32_16x16x32_bf16 a[40:43], a[232:235], v[72:75], a[40:43]
    buffer_load_dwordx4 v15, s[8:11], s32 offen offset:1024 lds
    v_mfma_f32_16x16x32_bf16 a[44:47], a[232:235], v[76:79], a[44:47]
    v_exp_f32 v45, v45
    v_mfma_f32_16x16x32_bf16 a[48:51], a[236:239], v[64:67], a[48:51]
    ds_read_b128 a[204:207], v5 offset:49152
    v_cvt_pk_bf16_f32 v92, v44, v45
    v_mfma_f32_16x16x32_bf16 a[52:55], a[236:239], v[68:71], a[52:55]
    v_exp_f32 v46, v46
    v_mfma_f32_16x16x32_bf16 a[56:59], a[236:239], v[72:75], a[56:59]
    buffer_store_dword v119, v118, s[92:95], 0 offen sc1
    v_mfma_f32_16x16x32_bf16 a[60:63], a[236:239], v[76:79], a[60:63]
    v_exp_f32 v47, v47
    v_mfma_f32_16x16x32_bf16 v[132:135], v[160:163], v[68:71], v[132:135]
    ds_read_b128 a[208:211], v2 offset:53248
    v_cvt_pk_bf16_f32 v93, v46, v47
    v_mfma_f32_16x16x32_bf16 a[64:67], a[240:243], v[64:67], a[64:67]
    v_exp_f32 v48, v48
    v_mfma_f32_16x16x32_bf16 a[68:71], a[240:243], v[68:71], a[68:71]
    buffer_load_dwordx4 v16, s[8:11], s32 offen offset:2048 lds
    v_mfma_f32_16x16x32_bf16 a[72:75], a[240:243], v[72:75], a[72:75]
    v_exp_f32 v49, v49
    v_mfma_f32_16x16x32_bf16 a[76:79], a[240:243], v[76:79], a[76:79]
    ds_read_b128 a[212:215], v3 offset:53248
    v_cvt_pk_bf16_f32 v82, v48, v49
    v_mfma_f32_16x16x32_bf16 a[80:83], a[244:247], v[64:67], a[80:83]
    v_exp_f32 v50, v50
    v_mfma_f32_16x16x32_bf16 a[84:87], a[244:247], v[68:71], a[84:87]
    v_or_b32 v118, 0x40000000, v118
    v_mfma_f32_16x16x32_bf16 a[88:91], a[244:247], v[72:75], a[88:91]
    v_exp_f32 v51, v51
    v_mfma_f32_16x16x32_bf16 a[92:95], a[244:247], v[76:79], a[92:95]
    ds_read_b128 a[216:219], v4 offset:53248
    v_cvt_pk_bf16_f32 v83, v50, v51
    v_mfma_f32_16x16x32_bf16 v[136:139], v[160:163], v[72:75], v[136:139]
    v_exp_f32 v52, v52
    v_mfma_f32_16x16x32_bf16 a[96:99], a[248:251], v[64:67], a[96:99]
    buffer_load_dwordx4 v17, s[8:11], s32 offen offset:3072 lds
    v_mfma_f32_16x16x32_bf16 a[100:103], a[248:251], v[68:71], a[100:103]
    v_exp_f32 v53, v53
    v_mfma_f32_16x16x32_bf16 a[104:107], a[248:251], v[72:75], a[104:107]
    ds_read_b128 a[220:223], v5 offset:53248
    v_cvt_pk_bf16_f32 v86, v52, v53
    v_mfma_f32_16x16x32_bf16 a[108:111], a[248:251], v[76:79], a[108:111]
    v_exp_f32 v54, v54
    v_mfma_f32_16x16x32_bf16 a[112:115], a[252:255], v[64:67], a[112:115]
    v_mfma_f32_16x16x32_bf16 a[116:119], a[252:255], v[68:71], a[116:119]
    v_exp_f32 v55, v55
    v_mfma_f32_16x16x32_bf16 a[120:123], a[252:255], v[72:75], a[120:123]
    v_cvt_pk_bf16_f32 v87, v54, v55
    v_mfma_f32_16x16x32_bf16 a[124:127], a[252:255], v[76:79], a[124:127]
    s_add_u32 s32, s32, 16384
    v_exp_f32 v56, v56
    v_mfma_f32_16x16x32_bf16 v[140:143], v[160:163], v[76:79], v[140:143]
    v_mfma_f32_16x16x32_bf16 v[32:35], a[192:195], v[144:147], v[96:99]
    s_waitcnt lgkmcnt(0)
    v_exp_f32 v57, v57
    v_mfma_f32_16x16x32_bf16 v[32:35], a[196:199], v[176:179], v[32:35]
    ds_read_b64_tr_b16 a[224:225], v6 offset:40960
    v_cvt_pk_bf16_f32 v90, v56, v57
    v_mfma_f32_16x16x32_bf16 v[32:35], a[200:203], v[208:211], v[32:35]
    v_exp_f32 v58, v58
    v_mfma_f32_16x16x32_bf16 v[32:35], a[204:207], v[240:243], v[32:35]
    ds_read_b64_tr_b16 a[226:227], v6 offset:45056
    v_mfma_f32_16x16x32_bf16 v[36:39], a[192:195], v[148:151], v[100:103]
    v_exp_f32 v59, v59
    v_mfma_f32_16x16x32_bf16 v[36:39], a[196:199], v[180:183], v[36:39]
    ds_read_b64_tr_b16 a[228:229], v7 offset:40960
    v_cvt_pk_bf16_f32 v91, v58, v59
    v_mfma_f32_16x16x32_bf16 v[36:39], a[200:203], v[212:215], v[36:39]
    v_exp_f32 v60, v60
    v_mfma_f32_16x16x32_bf16 v[36:39], a[204:207], v[244:247], v[36:39]
    ds_read_b64_tr_b16 a[230:231], v7 offset:45056
    v_mfma_f32_16x16x32_bf16 v[40:43], a[192:195], v[152:155], v[104:107]
    v_exp_f32 v61, v61
    v_mfma_f32_16x16x32_bf16 v[40:43], a[196:199], v[184:187], v[40:43]
    ds_read_b64_tr_b16 a[232:233], v8 offset:40960
    v_cvt_pk_bf16_f32 v94, v60, v61
    v_mfma_f32_16x16x32_bf16 v[40:43], a[200:203], v[216:219], v[40:43]
    v_exp_f32 v62, v62
    v_mfma_f32_16x16x32_bf16 v[40:43], a[204:207], v[248:251], v[40:43]
    ds_read_b64_tr_b16 a[234:235], v8 offset:45056
    v_mfma_f32_16x16x32_bf16 v[44:47], a[192:195], v[156:159], v[108:111]
    v_exp_f32 v63, v63
    v_mfma_f32_16x16x32_bf16 v[44:47], a[196:199], v[188:191], v[44:47]
    ds_read_b64_tr_b16 a[236:237], v9 offset:40960
    v_cvt_pk_bf16_f32 v95, v62, v63
    v_mfma_f32_16x16x32_bf16 v[44:47], a[200:203], v[220:223], v[44:47]
    v_mfma_f32_16x16x32_bf16 v[44:47], a[204:207], v[252:255], v[44:47]
    ds_read_b64_tr_b16 a[238:239], v9 offset:45056
    v_mfma_f32_16x16x32_bf16 v[48:51], a[208:211], v[144:147], v[96:99]
    v_mfma_f32_16x16x32_bf16 v[48:51], a[212:215], v[176:179], v[48:51]
    ds_read_b64_tr_b16 a[240:241], v10 offset:40960
    v_mfma_f32_16x16x32_bf16 v[48:51], a[216:219], v[208:211], v[48:51]
    v_exp_f32 v32, v32
    v_mfma_f32_16x16x32_bf16 v[48:51], a[220:223], v[240:243], v[48:51]
    ds_read_b64_tr_b16 a[242:243], v10 offset:45056
    v_mfma_f32_16x16x32_bf16 v[52:55], a[208:211], v[148:151], v[100:103]
    v_exp_f32 v33, v33
    v_mfma_f32_16x16x32_bf16 v[52:55], a[212:215], v[180:183], v[52:55]
    ds_read_b64_tr_b16 a[244:245], v11 offset:40960
    v_cvt_pk_bf16_f32 v64, v32, v33
    v_mfma_f32_16x16x32_bf16 v[52:55], a[216:219], v[212:215], v[52:55]
    v_exp_f32 v34, v34
    v_mfma_f32_16x16x32_bf16 v[52:55], a[220:223], v[244:247], v[52:55]
    ds_read_b64_tr_b16 a[246:247], v11 offset:45056
    v_mfma_f32_16x16x32_bf16 v[56:59], a[208:211], v[152:155], v[104:107]
    v_exp_f32 v35, v35
    v_mfma_f32_16x16x32_bf16 v[56:59], a[212:215], v[184:187], v[56:59]
    ds_read_b64_tr_b16 a[248:249], v12 offset:40960
    v_cvt_pk_bf16_f32 v65, v34, v35
    v_mfma_f32_16x16x32_bf16 v[56:59], a[216:219], v[216:219], v[56:59]
    v_exp_f32 v36, v36
    v_mfma_f32_16x16x32_bf16 v[56:59], a[220:223], v[248:251], v[56:59]
    ds_read_b64_tr_b16 a[250:251], v12 offset:45056
    v_mfma_f32_16x16x32_bf16 v[60:63], a[208:211], v[156:159], v[108:111]
    v_exp_f32 v37, v37
    v_mfma_f32_16x16x32_bf16 v[60:63], a[212:215], v[188:191], v[60:63]
    ds_read_b64_tr_b16 a[252:253], v13 offset:40960
    v_cvt_pk_bf16_f32 v68, v36, v37
    v_mfma_f32_16x16x32_bf16 v[60:63], a[216:219], v[220:223], v[60:63]
    v_exp_f32 v38, v38
    v_mfma_f32_16x16x32_bf16 v[60:63], a[220:223], v[252:255], v[60:63]
    s_waitcnt lgkmcnt(3)
    ds_read_b64_tr_b16 a[254:255], v13 offset:45056
    v_mfma_f32_16x16x32_bf16 a[0:3], a[224:227], v[80:83], a[0:3]
    v_exp_f32 v39, v39
    v_mfma_f32_16x16x32_bf16 a[4:7], a[224:227], v[84:87], a[4:7]
    ds_read_b128 a[192:195], v2 offset:57344
    v_cvt_pk_bf16_f32 v69, v38, v39
    v_mfma_f32_16x16x32_bf16 a[8:11], a[224:227], v[88:91], a[8:11]
    s_add_u32 m0, s34, 81920
    v_exp_f32 v40, v40
    v_mfma_f32_16x16x32_bf16 a[12:15], a[224:227], v[92:95], a[12:15]
    buffer_load_dwordx4 v18, s[12:15], s33 offen lds
    v_mfma_f32_16x16x32_bf16 a[16:19], a[228:231], v[80:83], a[16:19]
    v_exp_f32 v41, v41
    v_mfma_f32_16x16x32_bf16 a[20:23], a[228:231], v[84:87], a[20:23]
    ds_read_b128 a[196:199], v3 offset:57344
    v_cvt_pk_bf16_f32 v72, v40, v41
    v_mfma_f32_16x16x32_bf16 a[24:27], a[228:231], v[88:91], a[24:27]
    v_exp_f32 v42, v42
    v_mfma_f32_16x16x32_bf16 a[28:31], a[228:231], v[92:95], a[28:31]
    buffer_load_dword v125, v126, s[76:79], s90 offen
    v_mfma_f32_16x16x32_bf16 v[128:131], v[160:163], v[80:83], v[128:131]
    v_exp_f32 v43, v43
    v_mfma_f32_16x16x32_bf16 a[32:35], a[232:235], v[80:83], a[32:35]
    ds_read_b128 a[200:203], v4 offset:57344
    v_cvt_pk_bf16_f32 v73, v42, v43
    v_mfma_f32_16x16x32_bf16 a[36:39], a[232:235], v[84:87], a[36:39]
    v_exp_f32 v44, v44
    v_mfma_f32_16x16x32_bf16 a[40:43], a[232:235], v[88:91], a[40:43]
    buffer_load_dwordx4 v19, s[12:15], s33 offen offset:1024 lds
    v_mfma_f32_16x16x32_bf16 a[44:47], a[232:235], v[92:95], a[44:47]
    v_exp_f32 v45, v45
    v_mfma_f32_16x16x32_bf16 a[48:51], a[236:239], v[80:83], a[48:51]
    ds_read_b128 a[204:207], v5 offset:57344
    v_cvt_pk_bf16_f32 v76, v44, v45
    v_mfma_f32_16x16x32_bf16 a[52:55], a[236:239], v[84:87], a[52:55]
    v_exp_f32 v46, v46
    v_mfma_f32_16x16x32_bf16 a[56:59], a[236:239], v[88:91], a[56:59]
    v_mfma_f32_16x16x32_bf16 a[60:63], a[236:239], v[92:95], a[60:63]
    v_exp_f32 v47, v47
    v_mfma_f32_16x16x32_bf16 v[132:135], v[160:163], v[84:87], v[132:135]
    ds_read_b128 a[208:211], v2 offset:61440
    v_cvt_pk_bf16_f32 v77, v46, v47
    v_mfma_f32_16x16x32_bf16 a[64:67], a[240:243], v[80:83], a[64:67]
    v_exp_f32 v48, v48
    v_mfma_f32_16x16x32_bf16 a[68:71], a[240:243], v[84:87], a[68:71]
    buffer_load_dwordx4 v18, s[12:15], s33 offen offset:2048 lds
    v_mfma_f32_16x16x32_bf16 a[72:75], a[240:243], v[88:91], a[72:75]
    v_exp_f32 v49, v49
    v_mfma_f32_16x16x32_bf16 a[76:79], a[240:243], v[92:95], a[76:79]
    ds_read_b128 a[212:215], v3 offset:61440
    v_cvt_pk_bf16_f32 v66, v48, v49
    v_mfma_f32_16x16x32_bf16 a[80:83], a[244:247], v[80:83], a[80:83]
    v_exp_f32 v50, v50
    v_mfma_f32_16x16x32_bf16 a[84:87], a[244:247], v[84:87], a[84:87]
    v_mfma_f32_16x16x32_bf16 a[88:91], a[244:247], v[88:91], a[88:91]
    v_exp_f32 v51, v51
    v_mfma_f32_16x16x32_bf16 a[92:95], a[244:247], v[92:95], a[92:95]
    ds_read_b128 a[216:219], v4 offset:61440
    v_cvt_pk_bf16_f32 v67, v50, v51
    v_mfma_f32_16x16x32_bf16 v[136:139], v[160:163], v[88:91], v[136:139]
    s_waitcnt lgkmcnt(2)
    v_exp_f32 v52, v52
    v_mfma_f32_16x16x32_bf16 a[96:99], a[248:251], v[80:83], a[96:99]
    buffer_load_dwordx4 v19, s[12:15], s33 offen offset:3072 lds
    v_mfma_f32_16x16x32_bf16 a[100:103], a[248:251], v[84:87], a[100:103]
    v_exp_f32 v53, v53
    v_mfma_f32_16x16x32_bf16 a[104:107], a[248:251], v[88:91], a[104:107]
    ds_read_b128 a[220:223], v5 offset:61440
    v_cvt_pk_bf16_f32 v70, v52, v53
    v_mfma_f32_16x16x32_bf16 a[108:111], a[248:251], v[92:95], a[108:111]
    v_exp_f32 v54, v54
    v_mfma_f32_16x16x32_bf16 a[112:115], a[252:255], v[80:83], a[112:115]
    v_mfma_f32_16x16x32_bf16 a[116:119], a[252:255], v[84:87], a[116:119]
    v_exp_f32 v55, v55
    v_mfma_f32_16x16x32_bf16 a[120:123], a[252:255], v[88:91], a[120:123]
    v_cvt_pk_bf16_f32 v71, v54, v55
    v_mfma_f32_16x16x32_bf16 a[124:127], a[252:255], v[92:95], a[124:127]
    s_add_u32 s33, s33, 16384
    v_exp_f32 v56, v56
    v_mfma_f32_16x16x32_bf16 v[140:143], v[160:163], v[92:95], v[140:143]
    v_mfma_f32_16x16x32_bf16 v[32:35], a[192:195], v[144:147], v[96:99]
    v_exp_f32 v57, v57
    v_mfma_f32_16x16x32_bf16 v[32:35], a[196:199], v[176:179], v[32:35]
    ds_read_b64_tr_b16 a[224:225], v6 offset:49152
    v_cvt_pk_bf16_f32 v74, v56, v57
    v_mfma_f32_16x16x32_bf16 v[32:35], a[200:203], v[208:211], v[32:35]
    v_exp_f32 v58, v58
    v_mfma_f32_16x16x32_bf16 v[32:35], a[204:207], v[240:243], v[32:35]
    ds_read_b64_tr_b16 a[226:227], v6 offset:53248
    v_mfma_f32_16x16x32_bf16 v[36:39], a[192:195], v[148:151], v[100:103]
    v_exp_f32 v59, v59
    v_mfma_f32_16x16x32_bf16 v[36:39], a[196:199], v[180:183], v[36:39]
    ds_read_b64_tr_b16 a[228:229], v7 offset:49152
    v_cvt_pk_bf16_f32 v75, v58, v59
    v_mfma_f32_16x16x32_bf16 v[36:39], a[200:203], v[212:215], v[36:39]
    v_exp_f32 v60, v60
    v_mfma_f32_16x16x32_bf16 v[36:39], a[204:207], v[244:247], v[36:39]
    ds_read_b64_tr_b16 a[230:231], v7 offset:53248
    v_mfma_f32_16x16x32_bf16 v[40:43], a[192:195], v[152:155], v[104:107]
    v_exp_f32 v61, v61
    v_mfma_f32_16x16x32_bf16 v[40:43], a[196:199], v[184:187], v[40:43]
    ds_read_b64_tr_b16 a[232:233], v8 offset:49152
    v_cvt_pk_bf16_f32 v78, v60, v61
    v_mfma_f32_16x16x32_bf16 v[40:43], a[200:203], v[216:219], v[40:43]
    v_exp_f32 v62, v62
    v_mfma_f32_16x16x32_bf16 v[40:43], a[204:207], v[248:251], v[40:43]
    ds_read_b64_tr_b16 a[234:235], v8 offset:53248
    v_mfma_f32_16x16x32_bf16 v[44:47], a[192:195], v[156:159], v[108:111]
    v_exp_f32 v63, v63
    v_mfma_f32_16x16x32_bf16 v[44:47], a[196:199], v[188:191], v[44:47]
    ds_read_b64_tr_b16 a[236:237], v9 offset:49152
    v_cvt_pk_bf16_f32 v79, v62, v63
    v_mfma_f32_16x16x32_bf16 v[44:47], a[200:203], v[220:223], v[44:47]
    v_mfma_f32_16x16x32_bf16 v[44:47], a[204:207], v[252:255], v[44:47]
    ds_read_b64_tr_b16 a[238:239], v9 offset:53248
    v_mfma_f32_16x16x32_bf16 v[48:51], a[208:211], v[144:147], v[96:99]
    s_waitcnt lgkmcnt(3)
    v_mfma_f32_16x16x32_bf16 v[48:51], a[212:215], v[176:179], v[48:51]
    ds_read_b64_tr_b16 a[240:241], v10 offset:49152
    v_mfma_f32_16x16x32_bf16 v[48:51], a[216:219], v[208:211], v[48:51]
    v_exp_f32 v32, v32
    v_mfma_f32_16x16x32_bf16 v[48:51], a[220:223], v[240:243], v[48:51]
    ds_read_b64_tr_b16 a[242:243], v10 offset:53248
    v_mfma_f32_16x16x32_bf16 v[52:55], a[208:211], v[148:151], v[100:103]
    v_exp_f32 v33, v33
    v_mfma_f32_16x16x32_bf16 v[52:55], a[212:215], v[180:183], v[52:55]
    ds_read_b64_tr_b16 a[244:245], v11 offset:49152
    v_cvt_pk_bf16_f32 v80, v32, v33
    v_mfma_f32_16x16x32_bf16 v[52:55], a[216:219], v[212:215], v[52:55]
    v_exp_f32 v34, v34
    v_mfma_f32_16x16x32_bf16 v[52:55], a[220:223], v[244:247], v[52:55]
    ds_read_b64_tr_b16 a[246:247], v11 offset:53248
    v_mfma_f32_16x16x32_bf16 v[56:59], a[208:211], v[152:155], v[104:107]
    v_exp_f32 v35, v35
    v_mfma_f32_16x16x32_bf16 v[56:59], a[212:215], v[184:187], v[56:59]
    ds_read_b64_tr_b16 a[248:249], v12 offset:49152
    v_cvt_pk_bf16_f32 v81, v34, v35
    v_mfma_f32_16x16x32_bf16 v[56:59], a[216:219], v[216:219], v[56:59]
    v_exp_f32 v36, v36
    v_mfma_f32_16x16x32_bf16 v[56:59], a[220:223], v[248:251], v[56:59]
    ds_read_b64_tr_b16 a[250:251], v12 offset:53248
    v_mfma_f32_16x16x32_bf16 v[60:63], a[208:211], v[156:159], v[108:111]
    v_exp_f32 v37, v37
    v_mfma_f32_16x16x32_bf16 v[60:63], a[212:215], v[188:191], v[60:63]
    ds_read_b64_tr_b16 a[252:253], v13 offset:49152
    v_cvt_pk_bf16_f32 v84, v36, v37
    v_mfma_f32_16x16x32_bf16 v[60:63], a[216:219], v[220:223], v[60:63]
    v_exp_f32 v38, v38
    v_mfma_f32_16x16x32_bf16 v[60:63], a[220:223], v[252:255], v[60:63]
    ds_read_b64_tr_b16 a[254:255], v13 offset:53248
    s_waitcnt vmcnt(11)
    s_barrier
    v_mfma_f32_16x16x32_bf16 a[0:3], a[224:227], v[64:67], a[0:3]
    v_exp_f32 v39, v39
    v_mfma_f32_16x16x32_bf16 a[4:7], a[224:227], v[68:71], a[4:7]
    ds_read_b128 a[192:195], v2
    v_cvt_pk_bf16_f32 v85, v38, v39
    v_mfma_f32_16x16x32_bf16 a[8:11], a[224:227], v[72:75], a[8:11]
    s_add_u32 m0, s34, 49152
    v_exp_f32 v40, v40
    v_mfma_f32_16x16x32_bf16 a[12:15], a[224:227], v[76:79], a[12:15]
    buffer_load_dwordx4 v14, s[8:11], s32 offen lds
    v_mfma_f32_16x16x32_bf16 a[16:19], a[228:231], v[64:67], a[16:19]
    v_exp_f32 v41, v41
    v_mfma_f32_16x16x32_bf16 a[20:23], a[228:231], v[68:71], a[20:23]
    ds_read_b128 a[196:199], v3
    v_cvt_pk_bf16_f32 v88, v40, v41
    v_mfma_f32_16x16x32_bf16 a[24:27], a[228:231], v[72:75], a[24:27]
    v_exp_f32 v42, v42
    v_mfma_f32_16x16x32_bf16 a[28:31], a[228:231], v[76:79], a[28:31]
    buffer_load_dword v28, v29, s[92:95], 0 offen sc1
    v_mfma_f32_16x16x32_bf16 v[128:131], v[160:163], v[64:67], v[128:131]
    s_waitcnt lgkmcnt(1)
    v_exp_f32 v43, v43
    v_mfma_f32_16x16x32_bf16 a[32:35], a[232:235], v[64:67], a[32:35]
    ds_read_b128 a[200:203], v4
    v_cvt_pk_bf16_f32 v89, v42, v43
    v_mfma_f32_16x16x32_bf16 a[36:39], a[232:235], v[68:71], a[36:39]
    v_exp_f32 v44, v44
    v_mfma_f32_16x16x32_bf16 a[40:43], a[232:235], v[72:75], a[40:43]
    buffer_load_dwordx4 v15, s[8:11], s32 offen offset:1024 lds
    v_mfma_f32_16x16x32_bf16 a[44:47], a[232:235], v[76:79], a[44:47]
    v_exp_f32 v45, v45
    v_mfma_f32_16x16x32_bf16 a[48:51], a[236:239], v[64:67], a[48:51]
    ds_read_b128 a[204:207], v5
    v_cvt_pk_bf16_f32 v92, v44, v45
    v_mfma_f32_16x16x32_bf16 a[52:55], a[236:239], v[68:71], a[52:55]
    v_exp_f32 v46, v46
    v_mfma_f32_16x16x32_bf16 a[56:59], a[236:239], v[72:75], a[56:59]
    buffer_load_dwordx4 v[168:171], v30, s[92:95], s75 offen sc1
    v_mfma_f32_16x16x32_bf16 a[60:63], a[236:239], v[76:79], a[60:63]
    v_exp_f32 v47, v47
    v_mfma_f32_16x16x32_bf16 v[132:135], v[160:163], v[68:71], v[132:135]
    ds_read_b128 a[208:211], v2 offset:4096
    v_cvt_pk_bf16_f32 v93, v46, v47
    v_mfma_f32_16x16x32_bf16 a[64:67], a[240:243], v[64:67], a[64:67]
    v_exp_f32 v48, v48
    v_mfma_f32_16x16x32_bf16 a[68:71], a[240:243], v[68:71], a[68:71]
    buffer_load_dwordx4 v16, s[8:11], s32 offen offset:2048 lds
    v_mfma_f32_16x16x32_bf16 a[72:75], a[240:243], v[72:75], a[72:75]
    v_exp_f32 v49, v49
    v_mfma_f32_16x16x32_bf16 a[76:79], a[240:243], v[76:79], a[76:79]
    ds_read_b128 a[212:215], v3 offset:4096
    v_cvt_pk_bf16_f32 v82, v48, v49
    v_mfma_f32_16x16x32_bf16 a[80:83], a[244:247], v[64:67], a[80:83]
    v_exp_f32 v50, v50
    v_mfma_f32_16x16x32_bf16 a[84:87], a[244:247], v[68:71], a[84:87]
    v_mfma_f32_16x16x32_bf16 a[88:91], a[244:247], v[72:75], a[88:91]
    v_exp_f32 v51, v51
    v_mfma_f32_16x16x32_bf16 a[92:95], a[244:247], v[76:79], a[92:95]
    ds_read_b128 a[216:219], v4 offset:4096
    v_cvt_pk_bf16_f32 v83, v50, v51
    v_mfma_f32_16x16x32_bf16 v[136:139], v[160:163], v[72:75], v[136:139]
    v_exp_f32 v52, v52
    v_mfma_f32_16x16x32_bf16 a[96:99], a[248:251], v[64:67], a[96:99]
    buffer_load_dwordx4 v17, s[8:11], s32 offen offset:3072 lds
    v_mfma_f32_16x16x32_bf16 a[100:103], a[248:251], v[68:71], a[100:103]
    v_exp_f32 v53, v53
    v_mfma_f32_16x16x32_bf16 a[104:107], a[248:251], v[72:75], a[104:107]
    ds_read_b128 a[220:223], v5 offset:4096
    v_cvt_pk_bf16_f32 v86, v52, v53
    v_mfma_f32_16x16x32_bf16 a[108:111], a[248:251], v[76:79], a[108:111]
    v_exp_f32 v54, v54
    v_mfma_f32_16x16x32_bf16 a[112:115], a[252:255], v[64:67], a[112:115]
    v_mfma_f32_16x16x32_bf16 a[116:119], a[252:255], v[68:71], a[116:119]
    v_exp_f32 v55, v55
    v_mfma_f32_16x16x32_bf16 a[120:123], a[252:255], v[72:75], a[120:123]
    v_cvt_pk_bf16_f32 v87, v54, v55
    v_mfma_f32_16x16x32_bf16 a[124:127], a[252:255], v[76:79], a[124:127]
    s_add_u32 s32, s32, 16384
    v_exp_f32 v56, v56
    v_mfma_f32_16x16x32_bf16 v[140:143], v[160:163], v[76:79], v[140:143]
    v_mfma_f32_16x16x32_bf16 v[32:35], a[192:195], v[144:147], v[96:99]
    s_waitcnt lgkmcnt(0)
    v_exp_f32 v57, v57
    v_mfma_f32_16x16x32_bf16 v[32:35], a[196:199], v[176:179], v[32:35]
    ds_read_b64_tr_b16 a[224:225], v6 offset:57344
    v_cvt_pk_bf16_f32 v90, v56, v57
    v_mfma_f32_16x16x32_bf16 v[32:35], a[200:203], v[208:211], v[32:35]
    v_exp_f32 v58, v58
    v_mfma_f32_16x16x32_bf16 v[32:35], a[204:207], v[240:243], v[32:35]
    ds_read_b64_tr_b16 a[226:227], v6 offset:61440
    v_mfma_f32_16x16x32_bf16 v[36:39], a[192:195], v[148:151], v[100:103]
    v_exp_f32 v59, v59
    v_mfma_f32_16x16x32_bf16 v[36:39], a[196:199], v[180:183], v[36:39]
    ds_read_b64_tr_b16 a[228:229], v7 offset:57344
    v_cvt_pk_bf16_f32 v91, v58, v59
    v_mfma_f32_16x16x32_bf16 v[36:39], a[200:203], v[212:215], v[36:39]
    v_exp_f32 v60, v60
    v_mfma_f32_16x16x32_bf16 v[36:39], a[204:207], v[244:247], v[36:39]
    ds_read_b64_tr_b16 a[230:231], v7 offset:61440
    v_mfma_f32_16x16x32_bf16 v[40:43], a[192:195], v[152:155], v[104:107]
    v_exp_f32 v61, v61
    v_mfma_f32_16x16x32_bf16 v[40:43], a[196:199], v[184:187], v[40:43]
    ds_read_b64_tr_b16 a[232:233], v8 offset:57344
    v_cvt_pk_bf16_f32 v94, v60, v61
    v_mfma_f32_16x16x32_bf16 v[40:43], a[200:203], v[216:219], v[40:43]
    v_exp_f32 v62, v62
    v_mfma_f32_16x16x32_bf16 v[40:43], a[204:207], v[248:251], v[40:43]
    ds_read_b64_tr_b16 a[234:235], v8 offset:61440
    v_mfma_f32_16x16x32_bf16 v[44:47], a[192:195], v[156:159], v[108:111]
    v_exp_f32 v63, v63
    v_mfma_f32_16x16x32_bf16 v[44:47], a[196:199], v[188:191], v[44:47]
    ds_read_b64_tr_b16 a[236:237], v9 offset:57344
    v_cvt_pk_bf16_f32 v95, v62, v63
    v_mfma_f32_16x16x32_bf16 v[44:47], a[200:203], v[220:223], v[44:47]
    v_mfma_f32_16x16x32_bf16 v[44:47], a[204:207], v[252:255], v[44:47]
    ds_read_b64_tr_b16 a[238:239], v9 offset:61440
    v_mfma_f32_16x16x32_bf16 v[48:51], a[208:211], v[144:147], v[96:99]
    v_mfma_f32_16x16x32_bf16 v[48:51], a[212:215], v[176:179], v[48:51]
    ds_read_b64_tr_b16 a[240:241], v10 offset:57344
    v_mfma_f32_16x16x32_bf16 v[48:51], a[216:219], v[208:211], v[48:51]
    v_exp_f32 v32, v32
    v_mfma_f32_16x16x32_bf16 v[48:51], a[220:223], v[240:243], v[48:51]
    ds_read_b64_tr_b16 a[242:243], v10 offset:61440
    v_mfma_f32_16x16x32_bf16 v[52:55], a[208:211], v[148:151], v[100:103]
    v_exp_f32 v33, v33
    v_mfma_f32_16x16x32_bf16 v[52:55], a[212:215], v[180:183], v[52:55]
    ds_read_b64_tr_b16 a[244:245], v11 offset:57344
    v_cvt_pk_bf16_f32 v64, v32, v33
    v_mfma_f32_16x16x32_bf16 v[52:55], a[216:219], v[212:215], v[52:55]
    v_exp_f32 v34, v34
    v_mfma_f32_16x16x32_bf16 v[52:55], a[220:223], v[244:247], v[52:55]
    ds_read_b64_tr_b16 a[246:247], v11 offset:61440
    v_mfma_f32_16x16x32_bf16 v[56:59], a[208:211], v[152:155], v[104:107]
    v_exp_f32 v35, v35
    v_mfma_f32_16x16x32_bf16 v[56:59], a[212:215], v[184:187], v[56:59]
    ds_read_b64_tr_b16 a[248:249], v12 offset:57344
    v_cvt_pk_bf16_f32 v65, v34, v35
    v_mfma_f32_16x16x32_bf16 v[56:59], a[216:219], v[216:219], v[56:59]
    v_exp_f32 v36, v36
    v_mfma_f32_16x16x32_bf16 v[56:59], a[220:223], v[248:251], v[56:59]
    ds_read_b64_tr_b16 a[250:251], v12 offset:61440
    v_mfma_f32_16x16x32_bf16 v[60:63], a[208:211], v[156:159], v[108:111]
    v_exp_f32 v37, v37
    v_mfma_f32_16x16x32_bf16 v[60:63], a[212:215], v[188:191], v[60:63]
    ds_read_b64_tr_b16 a[252:253], v13 offset:57344
    v_cvt_pk_bf16_f32 v68, v36, v37
    v_mfma_f32_16x16x32_bf16 v[60:63], a[216:219], v[220:223], v[60:63]
    v_exp_f32 v38, v38
    v_mfma_f32_16x16x32_bf16 v[60:63], a[220:223], v[252:255], v[60:63]
    s_waitcnt lgkmcnt(3)
    ds_read_b64_tr_b16 a[254:255], v13 offset:61440
    v_mfma_f32_16x16x32_bf16 a[0:3], a[224:227], v[80:83], a[0:3]
    v_exp_f32 v39, v39
    v_mfma_f32_16x16x32_bf16 a[4:7], a[224:227], v[84:87], a[4:7]
    ds_read_b128 a[192:195], v2 offset:8192
    v_cvt_pk_bf16_f32 v69, v38, v39
    v_mfma_f32_16x16x32_bf16 a[8:11], a[224:227], v[88:91], a[8:11]
    s_add_u32 m0, s34, 98304
    v_exp_f32 v40, v40
    v_mfma_f32_16x16x32_bf16 a[12:15], a[224:227], v[92:95], a[12:15]
    buffer_load_dwordx4 v18, s[12:15], s33 offen lds
    v_mfma_f32_16x16x32_bf16 a[16:19], a[228:231], v[80:83], a[16:19]
    v_exp_f32 v41, v41
    v_mfma_f32_16x16x32_bf16 a[20:23], a[228:231], v[84:87], a[20:23]
    ds_read_b128 a[196:199], v3 offset:8192
    v_cvt_pk_bf16_f32 v72, v40, v41
    v_mfma_f32_16x16x32_bf16 a[24:27], a[228:231], v[88:91], a[24:27]
    v_exp_f32 v42, v42
    v_mfma_f32_16x16x32_bf16 a[28:31], a[228:231], v[92:95], a[28:31]
    v_mfma_f32_16x16x32_bf16 v[128:131], v[160:163], v[80:83], v[128:131]
    v_exp_f32 v43, v43
    v_mfma_f32_16x16x32_bf16 a[32:35], a[232:235], v[80:83], a[32:35]
    ds_read_b128 a[200:203], v4 offset:8192
    v_cvt_pk_bf16_f32 v73, v42, v43
    v_mfma_f32_16x16x32_bf16 a[36:39], a[232:235], v[84:87], a[36:39]
    v_exp_f32 v44, v44
    v_mfma_f32_16x16x32_bf16 a[40:43], a[232:235], v[88:91], a[40:43]
    buffer_load_dwordx4 v19, s[12:15], s33 offen offset:1024 lds
    v_mfma_f32_16x16x32_bf16 a[44:47], a[232:235], v[92:95], a[44:47]
    v_exp_f32 v45, v45
    v_mfma_f32_16x16x32_bf16 a[48:51], a[236:239], v[80:83], a[48:51]
    ds_read_b128 a[204:207], v5 offset:8192
    v_cvt_pk_bf16_f32 v76, v44, v45
    v_mfma_f32_16x16x32_bf16 a[52:55], a[236:239], v[84:87], a[52:55]
    v_exp_f32 v46, v46
    v_mfma_f32_16x16x32_bf16 a[56:59], a[236:239], v[88:91], a[56:59]
    v_mfma_f32_16x16x32_bf16 a[60:63], a[236:239], v[92:95], a[60:63]
    v_exp_f32 v47, v47
    v_mfma_f32_16x16x32_bf16 v[132:135], v[160:163], v[84:87], v[132:135]
    ds_read_b128 a[208:211], v2 offset:12288
    v_cvt_pk_bf16_f32 v77, v46, v47
    v_mfma_f32_16x16x32_bf16 a[64:67], a[240:243], v[80:83], a[64:67]
    v_exp_f32 v48, v48
    v_mfma_f32_16x16x32_bf16 a[68:71], a[240:243], v[84:87], a[68:71]
    buffer_load_dwordx4 v18, s[12:15], s33 offen offset:2048 lds
    v_mfma_f32_16x16x32_bf16 a[72:75], a[240:243], v[88:91], a[72:75]
    v_exp_f32 v49, v49
    v_mfma_f32_16x16x32_bf16 a[76:79], a[240:243], v[92:95], a[76:79]
    ds_read_b128 a[212:215], v3 offset:12288
    v_cvt_pk_bf16_f32 v66, v48, v49
    v_mfma_f32_16x16x32_bf16 a[80:83], a[244:247], v[80:83], a[80:83]
    v_exp_f32 v50, v50
    v_mfma_f32_16x16x32_bf16 a[84:87], a[244:247], v[84:87], a[84:87]
    v_mfma_f32_16x16x32_bf16 a[88:91], a[244:247], v[88:91], a[88:91]
    v_exp_f32 v51, v51
    v_mfma_f32_16x16x32_bf16 a[92:95], a[244:247], v[92:95], a[92:95]
    ds_read_b128 a[216:219], v4 offset:12288
    v_cvt_pk_bf16_f32 v67, v50, v51
    v_mfma_f32_16x16x32_bf16 v[136:139], v[160:163], v[88:91], v[136:139]
    s_waitcnt lgkmcnt(2)
    v_exp_f32 v52, v52
    v_mfma_f32_16x16x32_bf16 a[96:99], a[248:251], v[80:83], a[96:99]
    buffer_load_dwordx4 v19, s[12:15], s33 offen offset:3072 lds
    v_mfma_f32_16x16x32_bf16 a[100:103], a[248:251], v[84:87], a[100:103]
    v_exp_f32 v53, v53
    v_mfma_f32_16x16x32_bf16 a[104:107], a[248:251], v[88:91], a[104:107]
    ds_read_b128 a[220:223], v5 offset:12288
    v_cvt_pk_bf16_f32 v70, v52, v53
    v_mfma_f32_16x16x32_bf16 a[108:111], a[248:251], v[92:95], a[108:111]
    v_exp_f32 v54, v54
    v_mfma_f32_16x16x32_bf16 a[112:115], a[252:255], v[80:83], a[112:115]
    v_mfma_f32_16x16x32_bf16 a[116:119], a[252:255], v[84:87], a[116:119]
    v_exp_f32 v55, v55
    v_mfma_f32_16x16x32_bf16 a[120:123], a[252:255], v[88:91], a[120:123]
    v_cvt_pk_bf16_f32 v71, v54, v55
    v_mfma_f32_16x16x32_bf16 a[124:127], a[252:255], v[92:95], a[124:127]
    s_add_u32 s33, s33, 16384
    v_exp_f32 v56, v56
    v_mfma_f32_16x16x32_bf16 v[140:143], v[160:163], v[92:95], v[140:143]
    s_add_u32 s40, s40, 1
    s_cmp_lt_u32 s40, 7
    s_cbranch_scc1 mk_loop
    s_mov_b32 s7, 0
    s_waitcnt vmcnt(8)
    v_cmp_ne_u32_e64 vcc, s6, v28
    s_nop 4
    s_cbranch_vccz mk_hc_ok
    s_mov_b32 s62, 400000
mk_hc_poll:
    buffer_load_dword v28, v29, s[92:95], 0 offen sc1
    s_waitcnt vmcnt(0)
    v_cmp_ne_u32_e64 vcc, s6, v28
    s_nop 4
    s_cbranch_vccz mk_hc_ok
    s_sub_u32 s62, s62, 1
    s_cbranch_scc1 mk_hc_ok
    s_sleep 1
    s_branch mk_hc_poll
mk_hc_ok:
    s_and_b32 s60, s4, 25
    s_cmp_eq_u32 s60, 0x18
    s_cbranch_scc0 mk_pk_ok
    s_waitcnt vmcnt(6)
    v_xor_b32 v168, s91, v168
    v_xor_b32 v169, s91, v169
    v_xor_b32 v170, s91, v170
    v_xor_b32 v171, s91, v171
    v_or3_b32 v168, v168, v169, v170
    v_or_b32 v168, v168, v171
    v_cmp_ne_u32 vcc, 0, v168
    s_nop 4
    s_cbranch_vccz mk_pk_done
    s_mov_b32 s62, 400000
mk_pk_poll:
    buffer_load_dwordx4 v[168:171], v30, s[92:95], s75 offen sc1
    s_waitcnt vmcnt(0)
    v_xor_b32 v168, s91, v168
    v_xor_b32 v169, s91, v169
    v_xor_b32 v170, s91, v170
    v_xor_b32 v171, s91, v171
    v_or3_b32 v168, v168, v169, v170
    v_or_b32 v168, v168, v171
    v_cmp_ne_u32 vcc, 0, v168
    s_nop 4
    s_cbranch_vccz mk_pk_done
    s_sub_u32 s62, s62, 1
    s_cbranch_scc1 mk_pk_done
    s_sleep 1
    s_branch mk_pk_poll
mk_pk_done:
    s_cmp_lg_u32 s2, 24
    s_cbranch_scc1 mk_pk_ok
    s_cmp_lg_u32 s3, 0
    s_cbranch_scc1 mk_pk_ok
    v_mov_b32 v168, s91
    v_lshlrev_b32 v169, 20, v1
    buffer_store_dword v168, v169, s[92:95], 0 offen offset:1024 sc1
mk_pk_ok:
    s_add_u32 m0, s38, 131072
    s_nop 0
    buffer_load_dwordx4 v24, s[16:19], s41 offen lds
    buffer_load_dwordx4 v25, s[16:19], s41 offen offset:1024 lds
    buffer_load_dwordx4 v26, s[16:19], s41 offen offset:2048 lds
    buffer_load_dwordx4 v27, s[16:19], s41 offen offset:3072 lds
    s_add_u32 s41, s41, s29
    buffer_load_dwordx4 v[192:195], v30, s[20:23], s36 offen sc1
    s_add_u32 s36, s36, 1024
    buffer_load_dwordx4 v[196:199], v30, s[20:23], s37 offen sc1
    s_add_u32 s37, s37, 1024
    buffer_load_dwordx4 v[200:203], v30, s[20:23], s39 offen sc1
    s_add_u32 s39, s39, 1024
    buffer_load_dwordx4 v[204:207], v30, s[20:23], s42 offen sc1
    s_add_u32 s42, s42, 1024
    s_add_u32 m0, s38, 147456
    s_nop 0
    buffer_load_dwordx4 v24, s[16:19], s41 offen lds
    buffer_load_dwordx4 v25, s[16:19], s41 offen offset:1024 lds
    buffer_load_dwordx4 v26, s[16:19], s41 offen offset:2048 lds
    buffer_load_dwordx4 v27, s[16:19], s41 offen offset:3072 lds
    s_add_u32 s41, s41, s29
    buffer_load_dwordx4 v[224:227], v30, s[20:23], s36 offen sc1
    s_add_u32 s36, s36, 1024
    buffer_load_dwordx4 v[228:231], v30, s[20:23], s37 offen sc1
    s_add_u32 s37, s37, 1024
    buffer_load_dwordx4 v[232:235], v30, s[20:23], s39 offen sc1
    s_add_u32 s39, s39, 1024
    buffer_load_dwordx4 v[236:239], v30, s[20:23], s42 offen sc1
    s_add_u32 s42, s42, 1024
    v_mfma_f32_16x16x32_bf16 v[32:35], a[192:195], v[144:147], v[96:99]
    v_exp_f32 v57, v57
    v_mfma_f32_16x16x32_bf16 v[32:35], a[196:199], v[176:179], v[32:35]
    ds_read_b64_tr_b16 a[224:225], v6
    v_cvt_pk_bf16_f32 v74, v56, v57
    v_mfma_f32_16x16x32_bf16 v[32:35], a[200:203], v[208:211], v[32:35]
    v_exp_f32 v58, v58
    v_mfma_f32_16x16x32_bf16 v[32:35], a[204:207], v[240:243], v[32:35]
    ds_read_b64_tr_b16 a[226:227], v6 offset:4096
    v_mfma_f32_16x16x32_bf16 v[36:39], a[192:195], v[148:151], v[100:103]
    v_exp_f32 v59, v59
    v_mfma_f32_16x16x32_bf16 v[36:39], a[196:199], v[180:183], v[36:39]
    ds_read_b64_tr_b16 a[228:229], v7
    v_cvt_pk_bf16_f32 v75, v58, v59
    v_mfma_f32_16x16x32_bf16 v[36:39], a[200:203], v[212:215], v[36:39]
    v_exp_f32 v60, v60
    v_mfma_f32_16x16x32_bf16 v[36:39], a[204:207], v[244:247], v[36:39]
    ds_read_b64_tr_b16 a[230:231], v7 offset:4096
    v_mfma_f32_16x16x32_bf16 v[40:43], a[192:195], v[152:155], v[104:107]
    v_exp_f32 v61, v61
    v_mfma_f32_16x16x32_bf16 v[40:43], a[196:199], v[184:187], v[40:43]
    ds_read_b64_tr_b16 a[232:233], v8
    v_cvt_pk_bf16_f32 v78, v60, v61
    v_mfma_f32_16x16x32_bf16 v[40:43], a[200:203], v[216:219], v[40:43]
    v_exp_f32 v62, v62
    v_mfma_f32_16x16x32_bf16 v[40:43], a[204:207], v[248:251], v[40:43]
    ds_read_b64_tr_b16 a[234:235], v8 offset:4096
    v_mfma_f32_16x16x32_bf16 v[44:47], a[192:195], v[156:159], v[108:111]
    v_exp_f32 v63, v63
    v_mfma_f32_16x16x32_bf16 v[44:47], a[196:199], v[188:191], v[44:47]
    ds_read_b64_tr_b16 a[236:237], v9
    v_cvt_pk_bf16_f32 v79, v62, v63
    v_mfma_f32_16x16x32_bf16 v[44:47], a[200:203], v[220:223], v[44:47]
    v_mfma_f32_16x16x32_bf16 v[44:47], a[204:207], v[252:255], v[44:47]
    ds_read_b64_tr_b16 a[238:239], v9 offset:4096
    v_mfma_f32_16x16x32_bf16 v[48:51], a[208:211], v[144:147], v[96:99]
    s_waitcnt lgkmcnt(3)
    v_mfma_f32_16x16x32_bf16 v[48:51], a[212:215], v[176:179], v[48:51]
    ds_read_b64_tr_b16 a[240:241], v10
    v_mfma_f32_16x16x32_bf16 v[48:51], a[216:219], v[208:211], v[48:51]
    v_exp_f32 v32, v32
    v_mfma_f32_16x16x32_bf16 v[48:51], a[220:223], v[240:243], v[48:51]
    ds_read_b64_tr_b16 a[242:243], v10 offset:4096
    v_mfma_f32_16x16x32_bf16 v[52:55], a[208:211], v[148:151], v[100:103]
    v_exp_f32 v33, v33
    v_mfma_f32_16x16x32_bf16 v[52:55], a[212:215], v[180:183], v[52:55]
    ds_read_b64_tr_b16 a[244:245], v11
    v_cvt_pk_bf16_f32 v80, v32, v33
    v_mfma_f32_16x16x32_bf16 v[52:55], a[216:219], v[212:215], v[52:55]
    v_exp_f32 v34, v34
    v_mfma_f32_16x16x32_bf16 v[52:55], a[220:223], v[244:247], v[52:55]
    ds_read_b64_tr_b16 a[246:247], v11 offset:4096
    v_mfma_f32_16x16x32_bf16 v[56:59], a[208:211], v[152:155], v[104:107]
    v_exp_f32 v35, v35
    v_mfma_f32_16x16x32_bf16 v[56:59], a[212:215], v[184:187], v[56:59]
    ds_read_b64_tr_b16 a[248:249], v12
    v_cvt_pk_bf16_f32 v81, v34, v35
    v_mfma_f32_16x16x32_bf16 v[56:59], a[216:219], v[216:219], v[56:59]
    v_exp_f32 v36, v36
    v_mfma_f32_16x16x32_bf16 v[56:59], a[220:223], v[248:251], v[56:59]
    ds_read_b64_tr_b16 a[250:251], v12 offset:4096
    v_mfma_f32_16x16x32_bf16 v[60:63], a[208:211], v[156:159], v[108:111]
    v_exp_f32 v37, v37
    v_mfma_f32_16x16x32_bf16 v[60:63], a[212:215], v[188:191], v[60:63]
    ds_read_b64_tr_b16 a[252:253], v13
    v_cvt_pk_bf16_f32 v84, v36, v37
    v_mfma_f32_16x16x32_bf16 v[60:63], a[216:219], v[220:223], v[60:63]
    v_exp_f32 v38, v38
    v_mfma_f32_16x16x32_bf16 v[60:63], a[220:223], v[252:255], v[60:63]
    ds_read_b64_tr_b16 a[254:255], v13 offset:4096
    s_barrier
    v_mfma_f32_16x16x32_bf16 a[0:3], a[224:227], v[64:67], a[0:3]
    v_exp_f32 v39, v39
    v_mfma_f32_16x16x32_bf16 a[4:7], a[224:227], v[68:71], a[4:7]
    ds_read_b128 a[192:195], v2 offset:16384
    v_cvt_pk_bf16_f32 v85, v38, v39
    v_mfma_f32_16x16x32_bf16 a[8:11], a[224:227], v[72:75], a[8:11]
    s_add_u32 m0, s34, 114688
    v_exp_f32 v40, v40
    v_mfma_f32_16x16x32_bf16 a[12:15], a[224:227], v[76:79], a[12:15]
    buffer_load_dwordx4 v18, s[12:15], s33 offen lds
    v_mfma_f32_16x16x32_bf16 a[16:19], a[228:231], v[64:67], a[16:19]
    v_exp_f32 v41, v41
    v_mfma_f32_16x16x32_bf16 a[20:23], a[228:231], v[68:71], a[20:23]
    ds_read_b128 a[196:199], v3 offset:16384
    v_cvt_pk_bf16_f32 v88, v40, v41
    v_mfma_f32_16x16x32_bf16 a[24:27], a[228:231], v[72:75], a[24:27]
    v_exp_f32 v42, v42
    v_mfma_f32_16x16x32_bf16 a[28:31], a[228:231], v[76:79], a[28:31]
    buffer_load_dwordx4 v19, s[12:15], s33 offen offset:1024 lds
    v_mfma_f32_16x16x32_bf16 v[128:131], v[160:163], v[64:67], v[128:131]
    s_waitcnt vmcnt(14) lgkmcnt(1)
    v_exp_f32 v43, v43
    v_mfma_f32_16x16x32_bf16 a[32:35], a[232:235], v[64:67], a[32:35]
    ds_read_b128 a[200:203], v4 offset:16384
    ds_read_b64_tr_b16 v[112:113], v20
    ds_read_b64_tr_b16 v[114:115], v20 offset:2048
    v_cvt_pk_bf16_f32 v89, v42, v43
    v_mfma_f32_16x16x32_bf16 a[36:39], a[232:235], v[68:71], a[36:39]
    v_exp_f32 v44, v44
    v_mfma_f32_16x16x32_bf16 a[40:43], a[232:235], v[72:75], a[40:43]
    buffer_load_dwordx4 v18, s[12:15], s33 offen offset:2048 lds
    v_mfma_f32_16x16x32_bf16 a[44:47], a[232:235], v[76:79], a[44:47]
    v_exp_f32 v45, v45
    v_mfma_f32_16x16x32_bf16 a[48:51], a[236:239], v[64:67], a[48:51]
    ds_read_b128 a[204:207], v5 offset:16384
    v_cvt_pk_bf16_f32 v92, v44, v45
    v_mfma_f32_16x16x32_bf16 a[52:55], a[236:239], v[68:71], a[52:55]
    v_exp_f32 v46, v46
    v_mfma_f32_16x16x32_bf16 a[56:59], a[236:239], v[72:75], a[56:59]
    buffer_load_dwordx4 v19, s[12:15], s33 offen offset:3072 lds
    v_mfma_f32_16x16x32_bf16 a[60:63], a[236:239], v[76:79], a[60:63]
    s_add_u32 s33, s33, 16384
    v_exp_f32 v47, v47
    v_mfma_f32_16x16x32_bf16 v[132:135], v[160:163], v[68:71], v[132:135]
    ds_read_b128 a[208:211], v2 offset:20480
    ds_read_b64_tr_b16 v[116:117], v21
    ds_read_b64_tr_b16 v[118:119], v21 offset:2048
    v_cvt_pk_bf16_f32 v93, v46, v47
    v_mfma_f32_16x16x32_bf16 a[64:67], a[240:243], v[64:67], a[64:67]
    s_add_u32 m0, s38, 0
    v_exp_f32 v48, v48
    v_mfma_f32_16x16x32_bf16 a[68:71], a[240:243], v[68:71], a[68:71]
    buffer_load_dwordx4 v24, s[16:19], s41 offen lds
    v_mfma_f32_16x16x32_bf16 a[72:75], a[240:243], v[72:75], a[72:75]
    v_exp_f32 v49, v49
    v_mfma_f32_16x16x32_bf16 a[76:79], a[240:243], v[76:79], a[76:79]
    ds_read_b128 a[212:215], v3 offset:20480
    v_cvt_pk_bf16_f32 v82, v48, v49
    v_mfma_f32_16x16x32_bf16 a[80:83], a[244:247], v[64:67], a[80:83]
    v_exp_f32 v50, v50
    v_mfma_f32_16x16x32_bf16 a[84:87], a[244:247], v[68:71], a[84:87]
    buffer_load_dwordx4 v25, s[16:19], s41 offen offset:1024 lds
    v_mfma_f32_16x16x32_bf16 a[88:91], a[244:247], v[72:75], a[88:91]
    v_exp_f32 v51, v51
    v_mfma_f32_16x16x32_bf16 a[92:95], a[244:247], v[76:79], a[92:95]
    ds_read_b128 a[216:219], v4 offset:20480
    ds_read_b64_tr_b16 v[120:121], v22
    ds_read_b64_tr_b16 v[122:123], v22 offset:2048
    v_cvt_pk_bf16_f32 v83, v50, v51
    v_mfma_f32_16x16x32_bf16 v[136:139], v[160:163], v[72:75], v[136:139]
    v_exp_f32 v52, v52
    v_mfma_f32_16x16x32_bf16 a[96:99], a[248:251], v[64:67], a[96:99]
    buffer_load_dwordx4 v26, s[16:19], s41 offen offset:2048 lds
    v_mfma_f32_16x16x32_bf16 a[100:103], a[248:251], v[68:71], a[100:103]
    v_exp_f32 v53, v53
    v_mfma_f32_16x16x32_bf16 a[104:107], a[248:251], v[72:75], a[104:107]
    ds_read_b128 a[220:223], v5 offset:20480
    v_cvt_pk_bf16_f32 v86, v52, v53
    v_mfma_f32_16x16x32_bf16 a[108:111], a[248:251], v[76:79], a[108:111]
    v_exp_f32 v54, v54
    v_mfma_f32_16x16x32_bf16 a[112:115], a[252:255], v[64:67], a[112:115]
    buffer_load_dwordx4 v27, s[16:19], s41 offen offset:3072 lds
    v_mfma_f32_16x16x32_bf16 a[116:119], a[252:255], v[68:71], a[116:119]
    v_exp_f32 v55, v55
    v_mfma_f32_16x16x32_bf16 a[120:123], a[252:255], v[72:75], a[120:123]
    v_cvt_pk_bf16_f32 v87, v54, v55
    v_mfma_f32_16x16x32_bf16 a[124:127], a[252:255], v[76:79], a[124:127]
    s_add_u32 s41, s41, s29
    v_exp_f32 v56, v56
    v_mfma_f32_16x16x32_bf16 v[140:143], v[160:163], v[76:79], v[140:143]
    s_waitcnt vmcnt(19) lgkmcnt(1)
    v_mfma_f32_16x16x32_bf16 a[128:131], v[112:115], v[192:195], 0
    s_waitcnt vmcnt(18)
    ds_read_b64_tr_b16 v[124:125], v23
    v_mfma_f32_16x16x32_bf16 a[132:135], v[112:115], v[196:199], 0
    s_waitcnt vmcnt(17)
    ds_read_b64_tr_b16 v[126:127], v23 offset:2048
    v_mfma_f32_16x16x32_bf16 a[136:139], v[112:115], v[200:203], 0
    s_waitcnt vmcnt(16)
    v_mfma_f32_16x16x32_bf16 a[140:143], v[112:115], v[204:207], 0
    s_waitcnt vmcnt(12)
    v_mfma_f32_16x16x32_bf16 a[144:147], v[116:119], v[192:195], 0
    ds_read_b64_tr_b16 v[112:113], v20 offset:16384
    v_mfma_f32_16x16x32_bf16 a[148:151], v[116:119], v[196:199], 0
    ds_read_b64_tr_b16 v[114:115], v20 offset:18432
    v_mfma_f32_16x16x32_bf16 a[152:155], v[116:119], v[200:203], 0
    v_mfma_f32_16x16x32_bf16 a[156:159], v[116:119], v[204:207], 0
    v_mfma_f32_16x16x32_bf16 a[160:163], v[120:123], v[192:195], 0
    ds_read_b64_tr_b16 v[116:117], v21 offset:16384
    v_mfma_f32_16x16x32_bf16 a[164:167], v[120:123], v[196:199], 0
    ds_read_b64_tr_b16 v[118:119], v21 offset:18432
    v_mfma_f32_16x16x32_bf16 a[168:171], v[120:123], v[200:203], 0
    v_mfma_f32_16x16x32_bf16 a[172:175], v[120:123], v[204:207], 0
    s_waitcnt lgkmcnt(3)
    v_mfma_f32_16x16x32_bf16 a[176:179], v[124:127], v[192:195], 0
    ds_read_b64_tr_b16 v[120:121], v22 offset:16384
    v_mfma_f32_16x16x32_bf16 a[180:183], v[124:127], v[196:199], 0
    ds_read_b64_tr_b16 v[122:123], v22 offset:18432
    v_mfma_f32_16x16x32_bf16 a[184:187], v[124:127], v[200:203], 0
    v_mfma_f32_16x16x32_bf16 a[188:191], v[124:127], v[204:207], 0
    v_mfma_f32_16x16x32_bf16 v[32:35], a[192:195], v[144:147], v[96:99]
    v_exp_f32 v57, v57
    v_mfma_f32_16x16x32_bf16 v[32:35], a[196:199], v[176:179], v[32:35]
    ds_read_b64_tr_b16 a[224:225], v6 offset:8192
    v_cvt_pk_bf16_f32 v90, v56, v57
    v_mfma_f32_16x16x32_bf16 v[32:35], a[200:203], v[208:211], v[32:35]
    v_exp_f32 v58, v58
    v_mfma_f32_16x16x32_bf16 v[32:35], a[204:207], v[240:243], v[32:35]
    ds_read_b64_tr_b16 a[226:227], v6 offset:12288
    buffer_load_dwordx4 v[192:195], v30, s[20:23], s36 offen sc1
    v_mfma_f32_16x16x32_bf16 v[36:39], a[192:195], v[148:151], v[100:103]
    s_add_u32 s36, s36, 1024
    v_exp_f32 v59, v59
    v_mfma_f32_16x16x32_bf16 v[36:39], a[196:199], v[180:183], v[36:39]
    ds_read_b64_tr_b16 a[228:229], v7 offset:8192
    v_cvt_pk_bf16_f32 v91, v58, v59
    v_mfma_f32_16x16x32_bf16 v[36:39], a[200:203], v[212:215], v[36:39]
    v_exp_f32 v60, v60
    v_mfma_f32_16x16x32_bf16 v[36:39], a[204:207], v[244:247], v[36:39]
    ds_read_b64_tr_b16 a[230:231], v7 offset:12288
    buffer_load_dwordx4 v[196:199], v30, s[20:23], s37 offen sc1
    v_mfma_f32_16x16x32_bf16 v[40:43], a[192:195], v[152:155], v[104:107]
    s_add_u32 s37, s37, 1024
    v_exp_f32 v61, v61
    v_mfma_f32_16x16x32_bf16 v[40:43], a[196:199], v[184:187], v[40:43]
    ds_read_b64_tr_b16 a[232:233], v8 offset:8192
    v_cvt_pk_bf16_f32 v94, v60, v61
    v_mfma_f32_16x16x32_bf16 v[40:43], a[200:203], v[216:219], v[40:43]
    v_exp_f32 v62, v62
    v_mfma_f32_16x16x32_bf16 v[40:43], a[204:207], v[248:251], v[40:43]
    ds_read_b64_tr_b16 a[234:235], v8 offset:12288
    buffer_load_dwordx4 v[200:203], v30, s[20:23], s39 offen sc1
    v_mfma_f32_16x16x32_bf16 v[44:47], a[192:195], v[156:159], v[108:111]
    s_add_u32 s39, s39, 1024
    v_exp_f32 v63, v63
    v_mfma_f32_16x16x32_bf16 v[44:47], a[196:199], v[188:191], v[44:47]
    ds_read_b64_tr_b16 a[236:237], v9 offset:8192
    v_cvt_pk_bf16_f32 v95, v62, v63
    v_mfma_f32_16x16x32_bf16 v[44:47], a[200:203], v[220:223], v[44:47]
    v_mfma_f32_16x16x32_bf16 v[44:47], a[204:207], v[252:255], v[44:47]
    ds_read_b64_tr_b16 a[238:239], v9 offset:12288
    buffer_load_dwordx4 v[204:207], v30, s[20:23], s42 offen sc1
    v_mfma_f32_16x16x32_bf16 v[48:51], a[208:211], v[144:147], v[96:99]
    s_add_u32 s42, s42, 1024
    s_add_u32 m0, s38, 131072
    v_mfma_f32_16x16x32_bf16 v[48:51], a[212:215], v[176:179], v[48:51]
    ds_read_b64_tr_b16 a[240:241], v10 offset:8192
    buffer_load_dwordx4 v24, s[16:19], s41 offen lds
    v_mfma_f32_16x16x32_bf16 v[48:51], a[216:219], v[208:211], v[48:51]
    v_exp_f32 v32, v32
    v_mfma_f32_16x16x32_bf16 v[48:51], a[220:223], v[240:243], v[48:51]
    ds_read_b64_tr_b16 a[242:243], v10 offset:12288
    buffer_load_dwordx4 v25, s[16:19], s41 offen offset:1024 lds
    v_mfma_f32_16x16x32_bf16 v[52:55], a[208:211], v[148:151], v[100:103]
    v_exp_f32 v33, v33
    v_mfma_f32_16x16x32_bf16 v[52:55], a[212:215], v[180:183], v[52:55]
    ds_read_b64_tr_b16 a[244:245], v11 offset:8192
    v_cvt_pk_bf16_f32 v64, v32, v33
    v_mfma_f32_16x16x32_bf16 v[52:55], a[216:219], v[212:215], v[52:55]
    v_exp_f32 v34, v34
    v_mfma_f32_16x16x32_bf16 v[52:55], a[220:223], v[244:247], v[52:55]
    ds_read_b64_tr_b16 a[246:247], v11 offset:12288
    buffer_load_dwordx4 v26, s[16:19], s41 offen offset:2048 lds
    v_mfma_f32_16x16x32_bf16 v[56:59], a[208:211], v[152:155], v[104:107]
    v_exp_f32 v35, v35
    v_mfma_f32_16x16x32_bf16 v[56:59], a[212:215], v[184:187], v[56:59]
    ds_read_b64_tr_b16 a[248:249], v12 offset:8192
    v_cvt_pk_bf16_f32 v65, v34, v35
    v_mfma_f32_16x16x32_bf16 v[56:59], a[216:219], v[216:219], v[56:59]
    v_exp_f32 v36, v36
    v_mfma_f32_16x16x32_bf16 v[56:59], a[220:223], v[248:251], v[56:59]
    ds_read_b64_tr_b16 a[250:251], v12 offset:12288
    buffer_load_dwordx4 v27, s[16:19], s41 offen offset:3072 lds
    v_mfma_f32_16x16x32_bf16 v[60:63], a[208:211], v[156:159], v[108:111]
    s_add_u32 s41, s41, s29
    v_exp_f32 v37, v37
    v_mfma_f32_16x16x32_bf16 v[60:63], a[212:215], v[188:191], v[60:63]
    ds_read_b64_tr_b16 a[252:253], v13 offset:8192
    v_cvt_pk_bf16_f32 v68, v36, v37
    v_mfma_f32_16x16x32_bf16 v[60:63], a[216:219], v[220:223], v[60:63]
    v_exp_f32 v38, v38
    v_mfma_f32_16x16x32_bf16 v[60:63], a[220:223], v[252:255], v[60:63]
    s_waitcnt vmcnt(19) lgkmcnt(3)
    ds_read_b64_tr_b16 a[254:255], v13 offset:12288
    v_mfma_f32_16x16x32_bf16 a[128:131], v[112:115], v[224:227], a[128:131]
    s_waitcnt vmcnt(18)
    ds_read_b64_tr_b16 v[124:125], v23 offset:16384
    v_mfma_f32_16x16x32_bf16 a[132:135], v[112:115], v[228:231], a[132:135]
    s_waitcnt vmcnt(17)
    ds_read_b64_tr_b16 v[126:127], v23 offset:18432
    v_mfma_f32_16x16x32_bf16 a[136:139], v[112:115], v[232:235], a[136:139]
    s_waitcnt vmcnt(16)
    v_mfma_f32_16x16x32_bf16 a[140:143], v[112:115], v[236:239], a[140:143]
    s_waitcnt vmcnt(8)
    v_mfma_f32_16x16x32_bf16 a[144:147], v[116:119], v[224:227], a[144:147]
    ds_read_b64_tr_b16 v[112:113], v164
    v_mfma_f32_16x16x32_bf16 a[148:151], v[116:119], v[228:231], a[148:151]
    ds_read_b64_tr_b16 v[114:115], v164 offset:2048
    v_mfma_f32_16x16x32_bf16 a[152:155], v[116:119], v[232:235], a[152:155]
    v_mfma_f32_16x16x32_bf16 a[156:159], v[116:119], v[236:239], a[156:159]
    v_mfma_f32_16x16x32_bf16 a[160:163], v[120:123], v[224:227], a[160:163]
    ds_read_b64_tr_b16 v[116:117], v165
    v_mfma_f32_16x16x32_bf16 a[164:167], v[120:123], v[228:231], a[164:167]
    ds_read_b64_tr_b16 v[118:119], v165 offset:2048
    v_mfma_f32_16x16x32_bf16 a[168:171], v[120:123], v[232:235], a[168:171]
    v_mfma_f32_16x16x32_bf16 a[172:175], v[120:123], v[236:239], a[172:175]
    s_waitcnt lgkmcnt(3)
    v_mfma_f32_16x16x32_bf16 a[176:179], v[124:127], v[224:227], a[176:179]
    ds_read_b64_tr_b16 v[120:121], v166
    v_mfma_f32_16x16x32_bf16 a[180:183], v[124:127], v[228:231], a[180:183]
    ds_read_b64_tr_b16 v[122:123], v166 offset:2048
    v_mfma_f32_16x16x32_bf16 a[184:187], v[124:127], v[232:235], a[184:187]
    v_mfma_f32_16x16x32_bf16 a[188:191], v[124:127], v[236:239], a[188:191]
    v_mfma_f32_16x16x32_bf16 a[0:3], a[224:227], v[80:83], a[0:3]
    v_exp_f32 v39, v39
    v_mfma_f32_16x16x32_bf16 a[4:7], a[224:227], v[84:87], a[4:7]
    ds_read_b128 a[192:195], v2 offset:24576
    v_cvt_pk_bf16_f32 v69, v38, v39
    v_mfma_f32_16x16x32_bf16 a[8:11], a[224:227], v[88:91], a[8:11]
    v_exp_f32 v40, v40
    v_mfma_f32_16x16x32_bf16 a[12:15], a[224:227], v[92:95], a[12:15]
    buffer_load_dwordx4 v[224:227], v30, s[20:23], s36 offen sc1
    v_mfma_f32_16x16x32_bf16 a[16:19], a[228:231], v[80:83], a[16:19]
    s_add_u32 s36, s36, 1024
    v_exp_f32 v41, v41
    v_mfma_f32_16x16x32_bf16 a[20:23], a[228:231], v[84:87], a[20:23]
    ds_read_b128 a[196:199], v3 offset:24576
    v_cvt_pk_bf16_f32 v72, v40, v41
    v_mfma_f32_16x16x32_bf16 a[24:27], a[228:231], v[88:91], a[24:27]
    v_exp_f32 v42, v42
    v_mfma_f32_16x16x32_bf16 a[28:31], a[228:231], v[92:95], a[28:31]
    buffer_load_dwordx4 v[228:231], v30, s[20:23], s37 offen sc1
    v_mfma_f32_16x16x32_bf16 v[128:131], v[160:163], v[80:83], v[128:131]
    s_add_u32 s37, s37, 1024
    v_exp_f32 v43, v43
    v_mfma_f32_16x16x32_bf16 a[32:35], a[232:235], v[80:83], a[32:35]
    ds_read_b128 a[200:203], v4 offset:24576
    v_cvt_pk_bf16_f32 v73, v42, v43
    v_mfma_f32_16x16x32_bf16 a[36:39], a[232:235], v[84:87], a[36:39]
    v_exp_f32 v44, v44
    v_mfma_f32_16x16x32_bf16 a[40:43], a[232:235], v[88:91], a[40:43]
    buffer_load_dwordx4 v[232:235], v30, s[20:23], s39 offen sc1
    v_mfma_f32_16x16x32_bf16 a[44:47], a[232:235], v[92:95], a[44:47]
    s_add_u32 s39, s39, 1024
    v_exp_f32 v45, v45
    v_mfma_f32_16x16x32_bf16 a[48:51], a[236:239], v[80:83], a[48:51]
    ds_read_b128 a[204:207], v5 offset:24576
    v_cvt_pk_bf16_f32 v76, v44, v45
    v_mfma_f32_16x16x32_bf16 a[52:55], a[236:239], v[84:87], a[52:55]
    v_exp_f32 v46, v46
    v_mfma_f32_16x16x32_bf16 a[56:59], a[236:239], v[88:91], a[56:59]
    buffer_load_dwordx4 v[236:239], v30, s[20:23], s42 offen sc1
    v_mfma_f32_16x16x32_bf16 a[60:63], a[236:239], v[92:95], a[60:63]
    s_add_u32 s42, s42, 1024
    v_exp_f32 v47, v47
    v_mfma_f32_16x16x32_bf16 v[132:135], v[160:163], v[84:87], v[132:135]
    ds_read_b128 a[208:211], v2 offset:28672
    v_cvt_pk_bf16_f32 v77, v46, v47
    v_mfma_f32_16x16x32_bf16 a[64:67], a[240:243], v[80:83], a[64:67]
    s_add_u32 m0, s38, 147456
    v_exp_f32 v48, v48
    v_mfma_f32_16x16x32_bf16 a[68:71], a[240:243], v[84:87], a[68:71]
    buffer_load_dwordx4 v24, s[16:19], s41 offen lds
    v_mfma_f32_16x16x32_bf16 a[72:75], a[240:243], v[88:91], a[72:75]
    v_exp_f32 v49, v49
    v_mfma_f32_16x16x32_bf16 a[76:79], a[240:243], v[92:95], a[76:79]
    ds_read_b128 a[212:215], v3 offset:28672
    v_cvt_pk_bf16_f32 v66, v48, v49
    v_mfma_f32_16x16x32_bf16 a[80:83], a[244:247], v[80:83], a[80:83]
    v_exp_f32 v50, v50
    v_mfma_f32_16x16x32_bf16 a[84:87], a[244:247], v[84:87], a[84:87]
    buffer_load_dwordx4 v25, s[16:19], s41 offen offset:1024 lds
    v_mfma_f32_16x16x32_bf16 a[88:91], a[244:247], v[88:91], a[88:91]
    v_exp_f32 v51, v51
    v_mfma_f32_16x16x32_bf16 a[92:95], a[244:247], v[92:95], a[92:95]
    ds_read_b128 a[216:219], v4 offset:28672
    v_cvt_pk_bf16_f32 v67, v50, v51
    v_mfma_f32_16x16x32_bf16 v[136:139], v[160:163], v[88:91], v[136:139]
    v_exp_f32 v52, v52
    v_mfma_f32_16x16x32_bf16 a[96:99], a[248:251], v[80:83], a[96:99]
    buffer_load_dwordx4 v26, s[16:19], s41 offen offset:2048 lds
    v_mfma_f32_16x16x32_bf16 a[100:103], a[248:251], v[84:87], a[100:103]
    v_exp_f32 v53, v53
    v_mfma_f32_16x16x32_bf16 a[104:107], a[248:251], v[88:91], a[104:107]
    ds_read_b128 a[220:223], v5 offset:28672
    v_cvt_pk_bf16_f32 v70, v52, v53
    v_mfma_f32_16x16x32_bf16 a[108:111], a[248:251], v[92:95], a[108:111]
    v_exp_f32 v54, v54
    v_mfma_f32_16x16x32_bf16 a[112:115], a[252:255], v[80:83], a[112:115]
    buffer_load_dwordx4 v27, s[16:19], s41 offen offset:3072 lds
    v_mfma_f32_16x16x32_bf16 a[116:119], a[252:255], v[84:87], a[116:119]
    s_add_u32 s41, s41, s29
    v_exp_f32 v55, v55
    v_mfma_f32_16x16x32_bf16 a[120:123], a[252:255], v[88:91], a[120:123]
    v_cvt_pk_bf16_f32 v71, v54, v55
    v_mfma_f32_16x16x32_bf16 a[124:127], a[252:255], v[92:95], a[124:127]
    v_exp_f32 v56, v56
    v_mfma_f32_16x16x32_bf16 v[140:143], v[160:163], v[92:95], v[140:143]
    s_waitcnt vmcnt(15) lgkmcnt(1)
    v_mfma_f32_16x16x32_bf16 a[128:131], v[112:115], v[192:195], a[128:131]
    s_waitcnt vmcnt(14)
    ds_read_b64_tr_b16 v[124:125], v167
    v_mfma_f32_16x16x32_bf16 a[132:135], v[112:115], v[196:199], a[132:135]
    s_waitcnt vmcnt(13)
    ds_read_b64_tr_b16 v[126:127], v167 offset:2048
    v_mfma_f32_16x16x32_bf16 a[136:139], v[112:115], v[200:203], a[136:139]
    s_waitcnt vmcnt(12)
    v_mfma_f32_16x16x32_bf16 a[140:143], v[112:115], v[204:207], a[140:143]
    s_waitcnt vmcnt(8)
    v_mfma_f32_16x16x32_bf16 a[144:147], v[116:119], v[192:195], a[144:147]
    ds_read_b64_tr_b16 v[112:113], v20
    v_mfma_f32_16x16x32_bf16 a[148:151], v[116:119], v[196:199], a[148:151]
    ds_read_b64_tr_b16 v[114:115], v20 offset:2048
    v_mfma_f32_16x16x32_bf16 a[152:155], v[116:119], v[200:203], a[152:155]
    v_mfma_f32_16x16x32_bf16 a[156:159], v[116:119], v[204:207], a[156:159]
    v_mfma_f32_16x16x32_bf16 a[160:163], v[120:123], v[192:195], a[160:163]
    ds_read_b64_tr_b16 v[116:117], v21
    v_mfma_f32_16x16x32_bf16 a[164:167], v[120:123], v[196:199], a[164:167]
    ds_read_b64_tr_b16 v[118:119], v21 offset:2048
    v_mfma_f32_16x16x32_bf16 a[168:171], v[120:123], v[200:203], a[168:171]
    v_mfma_f32_16x16x32_bf16 a[172:175], v[120:123], v[204:207], a[172:175]
    s_waitcnt lgkmcnt(3)
    v_mfma_f32_16x16x32_bf16 a[176:179], v[124:127], v[192:195], a[176:179]
    ds_read_b64_tr_b16 v[120:121], v22
    v_mfma_f32_16x16x32_bf16 a[180:183], v[124:127], v[196:199], a[180:183]
    ds_read_b64_tr_b16 v[122:123], v22 offset:2048
    v_mfma_f32_16x16x32_bf16 a[184:187], v[124:127], v[200:203], a[184:187]
    v_mfma_f32_16x16x32_bf16 a[188:191], v[124:127], v[204:207], a[188:191]
    v_mfma_f32_16x16x32_bf16 v[32:35], a[192:195], v[144:147], v[96:99]
    v_exp_f32 v57, v57
    v_mfma_f32_16x16x32_bf16 v[32:35], a[196:199], v[176:179], v[32:35]
    ds_read_b64_tr_b16 a[224:225], v6 offset:16384
    v_cvt_pk_bf16_f32 v74, v56, v57
    v_mfma_f32_16x16x32_bf16 v[32:35], a[200:203], v[208:211], v[32:35]
    v_exp_f32 v58, v58
    v_mfma_f32_16x16x32_bf16 v[32:35], a[204:207], v[240:243], v[32:35]
    ds_read_b64_tr_b16 a[226:227], v6 offset:20480
    buffer_load_dwordx4 v[192:195], v30, s[20:23], s36 offen sc1
    v_mfma_f32_16x16x32_bf16 v[36:39], a[192:195], v[148:151], v[100:103]
    s_add_u32 s36, s36, 1024
    v_exp_f32 v59, v59
    v_mfma_f32_16x16x32_bf16 v[36:39], a[196:199], v[180:183], v[36:39]
    ds_read_b64_tr_b16 a[228:229], v7 offset:16384
    v_cvt_pk_bf16_f32 v75, v58, v59
    v_mfma_f32_16x16x32_bf16 v[36:39], a[200:203], v[212:215], v[36:39]
    v_exp_f32 v60, v60
    v_mfma_f32_16x16x32_bf16 v[36:39], a[204:207], v[244:247], v[36:39]
    ds_read_b64_tr_b16 a[230:231], v7 offset:20480
    buffer_load_dwordx4 v[196:199], v30, s[20:23], s37 offen sc1
    v_mfma_f32_16x16x32_bf16 v[40:43], a[192:195], v[152:155], v[104:107]
    s_add_u32 s37, s37, 1024
    v_exp_f32 v61, v61
    v_mfma_f32_16x16x32_bf16 v[40:43], a[196:199], v[184:187], v[40:43]
    ds_read_b64_tr_b16 a[232:233], v8 offset:16384
    v_cvt_pk_bf16_f32 v78, v60, v61
    v_mfma_f32_16x16x32_bf16 v[40:43], a[200:203], v[216:219], v[40:43]
    v_exp_f32 v62, v62
    v_mfma_f32_16x16x32_bf16 v[40:43], a[204:207], v[248:251], v[40:43]
    ds_read_b64_tr_b16 a[234:235], v8 offset:20480
    buffer_load_dwordx4 v[200:203], v30, s[20:23], s39 offen sc1
    v_mfma_f32_16x16x32_bf16 v[44:47], a[192:195], v[156:159], v[108:111]
    s_add_u32 s39, s39, 1024
    v_exp_f32 v63, v63
    v_mfma_f32_16x16x32_bf16 v[44:47], a[196:199], v[188:191], v[44:47]
    ds_read_b64_tr_b16 a[236:237], v9 offset:16384
    v_cvt_pk_bf16_f32 v79, v62, v63
    v_mfma_f32_16x16x32_bf16 v[44:47], a[200:203], v[220:223], v[44:47]
    v_mfma_f32_16x16x32_bf16 v[44:47], a[204:207], v[252:255], v[44:47]
    ds_read_b64_tr_b16 a[238:239], v9 offset:20480
    buffer_load_dwordx4 v[204:207], v30, s[20:23], s42 offen sc1
    v_mfma_f32_16x16x32_bf16 v[48:51], a[208:211], v[144:147], v[96:99]
    s_add_u32 s42, s42, 1024
    s_add_u32 m0, s38, 0
    v_mfma_f32_16x16x32_bf16 v[48:51], a[212:215], v[176:179], v[48:51]
    ds_read_b64_tr_b16 a[240:241], v10 offset:16384
    buffer_load_dwordx4 v24, s[16:19], s41 offen lds
    v_mfma_f32_16x16x32_bf16 v[48:51], a[216:219], v[208:211], v[48:51]
    v_exp_f32 v32, v32
    v_mfma_f32_16x16x32_bf16 v[48:51], a[220:223], v[240:243], v[48:51]
    ds_read_b64_tr_b16 a[242:243], v10 offset:20480
    buffer_load_dwordx4 v25, s[16:19], s41 offen offset:1024 lds
    v_mfma_f32_16x16x32_bf16 v[52:55], a[208:211], v[148:151], v[100:103]
    v_exp_f32 v33, v33
    v_mfma_f32_16x16x32_bf16 v[52:55], a[212:215], v[180:183], v[52:55]
    ds_read_b64_tr_b16 a[244:245], v11 offset:16384
    v_cvt_pk_bf16_f32 v80, v32, v33
    v_mfma_f32_16x16x32_bf16 v[52:55], a[216:219], v[212:215], v[52:55]
    v_exp_f32 v34, v34
    v_mfma_f32_16x16x32_bf16 v[52:55], a[220:223], v[244:247], v[52:55]
    ds_read_b64_tr_b16 a[246:247], v11 offset:20480
    buffer_load_dwordx4 v26, s[16:19], s41 offen offset:2048 lds
    v_mfma_f32_16x16x32_bf16 v[56:59], a[208:211], v[152:155], v[104:107]
    v_exp_f32 v35, v35
    v_mfma_f32_16x16x32_bf16 v[56:59], a[212:215], v[184:187], v[56:59]
    ds_read_b64_tr_b16 a[248:249], v12 offset:16384
    v_cvt_pk_bf16_f32 v81, v34, v35
    v_mfma_f32_16x16x32_bf16 v[56:59], a[216:219], v[216:219], v[56:59]
    v_exp_f32 v36, v36
    v_mfma_f32_16x16x32_bf16 v[56:59], a[220:223], v[248:251], v[56:59]
    ds_read_b64_tr_b16 a[250:251], v12 offset:20480
    buffer_load_dwordx4 v27, s[16:19], s41 offen offset:3072 lds
    v_mfma_f32_16x16x32_bf16 v[60:63], a[208:211], v[156:159], v[108:111]
    s_add_u32 s41, s41, s29
    v_exp_f32 v37, v37
    v_mfma_f32_16x16x32_bf16 v[60:63], a[212:215], v[188:191], v[60:63]
    ds_read_b64_tr_b16 a[252:253], v13 offset:16384
    v_cvt_pk_bf16_f32 v84, v36, v37
    v_mfma_f32_16x16x32_bf16 v[60:63], a[216:219], v[220:223], v[60:63]
    v_exp_f32 v38, v38
    v_mfma_f32_16x16x32_bf16 v[60:63], a[220:223], v[252:255], v[60:63]
    s_waitcnt vmcnt(15) lgkmcnt(3)
    ds_read_b64_tr_b16 a[254:255], v13 offset:20480
    v_mfma_f32_16x16x32_bf16 a[128:131], v[112:115], v[224:227], a[128:131]
    s_waitcnt vmcnt(14)
    ds_read_b64_tr_b16 v[124:125], v23
    v_mfma_f32_16x16x32_bf16 a[132:135], v[112:115], v[228:231], a[132:135]
    s_waitcnt vmcnt(13)
    ds_read_b64_tr_b16 v[126:127], v23 offset:2048
    v_mfma_f32_16x16x32_bf16 a[136:139], v[112:115], v[232:235], a[136:139]
    s_waitcnt vmcnt(12)
    v_mfma_f32_16x16x32_bf16 a[140:143], v[112:115], v[236:239], a[140:143]
    s_waitcnt vmcnt(8)
    v_mfma_f32_16x16x32_bf16 a[144:147], v[116:119], v[224:227], a[144:147]
    ds_read_b64_tr_b16 v[112:113], v20 offset:16384
    v_mfma_f32_16x16x32_bf16 a[148:151], v[116:119], v[228:231], a[148:151]
    ds_read_b64_tr_b16 v[114:115], v20 offset:18432
    v_mfma_f32_16x16x32_bf16 a[152:155], v[116:119], v[232:235], a[152:155]
    v_mfma_f32_16x16x32_bf16 a[156:159], v[116:119], v[236:239], a[156:159]
    v_mfma_f32_16x16x32_bf16 a[160:163], v[120:123], v[224:227], a[160:163]
    ds_read_b64_tr_b16 v[116:117], v21 offset:16384
    v_mfma_f32_16x16x32_bf16 a[164:167], v[120:123], v[228:231], a[164:167]
    ds_read_b64_tr_b16 v[118:119], v21 offset:18432
    v_mfma_f32_16x16x32_bf16 a[168:171], v[120:123], v[232:235], a[168:171]
    v_mfma_f32_16x16x32_bf16 a[172:175], v[120:123], v[236:239], a[172:175]
    s_waitcnt lgkmcnt(3)
    v_mfma_f32_16x16x32_bf16 a[176:179], v[124:127], v[224:227], a[176:179]
    ds_read_b64_tr_b16 v[120:121], v22 offset:16384
    v_mfma_f32_16x16x32_bf16 a[180:183], v[124:127], v[228:231], a[180:183]
    ds_read_b64_tr_b16 v[122:123], v22 offset:18432
    v_mfma_f32_16x16x32_bf16 a[184:187], v[124:127], v[232:235], a[184:187]
    v_mfma_f32_16x16x32_bf16 a[188:191], v[124:127], v[236:239], a[188:191]
    s_barrier
    v_mfma_f32_16x16x32_bf16 a[0:3], a[224:227], v[64:67], a[0:3]
    v_exp_f32 v39, v39
    v_mfma_f32_16x16x32_bf16 a[4:7], a[224:227], v[68:71], a[4:7]
    ds_read_b128 a[192:195], v2 offset:32768
    v_cvt_pk_bf16_f32 v85, v38, v39
    v_mfma_f32_16x16x32_bf16 a[8:11], a[224:227], v[72:75], a[8:11]
    v_exp_f32 v40, v40
    v_mfma_f32_16x16x32_bf16 a[12:15], a[224:227], v[76:79], a[12:15]
    buffer_load_dwordx4 v[224:227], v30, s[20:23], s36 offen sc1
    v_mfma_f32_16x16x32_bf16 a[16:19], a[228:231], v[64:67], a[16:19]
    s_add_u32 s36, s36, 1024
    v_exp_f32 v41, v41
    v_mfma_f32_16x16x32_bf16 a[20:23], a[228:231], v[68:71], a[20:23]
    ds_read_b128 a[196:199], v3 offset:32768
    v_cvt_pk_bf16_f32 v88, v40, v41
    v_mfma_f32_16x16x32_bf16 a[24:27], a[228:231], v[72:75], a[24:27]
    v_exp_f32 v42, v42
    v_mfma_f32_16x16x32_bf16 a[28:31], a[228:231], v[76:79], a[28:31]
    buffer_load_dwordx4 v[228:231], v30, s[20:23], s37 offen sc1
    v_mfma_f32_16x16x32_bf16 v[128:131], v[160:163], v[64:67], v[128:131]
    s_add_u32 s37, s37, 1024
    v_exp_f32 v43, v43
    v_mfma_f32_16x16x32_bf16 a[32:35], a[232:235], v[64:67], a[32:35]
    ds_read_b128 a[200:203], v4 offset:32768
    v_cvt_pk_bf16_f32 v89, v42, v43
    v_mfma_f32_16x16x32_bf16 a[36:39], a[232:235], v[68:71], a[36:39]
    v_exp_f32 v44, v44
    v_mfma_f32_16x16x32_bf16 a[40:43], a[232:235], v[72:75], a[40:43]
    buffer_load_dwordx4 v[232:235], v30, s[20:23], s39 offen sc1
    v_mfma_f32_16x16x32_bf16 a[44:47], a[232:235], v[76:79], a[44:47]
    s_add_u32 s39, s39, 1024
    v_exp_f32 v45, v45
    v_mfma_f32_16x16x32_bf16 a[48:51], a[236:239], v[64:67], a[48:51]
    ds_read_b128 a[204:207], v5 offset:32768
    v_cvt_pk_bf16_f32 v92, v44, v45
    v_mfma_f32_16x16x32_bf16 a[52:55], a[236:239], v[68:71], a[52:55]
    v_exp_f32 v46, v46
    v_mfma_f32_16x16x32_bf16 a[56:59], a[236:239], v[72:75], a[56:59]
    buffer_load_dwordx4 v[236:239], v30, s[20:23], s42 offen sc1
    v_mfma_f32_16x16x32_bf16 a[60:63], a[236:239], v[76:79], a[60:63]
    s_add_u32 s42, s42, 1024
    v_exp_f32 v47, v47
    v_mfma_f32_16x16x32_bf16 v[132:135], v[160:163], v[68:71], v[132:135]
    ds_read_b128 a[208:211], v2 offset:36864
    v_cvt_pk_bf16_f32 v93, v46, v47
    v_mfma_f32_16x16x32_bf16 a[64:67], a[240:243], v[64:67], a[64:67]
    s_add_u32 m0, s38, 131072
    v_exp_f32 v48, v48
    v_mfma_f32_16x16x32_bf16 a[68:71], a[240:243], v[68:71], a[68:71]
    buffer_load_dwordx4 v24, s[16:19], s41 offen lds
    v_mfma_f32_16x16x32_bf16 a[72:75], a[240:243], v[72:75], a[72:75]
    v_exp_f32 v49, v49
    v_mfma_f32_16x16x32_bf16 a[76:79], a[240:243], v[76:79], a[76:79]
    ds_read_b128 a[212:215], v3 offset:36864
    v_cvt_pk_bf16_f32 v82, v48, v49
    v_mfma_f32_16x16x32_bf16 a[80:83], a[244:247], v[64:67], a[80:83]
    v_exp_f32 v50, v50
    v_mfma_f32_16x16x32_bf16 a[84:87], a[244:247], v[68:71], a[84:87]
    buffer_load_dwordx4 v25, s[16:19], s41 offen offset:1024 lds
    v_mfma_f32_16x16x32_bf16 a[88:91], a[244:247], v[72:75], a[88:91]
    v_exp_f32 v51, v51
    v_mfma_f32_16x16x32_bf16 a[92:95], a[244:247], v[76:79], a[92:95]
    ds_read_b128 a[216:219], v4 offset:36864
    v_cvt_pk_bf16_f32 v83, v50, v51
    v_mfma_f32_16x16x32_bf16 v[136:139], v[160:163], v[72:75], v[136:139]
    v_exp_f32 v52, v52
    v_mfma_f32_16x16x32_bf16 a[96:99], a[248:251], v[64:67], a[96:99]
    buffer_load_dwordx4 v26, s[16:19], s41 offen offset:2048 lds
    v_mfma_f32_16x16x32_bf16 a[100:103], a[248:251], v[68:71], a[100:103]
    v_exp_f32 v53, v53
    v_mfma_f32_16x16x32_bf16 a[104:107], a[248:251], v[72:75], a[104:107]
    ds_read_b128 a[220:223], v5 offset:36864
    v_cvt_pk_bf16_f32 v86, v52, v53
    v_mfma_f32_16x16x32_bf16 a[108:111], a[248:251], v[76:79], a[108:111]
    v_exp_f32 v54, v54
    v_mfma_f32_16x16x32_bf16 a[112:115], a[252:255], v[64:67], a[112:115]
    buffer_load_dwordx4 v27, s[16:19], s41 offen offset:3072 lds
    v_mfma_f32_16x16x32_bf16 a[116:119], a[252:255], v[68:71], a[116:119]
    s_add_u32 s41, s41, s29
    v_exp_f32 v55, v55
    v_mfma_f32_16x16x32_bf16 a[120:123], a[252:255], v[72:75], a[120:123]
    v_cvt_pk_bf16_f32 v87, v54, v55
    v_mfma_f32_16x16x32_bf16 a[124:127], a[252:255], v[76:79], a[124:127]
    v_exp_f32 v56, v56
    v_mfma_f32_16x16x32_bf16 v[140:143], v[160:163], v[76:79], v[140:143]
    s_waitcnt vmcnt(15) lgkmcnt(1)
    v_mfma_f32_16x16x32_bf16 a[128:131], v[112:115], v[192:195], a[128:131]
    s_waitcnt vmcnt(14)
    ds_read_b64_tr_b16 v[124:125], v23 offset:16384
    v_mfma_f32_16x16x32_bf16 a[132:135], v[112:115], v[196:199], a[132:135]
    s_waitcnt vmcnt(13)
    ds_read_b64_tr_b16 v[126:127], v23 offset:18432
    v_mfma_f32_16x16x32_bf16 a[136:139], v[112:115], v[200:203], a[136:139]
    s_waitcnt vmcnt(12)
    v_mfma_f32_16x16x32_bf16 a[140:143], v[112:115], v[204:207], a[140:143]
    s_waitcnt vmcnt(8)
    v_mfma_f32_16x16x32_bf16 a[144:147], v[116:119], v[192:195], a[144:147]
    ds_read_b64_tr_b16 v[112:113], v164
    v_mfma_f32_16x16x32_bf16 a[148:151], v[116:119], v[196:199], a[148:151]
    ds_read_b64_tr_b16 v[114:115], v164 offset:2048
    v_mfma_f32_16x16x32_bf16 a[152:155], v[116:119], v[200:203], a[152:155]
    v_mfma_f32_16x16x32_bf16 a[156:159], v[116:119], v[204:207], a[156:159]
    v_mfma_f32_16x16x32_bf16 a[160:163], v[120:123], v[192:195], a[160:163]
    ds_read_b64_tr_b16 v[116:117], v165
    v_mfma_f32_16x16x32_bf16 a[164:167], v[120:123], v[196:199], a[164:167]
    ds_read_b64_tr_b16 v[118:119], v165 offset:2048
    v_mfma_f32_16x16x32_bf16 a[168:171], v[120:123], v[200:203], a[168:171]
    v_mfma_f32_16x16x32_bf16 a[172:175], v[120:123], v[204:207], a[172:175]
    s_waitcnt lgkmcnt(3)
    v_mfma_f32_16x16x32_bf16 a[176:179], v[124:127], v[192:195], a[176:179]
    ds_read_b64_tr_b16 v[120:121], v166
    v_mfma_f32_16x16x32_bf16 a[180:183], v[124:127], v[196:199], a[180:183]
    ds_read_b64_tr_b16 v[122:123], v166 offset:2048
    v_mfma_f32_16x16x32_bf16 a[184:187], v[124:127], v[200:203], a[184:187]
    v_mfma_f32_16x16x32_bf16 a[188:191], v[124:127], v[204:207], a[188:191]
    v_mfma_f32_16x16x32_bf16 v[32:35], a[192:195], v[144:147], v[96:99]
    v_exp_f32 v57, v57
    v_mfma_f32_16x16x32_bf16 v[32:35], a[196:199], v[176:179], v[32:35]
    ds_read_b64_tr_b16 a[224:225], v6 offset:24576
    v_cvt_pk_bf16_f32 v90, v56, v57
    v_mfma_f32_16x16x32_bf16 v[32:35], a[200:203], v[208:211], v[32:35]
    v_exp_f32 v58, v58
    v_mfma_f32_16x16x32_bf16 v[32:35], a[204:207], v[240:243], v[32:35]
    ds_read_b64_tr_b16 a[226:227], v6 offset:28672
    buffer_load_dwordx4 v[192:195], v30, s[20:23], s36 offen sc1
    v_mfma_f32_16x16x32_bf16 v[36:39], a[192:195], v[148:151], v[100:103]
    s_add_u32 s36, s36, 1024
    v_exp_f32 v59, v59
    v_mfma_f32_16x16x32_bf16 v[36:39], a[196:199], v[180:183], v[36:39]
    ds_read_b64_tr_b16 a[228:229], v7 offset:24576
    v_cvt_pk_bf16_f32 v91, v58, v59
    v_mfma_f32_16x16x32_bf16 v[36:39], a[200:203], v[212:215], v[36:39]
    v_exp_f32 v60, v60
    v_mfma_f32_16x16x32_bf16 v[36:39], a[204:207], v[244:247], v[36:39]
    ds_read_b64_tr_b16 a[230:231], v7 offset:28672
    buffer_load_dwordx4 v[196:199], v30, s[20:23], s37 offen sc1
    v_mfma_f32_16x16x32_bf16 v[40:43], a[192:195], v[152:155], v[104:107]
    s_add_u32 s37, s37, 1024
    v_exp_f32 v61, v61
    v_mfma_f32_16x16x32_bf16 v[40:43], a[196:199], v[184:187], v[40:43]
    ds_read_b64_tr_b16 a[232:233], v8 offset:24576
    v_cvt_pk_bf16_f32 v94, v60, v61
    v_mfma_f32_16x16x32_bf16 v[40:43], a[200:203], v[216:219], v[40:43]
    v_exp_f32 v62, v62
    v_mfma_f32_16x16x32_bf16 v[40:43], a[204:207], v[248:251], v[40:43]
    ds_read_b64_tr_b16 a[234:235], v8 offset:28672
    buffer_load_dwordx4 v[200:203], v30, s[20:23], s39 offen sc1
    v_mfma_f32_16x16x32_bf16 v[44:47], a[192:195], v[156:159], v[108:111]
    s_add_u32 s39, s39, 1024
    v_exp_f32 v63, v63
    v_mfma_f32_16x16x32_bf16 v[44:47], a[196:199], v[188:191], v[44:47]
    ds_read_b64_tr_b16 a[236:237], v9 offset:24576
    v_cvt_pk_bf16_f32 v95, v62, v63
    v_mfma_f32_16x16x32_bf16 v[44:47], a[200:203], v[220:223], v[44:47]
    v_mfma_f32_16x16x32_bf16 v[44:47], a[204:207], v[252:255], v[44:47]
    ds_read_b64_tr_b16 a[238:239], v9 offset:28672
    buffer_load_dwordx4 v[204:207], v30, s[20:23], s42 offen sc1
    v_mfma_f32_16x16x32_bf16 v[48:51], a[208:211], v[144:147], v[96:99]
    s_add_u32 s42, s42, 1024
    s_add_u32 m0, s38, 147456
    v_mfma_f32_16x16x32_bf16 v[48:51], a[212:215], v[176:179], v[48:51]
    ds_read_b64_tr_b16 a[240:241], v10 offset:24576
    buffer_load_dwordx4 v24, s[16:19], s41 offen lds
    v_mfma_f32_16x16x32_bf16 v[48:51], a[216:219], v[208:211], v[48:51]
    v_exp_f32 v32, v32
    v_mfma_f32_16x16x32_bf16 v[48:51], a[220:223], v[240:243], v[48:51]
    ds_read_b64_tr_b16 a[242:243], v10 offset:28672
    buffer_load_dwordx4 v25, s[16:19], s41 offen offset:1024 lds
    v_mfma_f32_16x16x32_bf16 v[52:55], a[208:211], v[148:151], v[100:103]
    v_exp_f32 v33, v33
    v_mfma_f32_16x16x32_bf16 v[52:55], a[212:215], v[180:183], v[52:55]
    ds_read_b64_tr_b16 a[244:245], v11 offset:24576
    v_cvt_pk_bf16_f32 v64, v32, v33
    v_mfma_f32_16x16x32_bf16 v[52:55], a[216:219], v[212:215], v[52:55]
    v_exp_f32 v34, v34
    v_mfma_f32_16x16x32_bf16 v[52:55], a[220:223], v[244:247], v[52:55]
    ds_read_b64_tr_b16 a[246:247], v11 offset:28672
    buffer_load_dwordx4 v26, s[16:19], s41 offen offset:2048 lds
    v_mfma_f32_16x16x32_bf16 v[56:59], a[208:211], v[152:155], v[104:107]
    v_exp_f32 v35, v35
    v_mfma_f32_16x16x32_bf16 v[56:59], a[212:215], v[184:187], v[56:59]
    ds_read_b64_tr_b16 a[248:249], v12 offset:24576
    v_cvt_pk_bf16_f32 v65, v34, v35
    v_mfma_f32_16x16x32_bf16 v[56:59], a[216:219], v[216:219], v[56:59]
    v_exp_f32 v36, v36
    v_mfma_f32_16x16x32_bf16 v[56:59], a[220:223], v[248:251], v[56:59]
    ds_read_b64_tr_b16 a[250:251], v12 offset:28672
    buffer_load_dwordx4 v27, s[16:19], s41 offen offset:3072 lds
    v_mfma_f32_16x16x32_bf16 v[60:63], a[208:211], v[156:159], v[108:111]
    s_add_u32 s41, s41, s29
    v_exp_f32 v37, v37
    v_mfma_f32_16x16x32_bf16 v[60:63], a[212:215], v[188:191], v[60:63]
    ds_read_b64_tr_b16 a[252:253], v13 offset:24576
    v_cvt_pk_bf16_f32 v68, v36, v37
    v_mfma_f32_16x16x32_bf16 v[60:63], a[216:219], v[220:223], v[60:63]
    v_exp_f32 v38, v38
    v_mfma_f32_16x16x32_bf16 v[60:63], a[220:223], v[252:255], v[60:63]
    s_waitcnt vmcnt(15) lgkmcnt(3)
    ds_read_b64_tr_b16 a[254:255], v13 offset:28672
    v_mfma_f32_16x16x32_bf16 a[128:131], v[112:115], v[224:227], a[128:131]
    s_waitcnt vmcnt(14)
    ds_read_b64_tr_b16 v[124:125], v167
    v_mfma_f32_16x16x32_bf16 a[132:135], v[112:115], v[228:231], a[132:135]
    s_waitcnt vmcnt(13)
    ds_read_b64_tr_b16 v[126:127], v167 offset:2048
    v_mfma_f32_16x16x32_bf16 a[136:139], v[112:115], v[232:235], a[136:139]
    s_waitcnt vmcnt(12)
    v_mfma_f32_16x16x32_bf16 a[140:143], v[112:115], v[236:239], a[140:143]
    s_waitcnt vmcnt(8)
    v_mfma_f32_16x16x32_bf16 a[144:147], v[116:119], v[224:227], a[144:147]
    ds_read_b64_tr_b16 v[112:113], v20
    v_mfma_f32_16x16x32_bf16 a[148:151], v[116:119], v[228:231], a[148:151]
    ds_read_b64_tr_b16 v[114:115], v20 offset:2048
    v_mfma_f32_16x16x32_bf16 a[152:155], v[116:119], v[232:235], a[152:155]
    v_mfma_f32_16x16x32_bf16 a[156:159], v[116:119], v[236:239], a[156:159]
    v_mfma_f32_16x16x32_bf16 a[160:163], v[120:123], v[224:227], a[160:163]
    ds_read_b64_tr_b16 v[116:117], v21
    v_mfma_f32_16x16x32_bf16 a[164:167], v[120:123], v[228:231], a[164:167]
    ds_read_b64_tr_b16 v[118:119], v21 offset:2048
    v_mfma_f32_16x16x32_bf16 a[168:171], v[120:123], v[232:235], a[168:171]
    v_mfma_f32_16x16x32_bf16 a[172:175], v[120:123], v[236:239], a[172:175]
    s_waitcnt lgkmcnt(3)
    v_mfma_f32_16x16x32_bf16 a[176:179], v[124:127], v[224:227], a[176:179]
    ds_read_b64_tr_b16 v[120:121], v22
    v_mfma_f32_16x16x32_bf16 a[180:183], v[124:127], v[228:231], a[180:183]
    ds_read_b64_tr_b16 v[122:123], v22 offset:2048
    v_mfma_f32_16x16x32_bf16 a[184:187], v[124:127], v[232:235], a[184:187]
    v_mfma_f32_16x16x32_bf16 a[188:191], v[124:127], v[236:239], a[188:191]
    v_mfma_f32_16x16x32_bf16 a[0:3], a[224:227], v[80:83], a[0:3]
    v_exp_f32 v39, v39
    v_mfma_f32_16x16x32_bf16 a[4:7], a[224:227], v[84:87], a[4:7]
    ds_read_b128 a[192:195], v2 offset:40960
    v_cvt_pk_bf16_f32 v69, v38, v39
    v_mfma_f32_16x16x32_bf16 a[8:11], a[224:227], v[88:91], a[8:11]
    v_exp_f32 v40, v40
    v_mfma_f32_16x16x32_bf16 a[12:15], a[224:227], v[92:95], a[12:15]
    buffer_load_dwordx4 v[224:227], v30, s[20:23], s36 offen sc1
    v_mfma_f32_16x16x32_bf16 a[16:19], a[228:231], v[80:83], a[16:19]
    s_add_u32 s36, s36, 1024
    v_exp_f32 v41, v41
    v_mfma_f32_16x16x32_bf16 a[20:23], a[228:231], v[84:87], a[20:23]
    ds_read_b128 a[196:199], v3 offset:40960
    v_cvt_pk_bf16_f32 v72, v40, v41
    v_mfma_f32_16x16x32_bf16 a[24:27], a[228:231], v[88:91], a[24:27]
    v_exp_f32 v42, v42
    v_mfma_f32_16x16x32_bf16 a[28:31], a[228:231], v[92:95], a[28:31]
    buffer_load_dwordx4 v[228:231], v30, s[20:23], s37 offen sc1
    v_mfma_f32_16x16x32_bf16 v[128:131], v[160:163], v[80:83], v[128:131]
    s_add_u32 s37, s37, 1024
    v_exp_f32 v43, v43
    v_mfma_f32_16x16x32_bf16 a[32:35], a[232:235], v[80:83], a[32:35]
    ds_read_b128 a[200:203], v4 offset:40960
    v_cvt_pk_bf16_f32 v73, v42, v43
    v_mfma_f32_16x16x32_bf16 a[36:39], a[232:235], v[84:87], a[36:39]
    v_exp_f32 v44, v44
    v_mfma_f32_16x16x32_bf16 a[40:43], a[232:235], v[88:91], a[40:43]
    buffer_load_dwordx4 v[232:235], v30, s[20:23], s39 offen sc1
    v_mfma_f32_16x16x32_bf16 a[44:47], a[232:235], v[92:95], a[44:47]
    s_add_u32 s39, s39, 1024
    v_exp_f32 v45, v45
    v_mfma_f32_16x16x32_bf16 a[48:51], a[236:239], v[80:83], a[48:51]
    ds_read_b128 a[204:207], v5 offset:40960
    v_cvt_pk_bf16_f32 v76, v44, v45
    v_mfma_f32_16x16x32_bf16 a[52:55], a[236:239], v[84:87], a[52:55]
    v_exp_f32 v46, v46
    v_mfma_f32_16x16x32_bf16 a[56:59], a[236:239], v[88:91], a[56:59]
    buffer_load_dwordx4 v[236:239], v30, s[20:23], s42 offen sc1
    v_mfma_f32_16x16x32_bf16 a[60:63], a[236:239], v[92:95], a[60:63]
    s_add_u32 s42, s42, 1024
    v_exp_f32 v47, v47
    v_mfma_f32_16x16x32_bf16 v[132:135], v[160:163], v[84:87], v[132:135]
    ds_read_b128 a[208:211], v2 offset:45056
    v_cvt_pk_bf16_f32 v77, v46, v47
    v_mfma_f32_16x16x32_bf16 a[64:67], a[240:243], v[80:83], a[64:67]
    s_add_u32 m0, s38, 0
    v_exp_f32 v48, v48
    v_mfma_f32_16x16x32_bf16 a[68:71], a[240:243], v[84:87], a[68:71]
    buffer_load_dwordx4 v24, s[16:19], s41 offen lds
    v_mfma_f32_16x16x32_bf16 a[72:75], a[240:243], v[88:91], a[72:75]
    v_exp_f32 v49, v49
    v_mfma_f32_16x16x32_bf16 a[76:79], a[240:243], v[92:95], a[76:79]
    ds_read_b128 a[212:215], v3 offset:45056
    v_cvt_pk_bf16_f32 v66, v48, v49
    v_mfma_f32_16x16x32_bf16 a[80:83], a[244:247], v[80:83], a[80:83]
    v_exp_f32 v50, v50
    v_mfma_f32_16x16x32_bf16 a[84:87], a[244:247], v[84:87], a[84:87]
    buffer_load_dwordx4 v25, s[16:19], s41 offen offset:1024 lds
    v_mfma_f32_16x16x32_bf16 a[88:91], a[244:247], v[88:91], a[88:91]
    v_exp_f32 v51, v51
    v_mfma_f32_16x16x32_bf16 a[92:95], a[244:247], v[92:95], a[92:95]
    ds_read_b128 a[216:219], v4 offset:45056
    v_cvt_pk_bf16_f32 v67, v50, v51
    v_mfma_f32_16x16x32_bf16 v[136:139], v[160:163], v[88:91], v[136:139]
    v_exp_f32 v52, v52
    v_mfma_f32_16x16x32_bf16 a[96:99], a[248:251], v[80:83], a[96:99]
    buffer_load_dwordx4 v26, s[16:19], s41 offen offset:2048 lds
    v_mfma_f32_16x16x32_bf16 a[100:103], a[248:251], v[84:87], a[100:103]
    v_exp_f32 v53, v53
    v_mfma_f32_16x16x32_bf16 a[104:107], a[248:251], v[88:91], a[104:107]
    ds_read_b128 a[220:223], v5 offset:45056
    v_cvt_pk_bf16_f32 v70, v52, v53
    v_mfma_f32_16x16x32_bf16 a[108:111], a[248:251], v[92:95], a[108:111]
    v_exp_f32 v54, v54
    v_mfma_f32_16x16x32_bf16 a[112:115], a[252:255], v[80:83], a[112:115]
    buffer_load_dwordx4 v27, s[16:19], s41 offen offset:3072 lds
    v_mfma_f32_16x16x32_bf16 a[116:119], a[252:255], v[84:87], a[116:119]
    s_add_u32 s41, s41, s29
    v_exp_f32 v55, v55
    v_mfma_f32_16x16x32_bf16 a[120:123], a[252:255], v[88:91], a[120:123]
    v_cvt_pk_bf16_f32 v71, v54, v55
    v_mfma_f32_16x16x32_bf16 a[124:127], a[252:255], v[92:95], a[124:127]
    v_exp_f32 v56, v56
    v_mfma_f32_16x16x32_bf16 v[140:143], v[160:163], v[92:95], v[140:143]
    s_waitcnt vmcnt(15) lgkmcnt(1)
    v_mfma_f32_16x16x32_bf16 a[128:131], v[112:115], v[192:195], a[128:131]
    s_waitcnt vmcnt(14)
    ds_read_b64_tr_b16 v[124:125], v23
    v_mfma_f32_16x16x32_bf16 a[132:135], v[112:115], v[196:199], a[132:135]
    s_waitcnt vmcnt(13)
    ds_read_b64_tr_b16 v[126:127], v23 offset:2048
    v_mfma_f32_16x16x32_bf16 a[136:139], v[112:115], v[200:203], a[136:139]
    s_waitcnt vmcnt(12)
    v_mfma_f32_16x16x32_bf16 a[140:143], v[112:115], v[204:207], a[140:143]
    s_waitcnt vmcnt(8)
    v_mfma_f32_16x16x32_bf16 a[144:147], v[116:119], v[192:195], a[144:147]
    ds_read_b64_tr_b16 v[112:113], v20 offset:16384
    v_mfma_f32_16x16x32_bf16 a[148:151], v[116:119], v[196:199], a[148:151]
    ds_read_b64_tr_b16 v[114:115], v20 offset:18432
    v_mfma_f32_16x16x32_bf16 a[152:155], v[116:119], v[200:203], a[152:155]
    v_mfma_f32_16x16x32_bf16 a[156:159], v[116:119], v[204:207], a[156:159]
    v_mfma_f32_16x16x32_bf16 a[160:163], v[120:123], v[192:195], a[160:163]
    ds_read_b64_tr_b16 v[116:117], v21 offset:16384
    v_mfma_f32_16x16x32_bf16 a[164:167], v[120:123], v[196:199], a[164:167]
    ds_read_b64_tr_b16 v[118:119], v21 offset:18432
    v_mfma_f32_16x16x32_bf16 a[168:171], v[120:123], v[200:203], a[168:171]
    v_mfma_f32_16x16x32_bf16 a[172:175], v[120:123], v[204:207], a[172:175]
    s_waitcnt lgkmcnt(3)
    v_mfma_f32_16x16x32_bf16 a[176:179], v[124:127], v[192:195], a[176:179]
    ds_read_b64_tr_b16 v[120:121], v22 offset:16384
    v_mfma_f32_16x16x32_bf16 a[180:183], v[124:127], v[196:199], a[180:183]
    ds_read_b64_tr_b16 v[122:123], v22 offset:18432
    v_mfma_f32_16x16x32_bf16 a[184:187], v[124:127], v[200:203], a[184:187]
    v_mfma_f32_16x16x32_bf16 a[188:191], v[124:127], v[204:207], a[188:191]
    v_mfma_f32_16x16x32_bf16 v[32:35], a[192:195], v[144:147], v[96:99]
    v_exp_f32 v57, v57
    v_mfma_f32_16x16x32_bf16 v[32:35], a[196:199], v[176:179], v[32:35]
    ds_read_b64_tr_b16 a[224:225], v6 offset:32768
    v_cvt_pk_bf16_f32 v74, v56, v57
    v_mfma_f32_16x16x32_bf16 v[32:35], a[200:203], v[208:211], v[32:35]
    v_exp_f32 v58, v58
    v_mfma_f32_16x16x32_bf16 v[32:35], a[204:207], v[240:243], v[32:35]
    ds_read_b64_tr_b16 a[226:227], v6 offset:36864
    buffer_load_dwordx4 v[192:195], v30, s[20:23], s36 offen sc1
    v_mfma_f32_16x16x32_bf16 v[36:39], a[192:195], v[148:151], v[100:103]
    s_add_u32 s36, s36, 1024
    v_exp_f32 v59, v59
    v_mfma_f32_16x16x32_bf16 v[36:39], a[196:199], v[180:183], v[36:39]
    ds_read_b64_tr_b16 a[228:229], v7 offset:32768
    v_cvt_pk_bf16_f32 v75, v58, v59
    v_mfma_f32_16x16x32_bf16 v[36:39], a[200:203], v[212:215], v[36:39]
    v_exp_f32 v60, v60
    v_mfma_f32_16x16x32_bf16 v[36:39], a[204:207], v[244:247], v[36:39]
    ds_read_b64_tr_b16 a[230:231], v7 offset:36864
    buffer_load_dwordx4 v[196:199], v30, s[20:23], s37 offen sc1
    v_mfma_f32_16x16x32_bf16 v[40:43], a[192:195], v[152:155], v[104:107]
    s_add_u32 s37, s37, 1024
    v_exp_f32 v61, v61
    v_mfma_f32_16x16x32_bf16 v[40:43], a[196:199], v[184:187], v[40:43]
    ds_read_b64_tr_b16 a[232:233], v8 offset:32768
    v_cvt_pk_bf16_f32 v78, v60, v61
    v_mfma_f32_16x16x32_bf16 v[40:43], a[200:203], v[216:219], v[40:43]
    v_exp_f32 v62, v62
    v_mfma_f32_16x16x32_bf16 v[40:43], a[204:207], v[248:251], v[40:43]
    ds_read_b64_tr_b16 a[234:235], v8 offset:36864
    buffer_load_dwordx4 v[200:203], v30, s[20:23], s39 offen sc1
    v_mfma_f32_16x16x32_bf16 v[44:47], a[192:195], v[156:159], v[108:111]
    s_add_u32 s39, s39, 1024
    v_exp_f32 v63, v63
    v_mfma_f32_16x16x32_bf16 v[44:47], a[196:199], v[188:191], v[44:47]
    ds_read_b64_tr_b16 a[236:237], v9 offset:32768
    v_cvt_pk_bf16_f32 v79, v62, v63
    v_mfma_f32_16x16x32_bf16 v[44:47], a[200:203], v[220:223], v[44:47]
    v_mfma_f32_16x16x32_bf16 v[44:47], a[204:207], v[252:255], v[44:47]
    ds_read_b64_tr_b16 a[238:239], v9 offset:36864
    buffer_load_dwordx4 v[204:207], v30, s[20:23], s42 offen sc1
    v_mfma_f32_16x16x32_bf16 v[48:51], a[208:211], v[144:147], v[96:99]
    s_add_u32 s42, s42, 1024
    s_add_u32 m0, s38, 131072
    v_mfma_f32_16x16x32_bf16 v[48:51], a[212:215], v[176:179], v[48:51]
    ds_read_b64_tr_b16 a[240:241], v10 offset:32768
    buffer_load_dwordx4 v24, s[16:19], s41 offen lds
    v_mfma_f32_16x16x32_bf16 v[48:51], a[216:219], v[208:211], v[48:51]
    v_exp_f32 v32, v32
    v_mfma_f32_16x16x32_bf16 v[48:51], a[220:223], v[240:243], v[48:51]
    ds_read_b64_tr_b16 a[242:243], v10 offset:36864
    buffer_load_dwordx4 v25, s[16:19], s41 offen offset:1024 lds
    v_mfma_f32_16x16x32_bf16 v[52:55], a[208:211], v[148:151], v[100:103]
    v_exp_f32 v33, v33
    v_mfma_f32_16x16x32_bf16 v[52:55], a[212:215], v[180:183], v[52:55]
    ds_read_b64_tr_b16 a[244:245], v11 offset:32768
    v_cvt_pk_bf16_f32 v80, v32, v33
    v_mfma_f32_16x16x32_bf16 v[52:55], a[216:219], v[212:215], v[52:55]
    v_exp_f32 v34, v34
    v_mfma_f32_16x16x32_bf16 v[52:55], a[220:223], v[244:247], v[52:55]
    ds_read_b64_tr_b16 a[246:247], v11 offset:36864
    buffer_load_dwordx4 v26, s[16:19], s41 offen offset:2048 lds
    v_mfma_f32_16x16x32_bf16 v[56:59], a[208:211], v[152:155], v[104:107]
    v_exp_f32 v35, v35
    v_mfma_f32_16x16x32_bf16 v[56:59], a[212:215], v[184:187], v[56:59]
    ds_read_b64_tr_b16 a[248:249], v12 offset:32768
    v_cvt_pk_bf16_f32 v81, v34, v35
    v_mfma_f32_16x16x32_bf16 v[56:59], a[216:219], v[216:219], v[56:59]
    v_exp_f32 v36, v36
    v_mfma_f32_16x16x32_bf16 v[56:59], a[220:223], v[248:251], v[56:59]
    ds_read_b64_tr_b16 a[250:251], v12 offset:36864
    buffer_load_dwordx4 v27, s[16:19], s41 offen offset:3072 lds
    v_mfma_f32_16x16x32_bf16 v[60:63], a[208:211], v[156:159], v[108:111]
    s_add_u32 s41, s41, s29
    v_exp_f32 v37, v37
    v_mfma_f32_16x16x32_bf16 v[60:63], a[212:215], v[188:191], v[60:63]
    ds_read_b64_tr_b16 a[252:253], v13 offset:32768
    v_cvt_pk_bf16_f32 v84, v36, v37
    v_mfma_f32_16x16x32_bf16 v[60:63], a[216:219], v[220:223], v[60:63]
    v_exp_f32 v38, v38
    v_mfma_f32_16x16x32_bf16 v[60:63], a[220:223], v[252:255], v[60:63]
    s_waitcnt vmcnt(15) lgkmcnt(3)
    ds_read_b64_tr_b16 a[254:255], v13 offset:36864
    v_mfma_f32_16x16x32_bf16 a[128:131], v[112:115], v[224:227], a[128:131]
    s_waitcnt vmcnt(14)
    ds_read_b64_tr_b16 v[124:125], v23 offset:16384
    v_mfma_f32_16x16x32_bf16 a[132:135], v[112:115], v[228:231], a[132:135]
    s_waitcnt vmcnt(13)
    ds_read_b64_tr_b16 v[126:127], v23 offset:18432
    v_mfma_f32_16x16x32_bf16 a[136:139], v[112:115], v[232:235], a[136:139]
    s_waitcnt vmcnt(12)
    v_mfma_f32_16x16x32_bf16 a[140:143], v[112:115], v[236:239], a[140:143]
    s_waitcnt vmcnt(8)
    v_mfma_f32_16x16x32_bf16 a[144:147], v[116:119], v[224:227], a[144:147]
    ds_read_b64_tr_b16 v[112:113], v164
    v_mfma_f32_16x16x32_bf16 a[148:151], v[116:119], v[228:231], a[148:151]
    ds_read_b64_tr_b16 v[114:115], v164 offset:2048
    v_mfma_f32_16x16x32_bf16 a[152:155], v[116:119], v[232:235], a[152:155]
    v_mfma_f32_16x16x32_bf16 a[156:159], v[116:119], v[236:239], a[156:159]
    v_mfma_f32_16x16x32_bf16 a[160:163], v[120:123], v[224:227], a[160:163]
    ds_read_b64_tr_b16 v[116:117], v165
    v_mfma_f32_16x16x32_bf16 a[164:167], v[120:123], v[228:231], a[164:167]
    ds_read_b64_tr_b16 v[118:119], v165 offset:2048
    v_mfma_f32_16x16x32_bf16 a[168:171], v[120:123], v[232:235], a[168:171]
    v_mfma_f32_16x16x32_bf16 a[172:175], v[120:123], v[236:239], a[172:175]
    s_waitcnt lgkmcnt(3)
    v_mfma_f32_16x16x32_bf16 a[176:179], v[124:127], v[224:227], a[176:179]
    ds_read_b64_tr_b16 v[120:121], v166
    v_mfma_f32_16x16x32_bf16 a[180:183], v[124:127], v[228:231], a[180:183]
    ds_read_b64_tr_b16 v[122:123], v166 offset:2048
    v_mfma_f32_16x16x32_bf16 a[184:187], v[124:127], v[232:235], a[184:187]
    v_mfma_f32_16x16x32_bf16 a[188:191], v[124:127], v[236:239], a[188:191]
    s_barrier
    v_mfma_f32_16x16x32_bf16 a[0:3], a[224:227], v[64:67], a[0:3]
    v_exp_f32 v39, v39
    v_mfma_f32_16x16x32_bf16 a[4:7], a[224:227], v[68:71], a[4:7]
    ds_read_b128 a[192:195], v2 offset:49152
    v_cvt_pk_bf16_f32 v85, v38, v39
    v_mfma_f32_16x16x32_bf16 a[8:11], a[224:227], v[72:75], a[8:11]
    v_exp_f32 v40, v40
    v_mfma_f32_16x16x32_bf16 a[12:15], a[224:227], v[76:79], a[12:15]
    buffer_load_dwordx4 v[224:227], v30, s[20:23], s36 offen sc1
    v_mfma_f32_16x16x32_bf16 a[16:19], a[228:231], v[64:67], a[16:19]
    s_add_u32 s36, s36, 1024
    v_exp_f32 v41, v41
    v_mfma_f32_16x16x32_bf16 a[20:23], a[228:231], v[68:71], a[20:23]
    ds_read_b128 a[196:199], v3 offset:49152
    v_cvt_pk_bf16_f32 v88, v40, v41
    v_mfma_f32_16x16x32_bf16 a[24:27], a[228:231], v[72:75], a[24:27]
    v_exp_f32 v42, v42
    v_mfma_f32_16x16x32_bf16 a[28:31], a[228:231], v[76:79], a[28:31]
    buffer_load_dwordx4 v[228:231], v30, s[20:23], s37 offen sc1
    v_mfma_f32_16x16x32_bf16 v[128:131], v[160:163], v[64:67], v[128:131]
    s_add_u32 s37, s37, 1024
    v_exp_f32 v43, v43
    v_mfma_f32_16x16x32_bf16 a[32:35], a[232:235], v[64:67], a[32:35]
    ds_read_b128 a[200:203], v4 offset:49152
    v_cvt_pk_bf16_f32 v89, v42, v43
    v_mfma_f32_16x16x32_bf16 a[36:39], a[232:235], v[68:71], a[36:39]
    v_exp_f32 v44, v44
    v_mfma_f32_16x16x32_bf16 a[40:43], a[232:235], v[72:75], a[40:43]
    buffer_load_dwordx4 v[232:235], v30, s[20:23], s39 offen sc1
    v_mfma_f32_16x16x32_bf16 a[44:47], a[232:235], v[76:79], a[44:47]
    s_add_u32 s39, s39, 1024
    v_exp_f32 v45, v45
    v_mfma_f32_16x16x32_bf16 a[48:51], a[236:239], v[64:67], a[48:51]
    ds_read_b128 a[204:207], v5 offset:49152
    v_cvt_pk_bf16_f32 v92, v44, v45
    v_mfma_f32_16x16x32_bf16 a[52:55], a[236:239], v[68:71], a[52:55]
    v_exp_f32 v46, v46
    v_mfma_f32_16x16x32_bf16 a[56:59], a[236:239], v[72:75], a[56:59]
    buffer_load_dwordx4 v[236:239], v30, s[20:23], s42 offen sc1
    v_mfma_f32_16x16x32_bf16 a[60:63], a[236:239], v[76:79], a[60:63]
    s_add_u32 s42, s42, 1024
    v_exp_f32 v47, v47
    v_mfma_f32_16x16x32_bf16 v[132:135], v[160:163], v[68:71], v[132:135]
    ds_read_b128 a[208:211], v2 offset:53248
    v_cvt_pk_bf16_f32 v93, v46, v47
    v_mfma_f32_16x16x32_bf16 a[64:67], a[240:243], v[64:67], a[64:67]
    s_add_u32 m0, s38, 147456
    v_exp_f32 v48, v48
    v_mfma_f32_16x16x32_bf16 a[68:71], a[240:243], v[68:71], a[68:71]
    buffer_load_dwordx4 v24, s[16:19], s41 offen lds
    v_mfma_f32_16x16x32_bf16 a[72:75], a[240:243], v[72:75], a[72:75]
    v_exp_f32 v49, v49
    v_mfma_f32_16x16x32_bf16 a[76:79], a[240:243], v[76:79], a[76:79]
    ds_read_b128 a[212:215], v3 offset:53248
    v_cvt_pk_bf16_f32 v82, v48, v49
    v_mfma_f32_16x16x32_bf16 a[80:83], a[244:247], v[64:67], a[80:83]
    v_exp_f32 v50, v50
    v_mfma_f32_16x16x32_bf16 a[84:87], a[244:247], v[68:71], a[84:87]
    buffer_load_dwordx4 v25, s[16:19], s41 offen offset:1024 lds
    v_mfma_f32_16x16x32_bf16 a[88:91], a[244:247], v[72:75], a[88:91]
    v_exp_f32 v51, v51
    v_mfma_f32_16x16x32_bf16 a[92:95], a[244:247], v[76:79], a[92:95]
    ds_read_b128 a[216:219], v4 offset:53248
    v_cvt_pk_bf16_f32 v83, v50, v51
    v_mfma_f32_16x16x32_bf16 v[136:139], v[160:163], v[72:75], v[136:139]
    v_exp_f32 v52, v52
    v_mfma_f32_16x16x32_bf16 a[96:99], a[248:251], v[64:67], a[96:99]
    buffer_load_dwordx4 v26, s[16:19], s41 offen offset:2048 lds
    v_mfma_f32_16x16x32_bf16 a[100:103], a[248:251], v[68:71], a[100:103]
    v_exp_f32 v53, v53
    v_mfma_f32_16x16x32_bf16 a[104:107], a[248:251], v[72:75], a[104:107]
    ds_read_b128 a[220:223], v5 offset:53248
    v_cvt_pk_bf16_f32 v86, v52, v53
    v_mfma_f32_16x16x32_bf16 a[108:111], a[248:251], v[76:79], a[108:111]
    v_exp_f32 v54, v54
    v_mfma_f32_16x16x32_bf16 a[112:115], a[252:255], v[64:67], a[112:115]
    buffer_load_dwordx4 v27, s[16:19], s41 offen offset:3072 lds
    v_mfma_f32_16x16x32_bf16 a[116:119], a[252:255], v[68:71], a[116:119]
    s_add_u32 s41, s41, s29
    v_exp_f32 v55, v55
    v_mfma_f32_16x16x32_bf16 a[120:123], a[252:255], v[72:75], a[120:123]
    v_cvt_pk_bf16_f32 v87, v54, v55
    v_mfma_f32_16x16x32_bf16 a[124:127], a[252:255], v[76:79], a[124:127]
    v_exp_f32 v56, v56
    v_mfma_f32_16x16x32_bf16 v[140:143], v[160:163], v[76:79], v[140:143]
    s_waitcnt vmcnt(15) lgkmcnt(1)
    v_mfma_f32_16x16x32_bf16 a[128:131], v[112:115], v[192:195], a[128:131]
    s_waitcnt vmcnt(14)
    ds_read_b64_tr_b16 v[124:125], v167
    v_mfma_f32_16x16x32_bf16 a[132:135], v[112:115], v[196:199], a[132:135]
    s_waitcnt vmcnt(13)
    ds_read_b64_tr_b16 v[126:127], v167 offset:2048
    v_mfma_f32_16x16x32_bf16 a[136:139], v[112:115], v[200:203], a[136:139]
    s_waitcnt vmcnt(12)
    v_mfma_f32_16x16x32_bf16 a[140:143], v[112:115], v[204:207], a[140:143]
    s_waitcnt vmcnt(8)
    v_mfma_f32_16x16x32_bf16 a[144:147], v[116:119], v[192:195], a[144:147]
    ds_read_b64_tr_b16 v[112:113], v20
    v_mfma_f32_16x16x32_bf16 a[148:151], v[116:119], v[196:199], a[148:151]
    ds_read_b64_tr_b16 v[114:115], v20 offset:2048
    v_mfma_f32_16x16x32_bf16 a[152:155], v[116:119], v[200:203], a[152:155]
    v_mfma_f32_16x16x32_bf16 a[156:159], v[116:119], v[204:207], a[156:159]
    v_mfma_f32_16x16x32_bf16 a[160:163], v[120:123], v[192:195], a[160:163]
    ds_read_b64_tr_b16 v[116:117], v21
    v_mfma_f32_16x16x32_bf16 a[164:167], v[120:123], v[196:199], a[164:167]
    ds_read_b64_tr_b16 v[118:119], v21 offset:2048
    v_mfma_f32_16x16x32_bf16 a[168:171], v[120:123], v[200:203], a[168:171]
    v_mfma_f32_16x16x32_bf16 a[172:175], v[120:123], v[204:207], a[172:175]
    s_waitcnt lgkmcnt(3)
    v_mfma_f32_16x16x32_bf16 a[176:179], v[124:127], v[192:195], a[176:179]
    ds_read_b64_tr_b16 v[120:121], v22
    v_mfma_f32_16x16x32_bf16 a[180:183], v[124:127], v[196:199], a[180:183]
    ds_read_b64_tr_b16 v[122:123], v22 offset:2048
    v_mfma_f32_16x16x32_bf16 a[184:187], v[124:127], v[200:203], a[184:187]
    v_mfma_f32_16x16x32_bf16 a[188:191], v[124:127], v[204:207], a[188:191]
    v_mfma_f32_16x16x32_bf16 v[32:35], a[192:195], v[144:147], v[96:99]
    v_exp_f32 v57, v57
    v_mfma_f32_16x16x32_bf16 v[32:35], a[196:199], v[176:179], v[32:35]
    ds_read_b64_tr_b16 a[224:225], v6 offset:40960
    v_cvt_pk_bf16_f32 v90, v56, v57
    v_mfma_f32_16x16x32_bf16 v[32:35], a[200:203], v[208:211], v[32:35]
    v_exp_f32 v58, v58
    v_mfma_f32_16x16x32_bf16 v[32:35], a[204:207], v[240:243], v[32:35]
    ds_read_b64_tr_b16 a[226:227], v6 offset:45056
    buffer_load_dwordx4 v[192:195], v30, s[20:23], s36 offen sc1
    v_mfma_f32_16x16x32_bf16 v[36:39], a[192:195], v[148:151], v[100:103]
    s_add_u32 s36, s36, 1024
    v_exp_f32 v59, v59
    v_mfma_f32_16x16x32_bf16 v[36:39], a[196:199], v[180:183], v[36:39]
    ds_read_b64_tr_b16 a[228:229], v7 offset:40960
    v_cvt_pk_bf16_f32 v91, v58, v59
    v_mfma_f32_16x16x32_bf16 v[36:39], a[200:203], v[212:215], v[36:39]
    v_exp_f32 v60, v60
    v_mfma_f32_16x16x32_bf16 v[36:39], a[204:207], v[244:247], v[36:39]
    ds_read_b64_tr_b16 a[230:231], v7 offset:45056
    buffer_load_dwordx4 v[196:199], v30, s[20:23], s37 offen sc1
    v_mfma_f32_16x16x32_bf16 v[40:43], a[192:195], v[152:155], v[104:107]
    s_add_u32 s37, s37, 1024
    v_exp_f32 v61, v61
    v_mfma_f32_16x16x32_bf16 v[40:43], a[196:199], v[184:187], v[40:43]
    ds_read_b64_tr_b16 a[232:233], v8 offset:40960
    v_cvt_pk_bf16_f32 v94, v60, v61
    v_mfma_f32_16x16x32_bf16 v[40:43], a[200:203], v[216:219], v[40:43]
    v_exp_f32 v62, v62
    v_mfma_f32_16x16x32_bf16 v[40:43], a[204:207], v[248:251], v[40:43]
    ds_read_b64_tr_b16 a[234:235], v8 offset:45056
    buffer_load_dwordx4 v[200:203], v30, s[20:23], s39 offen sc1
    v_mfma_f32_16x16x32_bf16 v[44:47], a[192:195], v[156:159], v[108:111]
    s_add_u32 s39, s39, 1024
    v_exp_f32 v63, v63
    v_mfma_f32_16x16x32_bf16 v[44:47], a[196:199], v[188:191], v[44:47]
    ds_read_b64_tr_b16 a[236:237], v9 offset:40960
    v_cvt_pk_bf16_f32 v95, v62, v63
    v_mfma_f32_16x16x32_bf16 v[44:47], a[200:203], v[220:223], v[44:47]
    v_mfma_f32_16x16x32_bf16 v[44:47], a[204:207], v[252:255], v[44:47]
    ds_read_b64_tr_b16 a[238:239], v9 offset:45056
    buffer_load_dwordx4 v[204:207], v30, s[20:23], s42 offen sc1
    v_mfma_f32_16x16x32_bf16 v[48:51], a[208:211], v[144:147], v[96:99]
    s_add_u32 s42, s42, 1024
    s_add_u32 m0, s38, 0
    v_mfma_f32_16x16x32_bf16 v[48:51], a[212:215], v[176:179], v[48:51]
    ds_read_b64_tr_b16 a[240:241], v10 offset:40960
    buffer_load_dwordx4 v24, s[16:19], s41 offen lds
    v_mfma_f32_16x16x32_bf16 v[48:51], a[216:219], v[208:211], v[48:51]
    v_exp_f32 v32, v32
    v_mfma_f32_16x16x32_bf16 v[48:51], a[220:223], v[240:243], v[48:51]
    ds_read_b64_tr_b16 a[242:243], v10 offset:45056
    buffer_load_dwordx4 v25, s[16:19], s41 offen offset:1024 lds
    v_mfma_f32_16x16x32_bf16 v[52:55], a[208:211], v[148:151], v[100:103]
    v_exp_f32 v33, v33
    v_mfma_f32_16x16x32_bf16 v[52:55], a[212:215], v[180:183], v[52:55]
    ds_read_b64_tr_b16 a[244:245], v11 offset:40960
    v_cvt_pk_bf16_f32 v64, v32, v33
    v_mfma_f32_16x16x32_bf16 v[52:55], a[216:219], v[212:215], v[52:55]
    v_exp_f32 v34, v34
    v_mfma_f32_16x16x32_bf16 v[52:55], a[220:223], v[244:247], v[52:55]
    ds_read_b64_tr_b16 a[246:247], v11 offset:45056
    buffer_load_dwordx4 v26, s[16:19], s41 offen offset:2048 lds
    v_mfma_f32_16x16x32_bf16 v[56:59], a[208:211], v[152:155], v[104:107]
    v_exp_f32 v35, v35
    v_mfma_f32_16x16x32_bf16 v[56:59], a[212:215], v[184:187], v[56:59]
    ds_read_b64_tr_b16 a[248:249], v12 offset:40960
    v_cvt_pk_bf16_f32 v65, v34, v35
    v_mfma_f32_16x16x32_bf16 v[56:59], a[216:219], v[216:219], v[56:59]
    v_exp_f32 v36, v36
    v_mfma_f32_16x16x32_bf16 v[56:59], a[220:223], v[248:251], v[56:59]
    ds_read_b64_tr_b16 a[250:251], v12 offset:45056
    buffer_load_dwordx4 v27, s[16:19], s41 offen offset:3072 lds
    v_mfma_f32_16x16x32_bf16 v[60:63], a[208:211], v[156:159], v[108:111]
    s_add_u32 s41, s41, s29
    v_exp_f32 v37, v37
    v_mfma_f32_16x16x32_bf16 v[60:63], a[212:215], v[188:191], v[60:63]
    ds_read_b64_tr_b16 a[252:253], v13 offset:40960
    v_cvt_pk_bf16_f32 v68, v36, v37
    v_mfma_f32_16x16x32_bf16 v[60:63], a[216:219], v[220:223], v[60:63]
    v_exp_f32 v38, v38
    v_mfma_f32_16x16x32_bf16 v[60:63], a[220:223], v[252:255], v[60:63]
    s_waitcnt vmcnt(15) lgkmcnt(3)
    ds_read_b64_tr_b16 a[254:255], v13 offset:45056
    v_mfma_f32_16x16x32_bf16 a[128:131], v[112:115], v[224:227], a[128:131]
    s_waitcnt vmcnt(14)
    ds_read_b64_tr_b16 v[124:125], v23
    v_mfma_f32_16x16x32_bf16 a[132:135], v[112:115], v[228:231], a[132:135]
    s_waitcnt vmcnt(13)
    ds_read_b64_tr_b16 v[126:127], v23 offset:2048
    v_mfma_f32_16x16x32_bf16 a[136:139], v[112:115], v[232:235], a[136:139]
    s_waitcnt vmcnt(12)
    v_mfma_f32_16x16x32_bf16 a[140:143], v[112:115], v[236:239], a[140:143]
    s_waitcnt vmcnt(8)
    v_mfma_f32_16x16x32_bf16 a[144:147], v[116:119], v[224:227], a[144:147]
    ds_read_b64_tr_b16 v[112:113], v20 offset:16384
    v_mfma_f32_16x16x32_bf16 a[148:151], v[116:119], v[228:231], a[148:151]
    ds_read_b64_tr_b16 v[114:115], v20 offset:18432
    v_mfma_f32_16x16x32_bf16 a[152:155], v[116:119], v[232:235], a[152:155]
    v_mfma_f32_16x16x32_bf16 a[156:159], v[116:119], v[236:239], a[156:159]
    v_mfma_f32_16x16x32_bf16 a[160:163], v[120:123], v[224:227], a[160:163]
    ds_read_b64_tr_b16 v[116:117], v21 offset:16384
    v_mfma_f32_16x16x32_bf16 a[164:167], v[120:123], v[228:231], a[164:167]
    ds_read_b64_tr_b16 v[118:119], v21 offset:18432
    v_mfma_f32_16x16x32_bf16 a[168:171], v[120:123], v[232:235], a[168:171]
    v_mfma_f32_16x16x32_bf16 a[172:175], v[120:123], v[236:239], a[172:175]
    s_waitcnt lgkmcnt(3)
    v_mfma_f32_16x16x32_bf16 a[176:179], v[124:127], v[224:227], a[176:179]
    ds_read_b64_tr_b16 v[120:121], v22 offset:16384
    v_mfma_f32_16x16x32_bf16 a[180:183], v[124:127], v[228:231], a[180:183]
    ds_read_b64_tr_b16 v[122:123], v22 offset:18432
    v_mfma_f32_16x16x32_bf16 a[184:187], v[124:127], v[232:235], a[184:187]
    v_mfma_f32_16x16x32_bf16 a[188:191], v[124:127], v[236:239], a[188:191]
    v_mfma_f32_16x16x32_bf16 a[0:3], a[224:227], v[80:83], a[0:3]
    v_exp_f32 v39, v39
    v_mfma_f32_16x16x32_bf16 a[4:7], a[224:227], v[84:87], a[4:7]
    ds_read_b128 a[192:195], v2 offset:57344
    v_cvt_pk_bf16_f32 v69, v38, v39
    v_mfma_f32_16x16x32_bf16 a[8:11], a[224:227], v[88:91], a[8:11]
    v_exp_f32 v40, v40
    v_mfma_f32_16x16x32_bf16 a[12:15], a[224:227], v[92:95], a[12:15]
    buffer_load_dwordx4 v[224:227], v30, s[20:23], s36 offen sc1
    v_mfma_f32_16x16x32_bf16 a[16:19], a[228:231], v[80:83], a[16:19]
    s_add_u32 s36, s36, 1024
    v_exp_f32 v41, v41
    v_mfma_f32_16x16x32_bf16 a[20:23], a[228:231], v[84:87], a[20:23]
    ds_read_b128 a[196:199], v3 offset:57344
    v_cvt_pk_bf16_f32 v72, v40, v41
    v_mfma_f32_16x16x32_bf16 a[24:27], a[228:231], v[88:91], a[24:27]
    v_exp_f32 v42, v42
    v_mfma_f32_16x16x32_bf16 a[28:31], a[228:231], v[92:95], a[28:31]
    buffer_load_dwordx4 v[228:231], v30, s[20:23], s37 offen sc1
    v_mfma_f32_16x16x32_bf16 v[128:131], v[160:163], v[80:83], v[128:131]
    s_add_u32 s37, s37, 1024
    v_exp_f32 v43, v43
    v_mfma_f32_16x16x32_bf16 a[32:35], a[232:235], v[80:83], a[32:35]
    ds_read_b128 a[200:203], v4 offset:57344
    v_cvt_pk_bf16_f32 v73, v42, v43
    v_mfma_f32_16x16x32_bf16 a[36:39], a[232:235], v[84:87], a[36:39]
    v_exp_f32 v44, v44
    v_mfma_f32_16x16x32_bf16 a[40:43], a[232:235], v[88:91], a[40:43]
    buffer_load_dwordx4 v[232:235], v30, s[20:23], s39 offen sc1
    v_mfma_f32_16x16x32_bf16 a[44:47], a[232:235], v[92:95], a[44:47]
    s_add_u32 s39, s39, 1024
    v_exp_f32 v45, v45
    v_mfma_f32_16x16x32_bf16 a[48:51], a[236:239], v[80:83], a[48:51]
    ds_read_b128 a[204:207], v5 offset:57344
    v_cvt_pk_bf16_f32 v76, v44, v45
    v_mfma_f32_16x16x32_bf16 a[52:55], a[236:239], v[84:87], a[52:55]
    v_exp_f32 v46, v46
    v_mfma_f32_16x16x32_bf16 a[56:59], a[236:239], v[88:91], a[56:59]
    buffer_load_dwordx4 v[236:239], v30, s[20:23], s42 offen sc1
    v_mfma_f32_16x16x32_bf16 a[60:63], a[236:239], v[92:95], a[60:63]
    s_add_u32 s42, s42, 1024
    v_exp_f32 v47, v47
    v_mfma_f32_16x16x32_bf16 v[132:135], v[160:163], v[84:87], v[132:135]
    ds_read_b128 a[208:211], v2 offset:61440
    v_cvt_pk_bf16_f32 v77, v46, v47
    v_mfma_f32_16x16x32_bf16 a[64:67], a[240:243], v[80:83], a[64:67]
    s_add_u32 m0, s38, 131072
    v_exp_f32 v48, v48
    v_mfma_f32_16x16x32_bf16 a[68:71], a[240:243], v[84:87], a[68:71]
    buffer_load_dwordx4 v24, s[16:19], s41 offen lds
    v_mfma_f32_16x16x32_bf16 a[72:75], a[240:243], v[88:91], a[72:75]
    v_exp_f32 v49, v49
    v_mfma_f32_16x16x32_bf16 a[76:79], a[240:243], v[92:95], a[76:79]
    ds_read_b128 a[212:215], v3 offset:61440
    v_cvt_pk_bf16_f32 v66, v48, v49
    v_mfma_f32_16x16x32_bf16 a[80:83], a[244:247], v[80:83], a[80:83]
    v_exp_f32 v50, v50
    v_mfma_f32_16x16x32_bf16 a[84:87], a[244:247], v[84:87], a[84:87]
    buffer_load_dwordx4 v25, s[16:19], s41 offen offset:1024 lds
    v_mfma_f32_16x16x32_bf16 a[88:91], a[244:247], v[88:91], a[88:91]
    v_exp_f32 v51, v51
    v_mfma_f32_16x16x32_bf16 a[92:95], a[244:247], v[92:95], a[92:95]
    ds_read_b128 a[216:219], v4 offset:61440
    v_cvt_pk_bf16_f32 v67, v50, v51
    v_mfma_f32_16x16x32_bf16 v[136:139], v[160:163], v[88:91], v[136:139]
    v_exp_f32 v52, v52
    v_mfma_f32_16x16x32_bf16 a[96:99], a[248:251], v[80:83], a[96:99]
    buffer_load_dwordx4 v26, s[16:19], s41 offen offset:2048 lds
    v_mfma_f32_16x16x32_bf16 a[100:103], a[248:251], v[84:87], a[100:103]
    v_exp_f32 v53, v53
    v_mfma_f32_16x16x32_bf16 a[104:107], a[248:251], v[88:91], a[104:107]
    ds_read_b128 a[220:223], v5 offset:61440
    v_cvt_pk_bf16_f32 v70, v52, v53
    v_mfma_f32_16x16x32_bf16 a[108:111], a[248:251], v[92:95], a[108:111]
    v_exp_f32 v54, v54
    v_mfma_f32_16x16x32_bf16 a[112:115], a[252:255], v[80:83], a[112:115]
    buffer_load_dwordx4 v27, s[16:19], s41 offen offset:3072 lds
    v_mfma_f32_16x16x32_bf16 a[116:119], a[252:255], v[84:87], a[116:119]
    s_add_u32 s41, s41, s29
    v_exp_f32 v55, v55
    v_mfma_f32_16x16x32_bf16 a[120:123], a[252:255], v[88:91], a[120:123]
    v_cvt_pk_bf16_f32 v71, v54, v55
    v_mfma_f32_16x16x32_bf16 a[124:127], a[252:255], v[92:95], a[124:127]
    v_exp_f32 v56, v56
    v_mfma_f32_16x16x32_bf16 v[140:143], v[160:163], v[92:95], v[140:143]
    s_waitcnt vmcnt(15) lgkmcnt(1)
    v_mfma_f32_16x16x32_bf16 a[128:131], v[112:115], v[192:195], a[128:131]
    s_waitcnt vmcnt(14)
    ds_read_b64_tr_b16 v[124:125], v23 offset:16384
    v_mfma_f32_16x16x32_bf16 a[132:135], v[112:115], v[196:199], a[132:135]
    s_waitcnt vmcnt(13)
    ds_read_b64_tr_b16 v[126:127], v23 offset:18432
    v_mfma_f32_16x16x32_bf16 a[136:139], v[112:115], v[200:203], a[136:139]
    s_waitcnt vmcnt(12)
    v_mfma_f32_16x16x32_bf16 a[140:143], v[112:115], v[204:207], a[140:143]
    s_waitcnt vmcnt(8)
    v_mfma_f32_16x16x32_bf16 a[144:147], v[116:119], v[192:195], a[144:147]
    ds_read_b64_tr_b16 v[112:113], v164
    v_mfma_f32_16x16x32_bf16 a[148:151], v[116:119], v[196:199], a[148:151]
    ds_read_b64_tr_b16 v[114:115], v164 offset:2048
    v_mfma_f32_16x16x32_bf16 a[152:155], v[116:119], v[200:203], a[152:155]
    v_mfma_f32_16x16x32_bf16 a[156:159], v[116:119], v[204:207], a[156:159]
    v_mfma_f32_16x16x32_bf16 a[160:163], v[120:123], v[192:195], a[160:163]
    ds_read_b64_tr_b16 v[116:117], v165
    v_mfma_f32_16x16x32_bf16 a[164:167], v[120:123], v[196:199], a[164:167]
    ds_read_b64_tr_b16 v[118:119], v165 offset:2048
    v_mfma_f32_16x16x32_bf16 a[168:171], v[120:123], v[200:203], a[168:171]
    v_mfma_f32_16x16x32_bf16 a[172:175], v[120:123], v[204:207], a[172:175]
    s_waitcnt lgkmcnt(3)
    v_mfma_f32_16x16x32_bf16 a[176:179], v[124:127], v[192:195], a[176:179]
    ds_read_b64_tr_b16 v[120:121], v166
    v_mfma_f32_16x16x32_bf16 a[180:183], v[124:127], v[196:199], a[180:183]
    ds_read_b64_tr_b16 v[122:123], v166 offset:2048
    v_mfma_f32_16x16x32_bf16 a[184:187], v[124:127], v[200:203], a[184:187]
    v_mfma_f32_16x16x32_bf16 a[188:191], v[124:127], v[204:207], a[188:191]
    v_mfma_f32_16x16x32_bf16 v[32:35], a[192:195], v[144:147], v[96:99]
    v_exp_f32 v57, v57
    v_mfma_f32_16x16x32_bf16 v[32:35], a[196:199], v[176:179], v[32:35]
    ds_read_b64_tr_b16 a[224:225], v6 offset:49152
    v_cvt_pk_bf16_f32 v74, v56, v57
    v_mfma_f32_16x16x32_bf16 v[32:35], a[200:203], v[208:211], v[32:35]
    v_exp_f32 v58, v58
    v_mfma_f32_16x16x32_bf16 v[32:35], a[204:207], v[240:243], v[32:35]
    ds_read_b64_tr_b16 a[226:227], v6 offset:53248
    buffer_load_dwordx4 v[192:195], v30, s[20:23], s36 offen sc1
    v_mfma_f32_16x16x32_bf16 v[36:39], a[192:195], v[148:151], v[100:103]
    s_add_u32 s36, s36, 1024
    v_exp_f32 v59, v59
    v_mfma_f32_16x16x32_bf16 v[36:39], a[196:199], v[180:183], v[36:39]
    ds_read_b64_tr_b16 a[228:229], v7 offset:49152
    v_cvt_pk_bf16_f32 v75, v58, v59
    v_mfma_f32_16x16x32_bf16 v[36:39], a[200:203], v[212:215], v[36:39]
    v_exp_f32 v60, v60
    v_mfma_f32_16x16x32_bf16 v[36:39], a[204:207], v[244:247], v[36:39]
    ds_read_b64_tr_b16 a[230:231], v7 offset:53248
    buffer_load_dwordx4 v[196:199], v30, s[20:23], s37 offen sc1
    v_mfma_f32_16x16x32_bf16 v[40:43], a[192:195], v[152:155], v[104:107]
    s_add_u32 s37, s37, 1024
    v_exp_f32 v61, v61
    v_mfma_f32_16x16x32_bf16 v[40:43], a[196:199], v[184:187], v[40:43]
    ds_read_b64_tr_b16 a[232:233], v8 offset:49152
    v_cvt_pk_bf16_f32 v78, v60, v61
    v_mfma_f32_16x16x32_bf16 v[40:43], a[200:203], v[216:219], v[40:43]
    v_exp_f32 v62, v62
    v_mfma_f32_16x16x32_bf16 v[40:43], a[204:207], v[248:251], v[40:43]
    ds_read_b64_tr_b16 a[234:235], v8 offset:53248
    buffer_load_dwordx4 v[200:203], v30, s[20:23], s39 offen sc1
    v_mfma_f32_16x16x32_bf16 v[44:47], a[192:195], v[156:159], v[108:111]
    s_add_u32 s39, s39, 1024
    v_exp_f32 v63, v63
    v_mfma_f32_16x16x32_bf16 v[44:47], a[196:199], v[188:191], v[44:47]
    ds_read_b64_tr_b16 a[236:237], v9 offset:49152
    v_cvt_pk_bf16_f32 v79, v62, v63
    v_mfma_f32_16x16x32_bf16 v[44:47], a[200:203], v[220:223], v[44:47]
    v_mfma_f32_16x16x32_bf16 v[44:47], a[204:207], v[252:255], v[44:47]
    ds_read_b64_tr_b16 a[238:239], v9 offset:53248
    buffer_load_dwordx4 v[204:207], v30, s[20:23], s42 offen sc1
    v_mfma_f32_16x16x32_bf16 v[48:51], a[208:211], v[144:147], v[96:99]
    s_add_u32 s42, s42, 1024
    s_add_u32 m0, s38, 147456
    v_mfma_f32_16x16x32_bf16 v[48:51], a[212:215], v[176:179], v[48:51]
    ds_read_b64_tr_b16 a[240:241], v10 offset:49152
    buffer_load_dwordx4 v24, s[16:19], s41 offen lds
    v_mfma_f32_16x16x32_bf16 v[48:51], a[216:219], v[208:211], v[48:51]
    v_exp_f32 v32, v32
    v_mfma_f32_16x16x32_bf16 v[48:51], a[220:223], v[240:243], v[48:51]
    ds_read_b64_tr_b16 a[242:243], v10 offset:53248
    buffer_load_dwordx4 v25, s[16:19], s41 offen offset:1024 lds
    v_mfma_f32_16x16x32_bf16 v[52:55], a[208:211], v[148:151], v[100:103]
    v_exp_f32 v33, v33
    v_mfma_f32_16x16x32_bf16 v[52:55], a[212:215], v[180:183], v[52:55]
    ds_read_b64_tr_b16 a[244:245], v11 offset:49152
    v_cvt_pk_bf16_f32 v80, v32, v33
    v_mfma_f32_16x16x32_bf16 v[52:55], a[216:219], v[212:215], v[52:55]
    v_exp_f32 v34, v34
    v_mfma_f32_16x16x32_bf16 v[52:55], a[220:223], v[244:247], v[52:55]
    ds_read_b64_tr_b16 a[246:247], v11 offset:53248
    buffer_load_dwordx4 v26, s[16:19], s41 offen offset:2048 lds
    v_mfma_f32_16x16x32_bf16 v[56:59], a[208:211], v[152:155], v[104:107]
    v_exp_f32 v35, v35
    v_mfma_f32_16x16x32_bf16 v[56:59], a[212:215], v[184:187], v[56:59]
    ds_read_b64_tr_b16 a[248:249], v12 offset:49152
    v_cvt_pk_bf16_f32 v81, v34, v35
    v_mfma_f32_16x16x32_bf16 v[56:59], a[216:219], v[216:219], v[56:59]
    v_exp_f32 v36, v36
    v_mfma_f32_16x16x32_bf16 v[56:59], a[220:223], v[248:251], v[56:59]
    ds_read_b64_tr_b16 a[250:251], v12 offset:53248
    buffer_load_dwordx4 v27, s[16:19], s41 offen offset:3072 lds
    v_mfma_f32_16x16x32_bf16 v[60:63], a[208:211], v[156:159], v[108:111]
    s_add_u32 s41, s41, s29
    v_exp_f32 v37, v37
    v_mfma_f32_16x16x32_bf16 v[60:63], a[212:215], v[188:191], v[60:63]
    ds_read_b64_tr_b16 a[252:253], v13 offset:49152
    v_cvt_pk_bf16_f32 v84, v36, v37
    v_mfma_f32_16x16x32_bf16 v[60:63], a[216:219], v[220:223], v[60:63]
    v_exp_f32 v38, v38
    v_mfma_f32_16x16x32_bf16 v[60:63], a[220:223], v[252:255], v[60:63]
    s_waitcnt vmcnt(15) lgkmcnt(3)
    ds_read_b64_tr_b16 a[254:255], v13 offset:53248
    v_mfma_f32_16x16x32_bf16 a[128:131], v[112:115], v[224:227], a[128:131]
    s_waitcnt vmcnt(14)
    ds_read_b64_tr_b16 v[124:125], v167
    v_mfma_f32_16x16x32_bf16 a[132:135], v[112:115], v[228:231], a[132:135]
    s_waitcnt vmcnt(13)
    ds_read_b64_tr_b16 v[126:127], v167 offset:2048
    v_mfma_f32_16x16x32_bf16 a[136:139], v[112:115], v[232:235], a[136:139]
    s_waitcnt vmcnt(12)
    v_mfma_f32_16x16x32_bf16 a[140:143], v[112:115], v[236:239], a[140:143]
    s_waitcnt vmcnt(8)
    v_mfma_f32_16x16x32_bf16 a[144:147], v[116:119], v[224:227], a[144:147]
    ds_read_b64_tr_b16 v[112:113], v20
    v_mfma_f32_16x16x32_bf16 a[148:151], v[116:119], v[228:231], a[148:151]
    ds_read_b64_tr_b16 v[114:115], v20 offset:2048
    v_mfma_f32_16x16x32_bf16 a[152:155], v[116:119], v[232:235], a[152:155]
    v_mfma_f32_16x16x32_bf16 a[156:159], v[116:119], v[236:239], a[156:159]
    v_mfma_f32_16x16x32_bf16 a[160:163], v[120:123], v[224:227], a[160:163]
    ds_read_b64_tr_b16 v[116:117], v21
    v_mfma_f32_16x16x32_bf16 a[164:167], v[120:123], v[228:231], a[164:167]
    ds_read_b64_tr_b16 v[118:119], v21 offset:2048
    v_mfma_f32_16x16x32_bf16 a[168:171], v[120:123], v[232:235], a[168:171]
    v_mfma_f32_16x16x32_bf16 a[172:175], v[120:123], v[236:239], a[172:175]
    s_waitcnt lgkmcnt(3)
    v_mfma_f32_16x16x32_bf16 a[176:179], v[124:127], v[224:227], a[176:179]
    ds_read_b64_tr_b16 v[120:121], v22
    v_mfma_f32_16x16x32_bf16 a[180:183], v[124:127], v[228:231], a[180:183]
    ds_read_b64_tr_b16 v[122:123], v22 offset:2048
    v_mfma_f32_16x16x32_bf16 a[184:187], v[124:127], v[232:235], a[184:187]
    v_mfma_f32_16x16x32_bf16 a[188:191], v[124:127], v[236:239], a[188:191]
    v_mfma_f32_16x16x32_bf16 a[0:3], a[224:227], v[64:67], a[0:3]
    v_exp_f32 v39, v39
    v_mfma_f32_16x16x32_bf16 a[4:7], a[224:227], v[68:71], a[4:7]
    v_cvt_pk_bf16_f32 v85, v38, v39
    v_mfma_f32_16x16x32_bf16 a[8:11], a[224:227], v[72:75], a[8:11]
    v_exp_f32 v40, v40
    v_mfma_f32_16x16x32_bf16 a[12:15], a[224:227], v[76:79], a[12:15]
    buffer_load_dwordx4 v[224:227], v30, s[20:23], s36 offen sc1
    v_mfma_f32_16x16x32_bf16 a[16:19], a[228:231], v[64:67], a[16:19]
    s_add_u32 s36, s36, 1024
    v_exp_f32 v41, v41
    v_mfma_f32_16x16x32_bf16 a[20:23], a[228:231], v[68:71], a[20:23]
    v_cvt_pk_bf16_f32 v88, v40, v41
    v_mfma_f32_16x16x32_bf16 a[24:27], a[228:231], v[72:75], a[24:27]
    v_exp_f32 v42, v42
    v_mfma_f32_16x16x32_bf16 a[28:31], a[228:231], v[76:79], a[28:31]
    buffer_load_dwordx4 v[228:231], v30, s[20:23], s37 offen sc1
    v_mfma_f32_16x16x32_bf16 v[128:131], v[160:163], v[64:67], v[128:131]
    s_add_u32 s37, s37, 1024
    v_exp_f32 v43, v43
    v_mfma_f32_16x16x32_bf16 a[32:35], a[232:235], v[64:67], a[32:35]
    v_cvt_pk_bf16_f32 v89, v42, v43
    v_mfma_f32_16x16x32_bf16 a[36:39], a[232:235], v[68:71], a[36:39]
    v_exp_f32 v44, v44
    v_mfma_f32_16x16x32_bf16 a[40:43], a[232:235], v[72:75], a[40:43]
    buffer_load_dwordx4 v[232:235], v30, s[20:23], s39 offen sc1
    v_mfma_f32_16x16x32_bf16 a[44:47], a[232:235], v[76:79], a[44:47]
    s_add_u32 s39, s39, 1024
    v_exp_f32 v45, v45
    v_mfma_f32_16x16x32_bf16 a[48:51], a[236:239], v[64:67], a[48:51]
    v_cvt_pk_bf16_f32 v92, v44, v45
    v_mfma_f32_16x16x32_bf16 a[52:55], a[236:239], v[68:71], a[52:55]
    v_exp_f32 v46, v46
    v_mfma_f32_16x16x32_bf16 a[56:59], a[236:239], v[72:75], a[56:59]
    buffer_load_dwordx4 v[236:239], v30, s[20:23], s42 offen sc1
    v_mfma_f32_16x16x32_bf16 a[60:63], a[236:239], v[76:79], a[60:63]
    s_add_u32 s42, s42, 1024
    v_exp_f32 v47, v47
    v_mfma_f32_16x16x32_bf16 v[132:135], v[160:163], v[68:71], v[132:135]
    v_cvt_pk_bf16_f32 v93, v46, v47
    v_mfma_f32_16x16x32_bf16 a[64:67], a[240:243], v[64:67], a[64:67]
    v_exp_f32 v48, v48
    v_mfma_f32_16x16x32_bf16 a[68:71], a[240:243], v[68:71], a[68:71]
    v_mfma_f32_16x16x32_bf16 a[72:75], a[240:243], v[72:75], a[72:75]
    v_exp_f32 v49, v49
    v_mfma_f32_16x16x32_bf16 a[76:79], a[240:243], v[76:79], a[76:79]
    v_cvt_pk_bf16_f32 v82, v48, v49
    v_mfma_f32_16x16x32_bf16 a[80:83], a[244:247], v[64:67], a[80:83]
    v_exp_f32 v50, v50
    v_mfma_f32_16x16x32_bf16 a[84:87], a[244:247], v[68:71], a[84:87]
    v_mfma_f32_16x16x32_bf16 a[88:91], a[244:247], v[72:75], a[88:91]
    v_exp_f32 v51, v51
    v_mfma_f32_16x16x32_bf16 a[92:95], a[244:247], v[76:79], a[92:95]
    v_cvt_pk_bf16_f32 v83, v50, v51
    v_mfma_f32_16x16x32_bf16 v[136:139], v[160:163], v[72:75], v[136:139]
    v_exp_f32 v52, v52
    v_mfma_f32_16x16x32_bf16 a[96:99], a[248:251], v[64:67], a[96:99]
    v_mfma_f32_16x16x32_bf16 a[100:103], a[248:251], v[68:71], a[100:103]
    v_exp_f32 v53, v53
    v_mfma_f32_16x16x32_bf16 a[104:107], a[248:251], v[72:75], a[104:107]
    v_cvt_pk_bf16_f32 v86, v52, v53
    v_mfma_f32_16x16x32_bf16 a[108:111], a[248:251], v[76:79], a[108:111]
    v_exp_f32 v54, v54
    v_mfma_f32_16x16x32_bf16 a[112:115], a[252:255], v[64:67], a[112:115]
    v_mfma_f32_16x16x32_bf16 a[116:119], a[252:255], v[68:71], a[116:119]
    v_exp_f32 v55, v55
    v_mfma_f32_16x16x32_bf16 a[120:123], a[252:255], v[72:75], a[120:123]
    v_cvt_pk_bf16_f32 v87, v54, v55
    v_mfma_f32_16x16x32_bf16 a[124:127], a[252:255], v[76:79], a[124:127]
    v_exp_f32 v56, v56
    v_mfma_f32_16x16x32_bf16 v[140:143], v[160:163], v[76:79], v[140:143]
    s_waitcnt vmcnt(11) lgkmcnt(0)
    v_mfma_f32_16x16x32_bf16 a[128:131], v[112:115], v[192:195], a[128:131]
    s_waitcnt vmcnt(10)
    ds_read_b64_tr_b16 v[124:125], v23
    v_mfma_f32_16x16x32_bf16 a[132:135], v[112:115], v[196:199], a[132:135]
    s_waitcnt vmcnt(9)
    ds_read_b64_tr_b16 v[126:127], v23 offset:2048
    v_mfma_f32_16x16x32_bf16 a[136:139], v[112:115], v[200:203], a[136:139]
    s_waitcnt vmcnt(8)
    v_mfma_f32_16x16x32_bf16 a[140:143], v[112:115], v[204:207], a[140:143]
    s_waitcnt vmcnt(4)
    v_mfma_f32_16x16x32_bf16 a[144:147], v[116:119], v[192:195], a[144:147]
    ds_read_b64_tr_b16 v[112:113], v20 offset:16384
    v_mfma_f32_16x16x32_bf16 a[148:151], v[116:119], v[196:199], a[148:151]
    ds_read_b64_tr_b16 v[114:115], v20 offset:18432
    v_mfma_f32_16x16x32_bf16 a[152:155], v[116:119], v[200:203], a[152:155]
    v_mfma_f32_16x16x32_bf16 a[156:159], v[116:119], v[204:207], a[156:159]
    v_mfma_f32_16x16x32_bf16 a[160:163], v[120:123], v[192:195], a[160:163]
    ds_read_b64_tr_b16 v[116:117], v21 offset:16384
    v_mfma_f32_16x16x32_bf16 a[164:167], v[120:123], v[196:199], a[164:167]
    ds_read_b64_tr_b16 v[118:119], v21 offset:18432
    v_mfma_f32_16x16x32_bf16 a[168:171], v[120:123], v[200:203], a[168:171]
    v_mfma_f32_16x16x32_bf16 a[172:175], v[120:123], v[204:207], a[172:175]
    s_waitcnt lgkmcnt(3)
    v_mfma_f32_16x16x32_bf16 a[176:179], v[124:127], v[192:195], a[176:179]
    ds_read_b64_tr_b16 v[120:121], v22 offset:16384
    v_mfma_f32_16x16x32_bf16 a[180:183], v[124:127], v[196:199], a[180:183]
    ds_read_b64_tr_b16 v[122:123], v22 offset:18432
    v_mfma_f32_16x16x32_bf16 a[184:187], v[124:127], v[200:203], a[184:187]
    v_mfma_f32_16x16x32_bf16 a[188:191], v[124:127], v[204:207], a[188:191]
    s_waitcnt vmcnt(3) lgkmcnt(3)
    s_nop 0
    v_exp_f32 v57, v57
    s_nop 0
    ds_read_b64_tr_b16 a[224:225], v6 offset:57344
    v_cvt_pk_bf16_f32 v90, v56, v57
    s_nop 0
    v_exp_f32 v58, v58
    s_nop 0
    ds_read_b64_tr_b16 a[226:227], v6 offset:61440
    s_nop 0
    v_exp_f32 v59, v59
    s_nop 0
    ds_read_b64_tr_b16 a[228:229], v7 offset:57344
    v_cvt_pk_bf16_f32 v91, v58, v59
    s_nop 0
    v_exp_f32 v60, v60
    s_nop 0
    ds_read_b64_tr_b16 a[230:231], v7 offset:61440
    s_nop 0
    v_exp_f32 v61, v61
    s_nop 0
    ds_read_b64_tr_b16 a[232:233], v8 offset:57344
    v_cvt_pk_bf16_f32 v94, v60, v61
    s_nop 0
    v_exp_f32 v62, v62
    s_nop 0
    ds_read_b64_tr_b16 a[234:235], v8 offset:61440
    s_nop 0
    v_exp_f32 v63, v63
    s_nop 0
    ds_read_b64_tr_b16 a[236:237], v9 offset:57344
    v_cvt_pk_bf16_f32 v95, v62, v63
    s_nop 0
    s_nop 0
    ds_read_b64_tr_b16 a[238:239], v9 offset:61440
    s_nop 0
    s_nop 0
    ds_read_b64_tr_b16 a[240:241], v10 offset:57344
    s_nop 0
    s_nop 0
    ds_read_b64_tr_b16 a[242:243], v10 offset:61440
    s_nop 0
    s_nop 0
    ds_read_b64_tr_b16 a[244:245], v11 offset:57344
    s_nop 0
    s_nop 0
    ds_read_b64_tr_b16 a[246:247], v11 offset:61440
    s_nop 0
    s_nop 0
    ds_read_b64_tr_b16 a[248:249], v12 offset:57344
    s_nop 0
    s_nop 0
    ds_read_b64_tr_b16 a[250:251], v12 offset:61440
    s_nop 0
    s_nop 0
    ds_read_b64_tr_b16 a[252:253], v13 offset:57344
    s_nop 0
    s_nop 0
    ds_read_b64_tr_b16 a[254:255], v13 offset:61440
    v_mfma_f32_16x16x32_bf16 a[128:131], v[112:115], v[224:227], a[128:131]
    s_waitcnt vmcnt(2)
    ds_read_b64_tr_b16 v[124:125], v23 offset:16384
    v_mfma_f32_16x16x32_bf16 a[132:135], v[112:115], v[228:231], a[132:135]
    s_waitcnt vmcnt(1)
    ds_read_b64_tr_b16 v[126:127], v23 offset:18432
    v_mfma_f32_16x16x32_bf16 a[136:139], v[112:115], v[232:235], a[136:139]
    s_waitcnt vmcnt(0)
    v_mfma_f32_16x16x32_bf16 a[140:143], v[112:115], v[236:239], a[140:143]
    s_waitcnt lgkmcnt(15)
    v_mfma_f32_16x16x32_bf16 a[144:147], v[116:119], v[224:227], a[144:147]
    v_mfma_f32_16x16x32_bf16 a[148:151], v[116:119], v[228:231], a[148:151]
    v_mfma_f32_16x16x32_bf16 a[152:155], v[116:119], v[232:235], a[152:155]
    v_mfma_f32_16x16x32_bf16 a[156:159], v[116:119], v[236:239], a[156:159]
    v_mfma_f32_16x16x32_bf16 a[160:163], v[120:123], v[224:227], a[160:163]
    v_mfma_f32_16x16x32_bf16 a[164:167], v[120:123], v[228:231], a[164:167]
    v_mfma_f32_16x16x32_bf16 a[168:171], v[120:123], v[232:235], a[168:171]
    v_mfma_f32_16x16x32_bf16 a[172:175], v[120:123], v[236:239], a[172:175]
    s_waitcnt lgkmcnt(0)
    v_mfma_f32_16x16x32_bf16 a[176:179], v[124:127], v[224:227], a[176:179]
    v_mfma_f32_16x16x32_bf16 a[180:183], v[124:127], v[228:231], a[180:183]
    v_mfma_f32_16x16x32_bf16 a[184:187], v[124:127], v[232:235], a[184:187]
    v_mfma_f32_16x16x32_bf16 a[188:191], v[124:127], v[236:239], a[188:191]
    v_mfma_f32_16x16x32_bf16 a[0:3], a[224:227], v[80:83], a[0:3]
    v_mfma_f32_16x16x32_bf16 a[4:7], a[224:227], v[84:87], a[4:7]
    v_mfma_f32_16x16x32_bf16 a[8:11], a[224:227], v[88:91], a[8:11]
    v_mfma_f32_16x16x32_bf16 a[12:15], a[224:227], v[92:95], a[12:15]
    v_mfma_f32_16x16x32_bf16 a[16:19], a[228:231], v[80:83], a[16:19]
    v_mfma_f32_16x16x32_bf16 a[20:23], a[228:231], v[84:87], a[20:23]
    v_mfma_f32_16x16x32_bf16 a[24:27], a[228:231], v[88:91], a[24:27]
    v_mfma_f32_16x16x32_bf16 a[28:31], a[228:231], v[92:95], a[28:31]
    v_mfma_f32_16x16x32_bf16 v[128:131], v[160:163], v[80:83], v[128:131]
    v_mfma_f32_16x16x32_bf16 a[32:35], a[232:235], v[80:83], a[32:35]
    v_mfma_f32_16x16x32_bf16 a[36:39], a[232:235], v[84:87], a[36:39]
    v_mfma_f32_16x16x32_bf16 a[40:43], a[232:235], v[88:91], a[40:43]
    v_mfma_f32_16x16x32_bf16 a[44:47], a[232:235], v[92:95], a[44:47]
    v_mfma_f32_16x16x32_bf16 a[48:51], a[236:239], v[80:83], a[48:51]
    v_mfma_f32_16x16x32_bf16 a[52:55], a[236:239], v[84:87], a[52:55]
    v_mfma_f32_16x16x32_bf16 a[56:59], a[236:239], v[88:91], a[56:59]
    v_mfma_f32_16x16x32_bf16 a[60:63], a[236:239], v[92:95], a[60:63]
    v_mfma_f32_16x16x32_bf16 v[132:135], v[160:163], v[84:87], v[132:135]
    v_mfma_f32_16x16x32_bf16 a[64:67], a[240:243], v[80:83], a[64:67]
    v_mfma_f32_16x16x32_bf16 a[68:71], a[240:243], v[84:87], a[68:71]
    v_mfma_f32_16x16x32_bf16 a[72:75], a[240:243], v[88:91], a[72:75]
    v_mfma_f32_16x16x32_bf16 a[76:79], a[240:243], v[92:95], a[76:79]
    v_mfma_f32_16x16x32_bf16 a[80:83], a[244:247], v[80:83], a[80:83]
    v_mfma_f32_16x16x32_bf16 a[84:87], a[244:247], v[84:87], a[84:87]
    v_mfma_f32_16x16x32_bf16 a[88:91], a[244:247], v[88:91], a[88:91]
    v_mfma_f32_16x16x32_bf16 a[92:95], a[244:247], v[92:95], a[92:95]
    v_mfma_f32_16x16x32_bf16 v[136:139], v[160:163], v[88:91], v[136:139]
    v_mfma_f32_16x16x32_bf16 a[96:99], a[248:251], v[80:83], a[96:99]
    v_mfma_f32_16x16x32_bf16 a[100:103], a[248:251], v[84:87], a[100:103]
    v_mfma_f32_16x16x32_bf16 a[104:107], a[248:251], v[88:91], a[104:107]
    v_mfma_f32_16x16x32_bf16 a[108:111], a[248:251], v[92:95], a[108:111]
    v_mfma_f32_16x16x32_bf16 a[112:115], a[252:255], v[80:83], a[112:115]
    v_mfma_f32_16x16x32_bf16 a[116:119], a[252:255], v[84:87], a[116:119]
    v_mfma_f32_16x16x32_bf16 a[120:123], a[252:255], v[88:91], a[120:123]
    v_mfma_f32_16x16x32_bf16 a[124:127], a[252:255], v[92:95], a[124:127]
    v_mfma_f32_16x16x32_bf16 v[140:143], v[160:163], v[92:95], v[140:143]
    s_nop 7
mk_fbret:
    s_lshl_b32 s63, s5, 4
    s_lshl_b32 s62, s3, 2
    s_add_u32 s63, s63, s62
    s_lshl_b32 s60, s63, 7
    s_lshl_b32 s61, s4, 2
    s_add_u32 s60, s60, s61
    s_lshl_b32 s60, s60, 10
    s_add_u32 s60, s60, 2097152
    s_add_u32 s24, s58, s60
    s_addc_u32 s25, s59, 0
    s_mov_b32 s26, 397312
    s_mov_b32 s27, 0x00020000
    v_rcp_f32 v112, v128
    v_rcp_f32 v113, v132
    v_rcp_f32 v114, v136
    v_rcp_f32 v115, v140
    s_nop 0
    v_fma_f32 v116, -v128, v112, 2.0
    v_fma_f32 v117, -v132, v113, 2.0
    v_fma_f32 v118, -v136, v114, 2.0
    v_fma_f32 v119, -v140, v115, 2.0
    v_mul_f32 v112, v112, v116
    v_mul_f32 v113, v113, v117
    v_mul_f32 v114, v114, v118
    v_mul_f32 v115, v115, v119
    s_mov_b32 s60, 0x45800000
    v_cmp_nle_f32_e64 s[44:45], v128, s60
    v_cmp_nle_f32_e64 s[46:47], v132, s60
    v_cmp_nle_f32_e64 s[62:63], v136, s60
    v_cmp_nle_f32_e64 vcc, v140, s60
    s_nop 4
    s_or_b64 s[44:45], s[44:45], s[46:47]
    s_or_b64 s[62:63], s[62:63], vcc
    s_or_b64 s[44:45], s[44:45], s[62:63]
    s_or_b32 s44, s44, s45
    s_cmp_eq_u32 s7, 0
    s_cselect_b32 s44, s44, 0
    v_mov_b32 v120, s44
    s_lshl_b32 s60, s3, 2
    s_add_u32 s60, s60, 28672
    v_mov_b32 v121, s60
    ds_write_b32 v121, v120
    s_mov_b32 s44, 0
    s_mov_b32 s45, 131072
    s_mov_b32 s46, 262144
    s_mov_b32 s47, 393216
    v_accvgpr_read_b32 v32, a0
    v_accvgpr_read_b32 v33, a1
    v_accvgpr_read_b32 v34, a2
    v_accvgpr_read_b32 v35, a3
    v_accvgpr_read_b32 v36, a16
    v_accvgpr_read_b32 v37, a17
    v_accvgpr_read_b32 v38, a18
    v_accvgpr_read_b32 v39, a19
    v_mul_f32 v32, v32, v112
    v_mul_f32 v33, v33, v112
    v_mul_f32 v34, v34, v112
    v_mul_f32 v35, v35, v112
    v_mul_f32 v36, v36, v112
    v_mul_f32 v37, v37, v112
    v_mul_f32 v38, v38, v112
    v_mul_f32 v39, v39, v112
    v_cvt_pk_bf16_f32 v48, v32, v33
    v_cvt_pk_bf16_f32 v49, v34, v35
    v_cvt_pk_bf16_f32 v50, v36, v37
    v_cvt_pk_bf16_f32 v51, v38, v39
    buffer_store_dwordx4 v[48:51], v30, s[24:27], s44 offen sc1
    v_accvgpr_read_b32 v40, a32
    v_accvgpr_read_b32 v41, a33
    v_accvgpr_read_b32 v42, a34
    v_accvgpr_read_b32 v43, a35
    v_accvgpr_read_b32 v44, a48
    v_accvgpr_read_b32 v45, a49
    v_accvgpr_read_b32 v46, a50
    v_accvgpr_read_b32 v47, a51
    v_mul_f32 v40, v40, v112
    v_mul_f32 v41, v41, v112
    v_mul_f32 v42, v42, v112
    v_mul_f32 v43, v43, v112
    v_mul_f32 v44, v44, v112
    v_mul_f32 v45, v45, v112
    v_mul_f32 v46, v46, v112
    v_mul_f32 v47, v47, v112
    v_cvt_pk_bf16_f32 v52, v40, v41
    v_cvt_pk_bf16_f32 v53, v42, v43
    v_cvt_pk_bf16_f32 v54, v44, v45
    v_cvt_pk_bf16_f32 v55, v46, v47
    buffer_store_dwordx4 v[52:55], v30, s[24:27], s44 offen offset:1024 sc1
    v_accvgpr_read_b32 v32, a64
    v_accvgpr_read_b32 v33, a65
    v_accvgpr_read_b32 v34, a66
    v_accvgpr_read_b32 v35, a67
    v_accvgpr_read_b32 v36, a80
    v_accvgpr_read_b32 v37, a81
    v_accvgpr_read_b32 v38, a82
    v_accvgpr_read_b32 v39, a83
    v_mul_f32 v32, v32, v112
    v_mul_f32 v33, v33, v112
    v_mul_f32 v34, v34, v112
    v_mul_f32 v35, v35, v112
    v_mul_f32 v36, v36, v112
    v_mul_f32 v37, v37, v112
    v_mul_f32 v38, v38, v112
    v_mul_f32 v39, v39, v112
    v_cvt_pk_bf16_f32 v56, v32, v33
    v_cvt_pk_bf16_f32 v57, v34, v35
    v_cvt_pk_bf16_f32 v58, v36, v37
    v_cvt_pk_bf16_f32 v59, v38, v39
    buffer_store_dwordx4 v[56:59], v30, s[24:27], s44 offen offset:2048 sc1
    v_accvgpr_read_b32 v40, a96
    v_accvgpr_read_b32 v41, a97
    v_accvgpr_read_b32 v42, a98
    v_accvgpr_read_b32 v43, a99
    v_accvgpr_read_b32 v44, a112
    v_accvgpr_read_b32 v45, a113
    v_accvgpr_read_b32 v46, a114
    v_accvgpr_read_b32 v47, a115
    v_mul_f32 v40, v40, v112
    v_mul_f32 v41, v41, v112
    v_mul_f32 v42, v42, v112
    v_mul_f32 v43, v43, v112
    v_mul_f32 v44, v44, v112
    v_mul_f32 v45, v45, v112
    v_mul_f32 v46, v46, v112
    v_mul_f32 v47, v47, v112
    v_cvt_pk_bf16_f32 v60, v40, v41
    v_cvt_pk_bf16_f32 v61, v42, v43
    v_cvt_pk_bf16_f32 v62, v44, v45
    v_cvt_pk_bf16_f32 v63, v46, v47
    buffer_store_dwordx4 v[60:63], v30, s[24:27], s44 offen offset:3072 sc1
    v_accvgpr_read_b32 v32, a4
    v_accvgpr_read_b32 v33, a5
    v_accvgpr_read_b32 v34, a6
    v_accvgpr_read_b32 v35, a7
    v_accvgpr_read_b32 v36, a20
    v_accvgpr_read_b32 v37, a21
    v_accvgpr_read_b32 v38, a22
    v_accvgpr_read_b32 v39, a23
    v_mul_f32 v32, v32, v113
    v_mul_f32 v33, v33, v113
    v_mul_f32 v34, v34, v113
    v_mul_f32 v35, v35, v113
    v_mul_f32 v36, v36, v113
    v_mul_f32 v37, v37, v113
    v_mul_f32 v38, v38, v113
    v_mul_f32 v39, v39, v113
    v_cvt_pk_bf16_f32 v48, v32, v33
    v_cvt_pk_bf16_f32 v49, v34, v35
    v_cvt_pk_bf16_f32 v50, v36, v37
    v_cvt_pk_bf16_f32 v51, v38, v39
    buffer_store_dwordx4 v[48:51], v30, s[24:27], s45 offen sc1
    v_accvgpr_read_b32 v40, a36
    v_accvgpr_read_b32 v41, a37
    v_accvgpr_read_b32 v42, a38
    v_accvgpr_read_b32 v43, a39
    v_accvgpr_read_b32 v44, a52
    v_accvgpr_read_b32 v45, a53
    v_accvgpr_read_b32 v46, a54
    v_accvgpr_read_b32 v47, a55
    v_mul_f32 v40, v40, v113
    v_mul_f32 v41, v41, v113
    v_mul_f32 v42, v42, v113
    v_mul_f32 v43, v43, v113
    v_mul_f32 v44, v44, v113
    v_mul_f32 v45, v45, v113
    v_mul_f32 v46, v46, v113
    v_mul_f32 v47, v47, v113
    v_cvt_pk_bf16_f32 v52, v40, v41
    v_cvt_pk_bf16_f32 v53, v42, v43
    v_cvt_pk_bf16_f32 v54, v44, v45
    v_cvt_pk_bf16_f32 v55, v46, v47
    buffer_store_dwordx4 v[52:55], v30, s[24:27], s45 offen offset:1024 sc1
    v_accvgpr_read_b32 v32, a68
    v_accvgpr_read_b32 v33, a69
    v_accvgpr_read_b32 v34, a70
    v_accvgpr_read_b32 v35, a71
    v_accvgpr_read_b32 v36, a84
    v_accvgpr_read_b32 v37, a85
    v_accvgpr_read_b32 v38, a86
    v_accvgpr_read_b32 v39, a87
    v_mul_f32 v32, v32, v113
    v_mul_f32 v33, v33, v113
    v_mul_f32 v34, v34, v113
    v_mul_f32 v35, v35, v113
    v_mul_f32 v36, v36, v113
    v_mul_f32 v37, v37, v113
    v_mul_f32 v38, v38, v113
    v_mul_f32 v39, v39, v113
    v_cvt_pk_bf16_f32 v56, v32, v33
    v_cvt_pk_bf16_f32 v57, v34, v35
    v_cvt_pk_bf16_f32 v58, v36, v37
    v_cvt_pk_bf16_f32 v59, v38, v39
    buffer_store_dwordx4 v[56:59], v30, s[24:27], s45 offen offset:2048 sc1
    v_accvgpr_read_b32 v40, a100
    v_accvgpr_read_b32 v41, a101
    v_accvgpr_read_b32 v42, a102
    v_accvgpr_read_b32 v43, a103
    v_accvgpr_read_b32 v44, a116
    v_accvgpr_read_b32 v45, a117
    v_accvgpr_read_b32 v46, a118
    v_accvgpr_read_b32 v47, a119
    v_mul_f32 v40, v40, v113
    v_mul_f32 v41, v41, v113
    v_mul_f32 v42, v42, v113
    v_mul_f32 v43, v43, v113
    v_mul_f32 v44, v44, v113
    v_mul_f32 v45, v45, v113
    v_mul_f32 v46, v46, v113
    v_mul_f32 v47, v47, v113
    v_cvt_pk_bf16_f32 v60, v40, v41
    v_cvt_pk_bf16_f32 v61, v42, v43
    v_cvt_pk_bf16_f32 v62, v44, v45
    v_cvt_pk_bf16_f32 v63, v46, v47
    buffer_store_dwordx4 v[60:63], v30, s[24:27], s45 offen offset:3072 sc1
    v_accvgpr_read_b32 v32, a8
    v_accvgpr_read_b32 v33, a9
    v_accvgpr_read_b32 v34, a10
    v_accvgpr_read_b32 v35, a11
    v_accvgpr_read_b32 v36, a24
    v_accvgpr_read_b32 v37, a25
    v_accvgpr_read_b32 v38, a26
    v_accvgpr_read_b32 v39, a27
    v_mul_f32 v32, v32, v114
    v_mul_f32 v33, v33, v114
    v_mul_f32 v34, v34, v114
    v_mul_f32 v35, v35, v114
    v_mul_f32 v36, v36, v114
    v_mul_f32 v37, v37, v114
    v_mul_f32 v38, v38, v114
    v_mul_f32 v39, v39, v114
    v_cvt_pk_bf16_f32 v48, v32, v33
    v_cvt_pk_bf16_f32 v49, v34, v35
    v_cvt_pk_bf16_f32 v50, v36, v37
    v_cvt_pk_bf16_f32 v51, v38, v39
    buffer_store_dwordx4 v[48:51], v30, s[24:27], s46 offen sc1
    v_accvgpr_read_b32 v40, a40
    v_accvgpr_read_b32 v41, a41
    v_accvgpr_read_b32 v42, a42
    v_accvgpr_read_b32 v43, a43
    v_accvgpr_read_b32 v44, a56
    v_accvgpr_read_b32 v45, a57
    v_accvgpr_read_b32 v46, a58
    v_accvgpr_read_b32 v47, a59
    v_mul_f32 v40, v40, v114
    v_mul_f32 v41, v41, v114
    v_mul_f32 v42, v42, v114
    v_mul_f32 v43, v43, v114
    v_mul_f32 v44, v44, v114
    v_mul_f32 v45, v45, v114
    v_mul_f32 v46, v46, v114
    v_mul_f32 v47, v47, v114
    v_cvt_pk_bf16_f32 v52, v40, v41
    v_cvt_pk_bf16_f32 v53, v42, v43
    v_cvt_pk_bf16_f32 v54, v44, v45
    v_cvt_pk_bf16_f32 v55, v46, v47
    buffer_store_dwordx4 v[52:55], v30, s[24:27], s46 offen offset:1024 sc1
    v_accvgpr_read_b32 v32, a72
    v_accvgpr_read_b32 v33, a73
    v_accvgpr_read_b32 v34, a74
    v_accvgpr_read_b32 v35, a75
    v_accvgpr_read_b32 v36, a88
    v_accvgpr_read_b32 v37, a89
    v_accvgpr_read_b32 v38, a90
    v_accvgpr_read_b32 v39, a91
    v_mul_f32 v32, v32, v114
    v_mul_f32 v33, v33, v114
    v_mul_f32 v34, v34, v114
    v_mul_f32 v35, v35, v114
    v_mul_f32 v36, v36, v114
    v_mul_f32 v37, v37, v114
    v_mul_f32 v38, v38, v114
    v_mul_f32 v39, v39, v114
    v_cvt_pk_bf16_f32 v56, v32, v33
    v_cvt_pk_bf16_f32 v57, v34, v35
    v_cvt_pk_bf16_f32 v58, v36, v37
    v_cvt_pk_bf16_f32 v59, v38, v39
    buffer_store_dwordx4 v[56:59], v30, s[24:27], s46 offen offset:2048 sc1
    v_accvgpr_read_b32 v40, a104
    v_accvgpr_read_b32 v41, a105
    v_accvgpr_read_b32 v42, a106
    v_accvgpr_read_b32 v43, a107
    v_accvgpr_read_b32 v44, a120
    v_accvgpr_read_b32 v45, a121
    v_accvgpr_read_b32 v46, a122
    v_accvgpr_read_b32 v47, a123
    v_mul_f32 v40, v40, v114
    v_mul_f32 v41, v41, v114
    v_mul_f32 v42, v42, v114
    v_mul_f32 v43, v43, v114
    v_mul_f32 v44, v44, v114
    v_mul_f32 v45, v45, v114
    v_mul_f32 v46, v46, v114
    v_mul_f32 v47, v47, v114
    v_cvt_pk_bf16_f32 v60, v40, v41
    v_cvt_pk_bf16_f32 v61, v42, v43
    v_cvt_pk_bf16_f32 v62, v44, v45
    v_cvt_pk_bf16_f32 v63, v46, v47
    buffer_store_dwordx4 v[60:63], v30, s[24:27], s46 offen offset:3072 sc1
    v_accvgpr_read_b32 v32, a12
    v_accvgpr_read_b32 v33, a13
    v_accvgpr_read_b32 v34, a14
    v_accvgpr_read_b32 v35, a15
    v_accvgpr_read_b32 v36, a28
    v_accvgpr_read_b32 v37, a29
    v_accvgpr_read_b32 v38, a30
    v_accvgpr_read_b32 v39, a31
    v_mul_f32 v32, v32, v115
    v_mul_f32 v33, v33, v115
    v_mul_f32 v34, v34, v115
    v_mul_f32 v35, v35, v115
    v_mul_f32 v36, v36, v115
    v_mul_f32 v37, v37, v115
    v_mul_f32 v38, v38, v115
    v_mul_f32 v39, v39, v115
    v_cvt_pk_bf16_f32 v48, v32, v33
    v_cvt_pk_bf16_f32 v49, v34, v35
    v_cvt_pk_bf16_f32 v50, v36, v37
    v_cvt_pk_bf16_f32 v51, v38, v39
    buffer_store_dwordx4 v[48:51], v30, s[24:27], s47 offen sc1
    v_accvgpr_read_b32 v40, a44
    v_accvgpr_read_b32 v41, a45
    v_accvgpr_read_b32 v42, a46
    v_accvgpr_read_b32 v43, a47
    v_accvgpr_read_b32 v44, a60
    v_accvgpr_read_b32 v45, a61
    v_accvgpr_read_b32 v46, a62
    v_accvgpr_read_b32 v47, a63
    v_mul_f32 v40, v40, v115
    v_mul_f32 v41, v41, v115
    v_mul_f32 v42, v42, v115
    v_mul_f32 v43, v43, v115
    v_mul_f32 v44, v44, v115
    v_mul_f32 v45, v45, v115
    v_mul_f32 v46, v46, v115
    v_mul_f32 v47, v47, v115
    v_cvt_pk_bf16_f32 v52, v40, v41
    v_cvt_pk_bf16_f32 v53, v42, v43
    v_cvt_pk_bf16_f32 v54, v44, v45
    v_cvt_pk_bf16_f32 v55, v46, v47
    buffer_store_dwordx4 v[52:55], v30, s[24:27], s47 offen offset:1024 sc1
    v_accvgpr_read_b32 v32, a76
    v_accvgpr_read_b32 v33, a77
    v_accvgpr_read_b32 v34, a78
    v_accvgpr_read_b32 v35, a79
    v_accvgpr_read_b32 v36, a92
    v_accvgpr_read_b32 v37, a93
    v_accvgpr_read_b32 v38, a94
    v_accvgpr_read_b32 v39, a95
    v_mul_f32 v32, v32, v115
    v_mul_f32 v33, v33, v115
    v_mul_f32 v34, v34, v115
    v_mul_f32 v35, v35, v115
    v_mul_f32 v36, v36, v115
    v_mul_f32 v37, v37, v115
    v_mul_f32 v38, v38, v115
    v_mul_f32 v39, v39, v115
    v_cvt_pk_bf16_f32 v56, v32, v33
    v_cvt_pk_bf16_f32 v57, v34, v35
    v_cvt_pk_bf16_f32 v58, v36, v37
    v_cvt_pk_bf16_f32 v59, v38, v39
    buffer_store_dwordx4 v[56:59], v30, s[24:27], s47 offen offset:2048 sc1
    v_accvgpr_read_b32 v40, a108
    v_accvgpr_read_b32 v41, a109
    v_accvgpr_read_b32 v42, a110
    v_accvgpr_read_b32 v43, a111
    v_accvgpr_read_b32 v44, a124
    v_accvgpr_read_b32 v45, a125
    v_accvgpr_read_b32 v46, a126
    v_accvgpr_read_b32 v47, a127
    v_mul_f32 v40, v40, v115
    v_mul_f32 v41, v41, v115
    v_mul_f32 v42, v42, v115
    v_mul_f32 v43, v43, v115
    v_mul_f32 v44, v44, v115
    v_mul_f32 v45, v45, v115
    v_mul_f32 v46, v46, v115
    v_mul_f32 v47, v47, v115
    v_cvt_pk_bf16_f32 v60, v40, v41
    v_cvt_pk_bf16_f32 v61, v42, v43
    v_cvt_pk_bf16_f32 v62, v44, v45
    v_cvt_pk_bf16_f32 v63, v46, v47
    buffer_store_dwordx4 v[60:63], v30, s[24:27], s47 offen offset:3072 sc1
    s_waitcnt lgkmcnt(0)
    s_barrier
    v_mov_b32 v121, 28672
    ds_read_b128 v[116:119], v121
    s_waitcnt lgkmcnt(0)
    v_or3_b32 v116, v116, v117, v118
    v_or_b32 v116, v116, v119
    s_nop 0
    v_readfirstlane_b32 s60, v116
    s_nop 3
    s_cmp_lg_u32 s60, 0
    s_cbranch_scc1 mk_fb
    s_and_b32 s60, s4, 7
    s_lshr_b32 s61, s4, 3
    s_lshr_b32 s62, s60, 1
    s_lshl_b32 s32, s5, 2
    s_add_u32 s32, s32, s62
    s_and_b32 s60, s60, 1
    s_lshl_b32 s60, s60, 2
    s_add_u32 s33, s60, s61
    s_lshl_b32 s60, s32, 9
    s_lshl_b32 s61, s3, 5
    s_add_u32 s60, s60, s61
    s_lshl_b32 s60, s60, 10
    s_add_u32 s60, s60, 2097152
    s_add_u32 s8, s58, s60
    s_addc_u32 s9, s59, 0
    s_mov_b32 s10, 425984
    s_mov_b32 s11, 0x00020000
    s_lshl_b32 s60, s3, 20
    s_lshl_b32 s61, s33, 7
    s_add_u32 s60, s60, s61
    s_sub_u32 s62, 4194304, s60
    s_add_u32 s16, s50, s60
    s_addc_u32 s17, s51, 0
    s_mov_b32 s18, s62
    s_mov_b32 s19, 0x00020000
    s_cmp_eq_u32 s33, 3
    s_mov_b32 s39, 1024
    s_mov_b32 s42, 32768
    s_mov_b32 s37, 1048575
    s_cselect_b32 s39, 128, s39
    s_cselect_b32 s42, 4096, s42
    s_cselect_b32 s37, 131071, s37
    s_lshl_b32 s60, s3, 17
    s_add_u32 s60, s60, 29360128
    s_add_u32 s60, s60, s58
    s_addc_u32 s61, s59, 0
    s_cmp_eq_u32 s33, 3
    s_cselect_b32 s16, s60, s16
    s_cselect_b32 s17, s61, s17
    s_cselect_b32 s18, 131072, s18
    s_mul_i32 s60, s3, 458752
    s_add_u32 s60, s60, s61
    s_sub_u32 s62, 1835008, s60
    s_lshl_b32 s34, s3, 15
    v_lshrrev_b32 v20, 4, v1
    v_bfe_u32 v21, v1, 2, 2
    v_and_b32 v22, 3, v1
    v_lshl_add_u32 v24, v20, 2, v21
    v_lshlrev_b32 v24, 7, v24
    v_lshl_add_u32 v24, v22, 3, v24
    v_add_u32 v24, s34, v24
    v_and_b32 v25, 1, v20
    v_lshlrev_b32 v25, 1, v25
    v_lshrrev_b32 v23, 1, v21
    v_add_u32 v25, v25, v23
    v_xor_b32 v23, 0, v25
    v_lshl_add_u32 v2, v23, 5, v24
    v_xor_b32 v23, 1, v25
    v_lshl_add_u32 v3, v23, 5, v24
    v_xor_b32 v23, 2, v25
    v_lshl_add_u32 v4, v23, 5, v24
    v_xor_b32 v23, 3, v25
    v_lshl_add_u32 v5, v23, 5, v24
    v_lshrrev_b32 v23, 3, v1
    v_mul_lo_u32 v24, v23, s39
    v_lshlrev_b32 v25, 1, v20
    v_and_b32 v23, 7, v1
    v_xor_b32 v23, v23, v25
    v_lshl_add_u32 v6, v23, 4, v24
    s_lshl_b32 s60, s39, 3
    s_sub_u32 s60, s60, 1024
    v_add_u32 v7, s60, v6
    v_add_u32 v8, s60, v7
    v_add_u32 v9, s60, v8
    v_lshlrev_b32 v10, 4, v1
    v_add_u32 v12, 0, v10
    v_add_u32 v16, 0, v10
    v_add_u32 v13, 131072, v10
    v_add_u32 v17, 57344, v10
    v_add_u32 v14, 262144, v10
    v_add_u32 v18, 114688, v10
    v_add_u32 v15, 393216, v10
    v_add_u32 v19, 172032, v10
    s_mul_i32 s35, s3, 1024
    s_mul_i32 s60, s5, 1024
    s_add_u32 s35, s35, s60
    s_and_b32 s35, s35, 32767
    s_lshr_b32 s36, s35, 10
    s_mul_i32 s36, s36, s42
    s_add_u32 m0, s34, 0
    s_nop 0
    buffer_load_dwordx4 v6, s[16:19], s36 offen lds
    buffer_load_dwordx4 v7, s[16:19], s36 offen offset:1024 lds
    buffer_load_dwordx4 v8, s[16:19], s36 offen offset:2048 lds
    buffer_load_dwordx4 v9, s[16:19], s36 offen offset:3072 lds
    s_add_u32 s36, s36, s42
    s_and_b32 s36, s36, s37
    s_add_u32 m0, s34, 4096
    s_nop 0
    buffer_load_dwordx4 v6, s[16:19], s36 offen lds
    buffer_load_dwordx4 v7, s[16:19], s36 offen offset:1024 lds
    buffer_load_dwordx4 v8, s[16:19], s36 offen offset:2048 lds
    buffer_load_dwordx4 v9, s[16:19], s36 offen offset:3072 lds
    s_add_u32 s36, s36, s42
    s_and_b32 s36, s36, s37
    s_add_u32 m0, s34, 8192
    s_nop 0
    buffer_load_dwordx4 v6, s[16:19], s36 offen lds
    buffer_load_dwordx4 v7, s[16:19], s36 offen offset:1024 lds
    buffer_load_dwordx4 v8, s[16:19], s36 offen offset:2048 lds
    buffer_load_dwordx4 v9, s[16:19], s36 offen offset:3072 lds
    s_add_u32 s36, s36, s42
    s_and_b32 s36, s36, s37
    s_add_u32 m0, s34, 12288
    s_nop 0
    buffer_load_dwordx4 v6, s[16:19], s36 offen lds
    buffer_load_dwordx4 v7, s[16:19], s36 offen offset:1024 lds
    buffer_load_dwordx4 v8, s[16:19], s36 offen offset:2048 lds
    buffer_load_dwordx4 v9, s[16:19], s36 offen offset:3072 lds
    s_add_u32 s36, s36, s42
    s_and_b32 s36, s36, s37
    s_add_u32 m0, s34, 16384
    s_nop 0
    buffer_load_dwordx4 v6, s[16:19], s36 offen lds
    buffer_load_dwordx4 v7, s[16:19], s36 offen offset:1024 lds
    buffer_load_dwordx4 v8, s[16:19], s36 offen offset:2048 lds
    buffer_load_dwordx4 v9, s[16:19], s36 offen offset:3072 lds
    s_add_u32 s36, s36, s42
    s_and_b32 s36, s36, s37
    s_add_u32 m0, s34, 20480
    s_nop 0
    buffer_load_dwordx4 v6, s[16:19], s36 offen lds
    buffer_load_dwordx4 v7, s[16:19], s36 offen offset:1024 lds
    buffer_load_dwordx4 v8, s[16:19], s36 offen offset:2048 lds
    buffer_load_dwordx4 v9, s[16:19], s36 offen offset:3072 lds
    s_add_u32 s36, s36, s42
    s_and_b32 s36, s36, s37
    s_add_u32 m0, s34, 24576
    s_nop 0
    buffer_load_dwordx4 v6, s[16:19], s36 offen lds
    buffer_load_dwordx4 v7, s[16:19], s36 offen offset:1024 lds
    buffer_load_dwordx4 v8, s[16:19], s36 offen offset:2048 lds
    buffer_load_dwordx4 v9, s[16:19], s36 offen offset:3072 lds
    s_add_u32 s36, s36, s42
    s_and_b32 s36, s36, s37
    s_waitcnt vmcnt(28)
    s_barrier
    s_cmp_lg_u32 s3, 0
    s_cbranch_scc1 mk_gb1_sig
    s_lshl_b32 s60, s5, 7
    s_add_u32 s60, s60, 8192
    s_lshl_b32 s61, s4, 2
    s_add_u32 s61, s61, s60
    v_mov_b32 v122, s6
    v_mov_b32 v123, 0
    s_mov_b64 exec, 1
    buffer_store_dword v122, v123, s[92:95], s61 offen sc1
    s_mov_b64 exec, -1
mk_gb1_sig:
    s_load_dwordx2 s[44:45], s[0:1], 0
    s_load_dwordx2 s[46:47], s[0:1], 72
    v_lshlrev_b32 v20, 4, v1
    s_lshl_b32 s60, s3, 13
    s_add_u32 s60, s60, 131072
    v_add_u32 v21, s60, v20
    s_lshl_b32 s60, s3, 10
    s_add_u32 s60, s60, 131072
    v_add_u32 v22, s60, v20
    v_and_b32 v23, 15, v1
    s_lshl_b32 s60, s32, 6
    s_lshl_b32 s61, s3, 4
    s_add_u32 s60, s60, s61
    v_add_u32 v23, s60, v23
    v_lshlrev_b32 v23, 10, v23
    v_lshrrev_b32 v24, 4, v1
    v_lshl_add_u32 v23, v24, 3, v23
    s_lshl_b32 s61, s33, 7
    v_add_u32 v23, s61, v23
    s_waitcnt lgkmcnt(0)
    s_mov_b32 s20, s44
    s_mov_b32 s21, s45
    s_mov_b32 s22, 2097152
    s_mov_b32 s23, 0x00020000
    s_mov_b32 s28, s46
    s_mov_b32 s29, s47
    s_mov_b32 s30, 2097152
    s_mov_b32 s31, 0x00020000
    buffer_load_dwordx2 v[240:241], v23, s[20:23], 0 offen
    buffer_load_dwordx2 v[242:243], v23, s[20:23], 0 offen offset:32
    buffer_load_dwordx2 v[244:245], v23, s[20:23], 0 offen offset:64
    buffer_load_dwordx2 v[246:247], v23, s[20:23], 0 offen offset:96
    ds_write_b128 v21, a[128:131]
    ds_write_b128 v21, a[132:135] offset:1024
    ds_write_b128 v21, a[136:139] offset:2048
    ds_write_b128 v21, a[140:143] offset:3072
    ds_write_b128 v21, a[144:147] offset:4096
    ds_write_b128 v21, a[148:151] offset:5120
    ds_write_b128 v21, a[152:155] offset:6144
    ds_write_b128 v21, a[156:159] offset:7168
    s_waitcnt lgkmcnt(0)
    s_barrier
    ds_read_b128 v[208:211], v22
    ds_read_b128 v[212:215], v22 offset:8192
    ds_read_b128 v[216:219], v22 offset:16384
    ds_read_b128 v[220:223], v22 offset:24576
    ds_read_b128 v[224:227], v22 offset:4096
    ds_read_b128 v[228:231], v22 offset:12288
    ds_read_b128 v[232:235], v22 offset:20480
    ds_read_b128 v[236:239], v22 offset:28672
    s_waitcnt lgkmcnt(6)
    v_add_f32 v208, v208, v212
    s_waitcnt lgkmcnt(4)
    v_add_f32 v216, v216, v220
    v_add_f32 v209, v209, v213
    v_add_f32 v217, v217, v221
    v_add_f32 v210, v210, v214
    v_add_f32 v218, v218, v222
    v_add_f32 v211, v211, v215
    v_add_f32 v219, v219, v223
    v_add_f32 v192, v208, v216
    v_add_f32 v193, v209, v217
    v_add_f32 v194, v210, v218
    v_add_f32 v195, v211, v219
    s_waitcnt lgkmcnt(2)
    v_add_f32 v224, v224, v228
    s_waitcnt lgkmcnt(0)
    v_add_f32 v232, v232, v236
    v_add_f32 v225, v225, v229
    v_add_f32 v233, v233, v237
    v_add_f32 v226, v226, v230
    v_add_f32 v234, v234, v238
    v_add_f32 v227, v227, v231
    v_add_f32 v235, v235, v239
    v_add_f32 v196, v224, v232
    v_add_f32 v197, v225, v233
    v_add_f32 v198, v226, v234
    v_add_f32 v199, v227, v235
    s_waitcnt lgkmcnt(0)
    s_barrier
    ds_write_b128 v21, a[160:163]
    ds_write_b128 v21, a[164:167] offset:1024
    ds_write_b128 v21, a[168:171] offset:2048
    ds_write_b128 v21, a[172:175] offset:3072
    ds_write_b128 v21, a[176:179] offset:4096
    ds_write_b128 v21, a[180:183] offset:5120
    ds_write_b128 v21, a[184:187] offset:6144
    ds_write_b128 v21, a[188:191] offset:7168
    s_waitcnt lgkmcnt(0)
    s_barrier
    ds_read_b128 v[208:211], v22
    ds_read_b128 v[212:215], v22 offset:8192
    ds_read_b128 v[216:219], v22 offset:16384
    ds_read_b128 v[220:223], v22 offset:24576
    ds_read_b128 v[224:227], v22 offset:4096
    ds_read_b128 v[228:231], v22 offset:12288
    ds_read_b128 v[232:235], v22 offset:20480
    ds_read_b128 v[236:239], v22 offset:28672
    s_waitcnt lgkmcnt(6)
    v_add_f32 v208, v208, v212
    s_waitcnt lgkmcnt(4)
    v_add_f32 v216, v216, v220
    v_add_f32 v209, v209, v213
    v_add_f32 v217, v217, v221
    v_add_f32 v210, v210, v214
    v_add_f32 v218, v218, v222
    v_add_f32 v211, v211, v215
    v_add_f32 v219, v219, v223
    v_add_f32 v200, v208, v216
    v_add_f32 v201, v209, v217
    v_add_f32 v202, v210, v218
    v_add_f32 v203, v211, v219
    s_waitcnt lgkmcnt(2)
    v_add_f32 v224, v224, v228
    s_waitcnt lgkmcnt(0)
    v_add_f32 v232, v232, v236
    v_add_f32 v225, v225, v229
    v_add_f32 v233, v233, v237
    v_add_f32 v226, v226, v230
    v_add_f32 v234, v234, v238
    v_add_f32 v227, v227, v231
    v_add_f32 v235, v235, v239
    v_add_f32 v204, v224, v232
    v_add_f32 v205, v225, v233
    v_add_f32 v206, v226, v234
    v_add_f32 v207, v227, v235
    s_waitcnt lgkmcnt(0)
    v_cvt_pk_bf16_f32 v208, v192, v193
    v_cvt_pk_bf16_f32 v209, v194, v195
    v_lshlrev_b32 v192, 16, v208
    v_and_b32 v193, 0xffff0000, v208
    v_lshlrev_b32 v194, 16, v209
    v_and_b32 v195, 0xffff0000, v209
    v_mul_f32 v212, 0xbfb8aa3b, v192
    v_mul_f32 v213, 0xbfb8aa3b, v193
    v_mul_f32 v214, 0xbfb8aa3b, v194
    v_mul_f32 v215, 0xbfb8aa3b, v195
    v_cvt_pk_bf16_f32 v216, v196, v197
    v_cvt_pk_bf16_f32 v217, v198, v199
    v_lshlrev_b32 v196, 16, v216
    v_and_b32 v197, 0xffff0000, v216
    v_lshlrev_b32 v198, 16, v217
    v_and_b32 v199, 0xffff0000, v217
    v_mul_f32 v220, 0xbfb8aa3b, v196
    v_mul_f32 v221, 0xbfb8aa3b, v197
    v_mul_f32 v222, 0xbfb8aa3b, v198
    v_mul_f32 v223, 0xbfb8aa3b, v199
    v_cvt_pk_bf16_f32 v224, v200, v201
    v_cvt_pk_bf16_f32 v225, v202, v203
    v_lshlrev_b32 v200, 16, v224
    v_and_b32 v201, 0xffff0000, v224
    v_lshlrev_b32 v202, 16, v225
    v_and_b32 v203, 0xffff0000, v225
    v_mul_f32 v228, 0xbfb8aa3b, v200
    v_mul_f32 v229, 0xbfb8aa3b, v201
    v_mul_f32 v230, 0xbfb8aa3b, v202
    v_mul_f32 v231, 0xbfb8aa3b, v203
    v_cvt_pk_bf16_f32 v232, v204, v205
    v_cvt_pk_bf16_f32 v233, v206, v207
    v_lshlrev_b32 v204, 16, v232
    v_and_b32 v205, 0xffff0000, v232
    v_lshlrev_b32 v206, 16, v233
    v_and_b32 v207, 0xffff0000, v233
    v_mul_f32 v236, 0xbfb8aa3b, v204
    v_mul_f32 v237, 0xbfb8aa3b, v205
    v_mul_f32 v238, 0xbfb8aa3b, v206
    v_mul_f32 v239, 0xbfb8aa3b, v207
    v_exp_f32 v212, v212
    v_exp_f32 v213, v213
    v_exp_f32 v214, v214
    v_exp_f32 v215, v215
    v_exp_f32 v220, v220
    v_exp_f32 v221, v221
    v_exp_f32 v222, v222
    v_exp_f32 v223, v223
    v_exp_f32 v228, v228
    v_exp_f32 v229, v229
    v_exp_f32 v230, v230
    v_exp_f32 v231, v231
    v_exp_f32 v236, v236
    v_exp_f32 v237, v237
    v_exp_f32 v238, v238
    v_exp_f32 v239, v239
    v_add_f32 v212, 1.0, v212
    v_add_f32 v213, 1.0, v213
    v_add_f32 v214, 1.0, v214
    v_add_f32 v215, 1.0, v215
    v_add_f32 v220, 1.0, v220
    v_add_f32 v221, 1.0, v221
    v_add_f32 v222, 1.0, v222
    v_add_f32 v223, 1.0, v223
    v_add_f32 v228, 1.0, v228
    v_add_f32 v229, 1.0, v229
    v_add_f32 v230, 1.0, v230
    v_add_f32 v231, 1.0, v231
    v_add_f32 v236, 1.0, v236
    v_add_f32 v237, 1.0, v237
    v_add_f32 v238, 1.0, v238
    v_add_f32 v239, 1.0, v239
    v_rcp_f32 v212, v212
    v_rcp_f32 v213, v213
    v_rcp_f32 v214, v214
    v_rcp_f32 v215, v215
    v_rcp_f32 v220, v220
    v_rcp_f32 v221, v221
    v_rcp_f32 v222, v222
    v_rcp_f32 v223, v223
    v_rcp_f32 v228, v228
    v_rcp_f32 v229, v229
    v_rcp_f32 v230, v230
    v_rcp_f32 v231, v231
    v_rcp_f32 v236, v236
    v_rcp_f32 v237, v237
    v_rcp_f32 v238, v238
    v_rcp_f32 v239, v239
    v_mul_f32 v192, v192, v212
    v_mul_f32 v193, v193, v213
    v_mul_f32 v194, v194, v214
    v_mul_f32 v195, v195, v215
    v_mul_f32 v196, v196, v220
    v_mul_f32 v197, v197, v221
    v_mul_f32 v198, v198, v222
    v_mul_f32 v199, v199, v223
    v_mul_f32 v200, v200, v228
    v_mul_f32 v201, v201, v229
    v_mul_f32 v202, v202, v230
    v_mul_f32 v203, v203, v231
    v_mul_f32 v204, v204, v236
    v_mul_f32 v205, v205, v237
    v_mul_f32 v206, v206, v238
    v_mul_f32 v207, v207, v239
    s_waitcnt vmcnt(3)
    v_lshlrev_b32 v208, 16, v240
    v_and_b32 v209, 0xffff0000, v240
    v_lshlrev_b32 v210, 16, v241
    v_and_b32 v211, 0xffff0000, v241
    s_waitcnt vmcnt(2)
    v_lshlrev_b32 v212, 16, v242
    v_and_b32 v213, 0xffff0000, v242
    v_lshlrev_b32 v214, 16, v243
    v_and_b32 v215, 0xffff0000, v243
    s_waitcnt vmcnt(1)
    v_lshlrev_b32 v216, 16, v244
    v_and_b32 v217, 0xffff0000, v244
    v_lshlrev_b32 v218, 16, v245
    v_and_b32 v219, 0xffff0000, v245
    s_waitcnt vmcnt(0)
    v_lshlrev_b32 v220, 16, v246
    v_and_b32 v221, 0xffff0000, v246
    v_lshlrev_b32 v222, 16, v247
    v_and_b32 v223, 0xffff0000, v247
    ds_read_b64_tr_b16 v[64:65], v2
    ds_read_b64_tr_b16 v[66:67], v2 offset:2048
    ds_read_b64_tr_b16 v[68:69], v3
    ds_read_b64_tr_b16 v[70:71], v3 offset:2048
    ds_read_b64_tr_b16 v[72:73], v4
    ds_read_b64_tr_b16 v[74:75], v4 offset:2048
    ds_read_b64_tr_b16 v[76:77], v5
    ds_read_b64_tr_b16 v[78:79], v5 offset:2048
    s_cmp_lg_u32 s3, 0
    s_cbranch_scc1 mk_gb1_skip
    s_lshl_b32 s60, s5, 7
    s_add_u32 s60, s60, 8192
    v_mov_b32 v122, s6
    s_mov_b32 exec_lo, -1
    s_mov_b32 exec_hi, 0
    v_lshlrev_b32 v123, 2, v1
    s_mov_b32 s62, 400000
mk_gb1_poll:
    buffer_load_dword v124, v123, s[92:95], s60 offen sc1
    s_waitcnt vmcnt(0)
    v_cmp_ne_u32 vcc, s6, v124
    s_nop 4
    s_cbranch_vccz mk_gb1_done
    s_sub_u32 s62, s62, 1
    s_cbranch_scc1 mk_gb1_done
    s_sleep 1
    s_branch mk_gb1_poll
mk_gb1_done:
    s_mov_b64 exec, -1
mk_gb1_skip:
    s_barrier
    buffer_load_dwordx4 a[0:3], v12, s[8:11], s35 offen sc1
    buffer_load_dwordx4 a[4:7], v13, s[8:11], s35 offen sc1
    buffer_load_dwordx4 a[8:11], v14, s[8:11], s35 offen sc1
    buffer_load_dwordx4 a[12:15], v15, s[8:11], s35 offen sc1
    s_add_u32 s35, s35, 1024
    s_and_b32 s35, s35, 32767
    buffer_load_dwordx4 a[16:19], v12, s[8:11], s35 offen sc1
    buffer_load_dwordx4 a[20:23], v13, s[8:11], s35 offen sc1
    buffer_load_dwordx4 a[24:27], v14, s[8:11], s35 offen sc1
    buffer_load_dwordx4 a[28:31], v15, s[8:11], s35 offen sc1
    s_add_u32 s35, s35, 1024
    s_and_b32 s35, s35, 32767
    buffer_load_dwordx4 a[32:35], v12, s[8:11], s35 offen sc1
    buffer_load_dwordx4 a[36:39], v13, s[8:11], s35 offen sc1
    buffer_load_dwordx4 a[40:43], v14, s[8:11], s35 offen sc1
    buffer_load_dwordx4 a[44:47], v15, s[8:11], s35 offen sc1
    s_add_u32 s35, s35, 1024
    s_and_b32 s35, s35, 32767
    s_waitcnt vmcnt(11) lgkmcnt(6)
    v_mfma_f32_16x16x32_bf16 v[128:131], v[64:67], a[0:3], 0
    s_waitcnt vmcnt(10)
    s_add_u32 m0, s34, 28672
    v_mfma_f32_16x16x32_bf16 v[132:135], v[64:67], a[4:7], 0
    s_waitcnt vmcnt(9)
    ds_read_b64_tr_b16 v[80:81], v2 offset:4096
    v_mfma_f32_16x16x32_bf16 v[136:139], v[64:67], a[8:11], 0
    s_waitcnt vmcnt(8)
    buffer_load_dwordx4 v6, s[16:19], s36 offen lds
    v_mfma_f32_16x16x32_bf16 v[140:143], v[64:67], a[12:15], 0
    s_waitcnt lgkmcnt(5)
    ds_read_b64_tr_b16 v[82:83], v2 offset:6144
    v_mfma_f32_16x16x32_bf16 v[144:147], v[68:71], a[0:3], 0
    buffer_load_dwordx4 v7, s[16:19], s36 offen offset:1024 lds
    v_mfma_f32_16x16x32_bf16 v[148:151], v[68:71], a[4:7], 0
    ds_read_b64_tr_b16 v[84:85], v3 offset:4096
    v_mfma_f32_16x16x32_bf16 v[152:155], v[68:71], a[8:11], 0
    buffer_load_dwordx4 v8, s[16:19], s36 offen offset:2048 lds
    v_mfma_f32_16x16x32_bf16 v[156:159], v[68:71], a[12:15], 0
    s_waitcnt lgkmcnt(3)
    ds_read_b64_tr_b16 v[86:87], v3 offset:6144
    v_mfma_f32_16x16x32_bf16 v[160:163], v[72:75], a[0:3], 0
    buffer_load_dwordx4 v9, s[16:19], s36 offen offset:3072 lds
    v_mfma_f32_16x16x32_bf16 v[164:167], v[72:75], a[4:7], 0
    s_add_u32 s36, s36, s42
    s_and_b32 s36, s36, s37
    ds_read_b64_tr_b16 v[88:89], v4 offset:4096
    v_mfma_f32_16x16x32_bf16 v[168:171], v[72:75], a[8:11], 0
    buffer_load_dwordx4 a[48:51], v12, s[8:11], s35 offen sc1
    v_mfma_f32_16x16x32_bf16 v[172:175], v[72:75], a[12:15], 0
    ds_read_b64_tr_b16 v[90:91], v4 offset:6144
    v_mfma_f32_16x16x32_bf16 v[176:179], v[76:79], a[0:3], 0
    buffer_load_dwordx4 a[52:55], v13, s[8:11], s35 offen sc1
    v_mfma_f32_16x16x32_bf16 v[180:183], v[76:79], a[4:7], 0
    ds_read_b64_tr_b16 v[92:93], v5 offset:4096
    v_mfma_f32_16x16x32_bf16 v[184:187], v[76:79], a[8:11], 0
    buffer_load_dwordx4 a[56:59], v14, s[8:11], s35 offen sc1
    v_mfma_f32_16x16x32_bf16 v[188:191], v[76:79], a[12:15], 0
    s_waitcnt vmcnt(14) lgkmcnt(3)
    ds_read_b64_tr_b16 v[94:95], v5 offset:6144
    buffer_load_dwordx4 a[60:63], v15, s[8:11], s35 offen sc1
    s_add_u32 s35, s35, 1024
    s_and_b32 s35, s35, 32767
    v_mfma_f32_16x16x32_bf16 v[128:131], v[80:83], a[16:19], v[128:131]
    s_waitcnt vmcnt(14)
    s_add_u32 m0, s34, 0
    v_mfma_f32_16x16x32_bf16 v[132:135], v[80:83], a[20:23], v[132:135]
    s_waitcnt vmcnt(13)
    ds_read_b64_tr_b16 v[64:65], v2 offset:8192
    v_mfma_f32_16x16x32_bf16 v[136:139], v[80:83], a[24:27], v[136:139]
    s_waitcnt vmcnt(12)
    buffer_load_dwordx4 v6, s[16:19], s36 offen lds
    v_mfma_f32_16x16x32_bf16 v[140:143], v[80:83], a[28:31], v[140:143]
    ds_read_b64_tr_b16 v[66:67], v2 offset:10240
    v_mfma_f32_16x16x32_bf16 v[144:147], v[84:87], a[16:19], v[144:147]
    buffer_load_dwordx4 v7, s[16:19], s36 offen offset:1024 lds
    v_mfma_f32_16x16x32_bf16 v[148:151], v[84:87], a[20:23], v[148:151]
    ds_read_b64_tr_b16 v[68:69], v3 offset:8192
    v_mfma_f32_16x16x32_bf16 v[152:155], v[84:87], a[24:27], v[152:155]
    buffer_load_dwordx4 v8, s[16:19], s36 offen offset:2048 lds
    v_mfma_f32_16x16x32_bf16 v[156:159], v[84:87], a[28:31], v[156:159]
    s_waitcnt lgkmcnt(3)
    ds_read_b64_tr_b16 v[70:71], v3 offset:10240
    v_mfma_f32_16x16x32_bf16 v[160:163], v[88:91], a[16:19], v[160:163]
    buffer_load_dwordx4 v9, s[16:19], s36 offen offset:3072 lds
    v_mfma_f32_16x16x32_bf16 v[164:167], v[88:91], a[20:23], v[164:167]
    s_add_u32 s36, s36, s42
    s_and_b32 s36, s36, s37
    ds_read_b64_tr_b16 v[72:73], v4 offset:8192
    v_mfma_f32_16x16x32_bf16 v[168:171], v[88:91], a[24:27], v[168:171]
    buffer_load_dwordx4 a[64:67], v12, s[8:11], s35 offen sc1
    v_mfma_f32_16x16x32_bf16 v[172:175], v[88:91], a[28:31], v[172:175]
    ds_read_b64_tr_b16 v[74:75], v4 offset:10240
    v_mfma_f32_16x16x32_bf16 v[176:179], v[92:95], a[16:19], v[176:179]
    buffer_load_dwordx4 a[68:71], v13, s[8:11], s35 offen sc1
    v_mfma_f32_16x16x32_bf16 v[180:183], v[92:95], a[20:23], v[180:183]
    ds_read_b64_tr_b16 v[76:77], v5 offset:8192
    v_mfma_f32_16x16x32_bf16 v[184:187], v[92:95], a[24:27], v[184:187]
    buffer_load_dwordx4 a[72:75], v14, s[8:11], s35 offen sc1
    v_mfma_f32_16x16x32_bf16 v[188:191], v[92:95], a[28:31], v[188:191]
    s_waitcnt vmcnt(18) lgkmcnt(3)
    ds_read_b64_tr_b16 v[78:79], v5 offset:10240
    buffer_load_dwordx4 a[76:79], v15, s[8:11], s35 offen sc1
    s_add_u32 s35, s35, 1024
    s_and_b32 s35, s35, 32767
    v_mfma_f32_16x16x32_bf16 v[128:131], v[64:67], a[32:35], v[128:131]
    s_waitcnt vmcnt(18)
    s_add_u32 m0, s34, 4096
    v_mfma_f32_16x16x32_bf16 v[132:135], v[64:67], a[36:39], v[132:135]
    s_waitcnt vmcnt(17)
    ds_read_b64_tr_b16 v[80:81], v2 offset:12288
    v_mfma_f32_16x16x32_bf16 v[136:139], v[64:67], a[40:43], v[136:139]
    s_waitcnt vmcnt(16)
    buffer_load_dwordx4 v6, s[16:19], s36 offen lds
    v_mfma_f32_16x16x32_bf16 v[140:143], v[64:67], a[44:47], v[140:143]
    ds_read_b64_tr_b16 v[82:83], v2 offset:14336
    v_mfma_f32_16x16x32_bf16 v[144:147], v[68:71], a[32:35], v[144:147]
    buffer_load_dwordx4 v7, s[16:19], s36 offen offset:1024 lds
    v_mfma_f32_16x16x32_bf16 v[148:151], v[68:71], a[36:39], v[148:151]
    ds_read_b64_tr_b16 v[84:85], v3 offset:12288
    v_mfma_f32_16x16x32_bf16 v[152:155], v[68:71], a[40:43], v[152:155]
    buffer_load_dwordx4 v8, s[16:19], s36 offen offset:2048 lds
    v_mfma_f32_16x16x32_bf16 v[156:159], v[68:71], a[44:47], v[156:159]
    s_waitcnt lgkmcnt(3)
    ds_read_b64_tr_b16 v[86:87], v3 offset:14336
    v_mfma_f32_16x16x32_bf16 v[160:163], v[72:75], a[32:35], v[160:163]
    buffer_load_dwordx4 v9, s[16:19], s36 offen offset:3072 lds
    v_mfma_f32_16x16x32_bf16 v[164:167], v[72:75], a[36:39], v[164:167]
    s_add_u32 s36, s36, s42
    s_and_b32 s36, s36, s37
    ds_read_b64_tr_b16 v[88:89], v4 offset:12288
    v_mfma_f32_16x16x32_bf16 v[168:171], v[72:75], a[40:43], v[168:171]
    buffer_load_dwordx4 a[80:83], v12, s[8:11], s35 offen sc1
    v_mfma_f32_16x16x32_bf16 v[172:175], v[72:75], a[44:47], v[172:175]
    ds_read_b64_tr_b16 v[90:91], v4 offset:14336
    v_mfma_f32_16x16x32_bf16 v[176:179], v[76:79], a[32:35], v[176:179]
    buffer_load_dwordx4 a[84:87], v13, s[8:11], s35 offen sc1
    v_mfma_f32_16x16x32_bf16 v[180:183], v[76:79], a[36:39], v[180:183]
    ds_read_b64_tr_b16 v[92:93], v5 offset:12288
    v_mfma_f32_16x16x32_bf16 v[184:187], v[76:79], a[40:43], v[184:187]
    buffer_load_dwordx4 a[88:91], v14, s[8:11], s35 offen sc1
    v_mfma_f32_16x16x32_bf16 v[188:191], v[76:79], a[44:47], v[188:191]
    s_waitcnt vmcnt(18) lgkmcnt(3)
    ds_read_b64_tr_b16 v[94:95], v5 offset:14336
    buffer_load_dwordx4 a[92:95], v15, s[8:11], s35 offen sc1
    s_add_u32 s35, s35, 1024
    s_and_b32 s35, s35, 32767
    v_mfma_f32_16x16x32_bf16 v[128:131], v[80:83], a[48:51], v[128:131]
    s_waitcnt vmcnt(18)
    s_add_u32 m0, s34, 8192
    v_mfma_f32_16x16x32_bf16 v[132:135], v[80:83], a[52:55], v[132:135]
    s_waitcnt vmcnt(17)
    ds_read_b64_tr_b16 v[64:65], v2 offset:16384
    v_mfma_f32_16x16x32_bf16 v[136:139], v[80:83], a[56:59], v[136:139]
    s_waitcnt vmcnt(16)
    buffer_load_dwordx4 v6, s[16:19], s36 offen lds
    v_mfma_f32_16x16x32_bf16 v[140:143], v[80:83], a[60:63], v[140:143]
    ds_read_b64_tr_b16 v[66:67], v2 offset:18432
    v_mfma_f32_16x16x32_bf16 v[144:147], v[84:87], a[48:51], v[144:147]
    buffer_load_dwordx4 v7, s[16:19], s36 offen offset:1024 lds
    v_mfma_f32_16x16x32_bf16 v[148:151], v[84:87], a[52:55], v[148:151]
    ds_read_b64_tr_b16 v[68:69], v3 offset:16384
    v_mfma_f32_16x16x32_bf16 v[152:155], v[84:87], a[56:59], v[152:155]
    buffer_load_dwordx4 v8, s[16:19], s36 offen offset:2048 lds
    v_mfma_f32_16x16x32_bf16 v[156:159], v[84:87], a[60:63], v[156:159]
    s_waitcnt lgkmcnt(3)
    ds_read_b64_tr_b16 v[70:71], v3 offset:18432
    v_mfma_f32_16x16x32_bf16 v[160:163], v[88:91], a[48:51], v[160:163]
    buffer_load_dwordx4 v9, s[16:19], s36 offen offset:3072 lds
    v_mfma_f32_16x16x32_bf16 v[164:167], v[88:91], a[52:55], v[164:167]
    s_add_u32 s36, s36, s42
    s_and_b32 s36, s36, s37
    ds_read_b64_tr_b16 v[72:73], v4 offset:16384
    v_mfma_f32_16x16x32_bf16 v[168:171], v[88:91], a[56:59], v[168:171]
    buffer_load_dwordx4 a[96:99], v12, s[8:11], s35 offen sc1
    v_mfma_f32_16x16x32_bf16 v[172:175], v[88:91], a[60:63], v[172:175]
    ds_read_b64_tr_b16 v[74:75], v4 offset:18432
    v_mfma_f32_16x16x32_bf16 v[176:179], v[92:95], a[48:51], v[176:179]
    buffer_load_dwordx4 a[100:103], v13, s[8:11], s35 offen sc1
    v_mfma_f32_16x16x32_bf16 v[180:183], v[92:95], a[52:55], v[180:183]
    ds_read_b64_tr_b16 v[76:77], v5 offset:16384
    v_mfma_f32_16x16x32_bf16 v[184:187], v[92:95], a[56:59], v[184:187]
    buffer_load_dwordx4 a[104:107], v14, s[8:11], s35 offen sc1
    v_mfma_f32_16x16x32_bf16 v[188:191], v[92:95], a[60:63], v[188:191]
    s_waitcnt vmcnt(18) lgkmcnt(3)
    ds_read_b64_tr_b16 v[78:79], v5 offset:18432
    buffer_load_dwordx4 a[108:111], v15, s[8:11], s35 offen sc1
    s_add_u32 s35, s35, 1024
    s_and_b32 s35, s35, 32767
    v_mfma_f32_16x16x32_bf16 v[128:131], v[64:67], a[64:67], v[128:131]
    s_waitcnt vmcnt(18)
    s_add_u32 m0, s34, 12288
    v_mfma_f32_16x16x32_bf16 v[132:135], v[64:67], a[68:71], v[132:135]
    s_waitcnt vmcnt(17)
    ds_read_b64_tr_b16 v[80:81], v2 offset:20480
    v_mfma_f32_16x16x32_bf16 v[136:139], v[64:67], a[72:75], v[136:139]
    s_waitcnt vmcnt(16)
    buffer_load_dwordx4 v6, s[16:19], s36 offen lds
    v_mfma_f32_16x16x32_bf16 v[140:143], v[64:67], a[76:79], v[140:143]
    ds_read_b64_tr_b16 v[82:83], v2 offset:22528
    v_mfma_f32_16x16x32_bf16 v[144:147], v[68:71], a[64:67], v[144:147]
    buffer_load_dwordx4 v7, s[16:19], s36 offen offset:1024 lds
    v_mfma_f32_16x16x32_bf16 v[148:151], v[68:71], a[68:71], v[148:151]
    ds_read_b64_tr_b16 v[84:85], v3 offset:20480
    v_mfma_f32_16x16x32_bf16 v[152:155], v[68:71], a[72:75], v[152:155]
    buffer_load_dwordx4 v8, s[16:19], s36 offen offset:2048 lds
    v_mfma_f32_16x16x32_bf16 v[156:159], v[68:71], a[76:79], v[156:159]
    s_waitcnt lgkmcnt(3)
    ds_read_b64_tr_b16 v[86:87], v3 offset:22528
    v_mfma_f32_16x16x32_bf16 v[160:163], v[72:75], a[64:67], v[160:163]
    buffer_load_dwordx4 v9, s[16:19], s36 offen offset:3072 lds
    v_mfma_f32_16x16x32_bf16 v[164:167], v[72:75], a[68:71], v[164:167]
    s_add_u32 s36, s36, s42
    s_and_b32 s36, s36, s37
    ds_read_b64_tr_b16 v[88:89], v4 offset:20480
    v_mfma_f32_16x16x32_bf16 v[168:171], v[72:75], a[72:75], v[168:171]
    buffer_load_dwordx4 a[112:115], v12, s[8:11], s35 offen sc1
    v_mfma_f32_16x16x32_bf16 v[172:175], v[72:75], a[76:79], v[172:175]
    ds_read_b64_tr_b16 v[90:91], v4 offset:22528
    v_mfma_f32_16x16x32_bf16 v[176:179], v[76:79], a[64:67], v[176:179]
    buffer_load_dwordx4 a[116:119], v13, s[8:11], s35 offen sc1
    v_mfma_f32_16x16x32_bf16 v[180:183], v[76:79], a[68:71], v[180:183]
    ds_read_b64_tr_b16 v[92:93], v5 offset:20480
    v_mfma_f32_16x16x32_bf16 v[184:187], v[76:79], a[72:75], v[184:187]
    buffer_load_dwordx4 a[120:123], v14, s[8:11], s35 offen sc1
    v_mfma_f32_16x16x32_bf16 v[188:191], v[76:79], a[76:79], v[188:191]
    s_waitcnt vmcnt(18) lgkmcnt(3)
    ds_read_b64_tr_b16 v[94:95], v5 offset:22528
    buffer_load_dwordx4 a[124:127], v15, s[8:11], s35 offen sc1
    s_add_u32 s35, s35, 1024
    s_and_b32 s35, s35, 32767
    v_mfma_f32_16x16x32_bf16 v[128:131], v[80:83], a[80:83], v[128:131]
    s_waitcnt vmcnt(18)
    s_add_u32 m0, s34, 16384
    v_mfma_f32_16x16x32_bf16 v[132:135], v[80:83], a[84:87], v[132:135]
    s_waitcnt vmcnt(17)
    ds_read_b64_tr_b16 v[64:65], v2 offset:24576
    v_mfma_f32_16x16x32_bf16 v[136:139], v[80:83], a[88:91], v[136:139]
    s_waitcnt vmcnt(16)
    buffer_load_dwordx4 v6, s[16:19], s36 offen lds
    v_mfma_f32_16x16x32_bf16 v[140:143], v[80:83], a[92:95], v[140:143]
    ds_read_b64_tr_b16 v[66:67], v2 offset:26624
    v_mfma_f32_16x16x32_bf16 v[144:147], v[84:87], a[80:83], v[144:147]
    buffer_load_dwordx4 v7, s[16:19], s36 offen offset:1024 lds
    v_mfma_f32_16x16x32_bf16 v[148:151], v[84:87], a[84:87], v[148:151]
    ds_read_b64_tr_b16 v[68:69], v3 offset:24576
    v_mfma_f32_16x16x32_bf16 v[152:155], v[84:87], a[88:91], v[152:155]
    buffer_load_dwordx4 v8, s[16:19], s36 offen offset:2048 lds
    v_mfma_f32_16x16x32_bf16 v[156:159], v[84:87], a[92:95], v[156:159]
    s_waitcnt lgkmcnt(3)
    ds_read_b64_tr_b16 v[70:71], v3 offset:26624
    v_mfma_f32_16x16x32_bf16 v[160:163], v[88:91], a[80:83], v[160:163]
    buffer_load_dwordx4 v9, s[16:19], s36 offen offset:3072 lds
    v_mfma_f32_16x16x32_bf16 v[164:167], v[88:91], a[84:87], v[164:167]
    s_add_u32 s36, s36, s42
    s_and_b32 s36, s36, s37
    ds_read_b64_tr_b16 v[72:73], v4 offset:24576
    v_mfma_f32_16x16x32_bf16 v[168:171], v[88:91], a[88:91], v[168:171]
    buffer_load_dwordx4 a[0:3], v12, s[8:11], s35 offen sc1
    v_mfma_f32_16x16x32_bf16 v[172:175], v[88:91], a[92:95], v[172:175]
    ds_read_b64_tr_b16 v[74:75], v4 offset:26624
    v_mfma_f32_16x16x32_bf16 v[176:179], v[92:95], a[80:83], v[176:179]
    buffer_load_dwordx4 a[4:7], v13, s[8:11], s35 offen sc1
    v_mfma_f32_16x16x32_bf16 v[180:183], v[92:95], a[84:87], v[180:183]
    ds_read_b64_tr_b16 v[76:77], v5 offset:24576
    v_mfma_f32_16x16x32_bf16 v[184:187], v[92:95], a[88:91], v[184:187]
    buffer_load_dwordx4 a[8:11], v14, s[8:11], s35 offen sc1
    v_mfma_f32_16x16x32_bf16 v[188:191], v[92:95], a[92:95], v[188:191]
    s_waitcnt vmcnt(18) lgkmcnt(3)
    ds_read_b64_tr_b16 v[78:79], v5 offset:26624
    buffer_load_dwordx4 a[12:15], v15, s[8:11], s35 offen sc1
    s_add_u32 s35, s35, 1024
    s_and_b32 s35, s35, 32767
    v_mfma_f32_16x16x32_bf16 v[128:131], v[64:67], a[96:99], v[128:131]
    s_waitcnt vmcnt(18)
    s_add_u32 m0, s34, 20480
    v_mfma_f32_16x16x32_bf16 v[132:135], v[64:67], a[100:103], v[132:135]
    s_waitcnt vmcnt(17)
    ds_read_b64_tr_b16 v[80:81], v2 offset:28672
    v_mfma_f32_16x16x32_bf16 v[136:139], v[64:67], a[104:107], v[136:139]
    s_waitcnt vmcnt(16)
    buffer_load_dwordx4 v6, s[16:19], s36 offen lds
    v_mfma_f32_16x16x32_bf16 v[140:143], v[64:67], a[108:111], v[140:143]
    ds_read_b64_tr_b16 v[82:83], v2 offset:30720
    v_mfma_f32_16x16x32_bf16 v[144:147], v[68:71], a[96:99], v[144:147]
    buffer_load_dwordx4 v7, s[16:19], s36 offen offset:1024 lds
    v_mfma_f32_16x16x32_bf16 v[148:151], v[68:71], a[100:103], v[148:151]
    ds_read_b64_tr_b16 v[84:85], v3 offset:28672
    v_mfma_f32_16x16x32_bf16 v[152:155], v[68:71], a[104:107], v[152:155]
    buffer_load_dwordx4 v8, s[16:19], s36 offen offset:2048 lds
    v_mfma_f32_16x16x32_bf16 v[156:159], v[68:71], a[108:111], v[156:159]
    s_waitcnt lgkmcnt(3)
    ds_read_b64_tr_b16 v[86:87], v3 offset:30720
    v_mfma_f32_16x16x32_bf16 v[160:163], v[72:75], a[96:99], v[160:163]
    buffer_load_dwordx4 v9, s[16:19], s36 offen offset:3072 lds
    v_mfma_f32_16x16x32_bf16 v[164:167], v[72:75], a[100:103], v[164:167]
    s_add_u32 s36, s36, s42
    s_and_b32 s36, s36, s37
    ds_read_b64_tr_b16 v[88:89], v4 offset:28672
    v_mfma_f32_16x16x32_bf16 v[168:171], v[72:75], a[104:107], v[168:171]
    buffer_load_dwordx4 a[16:19], v12, s[8:11], s35 offen sc1
    v_mfma_f32_16x16x32_bf16 v[172:175], v[72:75], a[108:111], v[172:175]
    ds_read_b64_tr_b16 v[90:91], v4 offset:30720
    v_mfma_f32_16x16x32_bf16 v[176:179], v[76:79], a[96:99], v[176:179]
    buffer_load_dwordx4 a[20:23], v13, s[8:11], s35 offen sc1
    v_mfma_f32_16x16x32_bf16 v[180:183], v[76:79], a[100:103], v[180:183]
    ds_read_b64_tr_b16 v[92:93], v5 offset:28672
    v_mfma_f32_16x16x32_bf16 v[184:187], v[76:79], a[104:107], v[184:187]
    buffer_load_dwordx4 a[24:27], v14, s[8:11], s35 offen sc1
    v_mfma_f32_16x16x32_bf16 v[188:191], v[76:79], a[108:111], v[188:191]
    s_waitcnt vmcnt(18) lgkmcnt(3)
    ds_read_b64_tr_b16 v[94:95], v5 offset:30720
    buffer_load_dwordx4 a[28:31], v15, s[8:11], s35 offen sc1
    s_add_u32 s35, s35, 1024
    s_and_b32 s35, s35, 32767
    v_mfma_f32_16x16x32_bf16 v[128:131], v[80:83], a[112:115], v[128:131]
    s_waitcnt vmcnt(18)
    s_add_u32 m0, s34, 24576
    v_mfma_f32_16x16x32_bf16 v[132:135], v[80:83], a[116:119], v[132:135]
    s_waitcnt vmcnt(17)
    ds_read_b64_tr_b16 v[64:65], v2
    v_mfma_f32_16x16x32_bf16 v[136:139], v[80:83], a[120:123], v[136:139]
    s_waitcnt vmcnt(16)
    buffer_load_dwordx4 v6, s[16:19], s36 offen lds
    v_mfma_f32_16x16x32_bf16 v[140:143], v[80:83], a[124:127], v[140:143]
    ds_read_b64_tr_b16 v[66:67], v2 offset:2048
    v_mfma_f32_16x16x32_bf16 v[144:147], v[84:87], a[112:115], v[144:147]
    buffer_load_dwordx4 v7, s[16:19], s36 offen offset:1024 lds
    v_mfma_f32_16x16x32_bf16 v[148:151], v[84:87], a[116:119], v[148:151]
    ds_read_b64_tr_b16 v[68:69], v3
    v_mfma_f32_16x16x32_bf16 v[152:155], v[84:87], a[120:123], v[152:155]
    buffer_load_dwordx4 v8, s[16:19], s36 offen offset:2048 lds
    v_mfma_f32_16x16x32_bf16 v[156:159], v[84:87], a[124:127], v[156:159]
    s_waitcnt lgkmcnt(3)
    ds_read_b64_tr_b16 v[70:71], v3 offset:2048
    v_mfma_f32_16x16x32_bf16 v[160:163], v[88:91], a[112:115], v[160:163]
    buffer_load_dwordx4 v9, s[16:19], s36 offen offset:3072 lds
    v_mfma_f32_16x16x32_bf16 v[164:167], v[88:91], a[116:119], v[164:167]
    s_add_u32 s36, s36, s42
    s_and_b32 s36, s36, s37
    ds_read_b64_tr_b16 v[72:73], v4
    v_mfma_f32_16x16x32_bf16 v[168:171], v[88:91], a[120:123], v[168:171]
    buffer_load_dwordx4 a[32:35], v12, s[8:11], s35 offen sc1
    v_mfma_f32_16x16x32_bf16 v[172:175], v[88:91], a[124:127], v[172:175]
    ds_read_b64_tr_b16 v[74:75], v4 offset:2048
    v_mfma_f32_16x16x32_bf16 v[176:179], v[92:95], a[112:115], v[176:179]
    buffer_load_dwordx4 a[36:39], v13, s[8:11], s35 offen sc1
    v_mfma_f32_16x16x32_bf16 v[180:183], v[92:95], a[116:119], v[180:183]
    ds_read_b64_tr_b16 v[76:77], v5
    v_mfma_f32_16x16x32_bf16 v[184:187], v[92:95], a[120:123], v[184:187]
    buffer_load_dwordx4 a[40:43], v14, s[8:11], s35 offen sc1
    v_mfma_f32_16x16x32_bf16 v[188:191], v[92:95], a[124:127], v[188:191]
    s_waitcnt vmcnt(18) lgkmcnt(3)
    ds_read_b64_tr_b16 v[78:79], v5 offset:2048
    buffer_load_dwordx4 a[44:47], v15, s[8:11], s35 offen sc1
    s_add_u32 s35, s35, 1024
    s_and_b32 s35, s35, 32767
    v_mfma_f32_16x16x32_bf16 v[128:131], v[64:67], a[0:3], v[128:131]
    s_waitcnt vmcnt(18)
    s_add_u32 m0, s34, 28672
    v_mfma_f32_16x16x32_bf16 v[132:135], v[64:67], a[4:7], v[132:135]
    s_waitcnt vmcnt(17)
    ds_read_b64_tr_b16 v[80:81], v2 offset:4096
    v_mfma_f32_16x16x32_bf16 v[136:139], v[64:67], a[8:11], v[136:139]
    s_waitcnt vmcnt(16)
    buffer_load_dwordx4 v6, s[16:19], s36 offen lds
    v_mfma_f32_16x16x32_bf16 v[140:143], v[64:67], a[12:15], v[140:143]
    ds_read_b64_tr_b16 v[82:83], v2 offset:6144
    v_mfma_f32_16x16x32_bf16 v[144:147], v[68:71], a[0:3], v[144:147]
    buffer_load_dwordx4 v7, s[16:19], s36 offen offset:1024 lds
    v_mfma_f32_16x16x32_bf16 v[148:151], v[68:71], a[4:7], v[148:151]
    ds_read_b64_tr_b16 v[84:85], v3 offset:4096
    v_mfma_f32_16x16x32_bf16 v[152:155], v[68:71], a[8:11], v[152:155]
    buffer_load_dwordx4 v8, s[16:19], s36 offen offset:2048 lds
    v_mfma_f32_16x16x32_bf16 v[156:159], v[68:71], a[12:15], v[156:159]
    s_waitcnt lgkmcnt(3)
    ds_read_b64_tr_b16 v[86:87], v3 offset:6144
    v_mfma_f32_16x16x32_bf16 v[160:163], v[72:75], a[0:3], v[160:163]
    buffer_load_dwordx4 v9, s[16:19], s36 offen offset:3072 lds
    v_mfma_f32_16x16x32_bf16 v[164:167], v[72:75], a[4:7], v[164:167]
    s_add_u32 s36, s36, s42
    s_and_b32 s36, s36, s37
    ds_read_b64_tr_b16 v[88:89], v4 offset:4096
    v_mfma_f32_16x16x32_bf16 v[168:171], v[72:75], a[8:11], v[168:171]
    buffer_load_dwordx4 a[48:51], v12, s[8:11], s35 offen sc1
    v_mfma_f32_16x16x32_bf16 v[172:175], v[72:75], a[12:15], v[172:175]
    ds_read_b64_tr_b16 v[90:91], v4 offset:6144
    v_mfma_f32_16x16x32_bf16 v[176:179], v[76:79], a[0:3], v[176:179]
    buffer_load_dwordx4 a[52:55], v13, s[8:11], s35 offen sc1
    v_mfma_f32_16x16x32_bf16 v[180:183], v[76:79], a[4:7], v[180:183]
    ds_read_b64_tr_b16 v[92:93], v5 offset:4096
    v_mfma_f32_16x16x32_bf16 v[184:187], v[76:79], a[8:11], v[184:187]
    buffer_load_dwordx4 a[56:59], v14, s[8:11], s35 offen sc1
    v_mfma_f32_16x16x32_bf16 v[188:191], v[76:79], a[12:15], v[188:191]
    s_waitcnt vmcnt(18) lgkmcnt(3)
    ds_read_b64_tr_b16 v[94:95], v5 offset:6144
    buffer_load_dwordx4 a[60:63], v15, s[8:11], s35 offen sc1
    s_add_u32 s35, s35, 1024
    s_and_b32 s35, s35, 32767
    v_mfma_f32_16x16x32_bf16 v[128:131], v[80:83], a[16:19], v[128:131]
    s_waitcnt vmcnt(18)
    s_add_u32 m0, s34, 0
    v_mfma_f32_16x16x32_bf16 v[132:135], v[80:83], a[20:23], v[132:135]
    s_waitcnt vmcnt(17)
    ds_read_b64_tr_b16 v[64:65], v2 offset:8192
    v_mfma_f32_16x16x32_bf16 v[136:139], v[80:83], a[24:27], v[136:139]
    s_waitcnt vmcnt(16)
    buffer_load_dwordx4 v6, s[16:19], s36 offen lds
    v_mfma_f32_16x16x32_bf16 v[140:143], v[80:83], a[28:31], v[140:143]
    ds_read_b64_tr_b16 v[66:67], v2 offset:10240
    v_mfma_f32_16x16x32_bf16 v[144:147], v[84:87], a[16:19], v[144:147]
    buffer_load_dwordx4 v7, s[16:19], s36 offen offset:1024 lds
    v_mfma_f32_16x16x32_bf16 v[148:151], v[84:87], a[20:23], v[148:151]
    ds_read_b64_tr_b16 v[68:69], v3 offset:8192
    v_mfma_f32_16x16x32_bf16 v[152:155], v[84:87], a[24:27], v[152:155]
    buffer_load_dwordx4 v8, s[16:19], s36 offen offset:2048 lds
    v_mfma_f32_16x16x32_bf16 v[156:159], v[84:87], a[28:31], v[156:159]
    s_waitcnt lgkmcnt(3)
    ds_read_b64_tr_b16 v[70:71], v3 offset:10240
    v_mfma_f32_16x16x32_bf16 v[160:163], v[88:91], a[16:19], v[160:163]
    buffer_load_dwordx4 v9, s[16:19], s36 offen offset:3072 lds
    v_mfma_f32_16x16x32_bf16 v[164:167], v[88:91], a[20:23], v[164:167]
    s_add_u32 s36, s36, s42
    s_and_b32 s36, s36, s37
    ds_read_b64_tr_b16 v[72:73], v4 offset:8192
    v_mfma_f32_16x16x32_bf16 v[168:171], v[88:91], a[24:27], v[168:171]
    buffer_load_dwordx4 a[64:67], v12, s[8:11], s35 offen sc1
    v_mfma_f32_16x16x32_bf16 v[172:175], v[88:91], a[28:31], v[172:175]
    ds_read_b64_tr_b16 v[74:75], v4 offset:10240
    v_mfma_f32_16x16x32_bf16 v[176:179], v[92:95], a[16:19], v[176:179]
    buffer_load_dwordx4 a[68:71], v13, s[8:11], s35 offen sc1
    v_mfma_f32_16x16x32_bf16 v[180:183], v[92:95], a[20:23], v[180:183]
    ds_read_b64_tr_b16 v[76:77], v5 offset:8192
    v_mfma_f32_16x16x32_bf16 v[184:187], v[92:95], a[24:27], v[184:187]
    buffer_load_dwordx4 a[72:75], v14, s[8:11], s35 offen sc1
    v_mfma_f32_16x16x32_bf16 v[188:191], v[92:95], a[28:31], v[188:191]
    s_waitcnt vmcnt(18) lgkmcnt(3)
    ds_read_b64_tr_b16 v[78:79], v5 offset:10240
    buffer_load_dwordx4 a[76:79], v15, s[8:11], s35 offen sc1
    s_add_u32 s35, s35, 1024
    s_and_b32 s35, s35, 32767
    v_mfma_f32_16x16x32_bf16 v[128:131], v[64:67], a[32:35], v[128:131]
    s_waitcnt vmcnt(18)
    s_add_u32 m0, s34, 4096
    v_mfma_f32_16x16x32_bf16 v[132:135], v[64:67], a[36:39], v[132:135]
    s_waitcnt vmcnt(17)
    ds_read_b64_tr_b16 v[80:81], v2 offset:12288
    v_mfma_f32_16x16x32_bf16 v[136:139], v[64:67], a[40:43], v[136:139]
    s_waitcnt vmcnt(16)
    buffer_load_dwordx4 v6, s[16:19], s36 offen lds
    v_mfma_f32_16x16x32_bf16 v[140:143], v[64:67], a[44:47], v[140:143]
    ds_read_b64_tr_b16 v[82:83], v2 offset:14336
    v_mfma_f32_16x16x32_bf16 v[144:147], v[68:71], a[32:35], v[144:147]
    buffer_load_dwordx4 v7, s[16:19], s36 offen offset:1024 lds
    v_mfma_f32_16x16x32_bf16 v[148:151], v[68:71], a[36:39], v[148:151]
    ds_read_b64_tr_b16 v[84:85], v3 offset:12288
    v_mfma_f32_16x16x32_bf16 v[152:155], v[68:71], a[40:43], v[152:155]
    buffer_load_dwordx4 v8, s[16:19], s36 offen offset:2048 lds
    v_mfma_f32_16x16x32_bf16 v[156:159], v[68:71], a[44:47], v[156:159]
    s_waitcnt lgkmcnt(3)
    ds_read_b64_tr_b16 v[86:87], v3 offset:14336
    v_mfma_f32_16x16x32_bf16 v[160:163], v[72:75], a[32:35], v[160:163]
    buffer_load_dwordx4 v9, s[16:19], s36 offen offset:3072 lds
    v_mfma_f32_16x16x32_bf16 v[164:167], v[72:75], a[36:39], v[164:167]
    s_add_u32 s36, s36, s42
    s_and_b32 s36, s36, s37
    ds_read_b64_tr_b16 v[88:89], v4 offset:12288
    v_mfma_f32_16x16x32_bf16 v[168:171], v[72:75], a[40:43], v[168:171]
    buffer_load_dwordx4 a[80:83], v12, s[8:11], s35 offen sc1
    v_mfma_f32_16x16x32_bf16 v[172:175], v[72:75], a[44:47], v[172:175]
    ds_read_b64_tr_b16 v[90:91], v4 offset:14336
    v_mfma_f32_16x16x32_bf16 v[176:179], v[76:79], a[32:35], v[176:179]
    buffer_load_dwordx4 a[84:87], v13, s[8:11], s35 offen sc1
    v_mfma_f32_16x16x32_bf16 v[180:183], v[76:79], a[36:39], v[180:183]
    ds_read_b64_tr_b16 v[92:93], v5 offset:12288
    v_mfma_f32_16x16x32_bf16 v[184:187], v[76:79], a[40:43], v[184:187]
    buffer_load_dwordx4 a[88:91], v14, s[8:11], s35 offen sc1
    v_mfma_f32_16x16x32_bf16 v[188:191], v[76:79], a[44:47], v[188:191]
    s_waitcnt vmcnt(18) lgkmcnt(3)
    ds_read_b64_tr_b16 v[94:95], v5 offset:14336
    buffer_load_dwordx4 a[92:95], v15, s[8:11], s35 offen sc1
    s_add_u32 s35, s35, 1024
    s_and_b32 s35, s35, 32767
    v_mfma_f32_16x16x32_bf16 v[128:131], v[80:83], a[48:51], v[128:131]
    s_waitcnt vmcnt(18)
    s_add_u32 m0, s34, 8192
    v_mfma_f32_16x16x32_bf16 v[132:135], v[80:83], a[52:55], v[132:135]
    s_waitcnt vmcnt(17)
    ds_read_b64_tr_b16 v[64:65], v2 offset:16384
    v_mfma_f32_16x16x32_bf16 v[136:139], v[80:83], a[56:59], v[136:139]
    s_waitcnt vmcnt(16)
    buffer_load_dwordx4 v6, s[16:19], s36 offen lds
    v_mfma_f32_16x16x32_bf16 v[140:143], v[80:83], a[60:63], v[140:143]
    ds_read_b64_tr_b16 v[66:67], v2 offset:18432
    v_mfma_f32_16x16x32_bf16 v[144:147], v[84:87], a[48:51], v[144:147]
    buffer_load_dwordx4 v7, s[16:19], s36 offen offset:1024 lds
    v_mfma_f32_16x16x32_bf16 v[148:151], v[84:87], a[52:55], v[148:151]
    ds_read_b64_tr_b16 v[68:69], v3 offset:16384
    v_mfma_f32_16x16x32_bf16 v[152:155], v[84:87], a[56:59], v[152:155]
    buffer_load_dwordx4 v8, s[16:19], s36 offen offset:2048 lds
    v_mfma_f32_16x16x32_bf16 v[156:159], v[84:87], a[60:63], v[156:159]
    s_waitcnt lgkmcnt(3)
    ds_read_b64_tr_b16 v[70:71], v3 offset:18432
    v_mfma_f32_16x16x32_bf16 v[160:163], v[88:91], a[48:51], v[160:163]
    buffer_load_dwordx4 v9, s[16:19], s36 offen offset:3072 lds
    v_mfma_f32_16x16x32_bf16 v[164:167], v[88:91], a[52:55], v[164:167]
    s_add_u32 s36, s36, s42
    s_and_b32 s36, s36, s37
    ds_read_b64_tr_b16 v[72:73], v4 offset:16384
    v_mfma_f32_16x16x32_bf16 v[168:171], v[88:91], a[56:59], v[168:171]
    buffer_load_dwordx4 a[96:99], v12, s[8:11], s35 offen sc1
    v_mfma_f32_16x16x32_bf16 v[172:175], v[88:91], a[60:63], v[172:175]
    ds_read_b64_tr_b16 v[74:75], v4 offset:18432
    v_mfma_f32_16x16x32_bf16 v[176:179], v[92:95], a[48:51], v[176:179]
    buffer_load_dwordx4 a[100:103], v13, s[8:11], s35 offen sc1
    v_mfma_f32_16x16x32_bf16 v[180:183], v[92:95], a[52:55], v[180:183]
    ds_read_b64_tr_b16 v[76:77], v5 offset:16384
    v_mfma_f32_16x16x32_bf16 v[184:187], v[92:95], a[56:59], v[184:187]
    buffer_load_dwordx4 a[104:107], v14, s[8:11], s35 offen sc1
    v_mfma_f32_16x16x32_bf16 v[188:191], v[92:95], a[60:63], v[188:191]
    s_waitcnt vmcnt(18) lgkmcnt(3)
    ds_read_b64_tr_b16 v[78:79], v5 offset:18432
    buffer_load_dwordx4 a[108:111], v15, s[8:11], s35 offen sc1
    s_add_u32 s35, s35, 1024
    s_and_b32 s35, s35, 32767
    v_mfma_f32_16x16x32_bf16 v[128:131], v[64:67], a[64:67], v[128:131]
    s_waitcnt vmcnt(18)
    s_add_u32 m0, s34, 12288
    v_mfma_f32_16x16x32_bf16 v[132:135], v[64:67], a[68:71], v[132:135]
    s_waitcnt vmcnt(17)
    ds_read_b64_tr_b16 v[80:81], v2 offset:20480
    v_mfma_f32_16x16x32_bf16 v[136:139], v[64:67], a[72:75], v[136:139]
    s_waitcnt vmcnt(16)
    buffer_load_dwordx4 v6, s[16:19], s36 offen lds
    v_mfma_f32_16x16x32_bf16 v[140:143], v[64:67], a[76:79], v[140:143]
    ds_read_b64_tr_b16 v[82:83], v2 offset:22528
    v_mfma_f32_16x16x32_bf16 v[144:147], v[68:71], a[64:67], v[144:147]
    buffer_load_dwordx4 v7, s[16:19], s36 offen offset:1024 lds
    v_mfma_f32_16x16x32_bf16 v[148:151], v[68:71], a[68:71], v[148:151]
    ds_read_b64_tr_b16 v[84:85], v3 offset:20480
    v_mfma_f32_16x16x32_bf16 v[152:155], v[68:71], a[72:75], v[152:155]
    buffer_load_dwordx4 v8, s[16:19], s36 offen offset:2048 lds
    v_mfma_f32_16x16x32_bf16 v[156:159], v[68:71], a[76:79], v[156:159]
    s_waitcnt lgkmcnt(3)
    ds_read_b64_tr_b16 v[86:87], v3 offset:22528
    v_mfma_f32_16x16x32_bf16 v[160:163], v[72:75], a[64:67], v[160:163]
    buffer_load_dwordx4 v9, s[16:19], s36 offen offset:3072 lds
    v_mfma_f32_16x16x32_bf16 v[164:167], v[72:75], a[68:71], v[164:167]
    s_add_u32 s36, s36, s42
    s_and_b32 s36, s36, s37
    ds_read_b64_tr_b16 v[88:89], v4 offset:20480
    v_mfma_f32_16x16x32_bf16 v[168:171], v[72:75], a[72:75], v[168:171]
    buffer_load_dwordx4 a[112:115], v12, s[8:11], s35 offen sc1
    v_mfma_f32_16x16x32_bf16 v[172:175], v[72:75], a[76:79], v[172:175]
    ds_read_b64_tr_b16 v[90:91], v4 offset:22528
    v_mfma_f32_16x16x32_bf16 v[176:179], v[76:79], a[64:67], v[176:179]
    buffer_load_dwordx4 a[116:119], v13, s[8:11], s35 offen sc1
    v_mfma_f32_16x16x32_bf16 v[180:183], v[76:79], a[68:71], v[180:183]
    ds_read_b64_tr_b16 v[92:93], v5 offset:20480
    v_mfma_f32_16x16x32_bf16 v[184:187], v[76:79], a[72:75], v[184:187]
    buffer_load_dwordx4 a[120:123], v14, s[8:11], s35 offen sc1
    v_mfma_f32_16x16x32_bf16 v[188:191], v[76:79], a[76:79], v[188:191]
    s_waitcnt vmcnt(18) lgkmcnt(3)
    ds_read_b64_tr_b16 v[94:95], v5 offset:22528
    buffer_load_dwordx4 a[124:127], v15, s[8:11], s35 offen sc1
    s_add_u32 s35, s35, 1024
    s_and_b32 s35, s35, 32767
    v_mfma_f32_16x16x32_bf16 v[128:131], v[80:83], a[80:83], v[128:131]
    s_waitcnt vmcnt(18)
    s_add_u32 m0, s34, 16384
    v_mfma_f32_16x16x32_bf16 v[132:135], v[80:83], a[84:87], v[132:135]
    s_waitcnt vmcnt(17)
    ds_read_b64_tr_b16 v[64:65], v2 offset:24576
    v_mfma_f32_16x16x32_bf16 v[136:139], v[80:83], a[88:91], v[136:139]
    s_waitcnt vmcnt(16)
    buffer_load_dwordx4 v6, s[16:19], s36 offen lds
    v_mfma_f32_16x16x32_bf16 v[140:143], v[80:83], a[92:95], v[140:143]
    ds_read_b64_tr_b16 v[66:67], v2 offset:26624
    v_mfma_f32_16x16x32_bf16 v[144:147], v[84:87], a[80:83], v[144:147]
    buffer_load_dwordx4 v7, s[16:19], s36 offen offset:1024 lds
    v_mfma_f32_16x16x32_bf16 v[148:151], v[84:87], a[84:87], v[148:151]
    ds_read_b64_tr_b16 v[68:69], v3 offset:24576
    v_mfma_f32_16x16x32_bf16 v[152:155], v[84:87], a[88:91], v[152:155]
    buffer_load_dwordx4 v8, s[16:19], s36 offen offset:2048 lds
    v_mfma_f32_16x16x32_bf16 v[156:159], v[84:87], a[92:95], v[156:159]
    s_waitcnt lgkmcnt(3)
    ds_read_b64_tr_b16 v[70:71], v3 offset:26624
    v_mfma_f32_16x16x32_bf16 v[160:163], v[88:91], a[80:83], v[160:163]
    buffer_load_dwordx4 v9, s[16:19], s36 offen offset:3072 lds
    v_mfma_f32_16x16x32_bf16 v[164:167], v[88:91], a[84:87], v[164:167]
    s_add_u32 s36, s36, s42
    s_and_b32 s36, s36, s37
    ds_read_b64_tr_b16 v[72:73], v4 offset:24576
    v_mfma_f32_16x16x32_bf16 v[168:171], v[88:91], a[88:91], v[168:171]
    buffer_load_dwordx4 a[0:3], v12, s[8:11], s35 offen sc1
    v_mfma_f32_16x16x32_bf16 v[172:175], v[88:91], a[92:95], v[172:175]
    ds_read_b64_tr_b16 v[74:75], v4 offset:26624
    v_mfma_f32_16x16x32_bf16 v[176:179], v[92:95], a[80:83], v[176:179]
    buffer_load_dwordx4 a[4:7], v13, s[8:11], s35 offen sc1
    v_mfma_f32_16x16x32_bf16 v[180:183], v[92:95], a[84:87], v[180:183]
    ds_read_b64_tr_b16 v[76:77], v5 offset:24576
    v_mfma_f32_16x16x32_bf16 v[184:187], v[92:95], a[88:91], v[184:187]
    buffer_load_dwordx4 a[8:11], v14, s[8:11], s35 offen sc1
    v_mfma_f32_16x16x32_bf16 v[188:191], v[92:95], a[92:95], v[188:191]
    s_waitcnt vmcnt(18) lgkmcnt(3)
    ds_read_b64_tr_b16 v[78:79], v5 offset:26624
    buffer_load_dwordx4 a[12:15], v15, s[8:11], s35 offen sc1
    s_add_u32 s35, s35, 1024
    s_and_b32 s35, s35, 32767
    v_mfma_f32_16x16x32_bf16 v[128:131], v[64:67], a[96:99], v[128:131]
    s_waitcnt vmcnt(18)
    s_add_u32 m0, s34, 20480
    v_mfma_f32_16x16x32_bf16 v[132:135], v[64:67], a[100:103], v[132:135]
    s_waitcnt vmcnt(17)
    ds_read_b64_tr_b16 v[80:81], v2 offset:28672
    v_mfma_f32_16x16x32_bf16 v[136:139], v[64:67], a[104:107], v[136:139]
    s_waitcnt vmcnt(16)
    buffer_load_dwordx4 v6, s[16:19], s36 offen lds
    v_mfma_f32_16x16x32_bf16 v[140:143], v[64:67], a[108:111], v[140:143]
    ds_read_b64_tr_b16 v[82:83], v2 offset:30720
    v_mfma_f32_16x16x32_bf16 v[144:147], v[68:71], a[96:99], v[144:147]
    buffer_load_dwordx4 v7, s[16:19], s36 offen offset:1024 lds
    v_mfma_f32_16x16x32_bf16 v[148:151], v[68:71], a[100:103], v[148:151]
    ds_read_b64_tr_b16 v[84:85], v3 offset:28672
    v_mfma_f32_16x16x32_bf16 v[152:155], v[68:71], a[104:107], v[152:155]
    buffer_load_dwordx4 v8, s[16:19], s36 offen offset:2048 lds
    v_mfma_f32_16x16x32_bf16 v[156:159], v[68:71], a[108:111], v[156:159]
    s_waitcnt lgkmcnt(3)
    ds_read_b64_tr_b16 v[86:87], v3 offset:30720
    v_mfma_f32_16x16x32_bf16 v[160:163], v[72:75], a[96:99], v[160:163]
    buffer_load_dwordx4 v9, s[16:19], s36 offen offset:3072 lds
    v_mfma_f32_16x16x32_bf16 v[164:167], v[72:75], a[100:103], v[164:167]
    s_add_u32 s36, s36, s42
    s_and_b32 s36, s36, s37
    ds_read_b64_tr_b16 v[88:89], v4 offset:28672
    v_mfma_f32_16x16x32_bf16 v[168:171], v[72:75], a[104:107], v[168:171]
    buffer_load_dwordx4 a[16:19], v12, s[8:11], s35 offen sc1
    v_mfma_f32_16x16x32_bf16 v[172:175], v[72:75], a[108:111], v[172:175]
    ds_read_b64_tr_b16 v[90:91], v4 offset:30720
    v_mfma_f32_16x16x32_bf16 v[176:179], v[76:79], a[96:99], v[176:179]
    buffer_load_dwordx4 a[20:23], v13, s[8:11], s35 offen sc1
    v_mfma_f32_16x16x32_bf16 v[180:183], v[76:79], a[100:103], v[180:183]
    ds_read_b64_tr_b16 v[92:93], v5 offset:28672
    v_mfma_f32_16x16x32_bf16 v[184:187], v[76:79], a[104:107], v[184:187]
    buffer_load_dwordx4 a[24:27], v14, s[8:11], s35 offen sc1
    v_mfma_f32_16x16x32_bf16 v[188:191], v[76:79], a[108:111], v[188:191]
    s_waitcnt vmcnt(18) lgkmcnt(3)
    ds_read_b64_tr_b16 v[94:95], v5 offset:30720
    buffer_load_dwordx4 a[28:31], v15, s[8:11], s35 offen sc1
    s_add_u32 s35, s35, 1024
    s_and_b32 s35, s35, 32767
    v_mfma_f32_16x16x32_bf16 v[128:131], v[80:83], a[112:115], v[128:131]
    s_waitcnt vmcnt(18)
    s_add_u32 m0, s34, 24576
    v_mfma_f32_16x16x32_bf16 v[132:135], v[80:83], a[116:119], v[132:135]
    s_waitcnt vmcnt(17)
    ds_read_b64_tr_b16 v[64:65], v2
    v_mfma_f32_16x16x32_bf16 v[136:139], v[80:83], a[120:123], v[136:139]
    s_waitcnt vmcnt(16)
    buffer_load_dwordx4 v6, s[16:19], s36 offen lds
    v_mfma_f32_16x16x32_bf16 v[140:143], v[80:83], a[124:127], v[140:143]
    ds_read_b64_tr_b16 v[66:67], v2 offset:2048
    v_mfma_f32_16x16x32_bf16 v[144:147], v[84:87], a[112:115], v[144:147]
    buffer_load_dwordx4 v7, s[16:19], s36 offen offset:1024 lds
    v_mfma_f32_16x16x32_bf16 v[148:151], v[84:87], a[116:119], v[148:151]
    ds_read_b64_tr_b16 v[68:69], v3
    v_mfma_f32_16x16x32_bf16 v[152:155], v[84:87], a[120:123], v[152:155]
    buffer_load_dwordx4 v8, s[16:19], s36 offen offset:2048 lds
    v_mfma_f32_16x16x32_bf16 v[156:159], v[84:87], a[124:127], v[156:159]
    s_waitcnt lgkmcnt(3)
    ds_read_b64_tr_b16 v[70:71], v3 offset:2048
    v_mfma_f32_16x16x32_bf16 v[160:163], v[88:91], a[112:115], v[160:163]
    buffer_load_dwordx4 v9, s[16:19], s36 offen offset:3072 lds
    v_mfma_f32_16x16x32_bf16 v[164:167], v[88:91], a[116:119], v[164:167]
    s_add_u32 s36, s36, s42
    s_and_b32 s36, s36, s37
    ds_read_b64_tr_b16 v[72:73], v4
    v_mfma_f32_16x16x32_bf16 v[168:171], v[88:91], a[120:123], v[168:171]
    buffer_load_dwordx4 a[32:35], v12, s[8:11], s35 offen sc1
    v_mfma_f32_16x16x32_bf16 v[172:175], v[88:91], a[124:127], v[172:175]
    ds_read_b64_tr_b16 v[74:75], v4 offset:2048
    v_mfma_f32_16x16x32_bf16 v[176:179], v[92:95], a[112:115], v[176:179]
    buffer_load_dwordx4 a[36:39], v13, s[8:11], s35 offen sc1
    v_mfma_f32_16x16x32_bf16 v[180:183], v[92:95], a[116:119], v[180:183]
    ds_read_b64_tr_b16 v[76:77], v5
    v_mfma_f32_16x16x32_bf16 v[184:187], v[92:95], a[120:123], v[184:187]
    buffer_load_dwordx4 a[40:43], v14, s[8:11], s35 offen sc1
    v_mfma_f32_16x16x32_bf16 v[188:191], v[92:95], a[124:127], v[188:191]
    s_waitcnt vmcnt(18) lgkmcnt(3)
    ds_read_b64_tr_b16 v[78:79], v5 offset:2048
    buffer_load_dwordx4 a[44:47], v15, s[8:11], s35 offen sc1
    s_add_u32 s35, s35, 1024
    s_and_b32 s35, s35, 32767
    v_mfma_f32_16x16x32_bf16 v[128:131], v[64:67], a[0:3], v[128:131]
    s_waitcnt vmcnt(18)
    s_add_u32 m0, s34, 28672
    v_mfma_f32_16x16x32_bf16 v[132:135], v[64:67], a[4:7], v[132:135]
    s_waitcnt vmcnt(17)
    ds_read_b64_tr_b16 v[80:81], v2 offset:4096
    v_mfma_f32_16x16x32_bf16 v[136:139], v[64:67], a[8:11], v[136:139]
    s_waitcnt vmcnt(16)
    buffer_load_dwordx4 v6, s[16:19], s36 offen lds
    v_mfma_f32_16x16x32_bf16 v[140:143], v[64:67], a[12:15], v[140:143]
    ds_read_b64_tr_b16 v[82:83], v2 offset:6144
    v_mfma_f32_16x16x32_bf16 v[144:147], v[68:71], a[0:3], v[144:147]
    buffer_load_dwordx4 v7, s[16:19], s36 offen offset:1024 lds
    v_mfma_f32_16x16x32_bf16 v[148:151], v[68:71], a[4:7], v[148:151]
    ds_read_b64_tr_b16 v[84:85], v3 offset:4096
    v_mfma_f32_16x16x32_bf16 v[152:155], v[68:71], a[8:11], v[152:155]
    buffer_load_dwordx4 v8, s[16:19], s36 offen offset:2048 lds
    v_mfma_f32_16x16x32_bf16 v[156:159], v[68:71], a[12:15], v[156:159]
    s_waitcnt lgkmcnt(3)
    ds_read_b64_tr_b16 v[86:87], v3 offset:6144
    v_mfma_f32_16x16x32_bf16 v[160:163], v[72:75], a[0:3], v[160:163]
    buffer_load_dwordx4 v9, s[16:19], s36 offen offset:3072 lds
    v_mfma_f32_16x16x32_bf16 v[164:167], v[72:75], a[4:7], v[164:167]
    s_add_u32 s36, s36, s42
    s_and_b32 s36, s36, s37
    ds_read_b64_tr_b16 v[88:89], v4 offset:4096
    v_mfma_f32_16x16x32_bf16 v[168:171], v[72:75], a[8:11], v[168:171]
    buffer_load_dwordx4 a[48:51], v12, s[8:11], s35 offen sc1
    v_mfma_f32_16x16x32_bf16 v[172:175], v[72:75], a[12:15], v[172:175]
    ds_read_b64_tr_b16 v[90:91], v4 offset:6144
    v_mfma_f32_16x16x32_bf16 v[176:179], v[76:79], a[0:3], v[176:179]
    buffer_load_dwordx4 a[52:55], v13, s[8:11], s35 offen sc1
    v_mfma_f32_16x16x32_bf16 v[180:183], v[76:79], a[4:7], v[180:183]
    ds_read_b64_tr_b16 v[92:93], v5 offset:4096
    v_mfma_f32_16x16x32_bf16 v[184:187], v[76:79], a[8:11], v[184:187]
    buffer_load_dwordx4 a[56:59], v14, s[8:11], s35 offen sc1
    v_mfma_f32_16x16x32_bf16 v[188:191], v[76:79], a[12:15], v[188:191]
    s_waitcnt vmcnt(18) lgkmcnt(3)
    ds_read_b64_tr_b16 v[94:95], v5 offset:6144
    buffer_load_dwordx4 a[60:63], v15, s[8:11], s35 offen sc1
    s_add_u32 s35, s35, 1024
    s_and_b32 s35, s35, 32767
    v_mfma_f32_16x16x32_bf16 v[128:131], v[80:83], a[16:19], v[128:131]
    s_waitcnt vmcnt(18)
    s_add_u32 m0, s34, 0
    v_mfma_f32_16x16x32_bf16 v[132:135], v[80:83], a[20:23], v[132:135]
    s_waitcnt vmcnt(17)
    ds_read_b64_tr_b16 v[64:65], v2 offset:8192
    v_mfma_f32_16x16x32_bf16 v[136:139], v[80:83], a[24:27], v[136:139]
    s_waitcnt vmcnt(16)
    buffer_load_dwordx4 v6, s[16:19], s36 offen lds
    v_mfma_f32_16x16x32_bf16 v[140:143], v[80:83], a[28:31], v[140:143]
    ds_read_b64_tr_b16 v[66:67], v2 offset:10240
    v_mfma_f32_16x16x32_bf16 v[144:147], v[84:87], a[16:19], v[144:147]
    buffer_load_dwordx4 v7, s[16:19], s36 offen offset:1024 lds
    v_mfma_f32_16x16x32_bf16 v[148:151], v[84:87], a[20:23], v[148:151]
    ds_read_b64_tr_b16 v[68:69], v3 offset:8192
    v_mfma_f32_16x16x32_bf16 v[152:155], v[84:87], a[24:27], v[152:155]
    buffer_load_dwordx4 v8, s[16:19], s36 offen offset:2048 lds
    v_mfma_f32_16x16x32_bf16 v[156:159], v[84:87], a[28:31], v[156:159]
    s_waitcnt lgkmcnt(3)
    ds_read_b64_tr_b16 v[70:71], v3 offset:10240
    v_mfma_f32_16x16x32_bf16 v[160:163], v[88:91], a[16:19], v[160:163]
    buffer_load_dwordx4 v9, s[16:19], s36 offen offset:3072 lds
    v_mfma_f32_16x16x32_bf16 v[164:167], v[88:91], a[20:23], v[164:167]
    s_add_u32 s36, s36, s42
    s_and_b32 s36, s36, s37
    ds_read_b64_tr_b16 v[72:73], v4 offset:8192
    v_mfma_f32_16x16x32_bf16 v[168:171], v[88:91], a[24:27], v[168:171]
    buffer_load_dwordx4 a[64:67], v12, s[8:11], s35 offen sc1
    v_mfma_f32_16x16x32_bf16 v[172:175], v[88:91], a[28:31], v[172:175]
    ds_read_b64_tr_b16 v[74:75], v4 offset:10240
    v_mfma_f32_16x16x32_bf16 v[176:179], v[92:95], a[16:19], v[176:179]
    buffer_load_dwordx4 a[68:71], v13, s[8:11], s35 offen sc1
    v_mfma_f32_16x16x32_bf16 v[180:183], v[92:95], a[20:23], v[180:183]
    ds_read_b64_tr_b16 v[76:77], v5 offset:8192
    v_mfma_f32_16x16x32_bf16 v[184:187], v[92:95], a[24:27], v[184:187]
    buffer_load_dwordx4 a[72:75], v14, s[8:11], s35 offen sc1
    v_mfma_f32_16x16x32_bf16 v[188:191], v[92:95], a[28:31], v[188:191]
    s_waitcnt vmcnt(18) lgkmcnt(3)
    ds_read_b64_tr_b16 v[78:79], v5 offset:10240
    buffer_load_dwordx4 a[76:79], v15, s[8:11], s35 offen sc1
    s_add_u32 s35, s35, 1024
    s_and_b32 s35, s35, 32767
    v_mfma_f32_16x16x32_bf16 v[128:131], v[64:67], a[32:35], v[128:131]
    s_waitcnt vmcnt(18)
    s_add_u32 m0, s34, 4096
    v_mfma_f32_16x16x32_bf16 v[132:135], v[64:67], a[36:39], v[132:135]
    s_waitcnt vmcnt(17)
    ds_read_b64_tr_b16 v[80:81], v2 offset:12288
    v_mfma_f32_16x16x32_bf16 v[136:139], v[64:67], a[40:43], v[136:139]
    s_waitcnt vmcnt(16)
    buffer_load_dwordx4 v6, s[16:19], s36 offen lds
    v_mfma_f32_16x16x32_bf16 v[140:143], v[64:67], a[44:47], v[140:143]
    ds_read_b64_tr_b16 v[82:83], v2 offset:14336
    v_mfma_f32_16x16x32_bf16 v[144:147], v[68:71], a[32:35], v[144:147]
    buffer_load_dwordx4 v7, s[16:19], s36 offen offset:1024 lds
    v_mfma_f32_16x16x32_bf16 v[148:151], v[68:71], a[36:39], v[148:151]
    ds_read_b64_tr_b16 v[84:85], v3 offset:12288
    v_mfma_f32_16x16x32_bf16 v[152:155], v[68:71], a[40:43], v[152:155]
    buffer_load_dwordx4 v8, s[16:19], s36 offen offset:2048 lds
    v_mfma_f32_16x16x32_bf16 v[156:159], v[68:71], a[44:47], v[156:159]
    s_waitcnt lgkmcnt(3)
    ds_read_b64_tr_b16 v[86:87], v3 offset:14336
    v_mfma_f32_16x16x32_bf16 v[160:163], v[72:75], a[32:35], v[160:163]
    buffer_load_dwordx4 v9, s[16:19], s36 offen offset:3072 lds
    v_mfma_f32_16x16x32_bf16 v[164:167], v[72:75], a[36:39], v[164:167]
    s_add_u32 s36, s36, s42
    s_and_b32 s36, s36, s37
    ds_read_b64_tr_b16 v[88:89], v4 offset:12288
    v_mfma_f32_16x16x32_bf16 v[168:171], v[72:75], a[40:43], v[168:171]
    buffer_load_dwordx4 a[80:83], v12, s[8:11], s35 offen sc1
    v_mfma_f32_16x16x32_bf16 v[172:175], v[72:75], a[44:47], v[172:175]
    ds_read_b64_tr_b16 v[90:91], v4 offset:14336
    v_mfma_f32_16x16x32_bf16 v[176:179], v[76:79], a[32:35], v[176:179]
    buffer_load_dwordx4 a[84:87], v13, s[8:11], s35 offen sc1
    v_mfma_f32_16x16x32_bf16 v[180:183], v[76:79], a[36:39], v[180:183]
    ds_read_b64_tr_b16 v[92:93], v5 offset:12288
    v_mfma_f32_16x16x32_bf16 v[184:187], v[76:79], a[40:43], v[184:187]
    buffer_load_dwordx4 a[88:91], v14, s[8:11], s35 offen sc1
    v_mfma_f32_16x16x32_bf16 v[188:191], v[76:79], a[44:47], v[188:191]
    s_waitcnt vmcnt(18) lgkmcnt(3)
    ds_read_b64_tr_b16 v[94:95], v5 offset:14336
    buffer_load_dwordx4 a[92:95], v15, s[8:11], s35 offen sc1
    s_add_u32 s35, s35, 1024
    s_and_b32 s35, s35, 32767
    v_mfma_f32_16x16x32_bf16 v[128:131], v[80:83], a[48:51], v[128:131]
    s_waitcnt vmcnt(18)
    s_add_u32 m0, s34, 8192
    v_mfma_f32_16x16x32_bf16 v[132:135], v[80:83], a[52:55], v[132:135]
    s_waitcnt vmcnt(17)
    ds_read_b64_tr_b16 v[64:65], v2 offset:16384
    v_mfma_f32_16x16x32_bf16 v[136:139], v[80:83], a[56:59], v[136:139]
    s_waitcnt vmcnt(16)
    buffer_load_dwordx4 v6, s[16:19], s36 offen lds
    v_mfma_f32_16x16x32_bf16 v[140:143], v[80:83], a[60:63], v[140:143]
    ds_read_b64_tr_b16 v[66:67], v2 offset:18432
    v_mfma_f32_16x16x32_bf16 v[144:147], v[84:87], a[48:51], v[144:147]
    buffer_load_dwordx4 v7, s[16:19], s36 offen offset:1024 lds
    v_mfma_f32_16x16x32_bf16 v[148:151], v[84:87], a[52:55], v[148:151]
    ds_read_b64_tr_b16 v[68:69], v3 offset:16384
    v_mfma_f32_16x16x32_bf16 v[152:155], v[84:87], a[56:59], v[152:155]
    buffer_load_dwordx4 v8, s[16:19], s36 offen offset:2048 lds
    v_mfma_f32_16x16x32_bf16 v[156:159], v[84:87], a[60:63], v[156:159]
    s_waitcnt lgkmcnt(3)
    ds_read_b64_tr_b16 v[70:71], v3 offset:18432
    v_mfma_f32_16x16x32_bf16 v[160:163], v[88:91], a[48:51], v[160:163]
    buffer_load_dwordx4 v9, s[16:19], s36 offen offset:3072 lds
    v_mfma_f32_16x16x32_bf16 v[164:167], v[88:91], a[52:55], v[164:167]
    s_add_u32 s36, s36, s42
    s_and_b32 s36, s36, s37
    ds_read_b64_tr_b16 v[72:73], v4 offset:16384
    v_mfma_f32_16x16x32_bf16 v[168:171], v[88:91], a[56:59], v[168:171]
    buffer_load_dwordx4 a[96:99], v12, s[8:11], s35 offen sc1
    v_mfma_f32_16x16x32_bf16 v[172:175], v[88:91], a[60:63], v[172:175]
    ds_read_b64_tr_b16 v[74:75], v4 offset:18432
    v_mfma_f32_16x16x32_bf16 v[176:179], v[92:95], a[48:51], v[176:179]
    buffer_load_dwordx4 a[100:103], v13, s[8:11], s35 offen sc1
    v_mfma_f32_16x16x32_bf16 v[180:183], v[92:95], a[52:55], v[180:183]
    ds_read_b64_tr_b16 v[76:77], v5 offset:16384
    v_mfma_f32_16x16x32_bf16 v[184:187], v[92:95], a[56:59], v[184:187]
    buffer_load_dwordx4 a[104:107], v14, s[8:11], s35 offen sc1
    v_mfma_f32_16x16x32_bf16 v[188:191], v[92:95], a[60:63], v[188:191]
    s_waitcnt vmcnt(18) lgkmcnt(3)
    ds_read_b64_tr_b16 v[78:79], v5 offset:18432
    buffer_load_dwordx4 a[108:111], v15, s[8:11], s35 offen sc1
    s_add_u32 s35, s35, 1024
    s_and_b32 s35, s35, 32767
    v_mfma_f32_16x16x32_bf16 v[128:131], v[64:67], a[64:67], v[128:131]
    s_waitcnt vmcnt(18)
    s_add_u32 m0, s34, 12288
    v_mfma_f32_16x16x32_bf16 v[132:135], v[64:67], a[68:71], v[132:135]
    s_waitcnt vmcnt(17)
    ds_read_b64_tr_b16 v[80:81], v2 offset:20480
    v_mfma_f32_16x16x32_bf16 v[136:139], v[64:67], a[72:75], v[136:139]
    s_waitcnt vmcnt(16)
    buffer_load_dwordx4 v6, s[16:19], s36 offen lds
    v_mfma_f32_16x16x32_bf16 v[140:143], v[64:67], a[76:79], v[140:143]
    ds_read_b64_tr_b16 v[82:83], v2 offset:22528
    v_mfma_f32_16x16x32_bf16 v[144:147], v[68:71], a[64:67], v[144:147]
    buffer_load_dwordx4 v7, s[16:19], s36 offen offset:1024 lds
    v_mfma_f32_16x16x32_bf16 v[148:151], v[68:71], a[68:71], v[148:151]
    ds_read_b64_tr_b16 v[84:85], v3 offset:20480
    v_mfma_f32_16x16x32_bf16 v[152:155], v[68:71], a[72:75], v[152:155]
    buffer_load_dwordx4 v8, s[16:19], s36 offen offset:2048 lds
    v_mfma_f32_16x16x32_bf16 v[156:159], v[68:71], a[76:79], v[156:159]
    s_waitcnt lgkmcnt(3)
    ds_read_b64_tr_b16 v[86:87], v3 offset:22528
    v_mfma_f32_16x16x32_bf16 v[160:163], v[72:75], a[64:67], v[160:163]
    buffer_load_dwordx4 v9, s[16:19], s36 offen offset:3072 lds
    v_mfma_f32_16x16x32_bf16 v[164:167], v[72:75], a[68:71], v[164:167]
    s_add_u32 s36, s36, s42
    s_and_b32 s36, s36, s37
    ds_read_b64_tr_b16 v[88:89], v4 offset:20480
    v_mfma_f32_16x16x32_bf16 v[168:171], v[72:75], a[72:75], v[168:171]
    buffer_load_dwordx4 a[112:115], v12, s[8:11], s35 offen sc1
    v_mfma_f32_16x16x32_bf16 v[172:175], v[72:75], a[76:79], v[172:175]
    ds_read_b64_tr_b16 v[90:91], v4 offset:22528
    v_mfma_f32_16x16x32_bf16 v[176:179], v[76:79], a[64:67], v[176:179]
    buffer_load_dwordx4 a[116:119], v13, s[8:11], s35 offen sc1
    v_mfma_f32_16x16x32_bf16 v[180:183], v[76:79], a[68:71], v[180:183]
    ds_read_b64_tr_b16 v[92:93], v5 offset:20480
    v_mfma_f32_16x16x32_bf16 v[184:187], v[76:79], a[72:75], v[184:187]
    buffer_load_dwordx4 a[120:123], v14, s[8:11], s35 offen sc1
    v_mfma_f32_16x16x32_bf16 v[188:191], v[76:79], a[76:79], v[188:191]
    s_waitcnt vmcnt(18) lgkmcnt(3)
    ds_read_b64_tr_b16 v[94:95], v5 offset:22528
    buffer_load_dwordx4 a[124:127], v15, s[8:11], s35 offen sc1
    s_add_u32 s35, s35, 1024
    s_and_b32 s35, s35, 32767
    v_mfma_f32_16x16x32_bf16 v[128:131], v[80:83], a[80:83], v[128:131]
    s_waitcnt vmcnt(18)
    s_add_u32 m0, s34, 16384
    v_mfma_f32_16x16x32_bf16 v[132:135], v[80:83], a[84:87], v[132:135]
    s_waitcnt vmcnt(17)
    ds_read_b64_tr_b16 v[64:65], v2 offset:24576
    v_mfma_f32_16x16x32_bf16 v[136:139], v[80:83], a[88:91], v[136:139]
    s_waitcnt vmcnt(16)
    buffer_load_dwordx4 v6, s[16:19], s36 offen lds
    v_mfma_f32_16x16x32_bf16 v[140:143], v[80:83], a[92:95], v[140:143]
    ds_read_b64_tr_b16 v[66:67], v2 offset:26624
    v_mfma_f32_16x16x32_bf16 v[144:147], v[84:87], a[80:83], v[144:147]
    buffer_load_dwordx4 v7, s[16:19], s36 offen offset:1024 lds
    v_mfma_f32_16x16x32_bf16 v[148:151], v[84:87], a[84:87], v[148:151]
    ds_read_b64_tr_b16 v[68:69], v3 offset:24576
    v_mfma_f32_16x16x32_bf16 v[152:155], v[84:87], a[88:91], v[152:155]
    buffer_load_dwordx4 v8, s[16:19], s36 offen offset:2048 lds
    v_mfma_f32_16x16x32_bf16 v[156:159], v[84:87], a[92:95], v[156:159]
    s_waitcnt lgkmcnt(3)
    ds_read_b64_tr_b16 v[70:71], v3 offset:26624
    v_mfma_f32_16x16x32_bf16 v[160:163], v[88:91], a[80:83], v[160:163]
    buffer_load_dwordx4 v9, s[16:19], s36 offen offset:3072 lds
    v_mfma_f32_16x16x32_bf16 v[164:167], v[88:91], a[84:87], v[164:167]
    s_add_u32 s36, s36, s42
    s_and_b32 s36, s36, s37
    ds_read_b64_tr_b16 v[72:73], v4 offset:24576
    v_mfma_f32_16x16x32_bf16 v[168:171], v[88:91], a[88:91], v[168:171]
    buffer_load_dwordx4 a[0:3], v12, s[8:11], s35 offen sc1
    v_mfma_f32_16x16x32_bf16 v[172:175], v[88:91], a[92:95], v[172:175]
    ds_read_b64_tr_b16 v[74:75], v4 offset:26624
    v_mfma_f32_16x16x32_bf16 v[176:179], v[92:95], a[80:83], v[176:179]
    buffer_load_dwordx4 a[4:7], v13, s[8:11], s35 offen sc1
    v_mfma_f32_16x16x32_bf16 v[180:183], v[92:95], a[84:87], v[180:183]
    ds_read_b64_tr_b16 v[76:77], v5 offset:24576
    v_mfma_f32_16x16x32_bf16 v[184:187], v[92:95], a[88:91], v[184:187]
    buffer_load_dwordx4 a[8:11], v14, s[8:11], s35 offen sc1
    v_mfma_f32_16x16x32_bf16 v[188:191], v[92:95], a[92:95], v[188:191]
    s_waitcnt vmcnt(18) lgkmcnt(3)
    ds_read_b64_tr_b16 v[78:79], v5 offset:26624
    buffer_load_dwordx4 a[12:15], v15, s[8:11], s35 offen sc1
    s_add_u32 s35, s35, 1024
    s_and_b32 s35, s35, 32767
    v_mfma_f32_16x16x32_bf16 v[128:131], v[64:67], a[96:99], v[128:131]
    s_waitcnt vmcnt(18)
    s_add_u32 m0, s34, 20480
    v_mfma_f32_16x16x32_bf16 v[132:135], v[64:67], a[100:103], v[132:135]
    s_waitcnt vmcnt(17)
    ds_read_b64_tr_b16 v[80:81], v2 offset:28672
    v_mfma_f32_16x16x32_bf16 v[136:139], v[64:67], a[104:107], v[136:139]
    s_waitcnt vmcnt(16)
    buffer_load_dwordx4 v6, s[16:19], s36 offen lds
    v_mfma_f32_16x16x32_bf16 v[140:143], v[64:67], a[108:111], v[140:143]
    ds_read_b64_tr_b16 v[82:83], v2 offset:30720
    v_mfma_f32_16x16x32_bf16 v[144:147], v[68:71], a[96:99], v[144:147]
    buffer_load_dwordx4 v7, s[16:19], s36 offen offset:1024 lds
    v_mfma_f32_16x16x32_bf16 v[148:151], v[68:71], a[100:103], v[148:151]
    ds_read_b64_tr_b16 v[84:85], v3 offset:28672
    v_mfma_f32_16x16x32_bf16 v[152:155], v[68:71], a[104:107], v[152:155]
    buffer_load_dwordx4 v8, s[16:19], s36 offen offset:2048 lds
    v_mfma_f32_16x16x32_bf16 v[156:159], v[68:71], a[108:111], v[156:159]
    s_waitcnt lgkmcnt(3)
    ds_read_b64_tr_b16 v[86:87], v3 offset:30720
    v_mfma_f32_16x16x32_bf16 v[160:163], v[72:75], a[96:99], v[160:163]
    buffer_load_dwordx4 v9, s[16:19], s36 offen offset:3072 lds
    v_mfma_f32_16x16x32_bf16 v[164:167], v[72:75], a[100:103], v[164:167]
    s_add_u32 s36, s36, s42
    s_and_b32 s36, s36, s37
    ds_read_b64_tr_b16 v[88:89], v4 offset:28672
    v_mfma_f32_16x16x32_bf16 v[168:171], v[72:75], a[104:107], v[168:171]
    buffer_load_dwordx4 a[16:19], v12, s[8:11], s35 offen sc1
    v_mfma_f32_16x16x32_bf16 v[172:175], v[72:75], a[108:111], v[172:175]
    ds_read_b64_tr_b16 v[90:91], v4 offset:30720
    v_mfma_f32_16x16x32_bf16 v[176:179], v[76:79], a[96:99], v[176:179]
    buffer_load_dwordx4 a[20:23], v13, s[8:11], s35 offen sc1
    v_mfma_f32_16x16x32_bf16 v[180:183], v[76:79], a[100:103], v[180:183]
    ds_read_b64_tr_b16 v[92:93], v5 offset:28672
    v_mfma_f32_16x16x32_bf16 v[184:187], v[76:79], a[104:107], v[184:187]
    buffer_load_dwordx4 a[24:27], v14, s[8:11], s35 offen sc1
    v_mfma_f32_16x16x32_bf16 v[188:191], v[76:79], a[108:111], v[188:191]
    s_waitcnt vmcnt(18) lgkmcnt(3)
    ds_read_b64_tr_b16 v[94:95], v5 offset:30720
    buffer_load_dwordx4 a[28:31], v15, s[8:11], s35 offen sc1
    s_add_u32 s35, s35, 1024
    s_and_b32 s35, s35, 32767
    v_mfma_f32_16x16x32_bf16 v[128:131], v[80:83], a[112:115], v[128:131]
    s_waitcnt vmcnt(18)
    s_add_u32 m0, s34, 24576
    v_mfma_f32_16x16x32_bf16 v[132:135], v[80:83], a[116:119], v[132:135]
    s_waitcnt vmcnt(17)
    ds_read_b64_tr_b16 v[64:65], v2
    v_mfma_f32_16x16x32_bf16 v[136:139], v[80:83], a[120:123], v[136:139]
    s_waitcnt vmcnt(16)
    buffer_load_dwordx4 v6, s[16:19], s36 offen lds
    v_mfma_f32_16x16x32_bf16 v[140:143], v[80:83], a[124:127], v[140:143]
    ds_read_b64_tr_b16 v[66:67], v2 offset:2048
    v_mfma_f32_16x16x32_bf16 v[144:147], v[84:87], a[112:115], v[144:147]
    buffer_load_dwordx4 v7, s[16:19], s36 offen offset:1024 lds
    v_mfma_f32_16x16x32_bf16 v[148:151], v[84:87], a[116:119], v[148:151]
    ds_read_b64_tr_b16 v[68:69], v3
    v_mfma_f32_16x16x32_bf16 v[152:155], v[84:87], a[120:123], v[152:155]
    buffer_load_dwordx4 v8, s[16:19], s36 offen offset:2048 lds
    v_mfma_f32_16x16x32_bf16 v[156:159], v[84:87], a[124:127], v[156:159]
    s_waitcnt lgkmcnt(3)
    ds_read_b64_tr_b16 v[70:71], v3 offset:2048
    v_mfma_f32_16x16x32_bf16 v[160:163], v[88:91], a[112:115], v[160:163]
    buffer_load_dwordx4 v9, s[16:19], s36 offen offset:3072 lds
    v_mfma_f32_16x16x32_bf16 v[164:167], v[88:91], a[116:119], v[164:167]
    s_add_u32 s36, s36, s42
    s_and_b32 s36, s36, s37
    ds_read_b64_tr_b16 v[72:73], v4
    v_mfma_f32_16x16x32_bf16 v[168:171], v[88:91], a[120:123], v[168:171]
    buffer_load_dwordx4 a[32:35], v12, s[8:11], s35 offen sc1
    v_mfma_f32_16x16x32_bf16 v[172:175], v[88:91], a[124:127], v[172:175]
    ds_read_b64_tr_b16 v[74:75], v4 offset:2048
    v_mfma_f32_16x16x32_bf16 v[176:179], v[92:95], a[112:115], v[176:179]
    buffer_load_dwordx4 a[36:39], v13, s[8:11], s35 offen sc1
    v_mfma_f32_16x16x32_bf16 v[180:183], v[92:95], a[116:119], v[180:183]
    ds_read_b64_tr_b16 v[76:77], v5
    v_mfma_f32_16x16x32_bf16 v[184:187], v[92:95], a[120:123], v[184:187]
    buffer_load_dwordx4 a[40:43], v14, s[8:11], s35 offen sc1
    v_mfma_f32_16x16x32_bf16 v[188:191], v[92:95], a[124:127], v[188:191]
    s_waitcnt vmcnt(18) lgkmcnt(3)
    ds_read_b64_tr_b16 v[78:79], v5 offset:2048
    buffer_load_dwordx4 a[44:47], v15, s[8:11], s35 offen sc1
    s_add_u32 s35, s35, 1024
    s_and_b32 s35, s35, 32767
    v_mfma_f32_16x16x32_bf16 v[128:131], v[64:67], a[0:3], v[128:131]
    s_waitcnt vmcnt(18)
    s_add_u32 m0, s34, 28672
    v_mfma_f32_16x16x32_bf16 v[132:135], v[64:67], a[4:7], v[132:135]
    s_waitcnt vmcnt(17)
    ds_read_b64_tr_b16 v[80:81], v2 offset:4096
    v_mfma_f32_16x16x32_bf16 v[136:139], v[64:67], a[8:11], v[136:139]
    s_waitcnt vmcnt(16)
    buffer_load_dwordx4 v6, s[16:19], s36 offen lds
    v_mfma_f32_16x16x32_bf16 v[140:143], v[64:67], a[12:15], v[140:143]
    ds_read_b64_tr_b16 v[82:83], v2 offset:6144
    v_mfma_f32_16x16x32_bf16 v[144:147], v[68:71], a[0:3], v[144:147]
    buffer_load_dwordx4 v7, s[16:19], s36 offen offset:1024 lds
    v_mfma_f32_16x16x32_bf16 v[148:151], v[68:71], a[4:7], v[148:151]
    ds_read_b64_tr_b16 v[84:85], v3 offset:4096
    v_mfma_f32_16x16x32_bf16 v[152:155], v[68:71], a[8:11], v[152:155]
    buffer_load_dwordx4 v8, s[16:19], s36 offen offset:2048 lds
    v_mfma_f32_16x16x32_bf16 v[156:159], v[68:71], a[12:15], v[156:159]
    s_waitcnt lgkmcnt(3)
    ds_read_b64_tr_b16 v[86:87], v3 offset:6144
    v_mfma_f32_16x16x32_bf16 v[160:163], v[72:75], a[0:3], v[160:163]
    buffer_load_dwordx4 v9, s[16:19], s36 offen offset:3072 lds
    v_mfma_f32_16x16x32_bf16 v[164:167], v[72:75], a[4:7], v[164:167]
    s_add_u32 s36, s36, s42
    s_and_b32 s36, s36, s37
    ds_read_b64_tr_b16 v[88:89], v4 offset:4096
    v_mfma_f32_16x16x32_bf16 v[168:171], v[72:75], a[8:11], v[168:171]
    buffer_load_dwordx4 a[48:51], v12, s[8:11], s35 offen sc1
    v_mfma_f32_16x16x32_bf16 v[172:175], v[72:75], a[12:15], v[172:175]
    ds_read_b64_tr_b16 v[90:91], v4 offset:6144
    v_mfma_f32_16x16x32_bf16 v[176:179], v[76:79], a[0:3], v[176:179]
    buffer_load_dwordx4 a[52:55], v13, s[8:11], s35 offen sc1
    v_mfma_f32_16x16x32_bf16 v[180:183], v[76:79], a[4:7], v[180:183]
    ds_read_b64_tr_b16 v[92:93], v5 offset:4096
    v_mfma_f32_16x16x32_bf16 v[184:187], v[76:79], a[8:11], v[184:187]
    buffer_load_dwordx4 a[56:59], v14, s[8:11], s35 offen sc1
    v_mfma_f32_16x16x32_bf16 v[188:191], v[76:79], a[12:15], v[188:191]
    s_waitcnt vmcnt(18) lgkmcnt(3)
    ds_read_b64_tr_b16 v[94:95], v5 offset:6144
    buffer_load_dwordx4 a[60:63], v15, s[8:11], s35 offen sc1
    s_add_u32 s35, s35, 1024
    s_and_b32 s35, s35, 32767
    v_mfma_f32_16x16x32_bf16 v[128:131], v[80:83], a[16:19], v[128:131]
    s_waitcnt vmcnt(18)
    v_mfma_f32_16x16x32_bf16 v[132:135], v[80:83], a[20:23], v[132:135]
    s_waitcnt vmcnt(17)
    ds_read_b64_tr_b16 v[64:65], v2 offset:8192
    v_mfma_f32_16x16x32_bf16 v[136:139], v[80:83], a[24:27], v[136:139]
    s_waitcnt vmcnt(16)
    v_mfma_f32_16x16x32_bf16 v[140:143], v[80:83], a[28:31], v[140:143]
    ds_read_b64_tr_b16 v[66:67], v2 offset:10240
    v_mfma_f32_16x16x32_bf16 v[144:147], v[84:87], a[16:19], v[144:147]
    v_mfma_f32_16x16x32_bf16 v[148:151], v[84:87], a[20:23], v[148:151]
    ds_read_b64_tr_b16 v[68:69], v3 offset:8192
    v_mfma_f32_16x16x32_bf16 v[152:155], v[84:87], a[24:27], v[152:155]
    v_mfma_f32_16x16x32_bf16 v[156:159], v[84:87], a[28:31], v[156:159]
    s_waitcnt lgkmcnt(3)
    ds_read_b64_tr_b16 v[70:71], v3 offset:10240
    v_mfma_f32_16x16x32_bf16 v[160:163], v[88:91], a[16:19], v[160:163]
    v_mfma_f32_16x16x32_bf16 v[164:167], v[88:91], a[20:23], v[164:167]
    ds_read_b64_tr_b16 v[72:73], v4 offset:8192
    v_mfma_f32_16x16x32_bf16 v[168:171], v[88:91], a[24:27], v[168:171]
    buffer_load_dwordx4 a[64:67], v12, s[8:11], s35 offen sc1
    v_mfma_f32_16x16x32_bf16 v[172:175], v[88:91], a[28:31], v[172:175]
    ds_read_b64_tr_b16 v[74:75], v4 offset:10240
    v_mfma_f32_16x16x32_bf16 v[176:179], v[92:95], a[16:19], v[176:179]
    buffer_load_dwordx4 a[68:71], v13, s[8:11], s35 offen sc1
    v_mfma_f32_16x16x32_bf16 v[180:183], v[92:95], a[20:23], v[180:183]
    ds_read_b64_tr_b16 v[76:77], v5 offset:8192
    v_mfma_f32_16x16x32_bf16 v[184:187], v[92:95], a[24:27], v[184:187]
    buffer_load_dwordx4 a[72:75], v14, s[8:11], s35 offen sc1
    v_mfma_f32_16x16x32_bf16 v[188:191], v[92:95], a[28:31], v[188:191]
    s_waitcnt vmcnt(14) lgkmcnt(3)
    ds_read_b64_tr_b16 v[78:79], v5 offset:10240
    buffer_load_dwordx4 a[76:79], v15, s[8:11], s35 offen sc1
    s_add_u32 s35, s35, 1024
    s_and_b32 s35, s35, 32767
    v_mfma_f32_16x16x32_bf16 v[128:131], v[64:67], a[32:35], v[128:131]
    s_waitcnt vmcnt(14)
    v_mfma_f32_16x16x32_bf16 v[132:135], v[64:67], a[36:39], v[132:135]
    s_waitcnt vmcnt(13)
    ds_read_b64_tr_b16 v[80:81], v2 offset:12288
    v_mfma_f32_16x16x32_bf16 v[136:139], v[64:67], a[40:43], v[136:139]
    s_waitcnt vmcnt(12)
    v_mfma_f32_16x16x32_bf16 v[140:143], v[64:67], a[44:47], v[140:143]
    ds_read_b64_tr_b16 v[82:83], v2 offset:14336
    v_mfma_f32_16x16x32_bf16 v[144:147], v[68:71], a[32:35], v[144:147]
    v_mfma_f32_16x16x32_bf16 v[148:151], v[68:71], a[36:39], v[148:151]
    ds_read_b64_tr_b16 v[84:85], v3 offset:12288
    v_mfma_f32_16x16x32_bf16 v[152:155], v[68:71], a[40:43], v[152:155]
    v_mfma_f32_16x16x32_bf16 v[156:159], v[68:71], a[44:47], v[156:159]
    s_waitcnt lgkmcnt(3)
    ds_read_b64_tr_b16 v[86:87], v3 offset:14336
    v_mfma_f32_16x16x32_bf16 v[160:163], v[72:75], a[32:35], v[160:163]
    v_mfma_f32_16x16x32_bf16 v[164:167], v[72:75], a[36:39], v[164:167]
    ds_read_b64_tr_b16 v[88:89], v4 offset:12288
    v_mfma_f32_16x16x32_bf16 v[168:171], v[72:75], a[40:43], v[168:171]
    buffer_load_dwordx4 a[80:83], v12, s[8:11], s35 offen sc1
    v_mfma_f32_16x16x32_bf16 v[172:175], v[72:75], a[44:47], v[172:175]
    ds_read_b64_tr_b16 v[90:91], v4 offset:14336
    v_mfma_f32_16x16x32_bf16 v[176:179], v[76:79], a[32:35], v[176:179]
    buffer_load_dwordx4 a[84:87], v13, s[8:11], s35 offen sc1
    v_mfma_f32_16x16x32_bf16 v[180:183], v[76:79], a[36:39], v[180:183]
    ds_read_b64_tr_b16 v[92:93], v5 offset:12288
    v_mfma_f32_16x16x32_bf16 v[184:187], v[76:79], a[40:43], v[184:187]
    buffer_load_dwordx4 a[88:91], v14, s[8:11], s35 offen sc1
    v_mfma_f32_16x16x32_bf16 v[188:191], v[76:79], a[44:47], v[188:191]
    s_waitcnt vmcnt(10) lgkmcnt(3)
    ds_read_b64_tr_b16 v[94:95], v5 offset:14336
    buffer_load_dwordx4 a[92:95], v15, s[8:11], s35 offen sc1
    s_add_u32 s35, s35, 1024
    s_and_b32 s35, s35, 32767
    v_mfma_f32_16x16x32_bf16 v[128:131], v[80:83], a[48:51], v[128:131]
    s_waitcnt vmcnt(10)
    v_mfma_f32_16x16x32_bf16 v[132:135], v[80:83], a[52:55], v[132:135]
    s_waitcnt vmcnt(9)
    ds_read_b64_tr_b16 v[64:65], v2 offset:16384
    v_mfma_f32_16x16x32_bf16 v[136:139], v[80:83], a[56:59], v[136:139]
    s_waitcnt vmcnt(8)
    v_mfma_f32_16x16x32_bf16 v[140:143], v[80:83], a[60:63], v[140:143]
    ds_read_b64_tr_b16 v[66:67], v2 offset:18432
    v_mfma_f32_16x16x32_bf16 v[144:147], v[84:87], a[48:51], v[144:147]
    v_mfma_f32_16x16x32_bf16 v[148:151], v[84:87], a[52:55], v[148:151]
    ds_read_b64_tr_b16 v[68:69], v3 offset:16384
    v_mfma_f32_16x16x32_bf16 v[152:155], v[84:87], a[56:59], v[152:155]
    v_mfma_f32_16x16x32_bf16 v[156:159], v[84:87], a[60:63], v[156:159]
    s_waitcnt lgkmcnt(3)
    ds_read_b64_tr_b16 v[70:71], v3 offset:18432
    v_mfma_f32_16x16x32_bf16 v[160:163], v[88:91], a[48:51], v[160:163]
    v_mfma_f32_16x16x32_bf16 v[164:167], v[88:91], a[52:55], v[164:167]
    ds_read_b64_tr_b16 v[72:73], v4 offset:16384
    v_mfma_f32_16x16x32_bf16 v[168:171], v[88:91], a[56:59], v[168:171]
    buffer_load_dwordx4 a[96:99], v12, s[8:11], s35 offen sc1
    v_mfma_f32_16x16x32_bf16 v[172:175], v[88:91], a[60:63], v[172:175]
    ds_read_b64_tr_b16 v[74:75], v4 offset:18432
    v_mfma_f32_16x16x32_bf16 v[176:179], v[92:95], a[48:51], v[176:179]
    buffer_load_dwordx4 a[100:103], v13, s[8:11], s35 offen sc1
    v_mfma_f32_16x16x32_bf16 v[180:183], v[92:95], a[52:55], v[180:183]
    ds_read_b64_tr_b16 v[76:77], v5 offset:16384
    v_mfma_f32_16x16x32_bf16 v[184:187], v[92:95], a[56:59], v[184:187]
    buffer_load_dwordx4 a[104:107], v14, s[8:11], s35 offen sc1
    v_mfma_f32_16x16x32_bf16 v[188:191], v[92:95], a[60:63], v[188:191]
    s_waitcnt vmcnt(10) lgkmcnt(3)
    ds_read_b64_tr_b16 v[78:79], v5 offset:18432
    buffer_load_dwordx4 a[108:111], v15, s[8:11], s35 offen sc1
    s_add_u32 s35, s35, 1024
    s_and_b32 s35, s35, 32767
    v_mfma_f32_16x16x32_bf16 v[128:131], v[64:67], a[64:67], v[128:131]
    s_waitcnt vmcnt(10)
    v_mfma_f32_16x16x32_bf16 v[132:135], v[64:67], a[68:71], v[132:135]
    s_waitcnt vmcnt(9)
    ds_read_b64_tr_b16 v[80:81], v2 offset:20480
    v_mfma_f32_16x16x32_bf16 v[136:139], v[64:67], a[72:75], v[136:139]
    s_waitcnt vmcnt(8)
    v_mfma_f32_16x16x32_bf16 v[140:143], v[64:67], a[76:79], v[140:143]
    ds_read_b64_tr_b16 v[82:83], v2 offset:22528
    v_mfma_f32_16x16x32_bf16 v[144:147], v[68:71], a[64:67], v[144:147]
    v_mfma_f32_16x16x32_bf16 v[148:151], v[68:71], a[68:71], v[148:151]
    ds_read_b64_tr_b16 v[84:85], v3 offset:20480
    v_mfma_f32_16x16x32_bf16 v[152:155], v[68:71], a[72:75], v[152:155]
    v_mfma_f32_16x16x32_bf16 v[156:159], v[68:71], a[76:79], v[156:159]
    s_waitcnt lgkmcnt(3)
    ds_read_b64_tr_b16 v[86:87], v3 offset:22528
    v_mfma_f32_16x16x32_bf16 v[160:163], v[72:75], a[64:67], v[160:163]
    v_mfma_f32_16x16x32_bf16 v[164:167], v[72:75], a[68:71], v[164:167]
    ds_read_b64_tr_b16 v[88:89], v4 offset:20480
    v_mfma_f32_16x16x32_bf16 v[168:171], v[72:75], a[72:75], v[168:171]
    buffer_load_dwordx4 a[112:115], v12, s[8:11], s35 offen sc1
    v_mfma_f32_16x16x32_bf16 v[172:175], v[72:75], a[76:79], v[172:175]
    ds_read_b64_tr_b16 v[90:91], v4 offset:22528
    v_mfma_f32_16x16x32_bf16 v[176:179], v[76:79], a[64:67], v[176:179]
    buffer_load_dwordx4 a[116:119], v13, s[8:11], s35 offen sc1
    v_mfma_f32_16x16x32_bf16 v[180:183], v[76:79], a[68:71], v[180:183]
    ds_read_b64_tr_b16 v[92:93], v5 offset:20480
    v_mfma_f32_16x16x32_bf16 v[184:187], v[76:79], a[72:75], v[184:187]
    buffer_load_dwordx4 a[120:123], v14, s[8:11], s35 offen sc1
    v_mfma_f32_16x16x32_bf16 v[188:191], v[76:79], a[76:79], v[188:191]
    s_waitcnt vmcnt(10) lgkmcnt(3)
    ds_read_b64_tr_b16 v[94:95], v5 offset:22528
    buffer_load_dwordx4 a[124:127], v15, s[8:11], s35 offen sc1
    s_add_u32 s35, s35, 1024
    s_and_b32 s35, s35, 32767
    v_mfma_f32_16x16x32_bf16 v[128:131], v[80:83], a[80:83], v[128:131]
    s_waitcnt vmcnt(10)
    v_mfma_f32_16x16x32_bf16 v[132:135], v[80:83], a[84:87], v[132:135]
    s_waitcnt vmcnt(9)
    ds_read_b64_tr_b16 v[64:65], v2 offset:24576
    v_mfma_f32_16x16x32_bf16 v[136:139], v[80:83], a[88:91], v[136:139]
    s_waitcnt vmcnt(8)
    v_mfma_f32_16x16x32_bf16 v[140:143], v[80:83], a[92:95], v[140:143]
    ds_read_b64_tr_b16 v[66:67], v2 offset:26624
    v_mfma_f32_16x16x32_bf16 v[144:147], v[84:87], a[80:83], v[144:147]
    v_mfma_f32_16x16x32_bf16 v[148:151], v[84:87], a[84:87], v[148:151]
    ds_read_b64_tr_b16 v[68:69], v3 offset:24576
    v_mfma_f32_16x16x32_bf16 v[152:155], v[84:87], a[88:91], v[152:155]
    v_mfma_f32_16x16x32_bf16 v[156:159], v[84:87], a[92:95], v[156:159]
    s_waitcnt lgkmcnt(3)
    ds_read_b64_tr_b16 v[70:71], v3 offset:26624
    v_mfma_f32_16x16x32_bf16 v[160:163], v[88:91], a[80:83], v[160:163]
    v_mfma_f32_16x16x32_bf16 v[164:167], v[88:91], a[84:87], v[164:167]
    ds_read_b64_tr_b16 v[72:73], v4 offset:24576
    v_mfma_f32_16x16x32_bf16 v[168:171], v[88:91], a[88:91], v[168:171]
    v_mfma_f32_16x16x32_bf16 v[172:175], v[88:91], a[92:95], v[172:175]
    ds_read_b64_tr_b16 v[74:75], v4 offset:26624
    v_mfma_f32_16x16x32_bf16 v[176:179], v[92:95], a[80:83], v[176:179]
    v_mfma_f32_16x16x32_bf16 v[180:183], v[92:95], a[84:87], v[180:183]
    ds_read_b64_tr_b16 v[76:77], v5 offset:24576
    v_mfma_f32_16x16x32_bf16 v[184:187], v[92:95], a[88:91], v[184:187]
    v_mfma_f32_16x16x32_bf16 v[188:191], v[92:95], a[92:95], v[188:191]
    s_waitcnt vmcnt(7) lgkmcnt(3)
    ds_read_b64_tr_b16 v[78:79], v5 offset:26624
    v_mfma_f32_16x16x32_bf16 v[128:131], v[64:67], a[96:99], v[128:131]
    s_waitcnt vmcnt(6)
    v_mfma_f32_16x16x32_bf16 v[132:135], v[64:67], a[100:103], v[132:135]
    s_waitcnt vmcnt(5)
    ds_read_b64_tr_b16 v[80:81], v2 offset:28672
    v_mfma_f32_16x16x32_bf16 v[136:139], v[64:67], a[104:107], v[136:139]
    s_waitcnt vmcnt(4)
    v_mfma_f32_16x16x32_bf16 v[140:143], v[64:67], a[108:111], v[140:143]
    ds_read_b64_tr_b16 v[82:83], v2 offset:30720
    v_mfma_f32_16x16x32_bf16 v[144:147], v[68:71], a[96:99], v[144:147]
    v_mfma_f32_16x16x32_bf16 v[148:151], v[68:71], a[100:103], v[148:151]
    ds_read_b64_tr_b16 v[84:85], v3 offset:28672
    v_mfma_f32_16x16x32_bf16 v[152:155], v[68:71], a[104:107], v[152:155]
    v_mfma_f32_16x16x32_bf16 v[156:159], v[68:71], a[108:111], v[156:159]
    s_waitcnt lgkmcnt(3)
    ds_read_b64_tr_b16 v[86:87], v3 offset:30720
    v_mfma_f32_16x16x32_bf16 v[160:163], v[72:75], a[96:99], v[160:163]
    v_mfma_f32_16x16x32_bf16 v[164:167], v[72:75], a[100:103], v[164:167]
    ds_read_b64_tr_b16 v[88:89], v4 offset:28672
    v_mfma_f32_16x16x32_bf16 v[168:171], v[72:75], a[104:107], v[168:171]
    v_mfma_f32_16x16x32_bf16 v[172:175], v[72:75], a[108:111], v[172:175]
    ds_read_b64_tr_b16 v[90:91], v4 offset:30720
    v_mfma_f32_16x16x32_bf16 v[176:179], v[76:79], a[96:99], v[176:179]
    v_mfma_f32_16x16x32_bf16 v[180:183], v[76:79], a[100:103], v[180:183]
    ds_read_b64_tr_b16 v[92:93], v5 offset:28672
    v_mfma_f32_16x16x32_bf16 v[184:187], v[76:79], a[104:107], v[184:187]
    v_mfma_f32_16x16x32_bf16 v[188:191], v[76:79], a[108:111], v[188:191]
    s_waitcnt vmcnt(3) lgkmcnt(3)
    ds_read_b64_tr_b16 v[94:95], v5 offset:30720
    v_mfma_f32_16x16x32_bf16 v[128:131], v[80:83], a[112:115], v[128:131]
    s_waitcnt vmcnt(2)
    v_mfma_f32_16x16x32_bf16 v[132:135], v[80:83], a[116:119], v[132:135]
    s_waitcnt vmcnt(1)
    v_mfma_f32_16x16x32_bf16 v[136:139], v[80:83], a[120:123], v[136:139]
    s_waitcnt vmcnt(0)
    v_mfma_f32_16x16x32_bf16 v[140:143], v[80:83], a[124:127], v[140:143]
    v_mfma_f32_16x16x32_bf16 v[144:147], v[84:87], a[112:115], v[144:147]
    v_mfma_f32_16x16x32_bf16 v[148:151], v[84:87], a[116:119], v[148:151]
    v_mfma_f32_16x16x32_bf16 v[152:155], v[84:87], a[120:123], v[152:155]
    v_mfma_f32_16x16x32_bf16 v[156:159], v[84:87], a[124:127], v[156:159]
    s_waitcnt lgkmcnt(0)
    v_mfma_f32_16x16x32_bf16 v[160:163], v[88:91], a[112:115], v[160:163]
    v_mfma_f32_16x16x32_bf16 v[164:167], v[88:91], a[116:119], v[164:167]
    v_mfma_f32_16x16x32_bf16 v[168:171], v[88:91], a[120:123], v[168:171]
    v_mfma_f32_16x16x32_bf16 v[172:175], v[88:91], a[124:127], v[172:175]
    v_mfma_f32_16x16x32_bf16 v[176:179], v[92:95], a[112:115], v[176:179]
    v_mfma_f32_16x16x32_bf16 v[180:183], v[92:95], a[116:119], v[180:183]
    v_mfma_f32_16x16x32_bf16 v[184:187], v[92:95], a[120:123], v[184:187]
    v_mfma_f32_16x16x32_bf16 v[188:191], v[92:95], a[124:127], v[188:191]
    v_add_u32 v21, s34, v20
    s_nop 5
    ds_write_b128 v21, v[128:131]
    ds_write_b128 v21, v[132:135] offset:1024
    ds_write_b128 v21, v[136:139] offset:2048
    ds_write_b128 v21, v[140:143] offset:3072
    ds_write_b128 v21, v[144:147] offset:4096
    ds_write_b128 v21, v[148:151] offset:5120
    ds_write_b128 v21, v[152:155] offset:6144
    ds_write_b128 v21, v[156:159] offset:7168
    ds_write_b128 v21, v[160:163] offset:8192
    ds_write_b128 v21, v[164:167] offset:9216
    ds_write_b128 v21, v[168:171] offset:10240
    ds_write_b128 v21, v[172:175] offset:11264
    ds_write_b128 v21, v[176:179] offset:12288
    ds_write_b128 v21, v[180:183] offset:13312
    ds_write_b128 v21, v[184:187] offset:14336
    ds_write_b128 v21, v[188:191] offset:15360
    s_lshl_b32 s60, s3, 10
    v_add_u32 v22, s60, v20
    v_add_u32 v24, 65536, v22
    s_waitcnt lgkmcnt(0)
    s_barrier
    ds_read_b128 v[32:35], v22
    ds_read_b128 v[36:39], v22 offset:32768
    ds_read_b128 v[40:43], v24
    ds_read_b128 v[44:47], v24 offset:32768
    ds_read_b128 v[48:51], v22 offset:4096
    ds_read_b128 v[52:55], v22 offset:36864
    ds_read_b128 v[56:59], v24 offset:4096
    ds_read_b128 v[60:63], v24 offset:36864
    ds_read_b128 v[64:67], v22 offset:8192
    ds_read_b128 v[68:71], v22 offset:40960
    ds_read_b128 v[72:75], v24 offset:8192
    ds_read_b128 v[76:79], v24 offset:40960
    ds_read_b128 v[80:83], v22 offset:12288
    ds_read_b128 v[84:87], v22 offset:45056
    ds_read_b128 v[88:91], v24 offset:12288
    ds_read_b128 v[92:95], v24 offset:45056
    s_waitcnt lgkmcnt(14)
    v_add_f32 v32, v32, v36
    s_waitcnt lgkmcnt(12)
    v_add_f32 v40, v40, v44
    v_add_f32 v33, v33, v37
    v_add_f32 v41, v41, v45
    v_add_f32 v34, v34, v38
    v_add_f32 v42, v42, v46
    v_add_f32 v35, v35, v39
    v_add_f32 v43, v43, v47
    v_add_f32 v32, v32, v40
    v_add_f32 v33, v33, v41
    v_add_f32 v34, v34, v42
    v_add_f32 v35, v35, v43
    v_cvt_pk_bf16_f32 v36, v32, v33
    v_cvt_pk_bf16_f32 v37, v34, v35
    v_lshlrev_b32 v32, 16, v36
    v_and_b32 v33, 0xffff0000, v36
    v_lshlrev_b32 v34, 16, v37
    v_and_b32 v35, 0xffff0000, v37
    v_fma_f32 v32, v32, v192, v208
    v_fma_f32 v33, v33, v193, v209
    v_fma_f32 v34, v34, v194, v210
    v_fma_f32 v35, v35, v195, v211
    v_cvt_pk_bf16_f32 v96, v32, v33
    v_cvt_pk_bf16_f32 v97, v34, v35
    buffer_store_dwordx2 v[96:97], v23, s[28:31], 0 offen
    s_waitcnt lgkmcnt(10)
    v_add_f32 v48, v48, v52
    s_waitcnt lgkmcnt(8)
    v_add_f32 v56, v56, v60
    v_add_f32 v49, v49, v53
    v_add_f32 v57, v57, v61
    v_add_f32 v50, v50, v54
    v_add_f32 v58, v58, v62
    v_add_f32 v51, v51, v55
    v_add_f32 v59, v59, v63
    v_add_f32 v48, v48, v56
    v_add_f32 v49, v49, v57
    v_add_f32 v50, v50, v58
    v_add_f32 v51, v51, v59
    v_cvt_pk_bf16_f32 v52, v48, v49
    v_cvt_pk_bf16_f32 v53, v50, v51
    v_lshlrev_b32 v48, 16, v52
    v_and_b32 v49, 0xffff0000, v52
    v_lshlrev_b32 v50, 16, v53
    v_and_b32 v51, 0xffff0000, v53
    v_fma_f32 v48, v48, v196, v212
    v_fma_f32 v49, v49, v197, v213
    v_fma_f32 v50, v50, v198, v214
    v_fma_f32 v51, v51, v199, v215
    v_cvt_pk_bf16_f32 v98, v48, v49
    v_cvt_pk_bf16_f32 v99, v50, v51
    buffer_store_dwordx2 v[98:99], v23, s[28:31], 0 offen offset:32
    s_waitcnt lgkmcnt(6)
    v_add_f32 v64, v64, v68
    s_waitcnt lgkmcnt(4)
    v_add_f32 v72, v72, v76
    v_add_f32 v65, v65, v69
    v_add_f32 v73, v73, v77
    v_add_f32 v66, v66, v70
    v_add_f32 v74, v74, v78
    v_add_f32 v67, v67, v71
    v_add_f32 v75, v75, v79
    v_add_f32 v64, v64, v72
    v_add_f32 v65, v65, v73
    v_add_f32 v66, v66, v74
    v_add_f32 v67, v67, v75
    v_cvt_pk_bf16_f32 v68, v64, v65
    v_cvt_pk_bf16_f32 v69, v66, v67
    v_lshlrev_b32 v64, 16, v68
    v_and_b32 v65, 0xffff0000, v68
    v_lshlrev_b32 v66, 16, v69
    v_and_b32 v67, 0xffff0000, v69
    v_fma_f32 v64, v64, v200, v216
    v_fma_f32 v65, v65, v201, v217
    v_fma_f32 v66, v66, v202, v218
    v_fma_f32 v67, v67, v203, v219
    v_cvt_pk_bf16_f32 v100, v64, v65
    v_cvt_pk_bf16_f32 v101, v66, v67
    buffer_store_dwordx2 v[100:101], v23, s[28:31], 0 offen offset:64
    s_waitcnt lgkmcnt(2)
    v_add_f32 v80, v80, v84
    s_waitcnt lgkmcnt(0)
    v_add_f32 v88, v88, v92
    v_add_f32 v81, v81, v85
    v_add_f32 v89, v89, v93
    v_add_f32 v82, v82, v86
    v_add_f32 v90, v90, v94
    v_add_f32 v83, v83, v87
    v_add_f32 v91, v91, v95
    v_add_f32 v80, v80, v88
    v_add_f32 v81, v81, v89
    v_add_f32 v82, v82, v90
    v_add_f32 v83, v83, v91
    v_cvt_pk_bf16_f32 v84, v80, v81
    v_cvt_pk_bf16_f32 v85, v82, v83
    v_lshlrev_b32 v80, 16, v84
    v_and_b32 v81, 0xffff0000, v84
    v_lshlrev_b32 v82, 16, v85
    v_and_b32 v83, 0xffff0000, v85
    v_fma_f32 v80, v80, v204, v220
    v_fma_f32 v81, v81, v205, v221
    v_fma_f32 v82, v82, v206, v222
    v_fma_f32 v83, v83, v207, v223
    v_cvt_pk_bf16_f32 v102, v80, v81
    v_cvt_pk_bf16_f32 v103, v82, v83
    buffer_store_dwordx2 v[102:103], v23, s[28:31], 0 offen offset:96
mk_end:
    s_endpgm
mk_codeend:
mk_fb:
    s_waitcnt vmcnt(0) lgkmcnt(0)
    s_barrier
    v_accvgpr_write_b32 a0, 0
    v_accvgpr_write_b32 a1, 0
    v_accvgpr_write_b32 a2, 0
    v_accvgpr_write_b32 a3, 0
    v_accvgpr_write_b32 a4, 0
    v_accvgpr_write_b32 a5, 0
    v_accvgpr_write_b32 a6, 0
    v_accvgpr_write_b32 a7, 0
    v_accvgpr_write_b32 a8, 0
    v_accvgpr_write_b32 a9, 0
    v_accvgpr_write_b32 a10, 0
    v_accvgpr_write_b32 a11, 0
    v_accvgpr_write_b32 a12, 0
    v_accvgpr_write_b32 a13, 0
    v_accvgpr_write_b32 a14, 0
    v_accvgpr_write_b32 a15, 0
    v_accvgpr_write_b32 a16, 0
    v_accvgpr_write_b32 a17, 0
    v_accvgpr_write_b32 a18, 0
    v_accvgpr_write_b32 a19, 0
    v_accvgpr_write_b32 a20, 0
    v_accvgpr_write_b32 a21, 0
    v_accvgpr_write_b32 a22, 0
    v_accvgpr_write_b32 a23, 0
    v_accvgpr_write_b32 a24, 0
    v_accvgpr_write_b32 a25, 0
    v_accvgpr_write_b32 a26, 0
    v_accvgpr_write_b32 a27, 0
    v_accvgpr_write_b32 a28, 0
    v_accvgpr_write_b32 a29, 0
    v_accvgpr_write_b32 a30, 0
    v_accvgpr_write_b32 a31, 0
    v_accvgpr_write_b32 a32, 0
    v_accvgpr_write_b32 a33, 0
    v_accvgpr_write_b32 a34, 0
    v_accvgpr_write_b32 a35, 0
    v_accvgpr_write_b32 a36, 0
    v_accvgpr_write_b32 a37, 0
    v_accvgpr_write_b32 a38, 0
    v_accvgpr_write_b32 a39, 0
    v_accvgpr_write_b32 a40, 0
    v_accvgpr_write_b32 a41, 0
    v_accvgpr_write_b32 a42, 0
    v_accvgpr_write_b32 a43, 0
    v_accvgpr_write_b32 a44, 0
    v_accvgpr_write_b32 a45, 0
    v_accvgpr_write_b32 a46, 0
    v_accvgpr_write_b32 a47, 0
    v_accvgpr_write_b32 a48, 0
    v_accvgpr_write_b32 a49, 0
    v_accvgpr_write_b32 a50, 0
    v_accvgpr_write_b32 a51, 0
    v_accvgpr_write_b32 a52, 0
    v_accvgpr_write_b32 a53, 0
    v_accvgpr_write_b32 a54, 0
    v_accvgpr_write_b32 a55, 0
    v_accvgpr_write_b32 a56, 0
    v_accvgpr_write_b32 a57, 0
    v_accvgpr_write_b32 a58, 0
    v_accvgpr_write_b32 a59, 0
    v_accvgpr_write_b32 a60, 0
    v_accvgpr_write_b32 a61, 0
    v_accvgpr_write_b32 a62, 0
    v_accvgpr_write_b32 a63, 0
    v_accvgpr_write_b32 a64, 0
    v_accvgpr_write_b32 a65, 0
    v_accvgpr_write_b32 a66, 0
    v_accvgpr_write_b32 a67, 0
    v_accvgpr_write_b32 a68, 0
    v_accvgpr_write_b32 a69, 0
    v_accvgpr_write_b32 a70, 0
    v_accvgpr_write_b32 a71, 0
    v_accvgpr_write_b32 a72, 0
    v_accvgpr_write_b32 a73, 0
    v_accvgpr_write_b32 a74, 0
    v_accvgpr_write_b32 a75, 0
    v_accvgpr_write_b32 a76, 0
    v_accvgpr_write_b32 a77, 0
    v_accvgpr_write_b32 a78, 0
    v_accvgpr_write_b32 a79, 0
    v_accvgpr_write_b32 a80, 0
    v_accvgpr_write_b32 a81, 0
    v_accvgpr_write_b32 a82, 0
    v_accvgpr_write_b32 a83, 0
    v_accvgpr_write_b32 a84, 0
    v_accvgpr_write_b32 a85, 0
    v_accvgpr_write_b32 a86, 0
    v_accvgpr_write_b32 a87, 0
    v_accvgpr_write_b32 a88, 0
    v_accvgpr_write_b32 a89, 0
    v_accvgpr_write_b32 a90, 0
    v_accvgpr_write_b32 a91, 0
    v_accvgpr_write_b32 a92, 0
    v_accvgpr_write_b32 a93, 0
    v_accvgpr_write_b32 a94, 0
    v_accvgpr_write_b32 a95, 0
    v_accvgpr_write_b32 a96, 0
    v_accvgpr_write_b32 a97, 0
    v_accvgpr_write_b32 a98, 0
    v_accvgpr_write_b32 a99, 0
    v_accvgpr_write_b32 a100, 0
    v_accvgpr_write_b32 a101, 0
    v_accvgpr_write_b32 a102, 0
    v_accvgpr_write_b32 a103, 0
    v_accvgpr_write_b32 a104, 0
    v_accvgpr_write_b32 a105, 0
    v_accvgpr_write_b32 a106, 0
    v_accvgpr_write_b32 a107, 0
    v_accvgpr_write_b32 a108, 0
    v_accvgpr_write_b32 a109, 0
    v_accvgpr_write_b32 a110, 0
    v_accvgpr_write_b32 a111, 0
    v_accvgpr_write_b32 a112, 0
    v_accvgpr_write_b32 a113, 0
    v_accvgpr_write_b32 a114, 0
    v_accvgpr_write_b32 a115, 0
    v_accvgpr_write_b32 a116, 0
    v_accvgpr_write_b32 a117, 0
    v_accvgpr_write_b32 a118, 0
    v_accvgpr_write_b32 a119, 0
    v_accvgpr_write_b32 a120, 0
    v_accvgpr_write_b32 a121, 0
    v_accvgpr_write_b32 a122, 0
    v_accvgpr_write_b32 a123, 0
    v_accvgpr_write_b32 a124, 0
    v_accvgpr_write_b32 a125, 0
    v_accvgpr_write_b32 a126, 0
    v_accvgpr_write_b32 a127, 0
    v_mov_b32 v128, 0
    v_mov_b32 v129, 0
    v_mov_b32 v130, 0
    v_mov_b32 v131, 0
    v_mov_b32 v132, 0
    v_mov_b32 v133, 0
    v_mov_b32 v134, 0
    v_mov_b32 v135, 0
    v_mov_b32 v136, 0
    v_mov_b32 v137, 0
    v_mov_b32 v138, 0
    v_mov_b32 v139, 0
    v_mov_b32 v140, 0
    v_mov_b32 v141, 0
    v_mov_b32 v142, 0
    v_mov_b32 v143, 0
    v_mov_b32 v112, 0xff800000
    v_mov_b32 v113, 0xff800000
    v_mov_b32 v114, 0xff800000
    v_mov_b32 v115, 0xff800000
    s_mov_b32 s32, s34
    s_mov_b32 s33, s34
    s_mov_b32 s40, 0
mk_fbloop:
    s_add_u32 m0, s34, 0
    s_nop 0
    buffer_load_dwordx4 v14, s[8:11], s32 offen lds
    buffer_load_dwordx4 v15, s[8:11], s32 offen offset:1024 lds
    buffer_load_dwordx4 v16, s[8:11], s32 offen offset:2048 lds
    buffer_load_dwordx4 v17, s[8:11], s32 offen offset:3072 lds
    s_add_u32 s32, s32, 16384
    s_add_u32 m0, s34, 65536
    s_nop 0
    buffer_load_dwordx4 v18, s[12:15], s33 offen lds
    buffer_load_dwordx4 v19, s[12:15], s33 offen offset:1024 lds
    buffer_load_dwordx4 v18, s[12:15], s33 offen offset:2048 lds
    buffer_load_dwordx4 v19, s[12:15], s33 offen offset:3072 lds
    s_add_u32 s33, s33, 16384
    s_waitcnt vmcnt(0)
    s_barrier
    ds_read_b128 a[192:195], v2
    ds_read_b128 a[196:199], v3
    ds_read_b128 a[200:203], v4
    ds_read_b128 a[204:207], v5
    ds_read_b128 a[208:211], v2 offset:4096
    ds_read_b128 a[212:215], v3 offset:4096
    ds_read_b128 a[216:219], v4 offset:4096
    ds_read_b128 a[220:223], v5 offset:4096
    ds_read_b64_tr_b16 a[224:225], v6
    ds_read_b64_tr_b16 a[226:227], v6 offset:4096
    ds_read_b64_tr_b16 a[228:229], v7
    ds_read_b64_tr_b16 a[230:231], v7 offset:4096
    ds_read_b64_tr_b16 a[232:233], v8
    ds_read_b64_tr_b16 a[234:235], v8 offset:4096
    ds_read_b64_tr_b16 a[236:237], v9
    ds_read_b64_tr_b16 a[238:239], v9 offset:4096
    ds_read_b64_tr_b16 a[240:241], v10
    ds_read_b64_tr_b16 a[242:243], v10 offset:4096
    ds_read_b64_tr_b16 a[244:245], v11
    ds_read_b64_tr_b16 a[246:247], v11 offset:4096
    ds_read_b64_tr_b16 a[248:249], v12
    ds_read_b64_tr_b16 a[250:251], v12 offset:4096
    ds_read_b64_tr_b16 a[252:253], v13
    ds_read_b64_tr_b16 a[254:255], v13 offset:4096
    s_waitcnt lgkmcnt(0)
    v_mfma_f32_16x16x32_bf16 v[32:35], a[192:195], v[144:147], 0
    v_mfma_f32_16x16x32_bf16 v[36:39], a[192:195], v[148:151], 0
    v_mfma_f32_16x16x32_bf16 v[40:43], a[192:195], v[152:155], 0
    v_mfma_f32_16x16x32_bf16 v[44:47], a[192:195], v[156:159], 0
    v_mfma_f32_16x16x32_bf16 v[32:35], a[196:199], v[176:179], v[32:35]
    v_mfma_f32_16x16x32_bf16 v[36:39], a[196:199], v[180:183], v[36:39]
    v_mfma_f32_16x16x32_bf16 v[40:43], a[196:199], v[184:187], v[40:43]
    v_mfma_f32_16x16x32_bf16 v[44:47], a[196:199], v[188:191], v[44:47]
    v_mfma_f32_16x16x32_bf16 v[32:35], a[200:203], v[208:211], v[32:35]
    v_mfma_f32_16x16x32_bf16 v[36:39], a[200:203], v[212:215], v[36:39]
    v_mfma_f32_16x16x32_bf16 v[40:43], a[200:203], v[216:219], v[40:43]
    v_mfma_f32_16x16x32_bf16 v[44:47], a[200:203], v[220:223], v[44:47]
    v_mfma_f32_16x16x32_bf16 v[32:35], a[204:207], v[240:243], v[32:35]
    v_mfma_f32_16x16x32_bf16 v[36:39], a[204:207], v[244:247], v[36:39]
    v_mfma_f32_16x16x32_bf16 v[40:43], a[204:207], v[248:251], v[40:43]
    v_mfma_f32_16x16x32_bf16 v[44:47], a[204:207], v[252:255], v[44:47]
    v_mfma_f32_16x16x32_bf16 v[48:51], a[208:211], v[144:147], 0
    v_mfma_f32_16x16x32_bf16 v[52:55], a[208:211], v[148:151], 0
    v_mfma_f32_16x16x32_bf16 v[56:59], a[208:211], v[152:155], 0
    v_mfma_f32_16x16x32_bf16 v[60:63], a[208:211], v[156:159], 0
    v_mfma_f32_16x16x32_bf16 v[48:51], a[212:215], v[176:179], v[48:51]
    v_mfma_f32_16x16x32_bf16 v[52:55], a[212:215], v[180:183], v[52:55]
    v_mfma_f32_16x16x32_bf16 v[56:59], a[212:215], v[184:187], v[56:59]
    v_mfma_f32_16x16x32_bf16 v[60:63], a[212:215], v[188:191], v[60:63]
    v_mfma_f32_16x16x32_bf16 v[48:51], a[216:219], v[208:211], v[48:51]
    v_mfma_f32_16x16x32_bf16 v[52:55], a[216:219], v[212:215], v[52:55]
    v_mfma_f32_16x16x32_bf16 v[56:59], a[216:219], v[216:219], v[56:59]
    v_mfma_f32_16x16x32_bf16 v[60:63], a[216:219], v[220:223], v[60:63]
    v_mfma_f32_16x16x32_bf16 v[48:51], a[220:223], v[240:243], v[48:51]
    v_mfma_f32_16x16x32_bf16 v[52:55], a[220:223], v[244:247], v[52:55]
    v_mfma_f32_16x16x32_bf16 v[56:59], a[220:223], v[248:251], v[56:59]
    v_mfma_f32_16x16x32_bf16 v[60:63], a[220:223], v[252:255], v[60:63]
    s_nop 7
    v_max3_f32 v116, v32, v33, v34
    v_max3_f32 v116, v116, v35, v48
    v_max3_f32 v116, v116, v49, v50
    v_max3_f32 v116, v116, v51, v112
    v_max3_f32 v117, v36, v37, v38
    v_max3_f32 v117, v117, v39, v52
    v_max3_f32 v117, v117, v53, v54
    v_max3_f32 v117, v117, v55, v113
    v_max3_f32 v118, v40, v41, v42
    v_max3_f32 v118, v118, v43, v56
    v_max3_f32 v118, v118, v57, v58
    v_max3_f32 v118, v118, v59, v114
    v_max3_f32 v119, v44, v45, v46
    v_max3_f32 v119, v119, v47, v60
    v_max3_f32 v119, v119, v61, v62
    v_max3_f32 v119, v119, v63, v115
    v_mov_b32 v120, v116
    v_mov_b32 v121, v117
    v_mov_b32 v122, v118
    v_mov_b32 v123, v119
    s_nop 1
    v_permlane16_swap_b32 v120, v116
    v_permlane16_swap_b32 v121, v117
    v_permlane16_swap_b32 v122, v118
    v_permlane16_swap_b32 v123, v119
    s_nop 1
    v_max_f32 v116, v116, v120
    v_max_f32 v117, v117, v121
    v_max_f32 v118, v118, v122
    v_max_f32 v119, v119, v123
    v_mov_b32 v120, v116
    v_mov_b32 v121, v117
    v_mov_b32 v122, v118
    v_mov_b32 v123, v119
    s_nop 1
    v_permlane32_swap_b32 v120, v116
    v_permlane32_swap_b32 v121, v117
    v_permlane32_swap_b32 v122, v118
    v_permlane32_swap_b32 v123, v119
    s_nop 1
    v_max_f32 v116, v116, v120
    v_max_f32 v117, v117, v121
    v_max_f32 v118, v118, v122
    v_max_f32 v119, v119, v123
    v_sub_f32 v120, v112, v116
    v_sub_f32 v121, v113, v117
    v_sub_f32 v122, v114, v118
    v_sub_f32 v123, v115, v119
    v_exp_f32 v120, v120
    v_exp_f32 v121, v121
    v_exp_f32 v122, v122
    v_exp_f32 v123, v123
    v_mov_b32 v112, v116
    v_mov_b32 v113, v117
    v_mov_b32 v114, v118
    v_mov_b32 v115, v119
    v_sub_f32 v32, v32, v112
    v_sub_f32 v33, v33, v112
    v_sub_f32 v34, v34, v112
    v_sub_f32 v35, v35, v112
    v_sub_f32 v36, v36, v113
    v_sub_f32 v37, v37, v113
    v_sub_f32 v38, v38, v113
    v_sub_f32 v39, v39, v113
    v_sub_f32 v40, v40, v114
    v_sub_f32 v41, v41, v114
    v_sub_f32 v42, v42, v114
    v_sub_f32 v43, v43, v114
    v_sub_f32 v44, v44, v115
    v_sub_f32 v45, v45, v115
    v_sub_f32 v46, v46, v115
    v_sub_f32 v47, v47, v115
    v_sub_f32 v48, v48, v112
    v_sub_f32 v49, v49, v112
    v_sub_f32 v50, v50, v112
    v_sub_f32 v51, v51, v112
    v_sub_f32 v52, v52, v113
    v_sub_f32 v53, v53, v113
    v_sub_f32 v54, v54, v113
    v_sub_f32 v55, v55, v113
    v_sub_f32 v56, v56, v114
    v_sub_f32 v57, v57, v114
    v_sub_f32 v58, v58, v114
    v_sub_f32 v59, v59, v114
    v_sub_f32 v60, v60, v115
    v_sub_f32 v61, v61, v115
    v_sub_f32 v62, v62, v115
    v_sub_f32 v63, v63, v115
    v_exp_f32 v32, v32
    v_exp_f32 v33, v33
    v_exp_f32 v34, v34
    v_exp_f32 v35, v35
    v_exp_f32 v36, v36
    v_exp_f32 v37, v37
    v_exp_f32 v38, v38
    v_exp_f32 v39, v39
    v_exp_f32 v40, v40
    v_exp_f32 v41, v41
    v_exp_f32 v42, v42
    v_exp_f32 v43, v43
    v_exp_f32 v44, v44
    v_exp_f32 v45, v45
    v_exp_f32 v46, v46
    v_exp_f32 v47, v47
    v_exp_f32 v48, v48
    v_exp_f32 v49, v49
    v_exp_f32 v50, v50
    v_exp_f32 v51, v51
    v_exp_f32 v52, v52
    v_exp_f32 v53, v53
    v_exp_f32 v54, v54
    v_exp_f32 v55, v55
    v_exp_f32 v56, v56
    v_exp_f32 v57, v57
    v_exp_f32 v58, v58
    v_exp_f32 v59, v59
    v_exp_f32 v60, v60
    v_exp_f32 v61, v61
    v_exp_f32 v62, v62
    v_exp_f32 v63, v63
    s_nop 0
    v_cvt_pk_bf16_f32 v64, v32, v33
    v_cvt_pk_bf16_f32 v65, v34, v35
    v_cvt_pk_bf16_f32 v68, v36, v37
    v_cvt_pk_bf16_f32 v69, v38, v39
    v_cvt_pk_bf16_f32 v72, v40, v41
    v_cvt_pk_bf16_f32 v73, v42, v43
    v_cvt_pk_bf16_f32 v76, v44, v45
    v_cvt_pk_bf16_f32 v77, v46, v47
    v_cvt_pk_bf16_f32 v66, v48, v49
    v_cvt_pk_bf16_f32 v67, v50, v51
    v_cvt_pk_bf16_f32 v70, v52, v53
    v_cvt_pk_bf16_f32 v71, v54, v55
    v_cvt_pk_bf16_f32 v74, v56, v57
    v_cvt_pk_bf16_f32 v75, v58, v59
    v_cvt_pk_bf16_f32 v78, v60, v61
    v_cvt_pk_bf16_f32 v79, v62, v63
    v_accvgpr_read_b32 v32, a0
    v_accvgpr_read_b32 v33, a1
    v_accvgpr_read_b32 v34, a2
    v_accvgpr_read_b32 v35, a3
    v_accvgpr_read_b32 v36, a4
    v_accvgpr_read_b32 v37, a5
    v_accvgpr_read_b32 v38, a6
    v_accvgpr_read_b32 v39, a7
    v_accvgpr_read_b32 v40, a8
    v_accvgpr_read_b32 v41, a9
    v_accvgpr_read_b32 v42, a10
    v_accvgpr_read_b32 v43, a11
    v_accvgpr_read_b32 v44, a12
    v_accvgpr_read_b32 v45, a13
    v_accvgpr_read_b32 v46, a14
    v_accvgpr_read_b32 v47, a15
    v_mul_f32 v32, v32, v120
    v_mul_f32 v33, v33, v120
    v_mul_f32 v34, v34, v120
    v_mul_f32 v35, v35, v120
    v_mul_f32 v36, v36, v121
    v_mul_f32 v37, v37, v121
    v_mul_f32 v38, v38, v121
    v_mul_f32 v39, v39, v121
    v_mul_f32 v40, v40, v122
    v_mul_f32 v41, v41, v122
    v_mul_f32 v42, v42, v122
    v_mul_f32 v43, v43, v122
    v_mul_f32 v44, v44, v123
    v_mul_f32 v45, v45, v123
    v_mul_f32 v46, v46, v123
    v_mul_f32 v47, v47, v123
    v_accvgpr_write_b32 a0, v32
    v_accvgpr_write_b32 a1, v33
    v_accvgpr_write_b32 a2, v34
    v_accvgpr_write_b32 a3, v35
    v_accvgpr_write_b32 a4, v36
    v_accvgpr_write_b32 a5, v37
    v_accvgpr_write_b32 a6, v38
    v_accvgpr_write_b32 a7, v39
    v_accvgpr_write_b32 a8, v40
    v_accvgpr_write_b32 a9, v41
    v_accvgpr_write_b32 a10, v42
    v_accvgpr_write_b32 a11, v43
    v_accvgpr_write_b32 a12, v44
    v_accvgpr_write_b32 a13, v45
    v_accvgpr_write_b32 a14, v46
    v_accvgpr_write_b32 a15, v47
    v_accvgpr_read_b32 v32, a16
    v_accvgpr_read_b32 v33, a17
    v_accvgpr_read_b32 v34, a18
    v_accvgpr_read_b32 v35, a19
    v_accvgpr_read_b32 v36, a20
    v_accvgpr_read_b32 v37, a21
    v_accvgpr_read_b32 v38, a22
    v_accvgpr_read_b32 v39, a23
    v_accvgpr_read_b32 v40, a24
    v_accvgpr_read_b32 v41, a25
    v_accvgpr_read_b32 v42, a26
    v_accvgpr_read_b32 v43, a27
    v_accvgpr_read_b32 v44, a28
    v_accvgpr_read_b32 v45, a29
    v_accvgpr_read_b32 v46, a30
    v_accvgpr_read_b32 v47, a31
    v_mul_f32 v32, v32, v120
    v_mul_f32 v33, v33, v120
    v_mul_f32 v34, v34, v120
    v_mul_f32 v35, v35, v120
    v_mul_f32 v36, v36, v121
    v_mul_f32 v37, v37, v121
    v_mul_f32 v38, v38, v121
    v_mul_f32 v39, v39, v121
    v_mul_f32 v40, v40, v122
    v_mul_f32 v41, v41, v122
    v_mul_f32 v42, v42, v122
    v_mul_f32 v43, v43, v122
    v_mul_f32 v44, v44, v123
    v_mul_f32 v45, v45, v123
    v_mul_f32 v46, v46, v123
    v_mul_f32 v47, v47, v123
    v_accvgpr_write_b32 a16, v32
    v_accvgpr_write_b32 a17, v33
    v_accvgpr_write_b32 a18, v34
    v_accvgpr_write_b32 a19, v35
    v_accvgpr_write_b32 a20, v36
    v_accvgpr_write_b32 a21, v37
    v_accvgpr_write_b32 a22, v38
    v_accvgpr_write_b32 a23, v39
    v_accvgpr_write_b32 a24, v40
    v_accvgpr_write_b32 a25, v41
    v_accvgpr_write_b32 a26, v42
    v_accvgpr_write_b32 a27, v43
    v_accvgpr_write_b32 a28, v44
    v_accvgpr_write_b32 a29, v45
    v_accvgpr_write_b32 a30, v46
    v_accvgpr_write_b32 a31, v47
    v_accvgpr_read_b32 v32, a32
    v_accvgpr_read_b32 v33, a33
    v_accvgpr_read_b32 v34, a34
    v_accvgpr_read_b32 v35, a35
    v_accvgpr_read_b32 v36, a36
    v_accvgpr_read_b32 v37, a37
    v_accvgpr_read_b32 v38, a38
    v_accvgpr_read_b32 v39, a39
    v_accvgpr_read_b32 v40, a40
    v_accvgpr_read_b32 v41, a41
    v_accvgpr_read_b32 v42, a42
    v_accvgpr_read_b32 v43, a43
    v_accvgpr_read_b32 v44, a44
    v_accvgpr_read_b32 v45, a45
    v_accvgpr_read_b32 v46, a46
    v_accvgpr_read_b32 v47, a47
    v_mul_f32 v32, v32, v120
    v_mul_f32 v33, v33, v120
    v_mul_f32 v34, v34, v120
    v_mul_f32 v35, v35, v120
    v_mul_f32 v36, v36, v121
    v_mul_f32 v37, v37, v121
    v_mul_f32 v38, v38, v121
    v_mul_f32 v39, v39, v121
    v_mul_f32 v40, v40, v122
    v_mul_f32 v41, v41, v122
    v_mul_f32 v42, v42, v122
    v_mul_f32 v43, v43, v122
    v_mul_f32 v44, v44, v123
    v_mul_f32 v45, v45, v123
    v_mul_f32 v46, v46, v123
    v_mul_f32 v47, v47, v123
    v_accvgpr_write_b32 a32, v32
    v_accvgpr_write_b32 a33, v33
    v_accvgpr_write_b32 a34, v34
    v_accvgpr_write_b32 a35, v35
    v_accvgpr_write_b32 a36, v36
    v_accvgpr_write_b32 a37, v37
    v_accvgpr_write_b32 a38, v38
    v_accvgpr_write_b32 a39, v39
    v_accvgpr_write_b32 a40, v40
    v_accvgpr_write_b32 a41, v41
    v_accvgpr_write_b32 a42, v42
    v_accvgpr_write_b32 a43, v43
    v_accvgpr_write_b32 a44, v44
    v_accvgpr_write_b32 a45, v45
    v_accvgpr_write_b32 a46, v46
    v_accvgpr_write_b32 a47, v47
    v_accvgpr_read_b32 v32, a48
    v_accvgpr_read_b32 v33, a49
    v_accvgpr_read_b32 v34, a50
    v_accvgpr_read_b32 v35, a51
    v_accvgpr_read_b32 v36, a52
    v_accvgpr_read_b32 v37, a53
    v_accvgpr_read_b32 v38, a54
    v_accvgpr_read_b32 v39, a55
    v_accvgpr_read_b32 v40, a56
    v_accvgpr_read_b32 v41, a57
    v_accvgpr_read_b32 v42, a58
    v_accvgpr_read_b32 v43, a59
    v_accvgpr_read_b32 v44, a60
    v_accvgpr_read_b32 v45, a61
    v_accvgpr_read_b32 v46, a62
    v_accvgpr_read_b32 v47, a63
    v_mul_f32 v32, v32, v120
    v_mul_f32 v33, v33, v120
    v_mul_f32 v34, v34, v120
    v_mul_f32 v35, v35, v120
    v_mul_f32 v36, v36, v121
    v_mul_f32 v37, v37, v121
    v_mul_f32 v38, v38, v121
    v_mul_f32 v39, v39, v121
    v_mul_f32 v40, v40, v122
    v_mul_f32 v41, v41, v122
    v_mul_f32 v42, v42, v122
    v_mul_f32 v43, v43, v122
    v_mul_f32 v44, v44, v123
    v_mul_f32 v45, v45, v123
    v_mul_f32 v46, v46, v123
    v_mul_f32 v47, v47, v123
    v_accvgpr_write_b32 a48, v32
    v_accvgpr_write_b32 a49, v33
    v_accvgpr_write_b32 a50, v34
    v_accvgpr_write_b32 a51, v35
    v_accvgpr_write_b32 a52, v36
    v_accvgpr_write_b32 a53, v37
    v_accvgpr_write_b32 a54, v38
    v_accvgpr_write_b32 a55, v39
    v_accvgpr_write_b32 a56, v40
    v_accvgpr_write_b32 a57, v41
    v_accvgpr_write_b32 a58, v42
    v_accvgpr_write_b32 a59, v43
    v_accvgpr_write_b32 a60, v44
    v_accvgpr_write_b32 a61, v45
    v_accvgpr_write_b32 a62, v46
    v_accvgpr_write_b32 a63, v47
    v_accvgpr_read_b32 v32, a64
    v_accvgpr_read_b32 v33, a65
    v_accvgpr_read_b32 v34, a66
    v_accvgpr_read_b32 v35, a67
    v_accvgpr_read_b32 v36, a68
    v_accvgpr_read_b32 v37, a69
    v_accvgpr_read_b32 v38, a70
    v_accvgpr_read_b32 v39, a71
    v_accvgpr_read_b32 v40, a72
    v_accvgpr_read_b32 v41, a73
    v_accvgpr_read_b32 v42, a74
    v_accvgpr_read_b32 v43, a75
    v_accvgpr_read_b32 v44, a76
    v_accvgpr_read_b32 v45, a77
    v_accvgpr_read_b32 v46, a78
    v_accvgpr_read_b32 v47, a79
    v_mul_f32 v32, v32, v120
    v_mul_f32 v33, v33, v120
    v_mul_f32 v34, v34, v120
    v_mul_f32 v35, v35, v120
    v_mul_f32 v36, v36, v121
    v_mul_f32 v37, v37, v121
    v_mul_f32 v38, v38, v121
    v_mul_f32 v39, v39, v121
    v_mul_f32 v40, v40, v122
    v_mul_f32 v41, v41, v122
    v_mul_f32 v42, v42, v122
    v_mul_f32 v43, v43, v122
    v_mul_f32 v44, v44, v123
    v_mul_f32 v45, v45, v123
    v_mul_f32 v46, v46, v123
    v_mul_f32 v47, v47, v123
    v_accvgpr_write_b32 a64, v32
    v_accvgpr_write_b32 a65, v33
    v_accvgpr_write_b32 a66, v34
    v_accvgpr_write_b32 a67, v35
    v_accvgpr_write_b32 a68, v36
    v_accvgpr_write_b32 a69, v37
    v_accvgpr_write_b32 a70, v38
    v_accvgpr_write_b32 a71, v39
    v_accvgpr_write_b32 a72, v40
    v_accvgpr_write_b32 a73, v41
    v_accvgpr_write_b32 a74, v42
    v_accvgpr_write_b32 a75, v43
    v_accvgpr_write_b32 a76, v44
    v_accvgpr_write_b32 a77, v45
    v_accvgpr_write_b32 a78, v46
    v_accvgpr_write_b32 a79, v47
    v_accvgpr_read_b32 v32, a80
    v_accvgpr_read_b32 v33, a81
    v_accvgpr_read_b32 v34, a82
    v_accvgpr_read_b32 v35, a83
    v_accvgpr_read_b32 v36, a84
    v_accvgpr_read_b32 v37, a85
    v_accvgpr_read_b32 v38, a86
    v_accvgpr_read_b32 v39, a87
    v_accvgpr_read_b32 v40, a88
    v_accvgpr_read_b32 v41, a89
    v_accvgpr_read_b32 v42, a90
    v_accvgpr_read_b32 v43, a91
    v_accvgpr_read_b32 v44, a92
    v_accvgpr_read_b32 v45, a93
    v_accvgpr_read_b32 v46, a94
    v_accvgpr_read_b32 v47, a95
    v_mul_f32 v32, v32, v120
    v_mul_f32 v33, v33, v120
    v_mul_f32 v34, v34, v120
    v_mul_f32 v35, v35, v120
    v_mul_f32 v36, v36, v121
    v_mul_f32 v37, v37, v121
    v_mul_f32 v38, v38, v121
    v_mul_f32 v39, v39, v121
    v_mul_f32 v40, v40, v122
    v_mul_f32 v41, v41, v122
    v_mul_f32 v42, v42, v122
    v_mul_f32 v43, v43, v122
    v_mul_f32 v44, v44, v123
    v_mul_f32 v45, v45, v123
    v_mul_f32 v46, v46, v123
    v_mul_f32 v47, v47, v123
    v_accvgpr_write_b32 a80, v32
    v_accvgpr_write_b32 a81, v33
    v_accvgpr_write_b32 a82, v34
    v_accvgpr_write_b32 a83, v35
    v_accvgpr_write_b32 a84, v36
    v_accvgpr_write_b32 a85, v37
    v_accvgpr_write_b32 a86, v38
    v_accvgpr_write_b32 a87, v39
    v_accvgpr_write_b32 a88, v40
    v_accvgpr_write_b32 a89, v41
    v_accvgpr_write_b32 a90, v42
    v_accvgpr_write_b32 a91, v43
    v_accvgpr_write_b32 a92, v44
    v_accvgpr_write_b32 a93, v45
    v_accvgpr_write_b32 a94, v46
    v_accvgpr_write_b32 a95, v47
    v_accvgpr_read_b32 v32, a96
    v_accvgpr_read_b32 v33, a97
    v_accvgpr_read_b32 v34, a98
    v_accvgpr_read_b32 v35, a99
    v_accvgpr_read_b32 v36, a100
    v_accvgpr_read_b32 v37, a101
    v_accvgpr_read_b32 v38, a102
    v_accvgpr_read_b32 v39, a103
    v_accvgpr_read_b32 v40, a104
    v_accvgpr_read_b32 v41, a105
    v_accvgpr_read_b32 v42, a106
    v_accvgpr_read_b32 v43, a107
    v_accvgpr_read_b32 v44, a108
    v_accvgpr_read_b32 v45, a109
    v_accvgpr_read_b32 v46, a110
    v_accvgpr_read_b32 v47, a111
    v_mul_f32 v32, v32, v120
    v_mul_f32 v33, v33, v120
    v_mul_f32 v34, v34, v120
    v_mul_f32 v35, v35, v120
    v_mul_f32 v36, v36, v121
    v_mul_f32 v37, v37, v121
    v_mul_f32 v38, v38, v121
    v_mul_f32 v39, v39, v121
    v_mul_f32 v40, v40, v122
    v_mul_f32 v41, v41, v122
    v_mul_f32 v42, v42, v122
    v_mul_f32 v43, v43, v122
    v_mul_f32 v44, v44, v123
    v_mul_f32 v45, v45, v123
    v_mul_f32 v46, v46, v123
    v_mul_f32 v47, v47, v123
    v_accvgpr_write_b32 a96, v32
    v_accvgpr_write_b32 a97, v33
    v_accvgpr_write_b32 a98, v34
    v_accvgpr_write_b32 a99, v35
    v_accvgpr_write_b32 a100, v36
    v_accvgpr_write_b32 a101, v37
    v_accvgpr_write_b32 a102, v38
    v_accvgpr_write_b32 a103, v39
    v_accvgpr_write_b32 a104, v40
    v_accvgpr_write_b32 a105, v41
    v_accvgpr_write_b32 a106, v42
    v_accvgpr_write_b32 a107, v43
    v_accvgpr_write_b32 a108, v44
    v_accvgpr_write_b32 a109, v45
    v_accvgpr_write_b32 a110, v46
    v_accvgpr_write_b32 a111, v47
    v_accvgpr_read_b32 v32, a112
    v_accvgpr_read_b32 v33, a113
    v_accvgpr_read_b32 v34, a114
    v_accvgpr_read_b32 v35, a115
    v_accvgpr_read_b32 v36, a116
    v_accvgpr_read_b32 v37, a117
    v_accvgpr_read_b32 v38, a118
    v_accvgpr_read_b32 v39, a119
    v_accvgpr_read_b32 v40, a120
    v_accvgpr_read_b32 v41, a121
    v_accvgpr_read_b32 v42, a122
    v_accvgpr_read_b32 v43, a123
    v_accvgpr_read_b32 v44, a124
    v_accvgpr_read_b32 v45, a125
    v_accvgpr_read_b32 v46, a126
    v_accvgpr_read_b32 v47, a127
    v_mul_f32 v32, v32, v120
    v_mul_f32 v33, v33, v120
    v_mul_f32 v34, v34, v120
    v_mul_f32 v35, v35, v120
    v_mul_f32 v36, v36, v121
    v_mul_f32 v37, v37, v121
    v_mul_f32 v38, v38, v121
    v_mul_f32 v39, v39, v121
    v_mul_f32 v40, v40, v122
    v_mul_f32 v41, v41, v122
    v_mul_f32 v42, v42, v122
    v_mul_f32 v43, v43, v122
    v_mul_f32 v44, v44, v123
    v_mul_f32 v45, v45, v123
    v_mul_f32 v46, v46, v123
    v_mul_f32 v47, v47, v123
    v_accvgpr_write_b32 a112, v32
    v_accvgpr_write_b32 a113, v33
    v_accvgpr_write_b32 a114, v34
    v_accvgpr_write_b32 a115, v35
    v_accvgpr_write_b32 a116, v36
    v_accvgpr_write_b32 a117, v37
    v_accvgpr_write_b32 a118, v38
    v_accvgpr_write_b32 a119, v39
    v_accvgpr_write_b32 a120, v40
    v_accvgpr_write_b32 a121, v41
    v_accvgpr_write_b32 a122, v42
    v_accvgpr_write_b32 a123, v43
    v_accvgpr_write_b32 a124, v44
    v_accvgpr_write_b32 a125, v45
    v_accvgpr_write_b32 a126, v46
    v_accvgpr_write_b32 a127, v47
    v_mul_f32 v128, v128, v120
    v_mul_f32 v129, v129, v120
    v_mul_f32 v130, v130, v120
    v_mul_f32 v131, v131, v120
    v_mul_f32 v132, v132, v121
    v_mul_f32 v133, v133, v121
    v_mul_f32 v134, v134, v121
    v_mul_f32 v135, v135, v121
    v_mul_f32 v136, v136, v122
    v_mul_f32 v137, v137, v122
    v_mul_f32 v138, v138, v122
    v_mul_f32 v139, v139, v122
    v_mul_f32 v140, v140, v123
    v_mul_f32 v141, v141, v123
    v_mul_f32 v142, v142, v123
    v_mul_f32 v143, v143, v123
    s_nop 1
    v_mfma_f32_16x16x32_bf16 a[0:3], a[224:227], v[64:67], a[0:3]
    v_mfma_f32_16x16x32_bf16 a[4:7], a[224:227], v[68:71], a[4:7]
    v_mfma_f32_16x16x32_bf16 a[8:11], a[224:227], v[72:75], a[8:11]
    v_mfma_f32_16x16x32_bf16 a[12:15], a[224:227], v[76:79], a[12:15]
    v_mfma_f32_16x16x32_bf16 a[16:19], a[228:231], v[64:67], a[16:19]
    v_mfma_f32_16x16x32_bf16 a[20:23], a[228:231], v[68:71], a[20:23]
    v_mfma_f32_16x16x32_bf16 a[24:27], a[228:231], v[72:75], a[24:27]
    v_mfma_f32_16x16x32_bf16 a[28:31], a[228:231], v[76:79], a[28:31]
    v_mfma_f32_16x16x32_bf16 a[32:35], a[232:235], v[64:67], a[32:35]
    v_mfma_f32_16x16x32_bf16 a[36:39], a[232:235], v[68:71], a[36:39]
    v_mfma_f32_16x16x32_bf16 a[40:43], a[232:235], v[72:75], a[40:43]
    v_mfma_f32_16x16x32_bf16 a[44:47], a[232:235], v[76:79], a[44:47]
    v_mfma_f32_16x16x32_bf16 a[48:51], a[236:239], v[64:67], a[48:51]
    v_mfma_f32_16x16x32_bf16 a[52:55], a[236:239], v[68:71], a[52:55]
    v_mfma_f32_16x16x32_bf16 a[56:59], a[236:239], v[72:75], a[56:59]
    v_mfma_f32_16x16x32_bf16 a[60:63], a[236:239], v[76:79], a[60:63]
    v_mfma_f32_16x16x32_bf16 a[64:67], a[240:243], v[64:67], a[64:67]
    v_mfma_f32_16x16x32_bf16 a[68:71], a[240:243], v[68:71], a[68:71]
    v_mfma_f32_16x16x32_bf16 a[72:75], a[240:243], v[72:75], a[72:75]
    v_mfma_f32_16x16x32_bf16 a[76:79], a[240:243], v[76:79], a[76:79]
    v_mfma_f32_16x16x32_bf16 a[80:83], a[244:247], v[64:67], a[80:83]
    v_mfma_f32_16x16x32_bf16 a[84:87], a[244:247], v[68:71], a[84:87]
    v_mfma_f32_16x16x32_bf16 a[88:91], a[244:247], v[72:75], a[88:91]
    v_mfma_f32_16x16x32_bf16 a[92:95], a[244:247], v[76:79], a[92:95]
    v_mfma_f32_16x16x32_bf16 a[96:99], a[248:251], v[64:67], a[96:99]
    v_mfma_f32_16x16x32_bf16 a[100:103], a[248:251], v[68:71], a[100:103]
    v_mfma_f32_16x16x32_bf16 a[104:107], a[248:251], v[72:75], a[104:107]
    v_mfma_f32_16x16x32_bf16 a[108:111], a[248:251], v[76:79], a[108:111]
    v_mfma_f32_16x16x32_bf16 a[112:115], a[252:255], v[64:67], a[112:115]
    v_mfma_f32_16x16x32_bf16 a[116:119], a[252:255], v[68:71], a[116:119]
    v_mfma_f32_16x16x32_bf16 a[120:123], a[252:255], v[72:75], a[120:123]
    v_mfma_f32_16x16x32_bf16 a[124:127], a[252:255], v[76:79], a[124:127]
    v_mfma_f32_16x16x32_bf16 v[128:131], v[160:163], v[64:67], v[128:131]
    v_mfma_f32_16x16x32_bf16 v[132:135], v[160:163], v[68:71], v[132:135]
    v_mfma_f32_16x16x32_bf16 v[136:139], v[160:163], v[72:75], v[136:139]
    v_mfma_f32_16x16x32_bf16 v[140:143], v[160:163], v[76:79], v[140:143]
    s_nop 7
    ds_read_b128 a[192:195], v2 offset:8192
    ds_read_b128 a[196:199], v3 offset:8192
    ds_read_b128 a[200:203], v4 offset:8192
    ds_read_b128 a[204:207], v5 offset:8192
    ds_read_b128 a[208:211], v2 offset:12288
    ds_read_b128 a[212:215], v3 offset:12288
    ds_read_b128 a[216:219], v4 offset:12288
    ds_read_b128 a[220:223], v5 offset:12288
    ds_read_b64_tr_b16 a[224:225], v6 offset:8192
    ds_read_b64_tr_b16 a[226:227], v6 offset:12288
    ds_read_b64_tr_b16 a[228:229], v7 offset:8192
    ds_read_b64_tr_b16 a[230:231], v7 offset:12288
    ds_read_b64_tr_b16 a[232:233], v8 offset:8192
    ds_read_b64_tr_b16 a[234:235], v8 offset:12288
    ds_read_b64_tr_b16 a[236:237], v9 offset:8192
    ds_read_b64_tr_b16 a[238:239], v9 offset:12288
    ds_read_b64_tr_b16 a[240:241], v10 offset:8192
    ds_read_b64_tr_b16 a[242:243], v10 offset:12288
    ds_read_b64_tr_b16 a[244:245], v11 offset:8192
    ds_read_b64_tr_b16 a[246:247], v11 offset:12288
    ds_read_b64_tr_b16 a[248:249], v12 offset:8192
    ds_read_b64_tr_b16 a[250:251], v12 offset:12288
    ds_read_b64_tr_b16 a[252:253], v13 offset:8192
    ds_read_b64_tr_b16 a[254:255], v13 offset:12288
    s_waitcnt lgkmcnt(0)
    v_mfma_f32_16x16x32_bf16 v[32:35], a[192:195], v[144:147], 0
    v_mfma_f32_16x16x32_bf16 v[36:39], a[192:195], v[148:151], 0
    v_mfma_f32_16x16x32_bf16 v[40:43], a[192:195], v[152:155], 0
    v_mfma_f32_16x16x32_bf16 v[44:47], a[192:195], v[156:159], 0
    v_mfma_f32_16x16x32_bf16 v[32:35], a[196:199], v[176:179], v[32:35]
    v_mfma_f32_16x16x32_bf16 v[36:39], a[196:199], v[180:183], v[36:39]
    v_mfma_f32_16x16x32_bf16 v[40:43], a[196:199], v[184:187], v[40:43]
    v_mfma_f32_16x16x32_bf16 v[44:47], a[196:199], v[188:191], v[44:47]
    v_mfma_f32_16x16x32_bf16 v[32:35], a[200:203], v[208:211], v[32:35]
    v_mfma_f32_16x16x32_bf16 v[36:39], a[200:203], v[212:215], v[36:39]
    v_mfma_f32_16x16x32_bf16 v[40:43], a[200:203], v[216:219], v[40:43]
    v_mfma_f32_16x16x32_bf16 v[44:47], a[200:203], v[220:223], v[44:47]
    v_mfma_f32_16x16x32_bf16 v[32:35], a[204:207], v[240:243], v[32:35]
    v_mfma_f32_16x16x32_bf16 v[36:39], a[204:207], v[244:247], v[36:39]
    v_mfma_f32_16x16x32_bf16 v[40:43], a[204:207], v[248:251], v[40:43]
    v_mfma_f32_16x16x32_bf16 v[44:47], a[204:207], v[252:255], v[44:47]
    v_mfma_f32_16x16x32_bf16 v[48:51], a[208:211], v[144:147], 0
    v_mfma_f32_16x16x32_bf16 v[52:55], a[208:211], v[148:151], 0
    v_mfma_f32_16x16x32_bf16 v[56:59], a[208:211], v[152:155], 0
    v_mfma_f32_16x16x32_bf16 v[60:63], a[208:211], v[156:159], 0
    v_mfma_f32_16x16x32_bf16 v[48:51], a[212:215], v[176:179], v[48:51]
    v_mfma_f32_16x16x32_bf16 v[52:55], a[212:215], v[180:183], v[52:55]
    v_mfma_f32_16x16x32_bf16 v[56:59], a[212:215], v[184:187], v[56:59]
    v_mfma_f32_16x16x32_bf16 v[60:63], a[212:215], v[188:191], v[60:63]
    v_mfma_f32_16x16x32_bf16 v[48:51], a[216:219], v[208:211], v[48:51]
    v_mfma_f32_16x16x32_bf16 v[52:55], a[216:219], v[212:215], v[52:55]
    v_mfma_f32_16x16x32_bf16 v[56:59], a[216:219], v[216:219], v[56:59]
    v_mfma_f32_16x16x32_bf16 v[60:63], a[216:219], v[220:223], v[60:63]
    v_mfma_f32_16x16x32_bf16 v[48:51], a[220:223], v[240:243], v[48:51]
    v_mfma_f32_16x16x32_bf16 v[52:55], a[220:223], v[244:247], v[52:55]
    v_mfma_f32_16x16x32_bf16 v[56:59], a[220:223], v[248:251], v[56:59]
    v_mfma_f32_16x16x32_bf16 v[60:63], a[220:223], v[252:255], v[60:63]
    s_nop 7
    v_max3_f32 v116, v32, v33, v34
    v_max3_f32 v116, v116, v35, v48
    v_max3_f32 v116, v116, v49, v50
    v_max3_f32 v116, v116, v51, v112
    v_max3_f32 v117, v36, v37, v38
    v_max3_f32 v117, v117, v39, v52
    v_max3_f32 v117, v117, v53, v54
    v_max3_f32 v117, v117, v55, v113
    v_max3_f32 v118, v40, v41, v42
    v_max3_f32 v118, v118, v43, v56
    v_max3_f32 v118, v118, v57, v58
    v_max3_f32 v118, v118, v59, v114
    v_max3_f32 v119, v44, v45, v46
    v_max3_f32 v119, v119, v47, v60
    v_max3_f32 v119, v119, v61, v62
    v_max3_f32 v119, v119, v63, v115
    v_mov_b32 v120, v116
    v_mov_b32 v121, v117
    v_mov_b32 v122, v118
    v_mov_b32 v123, v119
    s_nop 1
    v_permlane16_swap_b32 v120, v116
    v_permlane16_swap_b32 v121, v117
    v_permlane16_swap_b32 v122, v118
    v_permlane16_swap_b32 v123, v119
    s_nop 1
    v_max_f32 v116, v116, v120
    v_max_f32 v117, v117, v121
    v_max_f32 v118, v118, v122
    v_max_f32 v119, v119, v123
    v_mov_b32 v120, v116
    v_mov_b32 v121, v117
    v_mov_b32 v122, v118
    v_mov_b32 v123, v119
    s_nop 1
    v_permlane32_swap_b32 v120, v116
    v_permlane32_swap_b32 v121, v117
    v_permlane32_swap_b32 v122, v118
    v_permlane32_swap_b32 v123, v119
    s_nop 1
    v_max_f32 v116, v116, v120
    v_max_f32 v117, v117, v121
    v_max_f32 v118, v118, v122
    v_max_f32 v119, v119, v123
    v_sub_f32 v120, v112, v116
    v_sub_f32 v121, v113, v117
    v_sub_f32 v122, v114, v118
    v_sub_f32 v123, v115, v119
    v_exp_f32 v120, v120
    v_exp_f32 v121, v121
    v_exp_f32 v122, v122
    v_exp_f32 v123, v123
    v_mov_b32 v112, v116
    v_mov_b32 v113, v117
    v_mov_b32 v114, v118
    v_mov_b32 v115, v119
    v_sub_f32 v32, v32, v112
    v_sub_f32 v33, v33, v112
    v_sub_f32 v34, v34, v112
    v_sub_f32 v35, v35, v112
    v_sub_f32 v36, v36, v113
    v_sub_f32 v37, v37, v113
    v_sub_f32 v38, v38, v113
    v_sub_f32 v39, v39, v113
    v_sub_f32 v40, v40, v114
    v_sub_f32 v41, v41, v114
    v_sub_f32 v42, v42, v114
    v_sub_f32 v43, v43, v114
    v_sub_f32 v44, v44, v115
    v_sub_f32 v45, v45, v115
    v_sub_f32 v46, v46, v115
    v_sub_f32 v47, v47, v115
    v_sub_f32 v48, v48, v112
    v_sub_f32 v49, v49, v112
    v_sub_f32 v50, v50, v112
    v_sub_f32 v51, v51, v112
    v_sub_f32 v52, v52, v113
    v_sub_f32 v53, v53, v113
    v_sub_f32 v54, v54, v113
    v_sub_f32 v55, v55, v113
    v_sub_f32 v56, v56, v114
    v_sub_f32 v57, v57, v114
    v_sub_f32 v58, v58, v114
    v_sub_f32 v59, v59, v114
    v_sub_f32 v60, v60, v115
    v_sub_f32 v61, v61, v115
    v_sub_f32 v62, v62, v115
    v_sub_f32 v63, v63, v115
    v_exp_f32 v32, v32
    v_exp_f32 v33, v33
    v_exp_f32 v34, v34
    v_exp_f32 v35, v35
    v_exp_f32 v36, v36
    v_exp_f32 v37, v37
    v_exp_f32 v38, v38
    v_exp_f32 v39, v39
    v_exp_f32 v40, v40
    v_exp_f32 v41, v41
    v_exp_f32 v42, v42
    v_exp_f32 v43, v43
    v_exp_f32 v44, v44
    v_exp_f32 v45, v45
    v_exp_f32 v46, v46
    v_exp_f32 v47, v47
    v_exp_f32 v48, v48
    v_exp_f32 v49, v49
    v_exp_f32 v50, v50
    v_exp_f32 v51, v51
    v_exp_f32 v52, v52
    v_exp_f32 v53, v53
    v_exp_f32 v54, v54
    v_exp_f32 v55, v55
    v_exp_f32 v56, v56
    v_exp_f32 v57, v57
    v_exp_f32 v58, v58
    v_exp_f32 v59, v59
    v_exp_f32 v60, v60
    v_exp_f32 v61, v61
    v_exp_f32 v62, v62
    v_exp_f32 v63, v63
    s_nop 0
    v_cvt_pk_bf16_f32 v64, v32, v33
    v_cvt_pk_bf16_f32 v65, v34, v35
    v_cvt_pk_bf16_f32 v68, v36, v37
    v_cvt_pk_bf16_f32 v69, v38, v39
    v_cvt_pk_bf16_f32 v72, v40, v41
    v_cvt_pk_bf16_f32 v73, v42, v43
    v_cvt_pk_bf16_f32 v76, v44, v45
    v_cvt_pk_bf16_f32 v77, v46, v47
    v_cvt_pk_bf16_f32 v66, v48, v49
    v_cvt_pk_bf16_f32 v67, v50, v51
    v_cvt_pk_bf16_f32 v70, v52, v53
    v_cvt_pk_bf16_f32 v71, v54, v55
    v_cvt_pk_bf16_f32 v74, v56, v57
    v_cvt_pk_bf16_f32 v75, v58, v59
    v_cvt_pk_bf16_f32 v78, v60, v61
    v_cvt_pk_bf16_f32 v79, v62, v63
    v_accvgpr_read_b32 v32, a0
    v_accvgpr_read_b32 v33, a1
    v_accvgpr_read_b32 v34, a2
    v_accvgpr_read_b32 v35, a3
    v_accvgpr_read_b32 v36, a4
    v_accvgpr_read_b32 v37, a5
    v_accvgpr_read_b32 v38, a6
    v_accvgpr_read_b32 v39, a7
    v_accvgpr_read_b32 v40, a8
    v_accvgpr_read_b32 v41, a9
    v_accvgpr_read_b32 v42, a10
    v_accvgpr_read_b32 v43, a11
    v_accvgpr_read_b32 v44, a12
    v_accvgpr_read_b32 v45, a13
    v_accvgpr_read_b32 v46, a14
    v_accvgpr_read_b32 v47, a15
    v_mul_f32 v32, v32, v120
    v_mul_f32 v33, v33, v120
    v_mul_f32 v34, v34, v120
    v_mul_f32 v35, v35, v120
    v_mul_f32 v36, v36, v121
    v_mul_f32 v37, v37, v121
    v_mul_f32 v38, v38, v121
    v_mul_f32 v39, v39, v121
    v_mul_f32 v40, v40, v122
    v_mul_f32 v41, v41, v122
    v_mul_f32 v42, v42, v122
    v_mul_f32 v43, v43, v122
    v_mul_f32 v44, v44, v123
    v_mul_f32 v45, v45, v123
    v_mul_f32 v46, v46, v123
    v_mul_f32 v47, v47, v123
    v_accvgpr_write_b32 a0, v32
    v_accvgpr_write_b32 a1, v33
    v_accvgpr_write_b32 a2, v34
    v_accvgpr_write_b32 a3, v35
    v_accvgpr_write_b32 a4, v36
    v_accvgpr_write_b32 a5, v37
    v_accvgpr_write_b32 a6, v38
    v_accvgpr_write_b32 a7, v39
    v_accvgpr_write_b32 a8, v40
    v_accvgpr_write_b32 a9, v41
    v_accvgpr_write_b32 a10, v42
    v_accvgpr_write_b32 a11, v43
    v_accvgpr_write_b32 a12, v44
    v_accvgpr_write_b32 a13, v45
    v_accvgpr_write_b32 a14, v46
    v_accvgpr_write_b32 a15, v47
    v_accvgpr_read_b32 v32, a16
    v_accvgpr_read_b32 v33, a17
    v_accvgpr_read_b32 v34, a18
    v_accvgpr_read_b32 v35, a19
    v_accvgpr_read_b32 v36, a20
    v_accvgpr_read_b32 v37, a21
    v_accvgpr_read_b32 v38, a22
    v_accvgpr_read_b32 v39, a23
    v_accvgpr_read_b32 v40, a24
    v_accvgpr_read_b32 v41, a25
    v_accvgpr_read_b32 v42, a26
    v_accvgpr_read_b32 v43, a27
    v_accvgpr_read_b32 v44, a28
    v_accvgpr_read_b32 v45, a29
    v_accvgpr_read_b32 v46, a30
    v_accvgpr_read_b32 v47, a31
    v_mul_f32 v32, v32, v120
    v_mul_f32 v33, v33, v120
    v_mul_f32 v34, v34, v120
    v_mul_f32 v35, v35, v120
    v_mul_f32 v36, v36, v121
    v_mul_f32 v37, v37, v121
    v_mul_f32 v38, v38, v121
    v_mul_f32 v39, v39, v121
    v_mul_f32 v40, v40, v122
    v_mul_f32 v41, v41, v122
    v_mul_f32 v42, v42, v122
    v_mul_f32 v43, v43, v122
    v_mul_f32 v44, v44, v123
    v_mul_f32 v45, v45, v123
    v_mul_f32 v46, v46, v123
    v_mul_f32 v47, v47, v123
    v_accvgpr_write_b32 a16, v32
    v_accvgpr_write_b32 a17, v33
    v_accvgpr_write_b32 a18, v34
    v_accvgpr_write_b32 a19, v35
    v_accvgpr_write_b32 a20, v36
    v_accvgpr_write_b32 a21, v37
    v_accvgpr_write_b32 a22, v38
    v_accvgpr_write_b32 a23, v39
    v_accvgpr_write_b32 a24, v40
    v_accvgpr_write_b32 a25, v41
    v_accvgpr_write_b32 a26, v42
    v_accvgpr_write_b32 a27, v43
    v_accvgpr_write_b32 a28, v44
    v_accvgpr_write_b32 a29, v45
    v_accvgpr_write_b32 a30, v46
    v_accvgpr_write_b32 a31, v47
    v_accvgpr_read_b32 v32, a32
    v_accvgpr_read_b32 v33, a33
    v_accvgpr_read_b32 v34, a34
    v_accvgpr_read_b32 v35, a35
    v_accvgpr_read_b32 v36, a36
    v_accvgpr_read_b32 v37, a37
    v_accvgpr_read_b32 v38, a38
    v_accvgpr_read_b32 v39, a39
    v_accvgpr_read_b32 v40, a40
    v_accvgpr_read_b32 v41, a41
    v_accvgpr_read_b32 v42, a42
    v_accvgpr_read_b32 v43, a43
    v_accvgpr_read_b32 v44, a44
    v_accvgpr_read_b32 v45, a45
    v_accvgpr_read_b32 v46, a46
    v_accvgpr_read_b32 v47, a47
    v_mul_f32 v32, v32, v120
    v_mul_f32 v33, v33, v120
    v_mul_f32 v34, v34, v120
    v_mul_f32 v35, v35, v120
    v_mul_f32 v36, v36, v121
    v_mul_f32 v37, v37, v121
    v_mul_f32 v38, v38, v121
    v_mul_f32 v39, v39, v121
    v_mul_f32 v40, v40, v122
    v_mul_f32 v41, v41, v122
    v_mul_f32 v42, v42, v122
    v_mul_f32 v43, v43, v122
    v_mul_f32 v44, v44, v123
    v_mul_f32 v45, v45, v123
    v_mul_f32 v46, v46, v123
    v_mul_f32 v47, v47, v123
    v_accvgpr_write_b32 a32, v32
    v_accvgpr_write_b32 a33, v33
    v_accvgpr_write_b32 a34, v34
    v_accvgpr_write_b32 a35, v35
    v_accvgpr_write_b32 a36, v36
    v_accvgpr_write_b32 a37, v37
    v_accvgpr_write_b32 a38, v38
    v_accvgpr_write_b32 a39, v39
    v_accvgpr_write_b32 a40, v40
    v_accvgpr_write_b32 a41, v41
    v_accvgpr_write_b32 a42, v42
    v_accvgpr_write_b32 a43, v43
    v_accvgpr_write_b32 a44, v44
    v_accvgpr_write_b32 a45, v45
    v_accvgpr_write_b32 a46, v46
    v_accvgpr_write_b32 a47, v47
    v_accvgpr_read_b32 v32, a48
    v_accvgpr_read_b32 v33, a49
    v_accvgpr_read_b32 v34, a50
    v_accvgpr_read_b32 v35, a51
    v_accvgpr_read_b32 v36, a52
    v_accvgpr_read_b32 v37, a53
    v_accvgpr_read_b32 v38, a54
    v_accvgpr_read_b32 v39, a55
    v_accvgpr_read_b32 v40, a56
    v_accvgpr_read_b32 v41, a57
    v_accvgpr_read_b32 v42, a58
    v_accvgpr_read_b32 v43, a59
    v_accvgpr_read_b32 v44, a60
    v_accvgpr_read_b32 v45, a61
    v_accvgpr_read_b32 v46, a62
    v_accvgpr_read_b32 v47, a63
    v_mul_f32 v32, v32, v120
    v_mul_f32 v33, v33, v120
    v_mul_f32 v34, v34, v120
    v_mul_f32 v35, v35, v120
    v_mul_f32 v36, v36, v121
    v_mul_f32 v37, v37, v121
    v_mul_f32 v38, v38, v121
    v_mul_f32 v39, v39, v121
    v_mul_f32 v40, v40, v122
    v_mul_f32 v41, v41, v122
    v_mul_f32 v42, v42, v122
    v_mul_f32 v43, v43, v122
    v_mul_f32 v44, v44, v123
    v_mul_f32 v45, v45, v123
    v_mul_f32 v46, v46, v123
    v_mul_f32 v47, v47, v123
    v_accvgpr_write_b32 a48, v32
    v_accvgpr_write_b32 a49, v33
    v_accvgpr_write_b32 a50, v34
    v_accvgpr_write_b32 a51, v35
    v_accvgpr_write_b32 a52, v36
    v_accvgpr_write_b32 a53, v37
    v_accvgpr_write_b32 a54, v38
    v_accvgpr_write_b32 a55, v39
    v_accvgpr_write_b32 a56, v40
    v_accvgpr_write_b32 a57, v41
    v_accvgpr_write_b32 a58, v42
    v_accvgpr_write_b32 a59, v43
    v_accvgpr_write_b32 a60, v44
    v_accvgpr_write_b32 a61, v45
    v_accvgpr_write_b32 a62, v46
    v_accvgpr_write_b32 a63, v47
    v_accvgpr_read_b32 v32, a64
    v_accvgpr_read_b32 v33, a65
    v_accvgpr_read_b32 v34, a66
    v_accvgpr_read_b32 v35, a67
    v_accvgpr_read_b32 v36, a68
    v_accvgpr_read_b32 v37, a69
    v_accvgpr_read_b32 v38, a70
    v_accvgpr_read_b32 v39, a71
    v_accvgpr_read_b32 v40, a72
    v_accvgpr_read_b32 v41, a73
    v_accvgpr_read_b32 v42, a74
    v_accvgpr_read_b32 v43, a75
    v_accvgpr_read_b32 v44, a76
    v_accvgpr_read_b32 v45, a77
    v_accvgpr_read_b32 v46, a78
    v_accvgpr_read_b32 v47, a79
    v_mul_f32 v32, v32, v120
    v_mul_f32 v33, v33, v120
    v_mul_f32 v34, v34, v120
    v_mul_f32 v35, v35, v120
    v_mul_f32 v36, v36, v121
    v_mul_f32 v37, v37, v121
    v_mul_f32 v38, v38, v121
    v_mul_f32 v39, v39, v121
    v_mul_f32 v40, v40, v122
    v_mul_f32 v41, v41, v122
    v_mul_f32 v42, v42, v122
    v_mul_f32 v43, v43, v122
    v_mul_f32 v44, v44, v123
    v_mul_f32 v45, v45, v123
    v_mul_f32 v46, v46, v123
    v_mul_f32 v47, v47, v123
    v_accvgpr_write_b32 a64, v32
    v_accvgpr_write_b32 a65, v33
    v_accvgpr_write_b32 a66, v34
    v_accvgpr_write_b32 a67, v35
    v_accvgpr_write_b32 a68, v36
    v_accvgpr_write_b32 a69, v37
    v_accvgpr_write_b32 a70, v38
    v_accvgpr_write_b32 a71, v39
    v_accvgpr_write_b32 a72, v40
    v_accvgpr_write_b32 a73, v41
    v_accvgpr_write_b32 a74, v42
    v_accvgpr_write_b32 a75, v43
    v_accvgpr_write_b32 a76, v44
    v_accvgpr_write_b32 a77, v45
    v_accvgpr_write_b32 a78, v46
    v_accvgpr_write_b32 a79, v47
    v_accvgpr_read_b32 v32, a80
    v_accvgpr_read_b32 v33, a81
    v_accvgpr_read_b32 v34, a82
    v_accvgpr_read_b32 v35, a83
    v_accvgpr_read_b32 v36, a84
    v_accvgpr_read_b32 v37, a85
    v_accvgpr_read_b32 v38, a86
    v_accvgpr_read_b32 v39, a87
    v_accvgpr_read_b32 v40, a88
    v_accvgpr_read_b32 v41, a89
    v_accvgpr_read_b32 v42, a90
    v_accvgpr_read_b32 v43, a91
    v_accvgpr_read_b32 v44, a92
    v_accvgpr_read_b32 v45, a93
    v_accvgpr_read_b32 v46, a94
    v_accvgpr_read_b32 v47, a95
    v_mul_f32 v32, v32, v120
    v_mul_f32 v33, v33, v120
    v_mul_f32 v34, v34, v120
    v_mul_f32 v35, v35, v120
    v_mul_f32 v36, v36, v121
    v_mul_f32 v37, v37, v121
    v_mul_f32 v38, v38, v121
    v_mul_f32 v39, v39, v121
    v_mul_f32 v40, v40, v122
    v_mul_f32 v41, v41, v122
    v_mul_f32 v42, v42, v122
    v_mul_f32 v43, v43, v122
    v_mul_f32 v44, v44, v123
    v_mul_f32 v45, v45, v123
    v_mul_f32 v46, v46, v123
    v_mul_f32 v47, v47, v123
    v_accvgpr_write_b32 a80, v32
    v_accvgpr_write_b32 a81, v33
    v_accvgpr_write_b32 a82, v34
    v_accvgpr_write_b32 a83, v35
    v_accvgpr_write_b32 a84, v36
    v_accvgpr_write_b32 a85, v37
    v_accvgpr_write_b32 a86, v38
    v_accvgpr_write_b32 a87, v39
    v_accvgpr_write_b32 a88, v40
    v_accvgpr_write_b32 a89, v41
    v_accvgpr_write_b32 a90, v42
    v_accvgpr_write_b32 a91, v43
    v_accvgpr_write_b32 a92, v44
    v_accvgpr_write_b32 a93, v45
    v_accvgpr_write_b32 a94, v46
    v_accvgpr_write_b32 a95, v47
    v_accvgpr_read_b32 v32, a96
    v_accvgpr_read_b32 v33, a97
    v_accvgpr_read_b32 v34, a98
    v_accvgpr_read_b32 v35, a99
    v_accvgpr_read_b32 v36, a100
    v_accvgpr_read_b32 v37, a101
    v_accvgpr_read_b32 v38, a102
    v_accvgpr_read_b32 v39, a103
    v_accvgpr_read_b32 v40, a104
    v_accvgpr_read_b32 v41, a105
    v_accvgpr_read_b32 v42, a106
    v_accvgpr_read_b32 v43, a107
    v_accvgpr_read_b32 v44, a108
    v_accvgpr_read_b32 v45, a109
    v_accvgpr_read_b32 v46, a110
    v_accvgpr_read_b32 v47, a111
    v_mul_f32 v32, v32, v120
    v_mul_f32 v33, v33, v120
    v_mul_f32 v34, v34, v120
    v_mul_f32 v35, v35, v120
    v_mul_f32 v36, v36, v121
    v_mul_f32 v37, v37, v121
    v_mul_f32 v38, v38, v121
    v_mul_f32 v39, v39, v121
    v_mul_f32 v40, v40, v122
    v_mul_f32 v41, v41, v122
    v_mul_f32 v42, v42, v122
    v_mul_f32 v43, v43, v122
    v_mul_f32 v44, v44, v123
    v_mul_f32 v45, v45, v123
    v_mul_f32 v46, v46, v123
    v_mul_f32 v47, v47, v123
    v_accvgpr_write_b32 a96, v32
    v_accvgpr_write_b32 a97, v33
    v_accvgpr_write_b32 a98, v34
    v_accvgpr_write_b32 a99, v35
    v_accvgpr_write_b32 a100, v36
    v_accvgpr_write_b32 a101, v37
    v_accvgpr_write_b32 a102, v38
    v_accvgpr_write_b32 a103, v39
    v_accvgpr_write_b32 a104, v40
    v_accvgpr_write_b32 a105, v41
    v_accvgpr_write_b32 a106, v42
    v_accvgpr_write_b32 a107, v43
    v_accvgpr_write_b32 a108, v44
    v_accvgpr_write_b32 a109, v45
    v_accvgpr_write_b32 a110, v46
    v_accvgpr_write_b32 a111, v47
    v_accvgpr_read_b32 v32, a112
    v_accvgpr_read_b32 v33, a113
    v_accvgpr_read_b32 v34, a114
    v_accvgpr_read_b32 v35, a115
    v_accvgpr_read_b32 v36, a116
    v_accvgpr_read_b32 v37, a117
    v_accvgpr_read_b32 v38, a118
    v_accvgpr_read_b32 v39, a119
    v_accvgpr_read_b32 v40, a120
    v_accvgpr_read_b32 v41, a121
    v_accvgpr_read_b32 v42, a122
    v_accvgpr_read_b32 v43, a123
    v_accvgpr_read_b32 v44, a124
    v_accvgpr_read_b32 v45, a125
    v_accvgpr_read_b32 v46, a126
    v_accvgpr_read_b32 v47, a127
    v_mul_f32 v32, v32, v120
    v_mul_f32 v33, v33, v120
    v_mul_f32 v34, v34, v120
    v_mul_f32 v35, v35, v120
    v_mul_f32 v36, v36, v121
    v_mul_f32 v37, v37, v121
    v_mul_f32 v38, v38, v121
    v_mul_f32 v39, v39, v121
    v_mul_f32 v40, v40, v122
    v_mul_f32 v41, v41, v122
    v_mul_f32 v42, v42, v122
    v_mul_f32 v43, v43, v122
    v_mul_f32 v44, v44, v123
    v_mul_f32 v45, v45, v123
    v_mul_f32 v46, v46, v123
    v_mul_f32 v47, v47, v123
    v_accvgpr_write_b32 a112, v32
    v_accvgpr_write_b32 a113, v33
    v_accvgpr_write_b32 a114, v34
    v_accvgpr_write_b32 a115, v35
    v_accvgpr_write_b32 a116, v36
    v_accvgpr_write_b32 a117, v37
    v_accvgpr_write_b32 a118, v38
    v_accvgpr_write_b32 a119, v39
    v_accvgpr_write_b32 a120, v40
    v_accvgpr_write_b32 a121, v41
    v_accvgpr_write_b32 a122, v42
    v_accvgpr_write_b32 a123, v43
    v_accvgpr_write_b32 a124, v44
    v_accvgpr_write_b32 a125, v45
    v_accvgpr_write_b32 a126, v46
    v_accvgpr_write_b32 a127, v47
    v_mul_f32 v128, v128, v120
    v_mul_f32 v129, v129, v120
    v_mul_f32 v130, v130, v120
    v_mul_f32 v131, v131, v120
    v_mul_f32 v132, v132, v121
    v_mul_f32 v133, v133, v121
    v_mul_f32 v134, v134, v121
    v_mul_f32 v135, v135, v121
    v_mul_f32 v136, v136, v122
    v_mul_f32 v137, v137, v122
    v_mul_f32 v138, v138, v122
    v_mul_f32 v139, v139, v122
    v_mul_f32 v140, v140, v123
    v_mul_f32 v141, v141, v123
    v_mul_f32 v142, v142, v123
    v_mul_f32 v143, v143, v123
    s_nop 1
    v_mfma_f32_16x16x32_bf16 a[0:3], a[224:227], v[64:67], a[0:3]
    v_mfma_f32_16x16x32_bf16 a[4:7], a[224:227], v[68:71], a[4:7]
    v_mfma_f32_16x16x32_bf16 a[8:11], a[224:227], v[72:75], a[8:11]
    v_mfma_f32_16x16x32_bf16 a[12:15], a[224:227], v[76:79], a[12:15]
    v_mfma_f32_16x16x32_bf16 a[16:19], a[228:231], v[64:67], a[16:19]
    v_mfma_f32_16x16x32_bf16 a[20:23], a[228:231], v[68:71], a[20:23]
    v_mfma_f32_16x16x32_bf16 a[24:27], a[228:231], v[72:75], a[24:27]
    v_mfma_f32_16x16x32_bf16 a[28:31], a[228:231], v[76:79], a[28:31]
    v_mfma_f32_16x16x32_bf16 a[32:35], a[232:235], v[64:67], a[32:35]
    v_mfma_f32_16x16x32_bf16 a[36:39], a[232:235], v[68:71], a[36:39]
    v_mfma_f32_16x16x32_bf16 a[40:43], a[232:235], v[72:75], a[40:43]
    v_mfma_f32_16x16x32_bf16 a[44:47], a[232:235], v[76:79], a[44:47]
    v_mfma_f32_16x16x32_bf16 a[48:51], a[236:239], v[64:67], a[48:51]
    v_mfma_f32_16x16x32_bf16 a[52:55], a[236:239], v[68:71], a[52:55]
    v_mfma_f32_16x16x32_bf16 a[56:59], a[236:239], v[72:75], a[56:59]
    v_mfma_f32_16x16x32_bf16 a[60:63], a[236:239], v[76:79], a[60:63]
    v_mfma_f32_16x16x32_bf16 a[64:67], a[240:243], v[64:67], a[64:67]
    v_mfma_f32_16x16x32_bf16 a[68:71], a[240:243], v[68:71], a[68:71]
    v_mfma_f32_16x16x32_bf16 a[72:75], a[240:243], v[72:75], a[72:75]
    v_mfma_f32_16x16x32_bf16 a[76:79], a[240:243], v[76:79], a[76:79]
    v_mfma_f32_16x16x32_bf16 a[80:83], a[244:247], v[64:67], a[80:83]
    v_mfma_f32_16x16x32_bf16 a[84:87], a[244:247], v[68:71], a[84:87]
    v_mfma_f32_16x16x32_bf16 a[88:91], a[244:247], v[72:75], a[88:91]
    v_mfma_f32_16x16x32_bf16 a[92:95], a[244:247], v[76:79], a[92:95]
    v_mfma_f32_16x16x32_bf16 a[96:99], a[248:251], v[64:67], a[96:99]
    v_mfma_f32_16x16x32_bf16 a[100:103], a[248:251], v[68:71], a[100:103]
    v_mfma_f32_16x16x32_bf16 a[104:107], a[248:251], v[72:75], a[104:107]
    v_mfma_f32_16x16x32_bf16 a[108:111], a[248:251], v[76:79], a[108:111]
    v_mfma_f32_16x16x32_bf16 a[112:115], a[252:255], v[64:67], a[112:115]
    v_mfma_f32_16x16x32_bf16 a[116:119], a[252:255], v[68:71], a[116:119]
    v_mfma_f32_16x16x32_bf16 a[120:123], a[252:255], v[72:75], a[120:123]
    v_mfma_f32_16x16x32_bf16 a[124:127], a[252:255], v[76:79], a[124:127]
    v_mfma_f32_16x16x32_bf16 v[128:131], v[160:163], v[64:67], v[128:131]
    v_mfma_f32_16x16x32_bf16 v[132:135], v[160:163], v[68:71], v[132:135]
    v_mfma_f32_16x16x32_bf16 v[136:139], v[160:163], v[72:75], v[136:139]
    v_mfma_f32_16x16x32_bf16 v[140:143], v[160:163], v[76:79], v[140:143]
    s_nop 7
    s_barrier
    s_add_u32 s40, s40, 1
    s_cmp_lt_u32 s40, 32
    s_cbranch_scc1 mk_fbloop
    s_mov_b32 s7, 1
    s_branch mk_fbret

.section .rodata,"a"
.p2align 6
.amdhsa_kernel recurrent_scan__mha_block_cached__glu_gated_reglu__prompt_kernel
  .amdhsa_next_free_vgpr 512
  .amdhsa_next_free_sgpr 102
  .amdhsa_accum_offset 256
  .amdhsa_group_segment_fixed_size 0
  .amdhsa_kernarg_size 96
  .amdhsa_user_sgpr_count 2
  .amdhsa_user_sgpr_kernarg_segment_ptr 1
  .amdhsa_system_sgpr_workgroup_id_x 1
.end_amdhsa_kernel
```
